```python
import torch

def _softmax(x, axis=-1):
    return torch.softmax(x, dim=axis)
def _gelu(x):
    return torch.nn.functional.gelu(x, approximate="tanh")
def _silu(x):
    return torch.nn.functional.silu(x)
def _sigmoid(x):
    return torch.sigmoid(x)
def _layernorm(x, axis=-1, eps=1e-5):
    m = x.mean(dim=axis, keepdim=True)
    v = x.var(dim=axis, keepdim=True, unbiased=False)
    return (x - m) / torch.sqrt(v + eps)
def _scatter_add(tgt, idx, src, axis=0):
    return tgt.clone().index_add_(axis, idx, src)
def _segment_sum(src, seg, n):
    out = torch.zeros((n,) + src.shape[1:], dtype=src.dtype)
    return out.index_add_(0, seg, src)
def _pad(x, pw):
    flat = tuple(v for pair in reversed(pw) for v in pair)
    return torch.nn.functional.pad(x, flat)

kernel_name = 'concat_heads__mha_block_cached__gqa_block_cached__near_ridge'

def setup_inputs():

    _w = (lambda a: (lambda t: t.to(torch.bfloat16) if t.is_floating_point() else t)(torch.as_tensor(a)))
    def _A_setup():
        B, Sq, D = 8, 304, 512
        H, Sk, Dh = 32, 1024, 128
        return {
            "x": _w((lambda *s: torch.randn(*s, dtype=torch.bfloat16) * 0.8)(B, Sq, D)),
            "k_cache": _w((lambda *s: torch.randn(*s, dtype=torch.bfloat16) * 0.8)(B, H, Sk, Dh)),
            "v_cache": _w((lambda *s: torch.randn(*s, dtype=torch.bfloat16) * 0.05)(B, H, Sk, Dh)),
            "wq": _w((lambda *s: torch.randn(*s, dtype=torch.bfloat16) * 0.8)(D, H * Dh) * (D ** -0.5)),
            "wo": _w((lambda *s: torch.randn(*s, dtype=torch.bfloat16) * 0.05)(H * Dh, D) * ((H * Dh) ** -0.5)),
        }
    _A_in = _A_setup()

    def _B_setup():
        B, Sq, D = 8, 304, 512
        Hq, Hkv, Sk, Dh = 32, 32, 1024, 128
        assert Hq % Hkv == 0, (Hq, Hkv)
        return {
            "x": _w((lambda *s: torch.randn(*s, dtype=torch.bfloat16) * 0.8)(B, Sq, D)),
            "k_cache": _w((lambda *s: torch.randn(*s, dtype=torch.bfloat16) * 0.8)(B, Hkv, Sk, Dh)),
            "v_cache": _w((lambda *s: torch.randn(*s, dtype=torch.bfloat16) * 0.05)(B, Hkv, Sk, Dh)),
            "wq": _w((lambda *s: torch.randn(*s, dtype=torch.bfloat16) * 0.8)(D, Hq * Dh) * (D ** -0.5)),
            "wo": _w((lambda *s: torch.randn(*s, dtype=torch.bfloat16) * 0.05)(Hq * Dh, D) * ((Hq * Dh) ** -0.5)),
        }
    _B_in = _B_setup()

    return {
        "A_x": _A_in["x"],
        "A_k_cache": _A_in["k_cache"],
        "A_v_cache": _A_in["v_cache"],
        "A_wq": _A_in["wq"],
        "A_wo": _A_in["wo"],
        "B_x": _B_in["x"],
        "B_k_cache": _B_in["k_cache"],
        "B_v_cache": _B_in["v_cache"],
        "B_wq": _B_in["wq"],
        "B_wo": _B_in["wo"],
    }

def reference(A_x, A_k_cache, A_v_cache, A_wq, A_wo, B_x, B_k_cache, B_v_cache, B_wq, B_wo):
    def _A_ref(x, k_cache, v_cache, wq, wo):
        B, Sq, D = x.shape
        H, Dh = 32, 128
        q = (lambda x, *d: x.permute(*d))((x @ wq).reshape(B, Sq, H, Dh), 0, 2, 1, 3)
        scores = torch.einsum("bhqd,bhkd->bhqk", q, k_cache) * (Dh ** -0.5)
        p = _softmax(scores, axis=-1)
        o = torch.einsum("bhqk,bhkd->bhqd", p, v_cache)
        return (lambda x, *d: x.permute(*d))(o, 0, 2, 1, 3).reshape(B, Sq, H * Dh) @ wo

    def _B_ref(x, k_cache, v_cache, wq, wo):
        B, Sq, D = x.shape
        Hq, Dh = 32, 128
        Hkv = k_cache.shape[1]
        rep = Hq // Hkv
        q = (lambda x, *d: x.permute(*d))((x @ wq).reshape(B, Sq, Hq, Dh), 0, 2, 1, 3)
        k = (lambda x, n, axis: torch.repeat_interleave(x, n, dim=axis))(k_cache, rep, axis=1)
        v = (lambda x, n, axis: torch.repeat_interleave(x, n, dim=axis))(v_cache, rep, axis=1)
        scores = torch.einsum("bhqd,bhkd->bhqk", q, k) * (Dh ** -0.5)
        p = _softmax(scores, axis=-1)
        o = torch.einsum("bhqk,bhkd->bhqd", p, v)
        return (lambda x, *d: x.permute(*d))(o, 0, 2, 1, 3).reshape(B, Sq, Hq * Dh) @ wo

    a = _A_ref(A_x, A_k_cache, A_v_cache, A_wq, A_wo)
    b = _B_ref(B_x, B_k_cache, B_v_cache, B_wq, B_wo)
    return torch.concatenate([a, b], axis=-1)
```

```asm
; @launch grid=(256,1,1) block=(256,1,1) lds=163840
.amdgcn_target "amdgcn-amd-amdhsa--gfx950"
.macro maaa d, a, b
 v_mfma_f32_16x16x32_bf16 a[\d:\d+3], a[\a:\a+3], a[\b:\b+3], a[\d:\d+3]
.endm
.macro maaaz d, a, b
 v_mfma_f32_16x16x32_bf16 a[\d:\d+3], a[\a:\a+3], a[\b:\b+3], 0
.endm
.macro maav d, a, b
 v_mfma_f32_16x16x32_bf16 a[\d:\d+3], a[\a:\a+3], v[\b:\b+3], a[\d:\d+3]
.endm
.macro maavz d, a, b
 v_mfma_f32_16x16x32_bf16 a[\d:\d+3], a[\a:\a+3], v[\b:\b+3], 0
.endm
.macro mava d, a, b
 v_mfma_f32_16x16x32_bf16 a[\d:\d+3], v[\a:\a+3], a[\b:\b+3], a[\d:\d+3]
.endm
.macro mavaz d, a, b
 v_mfma_f32_16x16x32_bf16 a[\d:\d+3], v[\a:\a+3], a[\b:\b+3], 0
.endm
.macro mavv d, a, b
 v_mfma_f32_16x16x32_bf16 a[\d:\d+3], v[\a:\a+3], v[\b:\b+3], a[\d:\d+3]
.endm
.macro mavvz d, a, b
 v_mfma_f32_16x16x32_bf16 a[\d:\d+3], v[\a:\a+3], v[\b:\b+3], 0
.endm
.macro mvaa d, a, b
 v_mfma_f32_16x16x32_bf16 v[\d:\d+3], a[\a:\a+3], a[\b:\b+3], v[\d:\d+3]
.endm
.macro mvaac d, a, b, c
 v_mfma_f32_16x16x32_bf16 v[\d:\d+3], a[\a:\a+3], a[\b:\b+3], v[\c:\c+3]
.endm
.macro mvaaz d, a, b
 v_mfma_f32_16x16x32_bf16 v[\d:\d+3], a[\a:\a+3], a[\b:\b+3], 0
.endm
.macro mvav d, a, b
 v_mfma_f32_16x16x32_bf16 v[\d:\d+3], a[\a:\a+3], v[\b:\b+3], v[\d:\d+3]
.endm
.macro mvavz d, a, b
 v_mfma_f32_16x16x32_bf16 v[\d:\d+3], a[\a:\a+3], v[\b:\b+3], 0
.endm
.macro mvva d, a, b
 v_mfma_f32_16x16x32_bf16 v[\d:\d+3], v[\a:\a+3], a[\b:\b+3], v[\d:\d+3]
.endm
.macro mvvaz d, a, b
 v_mfma_f32_16x16x32_bf16 v[\d:\d+3], v[\a:\a+3], a[\b:\b+3], 0
.endm
.macro pk d, s
 v_cvt_pk_bf16_f32 v[\d], v[\s], v[\s+1]
.endm
.macro rta d, a, o
 ds_read_b64_tr_b16 a[\d:\d+1], v[\a] offset:\o
.endm
.macro rtv d, a, o
 ds_read_b64_tr_b16 v[\d:\d+1], v[\a] offset:\o
.endm
.text
.p2align 12
.globl concat_heads__mha_block_cached__gqa_block_cached__near_ridge_kernel
.p2align 8
.type concat_heads__mha_block_cached__gqa_block_cached__near_ridge_kernel,@function
concat_heads__mha_block_cached__gqa_block_cached__near_ridge_kernel:
 s_cmp_lt_u32 s2, 256
 s_cbranch_scc1 L_run
 s_endpgm
L_run:
 s_load_dwordx16 s[16:31], s[0:1], 0
 s_load_dwordx8 s[32:39], s[0:1], 64
 s_load_dwordx2 s[40:41], s[0:1], 96
 v_lshrrev_b32 v20, 6, v0
 v_and_b32 v0, 63, v0
 v_readfirstlane_b32 s42, v20
 s_getpc_b64 s[94:95]
L_pc0:
 s_and_b32 s3, s2, 0xf8
 s_lshl_b32 s3, s3, 6
 v_lshl_add_u32 v18, v20, 7, s3
 v_lshl_add_u32 v18, v0, 14, v18
 v_min_u32 v18, L14_hot_end-L_pc0-4, v18
 s_mul_i32 s3, s42, 1024
 s_cmp_eq_u32 s42, 3
 s_cselect_b32 s3, L_path4-L_pc0, s3
 s_sub_u32 s3, s3, 2048
 v_lshl_add_u32 v19, v0, 7, s3
 v_cmp_gt_u32 vcc, 16, v0
 s_nop 1
 v_cndmask_b32 v18, v19, v18, vcc
 s_bfm_b64 exec, 24, 0
 v_mov_b32 v19, s95
 v_add_co_u32 v18, vcc, s94, v18
 s_nop 1
 v_addc_co_u32 v19, vcc, 0, v19, vcc
 global_load_dword v255, v[18:19], off
 s_mov_b64 exec, -1
 s_bfe_u32 s5, s2, 0x10002
 s_bfe_u32 s6, s2, 0x10001
 s_lshl_b32 s6, s6, 2
 s_lshr_b32 s7, s2, 6
 s_add_u32 s6, s6, s7
 s_and_b32 s7, s2, 1
 s_lshl_b32 s7, s7, 3
 s_bfe_u32 s8, s2, 0x30003
 s_add_u32 s7, s7, s8
 s_mov_b32 s3, 0x64753120
 v_lshrrev_b32 v14, 4, v0
 v_and_b32 v15, 15, v0
 v_lshlrev_b32 v15, 4, v15
 v_lshl_add_u32 v13, v20, 2, v14
 v_lshl_add_u32 v6, v13, 15, v15
 v_lshlrev_b32 v16, 2, v14
 v_bfe_u32 v17, s3, v16, 3
 v_add_u32 v16, 16, v16
 v_bfe_u32 v16, s3, v16, 3
 v_and_b32 v18, 7, v0
 v_xor_b32 v17, v17, v18
 v_xor_b32 v16, v16, v18
 v_lshrrev_b32 v18, 3, v0
 v_mul_u32_u24 v19, 80, v20
 v_add_lshl_u32 v18, v18, v19, 10
 v_lshl_add_u32 v7, v17, 4, v18
 v_lshl_add_u32 v16, v16, 4, v18
 v_add_u32 v8, 8192, v16
 s_mul_i32 s92, s42, 4224
 s_mul_i32 s80, s42, 10240
 s_add_u32 s80, s80, 84480
 s_lshl_b32 s82, s6, 1
 s_add_u32 s82, s82, s7
 s_and_b32 s82, s82, 2
 s_lshl_b32 s83, s82, 19
 s_lshl_b32 s82, s82, 7
 s_mul_i32 s8, s6, 311296
 s_lshl_b32 s9, s7, 9
 s_sub_u32 s10, 4194304, s9
 s_waitcnt lgkmcnt(0)
 s_cmp_eq_u32 s5, 0
 s_cselect_b64 s[16:17], s[16:17], s[26:27]
 s_cselect_b64 s[22:23], s[22:23], s[32:33]
 s_cselect_b64 s[18:19], s[18:19], s[28:29]
 s_cselect_b64 s[20:21], s[20:21], s[30:31]
 s_cselect_b64 s[24:25], s[24:25], s[34:35]
 s_add_u32 s44, s16, s8
 s_addc_u32 s45, s17, 0
 s_mov_b32 s46, 311296
 s_mov_b32 s47, 0x20000
 s_add_u32 s48, s22, s9
 s_addc_u32 s49, s23, 0
 s_mov_b32 s50, s10
 s_mov_b32 s51, 0x20000
L_code0:
 s_cmp_eq_u32 s42, 3
 s_cbranch_scc1 L_path4
 s_add_u32 m0, s80, 0
 s_add_u32 s81, s82, 0
 s_and_b32 s81, s81, 0x380
 buffer_load_dwordx4 v7, s[44:47], s81 offen lds
 s_add_u32 m0, s80, 1024
 s_nop 0
 buffer_load_dwordx4 v8, s[44:47], s81 offen lds
 s_add_u32 m0, s80, 2048
 s_add_u32 s81, s81, 16384
 buffer_load_dwordx4 v7, s[44:47], s81 offen lds
 s_add_u32 m0, s80, 3072
 s_nop 0
 buffer_load_dwordx4 v8, s[44:47], s81 offen lds
 s_add_u32 m0, s80, 4096
 s_add_u32 s81, s81, 16384
 buffer_load_dwordx4 v7, s[44:47], s81 offen lds
 s_add_u32 m0, s80, 5120
 s_nop 0
 buffer_load_dwordx4 v8, s[44:47], s81 offen lds
 s_add_u32 m0, s80, 6144
 s_add_u32 s81, s81, 16384
 buffer_load_dwordx4 v7, s[44:47], s81 offen lds
 s_add_u32 m0, s80, 7168
 s_nop 0
 buffer_load_dwordx4 v8, s[44:47], s81 offen lds
 s_add_u32 m0, s80, 8192
 s_add_u32 s81, s81, 16384
 buffer_load_dwordx4 v7, s[44:47], s81 offen lds
 s_add_u32 m0, s80, 9216
 s_nop 0
 buffer_load_dwordx4 v8, s[44:47], s81 offen lds
 s_add_u32 m0, s92, 0
 s_add_u32 s86, s83, 256
 s_and_b32 s86, s86, 0x3fffff
 buffer_load_dwordx4 v6, s[48:51], s86 offen lds
 s_add_u32 m0, s92, 1056
 s_add_u32 s86, s86, 8192
 buffer_load_dwordx4 v6, s[48:51], s86 offen lds
 s_add_u32 m0, s92, 2112
 s_add_u32 s86, s86, 8192
 buffer_load_dwordx4 v6, s[48:51], s86 offen lds
 s_add_u32 m0, s92, 3168
 s_add_u32 s86, s86, 8192
 buffer_load_dwordx4 v6, s[48:51], s86 offen lds
 s_add_u32 m0, s92, 16896
 s_add_u32 s86, s83, 0
 s_and_b32 s86, s86, 0x3fffff
 buffer_load_dwordx4 v6, s[48:51], s86 offen lds
 s_add_u32 m0, s92, 17952
 s_add_u32 s86, s86, 8192
 buffer_load_dwordx4 v6, s[48:51], s86 offen lds
 s_add_u32 m0, s92, 19008
 s_add_u32 s86, s86, 8192
 buffer_load_dwordx4 v6, s[48:51], s86 offen lds
 s_add_u32 m0, s92, 20064
 s_add_u32 s86, s86, 8192
 buffer_load_dwordx4 v6, s[48:51], s86 offen lds
 v_lshlrev_b32 v2, 4, v0
 v_lshl_add_u32 v1, v20, 12, v2
 v_mov_b32 v12, v1
 v_lshl_add_u32 v13, v14, 2, v20
 v_lshl_add_u32 v11, v13, 12, v15
 v_mul_u32_u24 v13, 66, v15
 v_lshl_add_u32 v13, v14, 4, v13
 v_add_u32 v3, 67584, v13
 v_and_b32 v16, 14, v0
 v_lshlrev_b32 v16, 1, v16
 v_bfe_u32 v16, s3, v16, 3
 v_lshlrev_b32 v17, 1, v14
 v_xor_b32 v16, v16, v17
 v_lshlrev_b32 v16, 4, v16
 v_lshl_add_u32 v16, v15, 3, v16
 v_add_u32 v9, s80, v16
 v_xor_b32 v10, 16, v9
 v_lshrrev_b32 v13, 2, v0
 v_mul_u32_u24 v13, 1056, v13
 v_and_b32 v16, 3, v0
 v_lshl_add_u32 v5, v16, 4, v13
 v_lshl_add_u32 v13, v16, 3, v13
 v_add_u32 v4, 67584, v13
 v_lshlrev_b32 v0, 2, v0
 s_waitcnt vmcnt(8)
 ds_read_b128 a[0:3], v9 offset:0
 ds_read_b128 a[4:7], v10 offset:0
 ds_read_b128 a[8:11], v9 offset:2048
 ds_read_b128 a[12:15], v10 offset:2048
 ds_read_b128 a[16:19], v9 offset:4096
 ds_read_b128 a[20:23], v10 offset:4096
 ds_read_b128 a[24:27], v9 offset:6144
 ds_read_b128 a[28:31], v10 offset:6144
 ds_read_b128 a[32:35], v9 offset:8192
 ds_read_b128 a[36:39], v10 offset:8192
 s_waitcnt vmcnt(4) lgkmcnt(0)
 s_barrier
 rta 176,5,0
 rta 178,5,256
 rta 180,5,512
 rta 182,5,768
 rta 184,5,8
 rta 186,5,264
 rta 188,5,520
 rta 190,5,776
 s_waitcnt lgkmcnt(6)
 mvaaz 176,176,0
 s_waitcnt lgkmcnt(4)
 rta 192,5,64
 mvaa 176,180,4
 rta 194,5,320
 mvaaz 208,180,12
 rta 196,5,576
 mvaa 208,176,8
 rta 198,5,832
 maaaz 80,176,16
 s_add_u32 m0, s80, 38912
 s_add_u32 s81, s82, 128
 s_and_b32 s81, s81, 0x380
 maaa 80,180,20
 buffer_load_dwordx4 v7, s[44:47], s81 offen lds
 maaaz 112,180,28
 s_add_u32 m0, s80, 39936
 maaa 112,176,24
 buffer_load_dwordx4 v8, s[44:47], s81 offen lds
 maaaz 144,176,32
 s_add_u32 m0, s80, 40960
 s_add_u32 s81, s81, 16384
 maaa 144,180,36
 s_waitcnt lgkmcnt(3)
 buffer_load_dwordx4 v7, s[44:47], s81 offen lds
 maaaz 148,188,36
 rta 200,5,72
 maaa 148,184,32
 rta 202,5,328
 maaaz 116,184,24
 rta 204,5,584
 maaa 116,188,28
 rta 206,5,840
 maaaz 84,188,20
 s_add_u32 m0, s80, 41984
 maaa 84,184,16
 buffer_load_dwordx4 v8, s[44:47], s81 offen lds
 mvaaz 212,184,8
 s_add_u32 m0, s80, 43008
 s_add_u32 s81, s81, 16384
 mvaa 212,188,12
 buffer_load_dwordx4 v7, s[44:47], s81 offen lds
 mvaaz 180,188,4
 s_add_u32 m0, s80, 44032
 mvaa 180,184,0
 s_waitcnt lgkmcnt(3)
 buffer_load_dwordx4 v8, s[44:47], s81 offen lds
 mvaaz 184,192,0
 rta 176,5,128
 mvaa 184,196,4
 rta 178,5,384
 mvaaz 216,196,12
 rta 180,5,640
 mvaa 216,192,8
 rta 182,5,896
 maaaz 88,192,16
 s_add_u32 m0, s80, 45056
 s_add_u32 s81, s81, 16384
 maaa 88,196,20
 buffer_load_dwordx4 v7, s[44:47], s81 offen lds
 maaaz 120,196,28
 s_add_u32 m0, s80, 46080
 maaa 120,192,24
 buffer_load_dwordx4 v8, s[44:47], s81 offen lds
 maaaz 152,192,32
 s_add_u32 m0, s80, 47104
 s_add_u32 s81, s81, 16384
 maaa 152,196,36
 s_waitcnt lgkmcnt(3)
 buffer_load_dwordx4 v7, s[44:47], s81 offen lds
 maaaz 156,204,36
 rta 184,5,136
 maaa 156,200,32
 rta 186,5,392
 maaaz 124,200,24
 rta 188,5,648
 maaa 124,204,28
 rta 190,5,904
 maaaz 92,204,20
 s_add_u32 m0, s80, 48128
 maaa 92,200,16
 buffer_load_dwordx4 v8, s[44:47], s81 offen lds
 mvaaz 220,200,8
 s_add_u32 m0, s92, 33792
 s_add_u32 s86, s83, 524544
 s_and_b32 s86, s86, 0x3fffff
 mvaa 220,204,12
 buffer_load_dwordx4 v6, s[48:51], s86 offen lds
 mvaaz 188,204,4
 s_add_u32 m0, s92, 34848
 s_add_u32 s86, s86, 8192
 mvaa 188,200,0
 s_waitcnt lgkmcnt(3)
 buffer_load_dwordx4 v6, s[48:51], s86 offen lds
 mvaaz 192,176,0
 rta 192,5,192
 mvaa 192,180,4
 rta 194,5,448
 mvaaz 224,180,12
 rta 196,5,704
 mvaa 224,176,8
 rta 198,5,960
 maaaz 96,176,16
 s_add_u32 m0, s92, 35904
 s_add_u32 s86, s86, 8192
 maaa 96,180,20
 buffer_load_dwordx4 v6, s[48:51], s86 offen lds
 maaaz 128,180,28
 s_add_u32 m0, s92, 36960
 s_add_u32 s86, s86, 8192
 maaa 128,176,24
 buffer_load_dwordx4 v6, s[48:51], s86 offen lds
 maaaz 160,176,32
 maaa 160,180,36
 s_waitcnt lgkmcnt(3)
 maaaz 164,188,36
 rta 200,5,200
 maaa 164,184,32
 rta 202,5,456
 maaaz 132,184,24
 rta 204,5,712
 maaa 132,188,28
 rta 206,5,968
 maaaz 100,188,20
 maaa 100,184,16
 mvaaz 228,184,8
 mvaa 228,188,12
 mvaaz 196,188,4
 mvaa 196,184,0
 s_waitcnt lgkmcnt(3)
 mvaaz 200,192,0
 s_waitcnt vmcnt(14) lgkmcnt(0)
 s_barrier
 mvaa 200,196,4
 rta 176,5,16896
 mvaaz 232,196,12
 rta 178,5,17152
 mvaa 232,192,8
 rta 180,5,17408
 maaaz 104,192,16
 rta 182,5,17664
 maaa 104,196,20
 maaaz 136,196,28
 maaa 136,192,24
 maaaz 168,192,32
 maaa 168,196,36
 maaaz 172,204,36
 rta 184,5,16904
 maaa 172,200,32
 rta 186,5,17160
 maaaz 140,200,24
 rta 188,5,17416
 maaa 140,204,28
 rta 190,5,17672
 maaaz 108,204,20
 maaa 108,200,16
 mvaaz 236,200,8
 mvaa 236,204,12
 mvaaz 204,204,4
 mvaa 204,200,0
 s_waitcnt lgkmcnt(3)
 mvaaz 16,176,0
 rta 192,5,16960
 mvaa 16,180,4
 rta 194,5,17216
 mvaaz 48,180,12
 rta 196,5,17472
 mvaa 48,176,8
 rta 198,5,17728
 mvaaz 80,176,16
 s_add_u32 m0, s92, 50688
 s_add_u32 s86, s83, 524288
 s_and_b32 s86, s86, 0x3fffff
 mvaa 80,180,20
 buffer_load_dwordx4 v6, s[48:51], s86 offen lds
 mvaaz 112,180,28
 s_add_u32 m0, s92, 51744
 s_add_u32 s86, s86, 8192
 mvaa 112,176,24
 buffer_load_dwordx4 v6, s[48:51], s86 offen lds
 mvaaz 144,176,32
 s_add_u32 m0, s92, 52800
 s_add_u32 s86, s86, 8192
 mvaa 144,180,36
 s_waitcnt lgkmcnt(3)
 buffer_load_dwordx4 v6, s[48:51], s86 offen lds
 mvaaz 148,188,36
 rta 200,5,16968
 mvaa 148,184,32
 rta 202,5,17224
 mvaaz 116,184,24
 rta 204,5,17480
 mvaa 116,188,28
 rta 206,5,17736
 mvaaz 84,188,20
 s_add_u32 m0, s92, 53856
 s_add_u32 s86, s86, 8192
 mvaa 84,184,16
 buffer_load_dwordx4 v6, s[48:51], s86 offen lds
 mvaaz 52,184,8
 s_add_u32 m0, s80, 0
 s_add_u32 s81, s82, 256
 s_and_b32 s81, s81, 0x380
 mvaa 52,188,12
 buffer_load_dwordx4 v7, s[44:47], s81 offen lds
 mvaaz 20,188,4
 s_add_u32 m0, s80, 1024
 mvaa 20,184,0
 s_waitcnt lgkmcnt(3)
 buffer_load_dwordx4 v8, s[44:47], s81 offen lds
 mvaaz 24,192,0
 rta 176,5,17024
 mvaa 24,196,4
 rta 178,5,17280
 mvaaz 56,196,12
 rta 180,5,17536
 mvaa 56,192,8
 rta 182,5,17792
 mvaaz 88,192,16
 s_add_u32 m0, s80, 2048
 s_add_u32 s81, s81, 16384
 mvaa 88,196,20
 buffer_load_dwordx4 v7, s[44:47], s81 offen lds
 mvaaz 120,196,28
 s_add_u32 m0, s80, 3072
 mvaa 120,192,24
 buffer_load_dwordx4 v8, s[44:47], s81 offen lds
 mvaaz 152,192,32
 s_add_u32 m0, s80, 4096
 s_add_u32 s81, s81, 16384
 mvaa 152,196,36
 s_waitcnt lgkmcnt(3)
 buffer_load_dwordx4 v7, s[44:47], s81 offen lds
 mvaaz 156,204,36
 rta 184,5,17032
 mvaa 156,200,32
 rta 186,5,17288
 mvaaz 124,200,24
 rta 188,5,17544
 mvaa 124,204,28
 rta 190,5,17800
 mvaaz 92,204,20
 s_add_u32 m0, s80, 5120
 mvaa 92,200,16
 buffer_load_dwordx4 v8, s[44:47], s81 offen lds
 mvaaz 60,200,8
 s_add_u32 m0, s80, 6144
 s_add_u32 s81, s81, 16384
 mvaa 60,204,12
 buffer_load_dwordx4 v7, s[44:47], s81 offen lds
 mvaaz 28,204,4
 s_add_u32 m0, s80, 7168
 mvaa 28,200,0
 s_waitcnt lgkmcnt(3)
 buffer_load_dwordx4 v8, s[44:47], s81 offen lds
 mvaaz 32,176,0
 rta 192,5,17088
 mvaa 32,180,4
 rta 194,5,17344
 mvaaz 64,180,12
 rta 196,5,17600
 mvaa 64,176,8
 s_waitcnt vmcnt(16)
 rta 198,5,17856
 mvaaz 96,176,16
 s_add_u32 m0, s80, 8192
 s_add_u32 s81, s81, 16384
 ds_read_b128 a[40:43], v9 offset:38912
 mvaa 96,180,20
 buffer_load_dwordx4 v7, s[44:47], s81 offen lds
 mvaaz 128,180,28
 s_add_u32 m0, s80, 9216
 ds_read_b128 a[44:47], v10 offset:38912
 mvaa 128,176,24
 buffer_load_dwordx4 v8, s[44:47], s81 offen lds
 mvaaz 160,176,32
 ds_read_b128 a[48:51], v9 offset:40960
 mvaa 160,180,36
 s_waitcnt lgkmcnt(6)
 mvaaz 164,188,36
 rta 200,5,17096
 mvaa 164,184,32
 rta 202,5,17352
 mvaaz 132,184,24
 rta 204,5,17608
 mvaa 132,188,28
 rta 206,5,17864
 mvaaz 100,188,20
 ds_read_b128 a[52:55], v10 offset:40960
 mvaa 100,184,16
 mvaaz 68,184,8
 ds_read_b128 a[56:59], v9 offset:43008
 mvaa 68,188,12
 mvaaz 36,188,4
 ds_read_b128 a[60:63], v10 offset:43008
 mvaa 36,184,0
 s_waitcnt lgkmcnt(6)
 mvaaz 40,192,0
 s_waitcnt vmcnt(14) lgkmcnt(0)
 s_barrier
 mvaa 40,196,4
 rta 176,5,33792
 mvaaz 72,196,12
 rta 178,5,34048
 mvaa 72,192,8
 rta 180,5,34304
 mvaaz 104,192,16
 rta 182,5,34560
 mvaa 104,196,20
 mvaaz 136,196,28
 ds_read_b128 a[64:67], v9 offset:45056
 mvaa 136,192,24
 mvaaz 168,192,32
 ds_read_b128 a[68:71], v10 offset:45056
 mvaa 168,196,36
 mvaaz 172,204,36
 rta 184,5,33800
 mvaa 172,200,32
 rta 186,5,34056
 mvaaz 140,200,24
 rta 188,5,34312
 mvaa 140,204,28
 rta 190,5,34568
 mvaaz 108,204,20
 ds_read_b128 a[72:75], v9 offset:47104
 mvaa 108,200,16
 mvaaz 76,200,8
 ds_read_b128 a[76:79], v10 offset:47104
 mvaa 76,204,12
 mvaaz 44,204,4
 mvaa 44,200,0
 s_waitcnt lgkmcnt(5)
 mvaa 176,176,40
 rta 192,5,33856
 mvaa 176,180,44
 rta 194,5,34112
 mvaa 208,180,52
 rta 196,5,34368
 mvaa 208,176,48
 rta 198,5,34624
 maaa 80,176,56
 s_add_u32 m0, s92, 0
 s_add_u32 s86, s83, 1048832
 s_and_b32 s86, s86, 0x3fffff
 maaa 80,180,60
 buffer_load_dwordx4 v6, s[48:51], s86 offen lds
 maaa 112,180,68
 s_add_u32 m0, s92, 1056
 s_add_u32 s86, s86, 8192
 maaa 112,176,64
 s_waitcnt lgkmcnt(4)
 buffer_load_dwordx4 v6, s[48:51], s86 offen lds
 maaa 144,176,72
 s_add_u32 m0, s92, 2112
 s_add_u32 s86, s86, 8192
 maaa 144,180,76
 buffer_load_dwordx4 v6, s[48:51], s86 offen lds
 maaa 148,188,76
 rta 200,5,33864
 maaa 148,184,72
 rta 202,5,34120
 maaa 116,184,64
 rta 204,5,34376
 maaa 116,188,68
 rta 206,5,34632
 maaa 84,188,60
 s_add_u32 m0, s92, 3168
 s_add_u32 s86, s86, 8192
 maaa 84,184,56
 buffer_load_dwordx4 v6, s[48:51], s86 offen lds
 mvaa 212,184,48
 s_add_u32 m0, s92, 16896
 s_add_u32 s86, s83, 1048576
 s_and_b32 s86, s86, 0x3fffff
 mvaa 212,188,52
 buffer_load_dwordx4 v6, s[48:51], s86 offen lds
 mvaa 180,188,44
 s_add_u32 m0, s92, 17952
 s_add_u32 s86, s86, 8192
 mvaa 180,184,40
 s_waitcnt lgkmcnt(3)
 buffer_load_dwordx4 v6, s[48:51], s86 offen lds
 mvaa 184,192,40
 rta 176,5,33920
 mvaa 184,196,44
 rta 178,5,34176
 mvaa 216,196,52
 rta 180,5,34432
 mvaa 216,192,48
 rta 182,5,34688
 maaa 88,192,56
 s_add_u32 m0, s92, 19008
 s_add_u32 s86, s86, 8192
 maaa 88,196,60
 buffer_load_dwordx4 v6, s[48:51], s86 offen lds
 maaa 120,196,68
 s_add_u32 m0, s92, 20064
 s_add_u32 s86, s86, 8192
 maaa 120,192,64
 buffer_load_dwordx4 v6, s[48:51], s86 offen lds
 maaa 152,192,72
 maaa 152,196,76
 s_waitcnt lgkmcnt(3)
 maaa 156,204,76
 rta 184,5,33928
 maaa 156,200,72
 rta 186,5,34184
 maaa 124,200,64
 rta 188,5,34440
 maaa 124,204,68
 rta 190,5,34696
 maaa 92,204,60
 maaa 92,200,56
 mvaa 220,200,48
 mvaa 220,204,52
 mvaa 188,204,44
 mvaa 188,200,40
 s_waitcnt lgkmcnt(3)
 mvaa 192,176,40
 rta 192,5,33984
 mvaa 192,180,44
 rta 194,5,34240
 mvaa 224,180,52
 rta 196,5,34496
 mvaa 224,176,48
 rta 198,5,34752
 maaa 96,176,56
 maaa 96,180,60
 maaa 128,180,68
 maaa 128,176,64
 maaa 160,176,72
 maaa 160,180,76
 s_waitcnt lgkmcnt(3)
 maaa 164,188,76
 rta 200,5,33992
 maaa 164,184,72
 rta 202,5,34248
 maaa 132,184,64
 rta 204,5,34504
 maaa 132,188,68
 rta 206,5,34760
 maaa 100,188,60
 maaa 100,184,56
 mvaa 228,184,48
 mvaa 228,188,52
 mvaa 196,188,44
 mvaa 196,184,40
 s_waitcnt lgkmcnt(3)
 mvaa 200,192,40
 s_waitcnt vmcnt(18) lgkmcnt(0)
 s_barrier
 mvaa 200,196,44
 rta 176,5,50688
 mvaa 232,196,52
 rta 178,5,50944
 mvaa 232,192,48
 s_add_u32 m0, s92, 33792
 rta 180,5,51200
 maaa 104,192,56
 s_add_u32 s86, s83, 1573120
 s_and_b32 s86, s86, 0x3fffff
 rta 182,5,51456
 maaa 104,196,60
 buffer_load_dwordx4 v6, s[48:51], s86 offen lds
 maaa 136,196,68
 s_add_u32 m0, s92, 34848
 s_add_u32 s86, s86, 8192
 maaa 136,192,64
 buffer_load_dwordx4 v6, s[48:51], s86 offen lds
 maaa 168,192,72
 maaa 168,196,76
 maaa 172,204,76
 rta 184,5,50696
 maaa 172,200,72
 rta 186,5,50952
 maaa 140,200,64
 rta 188,5,51208
 maaa 140,204,68
 rta 190,5,51464
 maaa 108,204,60
 s_add_u32 m0, s92, 35904
 s_add_u32 s86, s86, 8192
 maaa 108,200,56
 buffer_load_dwordx4 v6, s[48:51], s86 offen lds
 mvaa 236,200,48
 s_add_u32 m0, s92, 36960
 s_add_u32 s86, s86, 8192
 mvaa 236,204,52
 buffer_load_dwordx4 v6, s[48:51], s86 offen lds
 mvaa 204,204,44
 mvaa 204,200,40
 s_waitcnt lgkmcnt(3)
 mvaa 16,176,40
 rta 192,5,50752
 mvaa 16,180,44
 rta 194,5,51008
 mvaa 48,180,52
 rta 196,5,51264
 mvaa 48,176,48
 s_add_u32 m0, s80, 38912
 s_waitcnt vmcnt(12)
 rta 198,5,51520
 mvaa 80,176,56
 s_add_u32 s81, s82, 384
 s_and_b32 s81, s81, 0x380
 ds_read_b128 a[0:3], v9 offset:0
 mvaa 80,180,60
 buffer_load_dwordx4 v7, s[44:47], s81 offen lds
 mvaa 112,180,68
 s_add_u32 m0, s80, 39936
 ds_read_b128 a[4:7], v10 offset:0
 mvaa 112,176,64
 buffer_load_dwordx4 v8, s[44:47], s81 offen lds
 mvaa 144,176,72
 s_add_u32 m0, s80, 40960
 s_add_u32 s81, s81, 16384
 ds_read_b128 a[8:11], v9 offset:2048
 mvaa 144,180,76
 s_waitcnt lgkmcnt(6)
 buffer_load_dwordx4 v7, s[44:47], s81 offen lds
 mvaa 148,188,76
 rta 200,5,50760
 mvaa 148,184,72
 rta 202,5,51016
 mvaa 116,184,64
 rta 204,5,51272
 mvaa 116,188,68
 rta 206,5,51528
 mvaa 84,188,60
 s_add_u32 m0, s80, 41984
 ds_read_b128 a[12:15], v10 offset:2048
 mvaa 84,184,56
 buffer_load_dwordx4 v8, s[44:47], s81 offen lds
 mvaa 52,184,48
 s_add_u32 m0, s80, 43008
 s_add_u32 s81, s81, 16384
 ds_read_b128 a[16:19], v9 offset:4096
 mvaa 52,188,52
 buffer_load_dwordx4 v7, s[44:47], s81 offen lds
 mvaa 20,188,44
 s_add_u32 m0, s80, 44032
 ds_read_b128 a[20:23], v10 offset:4096
 mvaa 20,184,40
 s_waitcnt lgkmcnt(6)
 buffer_load_dwordx4 v8, s[44:47], s81 offen lds
 mvaa 24,192,40
 rta 176,5,50816
 mvaa 24,196,44
 rta 178,5,51072
 mvaa 56,196,52
 rta 180,5,51328
 mvaa 56,192,48
 rta 182,5,51584
 mvaa 88,192,56
 s_add_u32 m0, s80, 45056
 s_add_u32 s81, s81, 16384
 ds_read_b128 a[24:27], v9 offset:6144
 mvaa 88,196,60
 buffer_load_dwordx4 v7, s[44:47], s81 offen lds
 mvaa 120,196,68
 s_add_u32 m0, s80, 46080
 ds_read_b128 a[28:31], v10 offset:6144
 mvaa 120,192,64
 buffer_load_dwordx4 v8, s[44:47], s81 offen lds
 mvaa 152,192,72
 s_add_u32 m0, s80, 47104
 s_add_u32 s81, s81, 16384
 ds_read_b128 a[32:35], v9 offset:8192
 mvaa 152,196,76
 s_waitcnt lgkmcnt(6)
 buffer_load_dwordx4 v7, s[44:47], s81 offen lds
 mvaa 156,204,76
 rta 184,5,50824
 mvaa 156,200,72
 rta 186,5,51080
 mvaa 124,200,64
 rta 188,5,51336
 mvaa 124,204,68
 rta 190,5,51592
 mvaa 92,204,60
 s_add_u32 m0, s80, 48128
 ds_read_b128 a[36:39], v10 offset:8192
 mvaa 92,200,56
 buffer_load_dwordx4 v8, s[44:47], s81 offen lds
 mvaa 60,200,48
 mvaa 60,204,52
 mvaa 28,204,44
 mvaa 28,200,40
 s_waitcnt lgkmcnt(4)
 mvaa 32,176,40
 rta 192,5,50880
 mvaa 32,180,44
 rta 194,5,51136
 mvaa 64,180,52
 rta 196,5,51392
 mvaa 64,176,48
 rta 198,5,51648
 mvaa 96,176,56
 mvaa 96,180,60
 mvaa 128,180,68
 mvaa 128,176,64
 mvaa 160,176,72
 mvaa 160,180,76
 s_waitcnt lgkmcnt(3)
 mvaa 164,188,76
 rta 200,5,50888
 mvaa 164,184,72
 rta 202,5,51144
 mvaa 132,184,64
 rta 204,5,51400
 mvaa 132,188,68
 rta 206,5,51656
 mvaa 100,188,60
 mvaa 100,184,56
 mvaa 68,184,48
 mvaa 68,188,52
 mvaa 36,188,44
 mvaa 36,184,40
 s_waitcnt lgkmcnt(3)
 mvaa 40,192,40
 s_waitcnt vmcnt(18) lgkmcnt(0)
 s_barrier
 mvaa 40,196,44
 rta 176,5,0
 mvaa 72,196,52
 rta 178,5,256
 mvaa 72,192,48
 s_add_u32 m0, s92, 50688
 rta 180,5,512
 mvaa 104,192,56
 s_add_u32 s86, s83, 1572864
 s_and_b32 s86, s86, 0x3fffff
 rta 182,5,768
 mvaa 104,196,60
 buffer_load_dwordx4 v6, s[48:51], s86 offen lds
 mvaa 136,196,68
 s_add_u32 m0, s92, 51744
 s_add_u32 s86, s86, 8192
 mvaa 136,192,64
 buffer_load_dwordx4 v6, s[48:51], s86 offen lds
 mvaa 168,192,72
 mvaa 168,196,76
 mvaa 172,204,76
 rta 184,5,8
 mvaa 172,200,72
 rta 186,5,264
 mvaa 140,200,64
 rta 188,5,520
 mvaa 140,204,68
 rta 190,5,776
 mvaa 108,204,60
 s_add_u32 m0, s92, 52800
 s_add_u32 s86, s86, 8192
 mvaa 108,200,56
 buffer_load_dwordx4 v6, s[48:51], s86 offen lds
 mvaa 76,200,48
 s_add_u32 m0, s92, 53856
 s_add_u32 s86, s86, 8192
 mvaa 76,204,52
 buffer_load_dwordx4 v6, s[48:51], s86 offen lds
 mvaa 44,204,44
 mvaa 44,200,40
 s_waitcnt lgkmcnt(3)
 mvaa 176,176,0
 rta 192,5,64
 mvaa 176,180,4
 rta 194,5,320
 mvaa 208,180,12
 rta 196,5,576
 mvaa 208,176,8
 rta 198,5,832
 maaa 80,176,16
 s_add_u32 m0, s80, 0
 s_add_u32 s81, s82, 512
 s_and_b32 s81, s81, 0x380
 maaa 80,180,20
 buffer_load_dwordx4 v7, s[44:47], s81 offen lds
 maaa 112,180,28
 s_add_u32 m0, s80, 1024
 maaa 112,176,24
 buffer_load_dwordx4 v8, s[44:47], s81 offen lds
 maaa 144,176,32
 s_add_u32 m0, s80, 2048
 s_add_u32 s81, s81, 16384
 maaa 144,180,36
 s_waitcnt lgkmcnt(3)
 buffer_load_dwordx4 v7, s[44:47], s81 offen lds
 maaa 148,188,36
 rta 200,5,72
 maaa 148,184,32
 rta 202,5,328
 maaa 116,184,24
 rta 204,5,584
 maaa 116,188,28
 rta 206,5,840
 maaa 84,188,20
 s_add_u32 m0, s80, 3072
 maaa 84,184,16
 buffer_load_dwordx4 v8, s[44:47], s81 offen lds
 mvaa 212,184,8
 s_add_u32 m0, s80, 4096
 s_add_u32 s81, s81, 16384
 mvaa 212,188,12
 buffer_load_dwordx4 v7, s[44:47], s81 offen lds
 mvaa 180,188,4
 s_add_u32 m0, s80, 5120
 mvaa 180,184,0
 s_waitcnt lgkmcnt(3)
 buffer_load_dwordx4 v8, s[44:47], s81 offen lds
 mvaa 184,192,0
 rta 176,5,128
 mvaa 184,196,4
 rta 178,5,384
 mvaa 216,196,12
 rta 180,5,640
 mvaa 216,192,8
 rta 182,5,896
 maaa 88,192,16
 s_add_u32 m0, s80, 6144
 s_add_u32 s81, s81, 16384
 maaa 88,196,20
 buffer_load_dwordx4 v7, s[44:47], s81 offen lds
 maaa 120,196,28
 s_add_u32 m0, s80, 7168
 maaa 120,192,24
 buffer_load_dwordx4 v8, s[44:47], s81 offen lds
 maaa 152,192,32
 s_add_u32 m0, s80, 8192
 s_add_u32 s81, s81, 16384
 maaa 152,196,36
 s_waitcnt lgkmcnt(3)
 buffer_load_dwordx4 v7, s[44:47], s81 offen lds
 maaa 156,204,36
 rta 184,5,136
 maaa 156,200,32
 rta 186,5,392
 maaa 124,200,24
 rta 188,5,648
 maaa 124,204,28
 rta 190,5,904
 maaa 92,204,20
 s_add_u32 m0, s80, 9216
 maaa 92,200,16
 buffer_load_dwordx4 v8, s[44:47], s81 offen lds
 mvaa 220,200,8
 mvaa 220,204,12
 mvaa 188,204,4
 mvaa 188,200,0
 s_waitcnt lgkmcnt(3)
 mvaa 192,176,0
 rta 192,5,192
 mvaa 192,180,4
 rta 194,5,448
 mvaa 224,180,12
 rta 196,5,704
 mvaa 224,176,8
 rta 198,5,960
 maaa 96,176,16
 maaa 96,180,20
 maaa 128,180,28
 maaa 128,176,24
 maaa 160,176,32
 maaa 160,180,36
 s_waitcnt lgkmcnt(3)
 maaa 164,188,36
 rta 200,5,200
 maaa 164,184,32
 rta 202,5,456
 maaa 132,184,24
 rta 204,5,712
 maaa 132,188,28
 rta 206,5,968
 maaa 100,188,20
 maaa 100,184,16
 mvaa 228,184,8
 mvaa 228,188,12
 mvaa 196,188,4
 mvaa 196,184,0
 s_waitcnt lgkmcnt(3)
 mvaa 200,192,0
 s_waitcnt vmcnt(28) lgkmcnt(0)
 s_barrier
 mvaa 200,196,4
 rta 176,5,16896
 mvaa 232,196,12
 rta 178,5,17152
 mvaa 232,192,8
 s_add_u32 m0, s92, 0
 rta 180,5,17408
 maaa 104,192,16
 s_add_u32 s86, s83, 2097408
 s_and_b32 s86, s86, 0x3fffff
 rta 182,5,17664
 maaa 104,196,20
 buffer_load_dwordx4 v6, s[48:51], s86 offen lds
 maaa 136,196,28
 s_add_u32 m0, s92, 1056
 s_add_u32 s86, s86, 8192
 maaa 136,192,24
 buffer_load_dwordx4 v6, s[48:51], s86 offen lds
 maaa 168,192,32
 maaa 168,196,36
 maaa 172,204,36
 rta 184,5,16904
 maaa 172,200,32
 rta 186,5,17160
 maaa 140,200,24
 rta 188,5,17416
 maaa 140,204,28
 rta 190,5,17672
 maaa 108,204,20
 s_add_u32 m0, s92, 2112
 s_add_u32 s86, s86, 8192
 maaa 108,200,16
 buffer_load_dwordx4 v6, s[48:51], s86 offen lds
 mvaa 236,200,8
 s_add_u32 m0, s92, 3168
 s_add_u32 s86, s86, 8192
 mvaa 236,204,12
 buffer_load_dwordx4 v6, s[48:51], s86 offen lds
 mvaa 204,204,4
 mvaa 204,200,0
 s_waitcnt lgkmcnt(3)
 mvaa 16,176,0
 rta 192,5,16960
 mvaa 16,180,4
 rta 194,5,17216
 mvaa 48,180,12
 rta 196,5,17472
 mvaa 48,176,8
 s_waitcnt vmcnt(18)
 rta 198,5,17728
 mvaa 80,176,16
 s_lshl_b32 s8, s6, 4
 s_add_u32 s10, s8, s7
 ds_read_b128 a[40:43], v9 offset:38912
 mvaa 80,180,20
 s_lshl_b32 s8, s10, 19
 s_add_u32 s52, s18, s8
 s_addc_u32 s53, s19, 0
 mvaa 112,180,28
 s_mov_b32 s54, 524288
 s_mov_b32 s55, 0x20000
 ds_read_b128 a[44:47], v10 offset:38912
 mvaa 112,176,24
 s_add_u32 s56, s20, s8
 s_addc_u32 s57, s21, 0
 s_mov_b32 s58, 524288
 mvaa 144,176,32
 s_mov_b32 s59, 0x20000
 s_lshl_b32 s8, s5, 3
 ds_read_b128 a[48:51], v9 offset:40960
 mvaa 144,180,36
 s_waitcnt lgkmcnt(6)
 s_add_u32 s8, s8, s6
 s_lshl_b32 s85, s8, 2
 s_add_u32 s8, s85, s42
 mvaa 148,188,36
 s_mul_i32 s8, s8, 655360
 s_add_u32 s8, s8, 0
 rta 200,5,16968
 mvaa 148,184,32
 s_mul_i32 s9, s7, 40960
 s_add_u32 s8, s8, s9
 rta 202,5,17224
 mvaa 116,184,24
 s_add_u32 s60, s40, s8
 s_addc_u32 s61, s41, 0
 rta 204,5,17480
 mvaa 116,188,28
 s_mov_b32 s62, 40960
 s_mov_b32 s63, 0x20000
 rta 206,5,17736
 mvaa 84,188,20
 s_lshl_b32 s8, s2, 2
 s_add_u32 s8, s8, s42
 ds_read_b128 a[52:55], v10 offset:40960
 mvaa 84,184,16
 s_mul_i32 s8, s8, 40960
 s_add_u32 s8, s8, 41943040
 s_add_u32 s64, s40, s8
 mvaa 52,184,8
 s_addc_u32 s65, s41, 0
 s_mov_b32 s66, 40960
 ds_read_b128 a[56:59], v9 offset:43008
 mvaa 52,188,12
 s_mov_b32 s67, 0x20000
 s_mov_b64 s[72:73], s[52:53]
 s_mov_b64 s[74:75], s[56:57]
 mvaa 20,188,4
 s_lshr_b32 s10, s7, 2
 s_and_b32 s11, s7, 3
 ds_read_b128 a[60:63], v10 offset:43008
 mvaa 20,184,0
 s_waitcnt lgkmcnt(6)
 s_lshl_b32 s8, s11, 8
 s_sub_u32 s9, 4194304, s8
 s_add_u32 s68, s24, s8
 mvaa 24,192,0
 s_addc_u32 s69, s25, 0
 s_mov_b32 s70, s9
 rta 176,5,17024
 mvaa 24,196,4
 s_mov_b32 s71, 0x20000
 s_add_u32 s8, s85, s42
 rta 178,5,17280
 mvaa 56,196,12
 s_mul_i32 s8, s8, 655360
 s_add_u32 s8, s8, 0
 rta 180,5,17536
 mvaa 56,192,8
 s_add_u32 s16, s40, s8
 s_addc_u32 s17, s41, 0
 rta 182,5,17792
 mvaa 88,192,16
 s_mov_b32 s18, 655360
 s_mov_b32 s19, 0x20000
 ds_read_b128 a[64:67], v9 offset:45056
 mvaa 88,196,20
 s_add_u32 s12, s85, s11
 s_mul_i32 s8, s12, 245760
 s_mul_i32 s9, s42, 5120
 mvaa 120,196,28
 s_add_u32 s8, s8, s9
 s_add_u32 s8, s8, 83886080
 ds_read_b128 a[68:71], v10 offset:45056
 mvaa 120,192,24
 s_add_u32 s20, s40, s8
 s_addc_u32 s21, s41, 0
 s_mov_b32 s22, 230400
 mvaa 152,192,32
 s_mov_b32 s23, 0x20000
 s_lshl_b32 s8, s12, 11
 ds_read_b128 a[72:75], v9 offset:47104
 mvaa 152,196,36
 s_waitcnt lgkmcnt(6)
 s_lshl_b32 s9, s42, 7
 s_add_u32 s8, s8, s9
 s_add_u32 s8, s8, 125829120
 mvaa 156,204,36
 s_add_u32 s32, s40, s8
 s_addc_u32 s33, s41, 0
 rta 184,5,17032
 mvaa 156,200,32
 s_mov_b32 s34, 1664
 s_mov_b32 s35, 0x20000
 rta 186,5,17288
 mvaa 124,200,24
 s_mul_i32 s8, s6, 304
 s_mul_i32 s9, s42, 80
 rta 188,5,17544
 mvaa 124,204,28
 s_add_u32 s8, s8, s9
 s_lshl_b32 s8, s8, 11
 rta 190,5,17800
 mvaa 92,204,20
 s_lshl_b32 s9, s5, 10
 s_add_u32 s8, s8, s9
 ds_read_b128 a[76:79], v10 offset:47104
 mvaa 92,200,16
 s_lshl_b32 s9, s11, 8
 s_add_u32 s8, s8, s9
 s_lshl_b32 s9, s10, 6
 mvaa 60,200,8
 s_add_u32 s8, s8, s9
 s_sub_u32 s9, 4980736, s8
 s_add_u32 s24, s36, s8
 mvaa 60,204,12
 s_addc_u32 s25, s37, 0
 s_mov_b32 s26, s9
 s_mov_b32 s27, 0x20000
 mvaa 28,204,4
 s_add_u32 s28, s38, 0
 s_addc_u32 s29, s39, 0
 s_mov_b32 s30, 64
 mvaa 28,200,0
 s_waitcnt lgkmcnt(4)
 s_mov_b32 s31, 0x20000
 s_lshl_b32 s36, 1, s7
 s_mov_b32 s38, 0
 mvaa 32,176,0
 s_add_u32 s9, s85, s42
 s_lshl_b32 s9, s9, 11
 rta 192,5,17088
 mvaa 32,180,4
 s_add_u32 s9, s9, 126877696
 s_add_u32 s40, s40, s9
 rta 194,5,17344
 mvaa 64,180,12
 s_addc_u32 s41, s41, 0
 s_mov_b32 s8, s10
 rta 196,5,17600
 mvaa 64,176,8
 s_lshl_b32 s9, s7, 1
 s_add_u32 s77, s92, 67584
 rta 198,5,17856
 mvaa 96,176,16
 s_mov_b32 s78, 4294899712
 s_mov_b32 s88, 0x3e0293ee
 s_mov_b32 s89, 0x3e0293ee
 mvaa 96,180,20
 s_mov_b32 s87, 0
 s_mov_b32 s43, 0
 s_mov_b32 s90, 0
 mvaa 128,180,28
 s_mov_b32 s91, 0x4f800000
 s_lshl_b32 s39, s6, 1
 s_add_u32 s39, s39, s7
 mvaa 128,176,24
 s_and_b32 s39, s39, 0
 s_lshl_b32 s39, s39, 14
 s_mov_b32 s5, 65536
 mvaa 160,176,32
 s_xor_b32 s76, s5, s39
 s_lshl_b32 s3, s8, 9
 v_mov_b32 v240, 0
 mvaa 160,180,36
 s_waitcnt lgkmcnt(3)
 v_mov_b32 v241, 0
 v_mov_b32 v242, 0
 mvaa 164,188,36
 rta 200,5,17096
 v_mov_b32 v243, 0
 mvaa 164,184,32
 rta 202,5,17352
 mvaa 132,184,24
 rta 204,5,17608
 mvaa 132,188,28
 rta 206,5,17864
 mvaa 100,188,20
 buffer_store_dwordx4 v[240:243], off, s[32:35], s3 sc1
 mvaa 100,184,16
 mvaa 68,184,8
 mvaa 68,188,12
 mvaa 36,188,4
 mvaa 36,184,0
 s_waitcnt lgkmcnt(3)
 mvaa 40,192,0
 s_waitcnt lgkmcnt(0)
 s_barrier
 mvaa 40,196,4
 rta 176,5,33792
 mvaa 72,196,12
 rta 178,5,34048
 mvaa 72,192,8
 s_add_u32 m0, s92, 16896
 rta 180,5,34304
 mvaa 104,192,16
 s_add_u32 s86, s83, 2097152
 s_and_b32 s86, s86, 0x3fffff
 rta 182,5,34560
 mvaa 104,196,20
 buffer_load_dwordx4 v6, s[48:51], s86 offen lds
 mvaa 136,196,28
 s_add_u32 m0, s92, 17952
 s_add_u32 s86, s86, 8192
 mvaa 136,192,24
 buffer_load_dwordx4 v6, s[48:51], s86 offen lds
 mvaa 168,192,32
 mvaa 168,196,36
 mvaa 172,204,36
 rta 184,5,33800
 mvaa 172,200,32
 rta 186,5,34056
 mvaa 140,200,24
 rta 188,5,34312
 mvaa 140,204,28
 rta 190,5,34568
 mvaa 108,204,20
 s_add_u32 m0, s92, 19008
 s_add_u32 s86, s86, 8192
 mvaa 108,200,16
 buffer_load_dwordx4 v6, s[48:51], s86 offen lds
 mvaa 76,200,8
 s_add_u32 m0, s92, 20064
 s_add_u32 s86, s86, 8192
 mvaa 76,204,12
 buffer_load_dwordx4 v6, s[48:51], s86 offen lds
 mvaa 44,204,4
 mvaa 44,200,0
 s_waitcnt lgkmcnt(3)
 mvaa 176,176,40
 rta 192,5,33856
 mvaa 176,180,44
 rta 194,5,34112
 mvaa 208,180,52
 rta 196,5,34368
 mvaa 208,176,48
 rta 198,5,34624
 maaa 80,176,56
 s_add_u32 m0, s80, 38912
 s_add_u32 s81, s82, 640
 s_and_b32 s81, s81, 0x380
 maaa 80,180,60
 buffer_load_dwordx4 v7, s[44:47], s81 offen lds
 maaa 112,180,68
 s_add_u32 m0, s80, 39936
 maaa 112,176,64
 buffer_load_dwordx4 v8, s[44:47], s81 offen lds
 maaa 144,176,72
 s_add_u32 m0, s80, 40960
 s_add_u32 s81, s81, 16384
 maaa 144,180,76
 s_waitcnt lgkmcnt(3)
 buffer_load_dwordx4 v7, s[44:47], s81 offen lds
 maaa 148,188,76
 rta 200,5,33864
 maaa 148,184,72
 rta 202,5,34120
 maaa 116,184,64
 rta 204,5,34376
 maaa 116,188,68
 rta 206,5,34632
 maaa 84,188,60
 s_add_u32 m0, s80, 41984
 maaa 84,184,56
 buffer_load_dwordx4 v8, s[44:47], s81 offen lds
 mvaa 212,184,48
 s_add_u32 m0, s80, 43008
 s_add_u32 s81, s81, 16384
 mvaa 212,188,52
 buffer_load_dwordx4 v7, s[44:47], s81 offen lds
 mvaa 180,188,44
 s_add_u32 m0, s80, 44032
 mvaa 180,184,40
 s_waitcnt lgkmcnt(3)
 buffer_load_dwordx4 v8, s[44:47], s81 offen lds
 mvaa 184,192,40
 rta 176,5,33920
 mvaa 184,196,44
 rta 178,5,34176
 mvaa 216,196,52
 rta 180,5,34432
 mvaa 216,192,48
 rta 182,5,34688
 maaa 88,192,56
 s_add_u32 m0, s80, 45056
 s_add_u32 s81, s81, 16384
 maaa 88,196,60
 buffer_load_dwordx4 v7, s[44:47], s81 offen lds
 maaa 120,196,68
 s_add_u32 m0, s80, 46080
 maaa 120,192,64
 buffer_load_dwordx4 v8, s[44:47], s81 offen lds
 maaa 152,192,72
 s_add_u32 m0, s80, 47104
 s_add_u32 s81, s81, 16384
 maaa 152,196,76
 s_waitcnt lgkmcnt(3)
 buffer_load_dwordx4 v7, s[44:47], s81 offen lds
 maaa 156,204,76
 rta 184,5,33928
 maaa 156,200,72
 rta 186,5,34184
 maaa 124,200,64
 rta 188,5,34440
 maaa 124,204,68
 rta 190,5,34696
 maaa 92,204,60
 s_add_u32 m0, s80, 48128
 maaa 92,200,56
 buffer_load_dwordx4 v8, s[44:47], s81 offen lds
 mvaa 220,200,48
 mvaa 220,204,52
 mvaa 188,204,44
 mvaa 188,200,40
 s_waitcnt lgkmcnt(3)
 mvaa 192,176,40
 rta 192,5,33984
 mvaa 192,180,44
 rta 194,5,34240
 mvaa 224,180,52
 rta 196,5,34496
 mvaa 224,176,48
 rta 198,5,34752
 maaa 96,176,56
 maaa 96,180,60
 maaa 128,180,68
 maaa 128,176,64
 maaa 160,176,72
 maaa 160,180,76
 s_waitcnt lgkmcnt(3)
 maaa 164,188,76
 rta 200,5,33992
 maaa 164,184,72
 rta 202,5,34248
 maaa 132,184,64
 rta 204,5,34504
 maaa 132,188,68
 rta 206,5,34760
 maaa 100,188,60
 maaa 100,184,56
 mvaa 228,184,48
 mvaa 228,188,52
 mvaa 196,188,44
 mvaa 196,184,40
 s_waitcnt lgkmcnt(3)
 mvaa 200,192,40
 s_waitcnt vmcnt(29) lgkmcnt(0)
 s_barrier
 mvaa 200,196,44
 rta 176,5,50688
 mvaa 232,196,52
 rta 178,5,50944
 mvaa 232,192,48
 s_add_u32 m0, s92, 33792
 rta 180,5,51200
 maaa 104,192,56
 s_add_u32 s86, s83, 2621696
 s_and_b32 s86, s86, 0x3fffff
 rta 182,5,51456
 maaa 104,196,60
 buffer_load_dwordx4 v6, s[48:51], s86 offen lds
 maaa 136,196,68
 s_add_u32 m0, s92, 34848
 s_add_u32 s86, s86, 8192
 maaa 136,192,64
 buffer_load_dwordx4 v6, s[48:51], s86 offen lds
 maaa 168,192,72
 maaa 168,196,76
 maaa 172,204,76
 rta 184,5,50696
 maaa 172,200,72
 rta 186,5,50952
 maaa 140,200,64
 rta 188,5,51208
 maaa 140,204,68
 rta 190,5,51464
 maaa 108,204,60
 s_add_u32 m0, s92, 35904
 s_add_u32 s86, s86, 8192
 maaa 108,200,56
 buffer_load_dwordx4 v6, s[48:51], s86 offen lds
 mvaa 236,200,48
 s_add_u32 m0, s92, 36960
 s_add_u32 s86, s86, 8192
 mvaa 236,204,52
 buffer_load_dwordx4 v6, s[48:51], s86 offen lds
 mvaa 204,204,44
 mvaa 204,200,40
 s_waitcnt lgkmcnt(3)
 mvaa 16,176,40
 rta 192,5,50752
 mvaa 16,180,44
 rta 194,5,51008
 mvaa 48,180,52
 rta 196,5,51264
 mvaa 48,176,48
 s_waitcnt vmcnt(23)
 rta 198,5,51520
 mvaa 80,176,56
 ds_read_b128 a[0:3], v9 offset:0
 mvaa 80,180,60
 mvaa 112,180,68
 ds_read_b128 a[4:7], v10 offset:0
 mvaa 112,176,64
 mvaa 144,176,72
 ds_read_b128 a[8:11], v9 offset:2048
 mvaa 144,180,76
 s_waitcnt lgkmcnt(6)
 mvaa 148,188,76
 rta 200,5,50760
 mvaa 148,184,72
 rta 202,5,51016
 mvaa 116,184,64
 rta 204,5,51272
 mvaa 116,188,68
 rta 206,5,51528
 mvaa 84,188,60
 ds_read_b128 a[12:15], v10 offset:2048
 mvaa 84,184,56
 mvaa 52,184,48
 ds_read_b128 a[16:19], v9 offset:4096
 mvaa 52,188,52
 mvaa 20,188,44
 ds_read_b128 a[20:23], v10 offset:4096
 mvaa 20,184,40
 s_waitcnt lgkmcnt(6)
 mvaa 24,192,40
 rta 176,5,50816
 mvaa 24,196,44
 rta 178,5,51072
 mvaa 56,196,52
 rta 180,5,51328
 mvaa 56,192,48
 rta 182,5,51584
 mvaa 88,192,56
 ds_read_b128 a[24:27], v9 offset:6144
 mvaa 88,196,60
 mvaa 120,196,68
 ds_read_b128 a[28:31], v10 offset:6144
 mvaa 120,192,64
 mvaa 152,192,72
 ds_read_b128 a[32:35], v9 offset:8192
 mvaa 152,196,76
 s_waitcnt lgkmcnt(6)
 mvaa 156,204,76
 rta 184,5,50824
 mvaa 156,200,72
 rta 186,5,51080
 mvaa 124,200,64
 rta 188,5,51336
 mvaa 124,204,68
 rta 190,5,51592
 mvaa 92,204,60
 ds_read_b128 a[36:39], v10 offset:8192
 mvaa 92,200,56
 mvaa 60,200,48
 mvaa 60,204,52
 mvaa 28,204,44
 mvaa 28,200,40
 s_waitcnt lgkmcnt(4)
 mvaa 32,176,40
 rta 192,5,50880
 mvaa 32,180,44
 rta 194,5,51136
 mvaa 64,180,52
 rta 196,5,51392
 mvaa 64,176,48
 rta 198,5,51648
 mvaa 96,176,56
 mvaa 96,180,60
 mvaa 128,180,68
 mvaa 128,176,64
 mvaa 160,176,72
 mvaa 160,180,76
 s_waitcnt lgkmcnt(3)
 mvaa 164,188,76
 rta 200,5,50888
 mvaa 164,184,72
 rta 202,5,51144
 mvaa 132,184,64
 rta 204,5,51400
 mvaa 132,188,68
 rta 206,5,51656
 mvaa 100,188,60
 mvaa 100,184,56
 mvaa 68,184,48
 mvaa 68,188,52
 mvaa 36,188,44
 mvaa 36,184,40
 s_waitcnt lgkmcnt(3)
 mvaa 40,192,40
 s_waitcnt vmcnt(19) lgkmcnt(0)
 s_barrier
 mvaa 40,196,44
 rta 176,5,0
 mvaa 72,196,52
 rta 178,5,256
 mvaa 72,192,48
 s_add_u32 m0, s92, 50688
 rta 180,5,512
 mvaa 104,192,56
 s_add_u32 s86, s83, 2621440
 s_and_b32 s86, s86, 0x3fffff
 rta 182,5,768
 mvaa 104,196,60
 buffer_load_dwordx4 v6, s[48:51], s86 offen lds
 mvaa 136,196,68
 s_add_u32 m0, s92, 51744
 s_add_u32 s86, s86, 8192
 mvaa 136,192,64
 buffer_load_dwordx4 v6, s[48:51], s86 offen lds
 mvaa 168,192,72
 mvaa 168,196,76
 mvaa 172,204,76
 rta 184,5,8
 mvaa 172,200,72
 rta 186,5,264
 mvaa 140,200,64
 rta 188,5,520
 mvaa 140,204,68
 rta 190,5,776
 mvaa 108,204,60
 s_add_u32 m0, s92, 52800
 s_add_u32 s86, s86, 8192
 mvaa 108,200,56
 buffer_load_dwordx4 v6, s[48:51], s86 offen lds
 mvaa 76,200,48
 s_add_u32 m0, s92, 53856
 s_add_u32 s86, s86, 8192
 mvaa 76,204,52
 buffer_load_dwordx4 v6, s[48:51], s86 offen lds
 mvaa 44,204,44
 mvaa 44,200,40
 s_waitcnt lgkmcnt(3)
 mvaa 176,176,0
 rta 192,5,64
 mvaa 176,180,4
 rta 194,5,320
 mvaa 208,180,12
 rta 196,5,576
 mvaa 208,176,8
 rta 198,5,832
 maaa 80,176,16
 s_add_u32 m0, s80, 0
 s_add_u32 s81, s82, 768
 s_and_b32 s81, s81, 0x380
 maaa 80,180,20
 buffer_load_dwordx4 v7, s[44:47], s81 offen lds
 maaa 112,180,28
 s_add_u32 m0, s80, 1024
 maaa 112,176,24
 buffer_load_dwordx4 v8, s[44:47], s81 offen lds
 maaa 144,176,32
 s_add_u32 m0, s80, 2048
 s_add_u32 s81, s81, 16384
 maaa 144,180,36
 s_waitcnt lgkmcnt(3)
 buffer_load_dwordx4 v7, s[44:47], s81 offen lds
 maaa 148,188,36
 rta 200,5,72
 maaa 148,184,32
 rta 202,5,328
 maaa 116,184,24
 rta 204,5,584
 maaa 116,188,28
 rta 206,5,840
 maaa 84,188,20
 s_add_u32 m0, s80, 3072
 maaa 84,184,16
 buffer_load_dwordx4 v8, s[44:47], s81 offen lds
 mvaa 212,184,8
 s_add_u32 m0, s80, 4096
 s_add_u32 s81, s81, 16384
 mvaa 212,188,12
 buffer_load_dwordx4 v7, s[44:47], s81 offen lds
 mvaa 180,188,4
 s_add_u32 m0, s80, 5120
 mvaa 180,184,0
 s_waitcnt lgkmcnt(3)
 buffer_load_dwordx4 v8, s[44:47], s81 offen lds
 mvaa 184,192,0
 rta 176,5,128
 mvaa 184,196,4
 rta 178,5,384
 mvaa 216,196,12
 rta 180,5,640
 mvaa 216,192,8
 rta 182,5,896
 maaa 88,192,16
 s_add_u32 m0, s80, 6144
 s_add_u32 s81, s81, 16384
 maaa 88,196,20
 buffer_load_dwordx4 v7, s[44:47], s81 offen lds
 maaa 120,196,28
 s_add_u32 m0, s80, 7168
 maaa 120,192,24
 buffer_load_dwordx4 v8, s[44:47], s81 offen lds
 maaa 152,192,32
 s_add_u32 m0, s80, 8192
 s_add_u32 s81, s81, 16384
 maaa 152,196,36
 s_waitcnt lgkmcnt(3)
 buffer_load_dwordx4 v7, s[44:47], s81 offen lds
 maaa 156,204,36
 rta 184,5,136
 maaa 156,200,32
 rta 186,5,392
 maaa 124,200,24
 rta 188,5,648
 maaa 124,204,28
 rta 190,5,904
 maaa 92,204,20
 s_add_u32 m0, s80, 9216
 maaa 92,200,16
 buffer_load_dwordx4 v8, s[44:47], s81 offen lds
 mvaa 220,200,8
 mvaa 220,204,12
 mvaa 188,204,4
 mvaa 188,200,0
 s_waitcnt lgkmcnt(3)
 mvaa 192,176,0
 rta 192,5,192
 mvaa 192,180,4
 rta 194,5,448
 mvaa 224,180,12
 rta 196,5,704
 mvaa 224,176,8
 rta 198,5,960
 maaa 96,176,16
 maaa 96,180,20
 maaa 128,180,28
 maaa 128,176,24
 maaa 160,176,32
 maaa 160,180,36
 s_waitcnt lgkmcnt(3)
 maaa 164,188,36
 rta 200,5,200
 maaa 164,184,32
 rta 202,5,456
 maaa 132,184,24
 rta 204,5,712
 maaa 132,188,28
 rta 206,5,968
 maaa 100,188,20
 maaa 100,184,16
 mvaa 228,184,8
 mvaa 228,188,12
 mvaa 196,188,4
 mvaa 196,184,0
 s_waitcnt lgkmcnt(3)
 mvaa 200,192,0
 s_waitcnt vmcnt(28) lgkmcnt(0)
 s_barrier
 mvaa 200,196,4
 rta 176,5,16896
 mvaa 232,196,12
 rta 178,5,17152
 mvaa 232,192,8
 s_add_u32 m0, s92, 0
 rta 180,5,17408
 maaa 104,192,16
 s_add_u32 s86, s83, 3145984
 s_and_b32 s86, s86, 0x3fffff
 rta 182,5,17664
 maaa 104,196,20
 buffer_load_dwordx4 v6, s[48:51], s86 offen lds
 maaa 136,196,28
 s_add_u32 m0, s92, 1056
 s_add_u32 s86, s86, 8192
 maaa 136,192,24
 buffer_load_dwordx4 v6, s[48:51], s86 offen lds
 maaa 168,192,32
 maaa 168,196,36
 maaa 172,204,36
 rta 184,5,16904
 maaa 172,200,32
 rta 186,5,17160
 maaa 140,200,24
 rta 188,5,17416
 maaa 140,204,28
 rta 190,5,17672
 maaa 108,204,20
 s_add_u32 m0, s92, 2112
 s_add_u32 s86, s86, 8192
 maaa 108,200,16
 buffer_load_dwordx4 v6, s[48:51], s86 offen lds
 mvaa 236,200,8
 s_add_u32 m0, s92, 3168
 s_add_u32 s86, s86, 8192
 mvaa 236,204,12
 buffer_load_dwordx4 v6, s[48:51], s86 offen lds
 mvaa 204,204,4
 mvaa 204,200,0
 s_waitcnt lgkmcnt(3)
 mvaa 16,176,0
 rta 192,5,16960
 mvaa 16,180,4
 rta 194,5,17216
 mvaa 48,180,12
 rta 196,5,17472
 mvaa 48,176,8
 s_waitcnt vmcnt(22)
 rta 198,5,17728
 mvaa 80,176,16
 s_add_u32 m0, s92, 67584
 s_xor_b32 s93, s39, 0
 ds_read_b128 a[40:43], v9 offset:38912
 mvaa 80,180,20
 buffer_load_dwordx4 v1, s[52:55], s93 offen offset:0 nt lds
 mvaa 112,180,28
 s_add_u32 m0, s92, 67616
 ds_read_b128 a[44:47], v10 offset:38912
 mvaa 112,176,24
 buffer_load_dwordx4 v1, s[52:55], s93 offen offset:1024 nt lds
 mvaa 144,176,32
 s_add_u32 m0, s92, 67648
 ds_read_b128 a[48:51], v9 offset:40960
 mvaa 144,180,36
 s_waitcnt lgkmcnt(6)
 buffer_load_dwordx4 v1, s[52:55], s93 offen offset:2048 nt lds
 mvaa 148,188,36
 rta 200,5,16968
 mvaa 148,184,32
 rta 202,5,17224
 mvaa 116,184,24
 rta 204,5,17480
 mvaa 116,188,28
 rta 206,5,17736
 mvaa 84,188,20
 s_add_u32 m0, s92, 67680
 ds_read_b128 a[52:55], v10 offset:40960
 mvaa 84,184,16
 buffer_load_dwordx4 v1, s[52:55], s93 offen offset:3072 nt lds
 mvaa 52,184,8
 ds_read_b128 a[56:59], v9 offset:43008
 mvaa 52,188,12
 mvaa 20,188,4
 ds_read_b128 a[60:63], v10 offset:43008
 mvaa 20,184,0
 s_waitcnt lgkmcnt(6)
 mvaa 24,192,0
 rta 176,5,17024
 mvaa 24,196,4
 rta 178,5,17280
 mvaa 56,196,12
 rta 180,5,17536
 mvaa 56,192,8
 rta 182,5,17792
 mvaa 88,192,16
 ds_read_b128 a[64:67], v9 offset:45056
 mvaa 88,196,20
 mvaa 120,196,28
 ds_read_b128 a[68:71], v10 offset:45056
 mvaa 120,192,24
 mvaa 152,192,32
 ds_read_b128 a[72:75], v9 offset:47104
 mvaa 152,196,36
 s_waitcnt lgkmcnt(6)
 mvaa 156,204,36
 rta 184,5,17032
 mvaa 156,200,32
 rta 186,5,17288
 mvaa 124,200,24
 rta 188,5,17544
 mvaa 124,204,28
 rta 190,5,17800
 mvaa 92,204,20
 ds_read_b128 a[76:79], v10 offset:47104
 mvaa 92,200,16
 mvaa 60,200,8
 mvaa 60,204,12
 mvaa 28,204,4
 mvaa 28,200,0
 s_waitcnt lgkmcnt(4)
 mvaa 32,176,0
 rta 192,5,17088
 mvaa 32,180,4
 rta 194,5,17344
 mvaa 64,180,12
 rta 196,5,17600
 mvaa 64,176,8
 rta 198,5,17856
 mvaa 96,176,16
 mvaa 96,180,20
 mvaa 128,180,28
 mvaa 128,176,24
 mvaa 160,176,32
 mvaa 160,180,36
 s_waitcnt lgkmcnt(3)
 mvaa 164,188,36
 rta 200,5,17096
 mvaa 164,184,32
 rta 202,5,17352
 mvaa 132,184,24
 rta 204,5,17608
 mvaa 132,188,28
 rta 206,5,17864
 mvaa 100,188,20
 mvaa 100,184,16
 mvaa 68,184,8
 mvaa 68,188,12
 mvaa 36,188,4
 mvaa 36,184,0
 s_waitcnt lgkmcnt(3)
 mvaa 40,192,0
 s_waitcnt vmcnt(22) lgkmcnt(0)
 s_barrier
 mvaa 40,196,4
 rta 176,5,33792
 mvaa 72,196,12
 rta 178,5,34048
 mvaa 72,192,8
 s_add_u32 m0, s92, 16896
 rta 180,5,34304
 mvaa 104,192,16
 s_add_u32 s86, s83, 3670272
 s_and_b32 s86, s86, 0x3fffff
 rta 182,5,34560
 mvaa 104,196,20
 buffer_load_dwordx4 v6, s[48:51], s86 offen lds
 mvaa 136,196,28
 s_add_u32 m0, s92, 17952
 s_add_u32 s86, s86, 8192
 mvaa 136,192,24
 buffer_load_dwordx4 v6, s[48:51], s86 offen lds
 mvaa 168,192,32
 mvaa 168,196,36
 mvaa 172,204,36
 rta 184,5,33800
 mvaa 172,200,32
 rta 186,5,34056
 mvaa 140,200,24
 rta 188,5,34312
 mvaa 140,204,28
 rta 190,5,34568
 mvaa 108,204,20
 s_add_u32 m0, s92, 19008
 s_add_u32 s86, s86, 8192
 mvaa 108,200,16
 buffer_load_dwordx4 v6, s[48:51], s86 offen lds
 mvaa 76,200,8
 s_add_u32 m0, s92, 20064
 s_add_u32 s86, s86, 8192
 mvaa 76,204,12
 buffer_load_dwordx4 v6, s[48:51], s86 offen lds
 mvaa 44,204,4
 mvaa 44,200,0
 s_waitcnt lgkmcnt(3)
 mvaa 176,176,40
 rta 192,5,33856
 mvaa 176,180,44
 rta 194,5,34112
 mvaa 208,180,52
 rta 196,5,34368
 mvaa 208,176,48
 rta 198,5,34624
 maaa 80,176,56
 s_add_u32 m0, s80, 38912
 s_add_u32 s81, s82, 896
 s_and_b32 s81, s81, 0x380
 maaa 80,180,60
 buffer_load_dwordx4 v7, s[44:47], s81 offen lds
 maaa 112,180,68
 s_add_u32 m0, s80, 39936
 maaa 112,176,64
 buffer_load_dwordx4 v8, s[44:47], s81 offen lds
 maaa 144,176,72
 s_add_u32 m0, s80, 40960
 s_add_u32 s81, s81, 16384
 maaa 144,180,76
 s_waitcnt lgkmcnt(3)
 buffer_load_dwordx4 v7, s[44:47], s81 offen lds
 maaa 148,188,76
 rta 200,5,33864
 maaa 148,184,72
 rta 202,5,34120
 maaa 116,184,64
 rta 204,5,34376
 maaa 116,188,68
 s_waitcnt vmcnt(15)
 rta 206,5,34632
 maaa 84,188,60
 s_add_u32 m0, s80, 41984
 ds_read_b128 a[0:3], v9 offset:0
 maaa 84,184,56
 buffer_load_dwordx4 v8, s[44:47], s81 offen lds
 mvaa 212,184,48
 s_add_u32 m0, s80, 43008
 s_add_u32 s81, s81, 16384
 ds_read_b128 a[4:7], v10 offset:0
 mvaa 212,188,52
 buffer_load_dwordx4 v7, s[44:47], s81 offen lds
 mvaa 180,188,44
 s_add_u32 m0, s80, 44032
 ds_read_b128 a[8:11], v9 offset:2048
 mvaa 180,184,40
 s_waitcnt lgkmcnt(6)
 buffer_load_dwordx4 v8, s[44:47], s81 offen lds
 mvaa 184,192,40
 rta 176,5,33920
 mvaa 184,196,44
 rta 178,5,34176
 mvaa 216,196,52
 rta 180,5,34432
 mvaa 216,192,48
 rta 182,5,34688
 maaa 88,192,56
 s_add_u32 m0, s80, 45056
 s_add_u32 s81, s81, 16384
 ds_read_b128 a[12:15], v10 offset:2048
 maaa 88,196,60
 buffer_load_dwordx4 v7, s[44:47], s81 offen lds
 maaa 120,196,68
 s_add_u32 m0, s80, 46080
 ds_read_b128 a[16:19], v9 offset:4096
 maaa 120,192,64
 buffer_load_dwordx4 v8, s[44:47], s81 offen lds
 maaa 152,192,72
 s_add_u32 m0, s80, 47104
 s_add_u32 s81, s81, 16384
 ds_read_b128 a[20:23], v10 offset:4096
 maaa 152,196,76
 s_waitcnt lgkmcnt(6)
 buffer_load_dwordx4 v7, s[44:47], s81 offen lds
 maaa 156,204,76
 rta 184,5,33928
 maaa 156,200,72
 rta 186,5,34184
 maaa 124,200,64
 rta 188,5,34440
 maaa 124,204,68
 rta 190,5,34696
 maaa 92,204,60
 s_add_u32 m0, s80, 48128
 ds_read_b128 a[24:27], v9 offset:6144
 maaa 92,200,56
 buffer_load_dwordx4 v8, s[44:47], s81 offen lds
 mvaa 220,200,48
 ds_read_b128 a[28:31], v10 offset:6144
 mvaa 220,204,52
 mvaa 188,204,44
 ds_read_b128 a[32:35], v9 offset:8192
 mvaa 188,200,40
 s_waitcnt lgkmcnt(6)
 mvaa 192,176,40
 rta 192,5,33984
 mvaa 192,180,44
 rta 194,5,34240
 mvaa 224,180,52
 rta 196,5,34496
 mvaa 224,176,48
 rta 198,5,34752
 maaa 96,176,56
 ds_read_b128 a[36:39], v10 offset:8192
 maaa 96,180,60
 maaa 128,180,68
 maaa 128,176,64
 maaa 160,176,72
 maaa 160,180,76
 s_waitcnt lgkmcnt(4)
 maaa 164,188,76
 rta 200,5,33992
 maaa 164,184,72
 rta 202,5,34248
 maaa 132,184,64
 rta 204,5,34504
 maaa 132,188,68
 rta 206,5,34760
 maaa 100,188,60
 maaa 100,184,56
 mvaa 228,184,48
 mvaa 228,188,52
 mvaa 196,188,44
 mvaa 196,184,40
 s_waitcnt lgkmcnt(3)
 mvaa 200,192,40
 s_waitcnt lgkmcnt(0)
 s_barrier
 mvaa 200,196,44
 rta 176,5,50688
 mvaa 232,196,52
 rta 178,5,50944
 mvaa 232,192,48
 s_add_u32 m0, s92, 33792
 rta 180,5,51200
 maaa 104,192,56
 s_add_u32 s86, s83, 3145728
 s_and_b32 s86, s86, 0x3fffff
 rta 182,5,51456
 maaa 104,196,60
 buffer_load_dwordx4 v6, s[48:51], s86 offen lds
 maaa 136,196,68
 s_add_u32 m0, s92, 34848
 s_add_u32 s86, s86, 8192
 maaa 136,192,64
 buffer_load_dwordx4 v6, s[48:51], s86 offen lds
 maaa 168,192,72
 maaa 168,196,76
 maaa 172,204,76
 rta 184,5,50696
 maaa 172,200,72
 rta 186,5,50952
 maaa 140,200,64
 rta 188,5,51208
 maaa 140,204,68
 rta 190,5,51464
 maaa 108,204,60
 s_add_u32 m0, s92, 35904
 s_add_u32 s86, s86, 8192
 maaa 108,200,56
 buffer_load_dwordx4 v6, s[48:51], s86 offen lds
 mvaa 236,200,48
 s_add_u32 m0, s92, 36960
 s_add_u32 s86, s86, 8192
 mvaa 236,204,52
 buffer_load_dwordx4 v6, s[48:51], s86 offen lds
 mvaa 204,204,44
 mvaa 204,200,40
 s_waitcnt lgkmcnt(3)
 mvaa 16,176,40
 rta 192,5,50752
 mvaa 16,180,44
 rta 194,5,51008
 mvaa 48,180,52
 rta 196,5,51264
 mvaa 48,176,48
 rta 198,5,51520
 mvaa 80,176,56
 s_add_u32 m0, s92, 84480
 s_xor_b32 s93, s39, 0
 mvaa 80,180,60
 buffer_load_dwordx4 v1, s[56:59], s93 offen offset:0 nt lds
 mvaa 112,180,68
 s_add_u32 m0, s92, 84512
 mvaa 112,176,64
 buffer_load_dwordx4 v1, s[56:59], s93 offen offset:1024 nt lds
 mvaa 144,176,72
 s_add_u32 m0, s92, 84544
 mvaa 144,180,76
 s_waitcnt lgkmcnt(3)
 buffer_load_dwordx4 v1, s[56:59], s93 offen offset:2048 nt lds
 mvaa 148,188,76
 rta 200,5,50760
 mvaa 148,184,72
 rta 202,5,51016
 mvaa 116,184,64
 rta 204,5,51272
 mvaa 116,188,68
 rta 206,5,51528
 mvaa 84,188,60
 s_add_u32 m0, s92, 84576
 mvaa 84,184,56
 buffer_load_dwordx4 v1, s[56:59], s93 offen offset:3072 nt lds
 mvaa 52,184,48
 s_add_u32 m0, s92, 101376
 s_xor_b32 s93, s39, 16384
 mvaa 52,188,52
 buffer_load_dwordx4 v1, s[52:55], s93 offen offset:0 nt lds
 mvaa 20,188,44
 s_add_u32 m0, s92, 101408
 mvaa 20,184,40
 s_waitcnt lgkmcnt(3)
 buffer_load_dwordx4 v1, s[52:55], s93 offen offset:1024 nt lds
 mvaa 24,192,40
 rta 176,5,50816
 mvaa 24,196,44
 rta 178,5,51072
 mvaa 56,196,52
 rta 180,5,51328
 mvaa 56,192,48
 rta 182,5,51584
 mvaa 88,192,56
 s_add_u32 m0, s92, 101440
 mvaa 88,196,60
 buffer_load_dwordx4 v1, s[52:55], s93 offen offset:2048 nt lds
 mvaa 120,196,68
 s_add_u32 m0, s92, 101472
 mvaa 120,192,64
 buffer_load_dwordx4 v1, s[52:55], s93 offen offset:3072 nt lds
 mvaa 152,192,72
 mvaa 152,196,76
 s_waitcnt lgkmcnt(3)
 mvaa 156,204,76
 rta 184,5,50824
 mvaa 156,200,72
 rta 186,5,51080
 mvaa 124,200,64
 rta 188,5,51336
 mvaa 124,204,68
 rta 190,5,51592
 mvaa 92,204,60
 mvaa 92,200,56
 mvaa 60,200,48
 mvaa 60,204,52
 mvaa 28,204,44
 mvaa 28,200,40
 s_waitcnt lgkmcnt(3)
 mvaa 32,176,40
 rta 192,5,50880
 mvaa 32,180,44
 rta 194,5,51136
 mvaa 64,180,52
 rta 196,5,51392
 mvaa 64,176,48
 rta 198,5,51648
 mvaa 96,176,56
 mvaa 96,180,60
 mvaa 128,180,68
 mvaa 128,176,64
 mvaa 160,176,72
 mvaa 160,180,76
 s_waitcnt lgkmcnt(3)
 mvaa 164,188,76
 rta 200,5,50888
 mvaa 164,184,72
 rta 202,5,51144
 mvaa 132,184,64
 rta 204,5,51400
 mvaa 132,188,68
 rta 206,5,51656
 mvaa 100,188,60
 mvaa 100,184,56
 mvaa 68,184,48
 mvaa 68,188,52
 mvaa 36,188,44
 mvaa 36,184,40
 s_waitcnt lgkmcnt(3)
 mvaa 40,192,40
 s_waitcnt vmcnt(30) lgkmcnt(0)
 s_barrier
 mvaa 40,196,44
 rta 176,5,0
 mvaa 72,196,52
 rta 178,5,256
 mvaa 72,192,48
 s_add_u32 m0, s92, 50688
 rta 180,5,512
 mvaa 104,192,56
 s_add_u32 s86, s83, 3670016
 s_and_b32 s86, s86, 0x3fffff
 rta 182,5,768
 mvaa 104,196,60
 buffer_load_dwordx4 v6, s[48:51], s86 offen lds
 mvaa 136,196,68
 s_add_u32 m0, s92, 51744
 s_add_u32 s86, s86, 8192
 mvaa 136,192,64
 buffer_load_dwordx4 v6, s[48:51], s86 offen lds
 mvaa 168,192,72
 mvaa 168,196,76
 mvaa 172,204,76
 rta 184,5,8
 mvaa 172,200,72
 rta 186,5,264
 mvaa 140,200,64
 rta 188,5,520
 mvaa 140,204,68
 rta 190,5,776
 mvaa 108,204,60
 s_add_u32 m0, s92, 52800
 s_add_u32 s86, s86, 8192
 mvaa 108,200,56
 buffer_load_dwordx4 v6, s[48:51], s86 offen lds
 mvaa 76,200,48
 s_add_u32 m0, s92, 53856
 s_add_u32 s86, s86, 8192
 mvaa 76,204,52
 buffer_load_dwordx4 v6, s[48:51], s86 offen lds
 mvaa 44,204,44
 mvaa 44,200,40
 s_waitcnt lgkmcnt(3)
 mvaa 176,176,0
 rta 192,5,64
 mvaa 176,180,4
 rta 194,5,320
 mvaa 208,180,12
 s_and_b32 s3, s2, 0xf8
 s_lshl_b32 s3, s3, 6
 rta 196,5,576
 mvaa 208,176,8
 s_waitcnt vmcnt(16)
 s_lshl_b32 s4, s42, 7
 rta 198,5,832
 maaa 80,176,16
 s_add_u32 s3, s3, s4
 ds_read_b128 a[40:43], v9 offset:38912
 v_and_b32 v244, 60, v0
 maaa 80,180,20
 v_lshl_add_u32 v244, v244, 12, s3
 v_min_u32 v246, L14_hot_end-L_pc0-4, v244
 maaa 112,180,28
 ds_read_b128 a[44:47], v10 offset:38912
 v_mov_b32 v247, s95
 maaa 112,176,24
 v_add_co_u32 v246, vcc, s94, v246
 s_nop 1
 v_addc_co_u32 v247, vcc, 0, v247, vcc
 maaa 144,176,32
 ds_read_b128 a[48:51], v9 offset:40960
 maaa 144,180,36
 s_waitcnt lgkmcnt(6)
 global_load_dword v13, v[246:247], off
 maaa 148,188,36
 rta 200,5,72
 maaa 148,184,32
 rta 202,5,328
 maaa 116,184,24
 rta 204,5,584
 maaa 116,188,28
 rta 206,5,840
 maaa 84,188,20
 ds_read_b128 a[52:55], v10 offset:40960
 maaa 84,184,16
 mvaa 212,184,8
 ds_read_b128 a[56:59], v9 offset:43008
 mvaa 212,188,12
 mvaa 180,188,4
 ds_read_b128 a[60:63], v10 offset:43008
 mvaa 180,184,0
 s_waitcnt lgkmcnt(6)
 mvaa 184,192,0
 rta 176,5,128
 mvaa 184,196,4
 rta 178,5,384
 mvaa 216,196,12
 rta 180,5,640
 mvaa 216,192,8
 rta 182,5,896
 maaa 88,192,16
 ds_read_b128 a[64:67], v9 offset:45056
 maaa 88,196,20
 maaa 120,196,28
 ds_read_b128 a[68:71], v10 offset:45056
 maaa 120,192,24
 maaa 152,192,32
 ds_read_b128 a[72:75], v9 offset:47104
 maaa 152,196,36
 s_waitcnt lgkmcnt(6)
 maaa 156,204,36
 rta 184,5,136
 maaa 156,200,32
 rta 186,5,392
 maaa 124,200,24
 rta 188,5,648
 maaa 124,204,28
 rta 190,5,904
 maaa 92,204,20
 ds_read_b128 a[76:79], v10 offset:47104
 maaa 92,200,16
 mvaa 220,200,8
 mvaa 220,204,12
 mvaa 188,204,4
 mvaa 188,200,0
 s_waitcnt lgkmcnt(4)
 mvaa 192,176,0
 rta 192,5,192
 mvaa 192,180,4
 rta 194,5,448
 mvaa 224,180,12
 rta 196,5,704
 mvaa 224,176,8
 rta 198,5,960
 maaa 96,176,16
 maaa 96,180,20
 maaa 128,180,28
 maaa 128,176,24
 maaa 160,176,32
 maaa 160,180,36
 s_waitcnt lgkmcnt(3)
 maaa 164,188,36
 rta 200,5,200
 maaa 164,184,32
 rta 202,5,456
 maaa 132,184,24
 rta 204,5,712
 maaa 132,188,28
 rta 206,5,968
 maaa 100,188,20
 maaa 100,184,16
 mvaa 228,184,8
 mvaa 228,188,12
 mvaa 196,188,4
 mvaa 196,184,0
 s_waitcnt lgkmcnt(3)
 mvaa 200,192,0
 s_waitcnt lgkmcnt(0)
 s_barrier
 mvaa 200,196,4
 rta 176,5,16896
 mvaa 232,196,12
 rta 178,5,17152
 mvaa 232,192,8
 rta 180,5,17408
 maaa 104,192,16
 s_add_u32 m0, s92, 0
 s_xor_b32 s93, s39, 32768
 rta 182,5,17664
 maaa 104,196,20
 buffer_load_dwordx4 v1, s[52:55], s93 offen offset:0 nt lds
 maaa 136,196,28
 s_add_u32 m0, s92, 32
 maaa 136,192,24
 buffer_load_dwordx4 v1, s[52:55], s93 offen offset:1024 nt lds
 maaa 168,192,32
 maaa 168,196,36
 maaa 172,204,36
 rta 184,5,16904
 maaa 172,200,32
 rta 186,5,17160
 maaa 140,200,24
 rta 188,5,17416
 maaa 140,204,28
 rta 190,5,17672
 maaa 108,204,20
 s_add_u32 m0, s92, 64
 maaa 108,200,16
 buffer_load_dwordx4 v1, s[52:55], s93 offen offset:2048 nt lds
 mvaa 236,200,8
 s_add_u32 m0, s92, 96
 mvaa 236,204,12
 buffer_load_dwordx4 v1, s[52:55], s93 offen offset:3072 nt lds
 mvaa 204,204,4
 mvaa 204,200,0
 s_waitcnt lgkmcnt(3)
 mvaa 176,176,40
 rta 192,5,16960
 mvaa 176,180,44
 rta 194,5,17216
 mvaa 208,180,52
 rta 196,5,17472
 mvaa 208,176,48
 rta 198,5,17728
 maaa 80,176,56
 s_add_u32 m0, s92, 118272
 s_xor_b32 s93, s39, 16384
 maaa 80,180,60
 buffer_load_dwordx4 v1, s[56:59], s93 offen offset:0 nt lds
 maaa 112,180,68
 s_add_u32 m0, s92, 118304
 maaa 112,176,64
 buffer_load_dwordx4 v1, s[56:59], s93 offen offset:1024 nt lds
 maaa 144,176,72
 s_add_u32 m0, s92, 118336
 maaa 144,180,76
 s_waitcnt lgkmcnt(3)
 buffer_load_dwordx4 v1, s[56:59], s93 offen offset:2048 nt lds
 maaa 148,188,76
 rta 200,5,16968
 maaa 148,184,72
 rta 202,5,17224
 maaa 116,184,64
 rta 204,5,17480
 maaa 116,188,68
 rta 206,5,17736
 maaa 84,188,60
 s_add_u32 m0, s92, 118368
 maaa 84,184,56
 buffer_load_dwordx4 v1, s[56:59], s93 offen offset:3072 nt lds
 mvaa 212,184,48
 mvaa 212,188,52
 mvaa 180,188,44
 mvaa 180,184,40
 s_waitcnt lgkmcnt(3)
 mvaa 184,192,40
 rta 176,5,17024
 mvaa 184,196,44
 rta 178,5,17280
 mvaa 216,196,52
 s_mul_i32 s3, s42, 7168
 s_add_u32 s3, s3, 135168
 rta 180,5,17536
 mvaa 216,192,48
 rta 182,5,17792
 v_add_u32 v14, s3, v2
 maaa 88,192,56
 v_mul_f32 v208, s88, v208
 v_mul_f32 v209, s88, v209
 maaa 88,196,60
 v_mul_f32 v210, s88, v210
 v_mul_f32 v211, s88, v211
 maaa 120,196,68
 v_mul_f32 v212, s88, v212
 v_mul_f32 v213, s88, v213
 maaa 120,192,64
 v_mul_f32 v214, s88, v214
 v_mul_f32 v215, s88, v215
 maaa 152,192,72
 pk 208,208
 pk 209,210
 maaa 152,196,76
 s_waitcnt lgkmcnt(3)
 pk 210,212
 pk 211,214
 maaa 156,204,76
 rta 184,5,17032
 maaa 156,200,72
 rta 186,5,17288
 maaa 124,200,64
 rta 188,5,17544
 maaa 124,204,68
 rta 190,5,17800
 maaa 92,204,60
 ds_write_b128 v14, v[208:211] offset:0
 v_mul_f32 v176, s88, v176
 maaa 92,200,56
 v_mul_f32 v177, s88, v177
 v_mul_f32 v178, s88, v178
 mvaa 220,200,48
 v_mul_f32 v179, s88, v179
 v_mul_f32 v180, s88, v180
 mvaa 220,204,52
 v_mul_f32 v181, s88, v181
 v_mul_f32 v182, s88, v182
 mvaa 188,204,44
 v_mul_f32 v183, s88, v183
 pk 176,176
 mvaa 188,200,40
 s_waitcnt lgkmcnt(4)
 pk 177,178
 pk 178,180
 mvaa 192,176,40
 rta 192,5,17088
 pk 179,182
 mvaa 192,180,44
 rta 194,5,17344
 mvaa 224,180,52
 rta 196,5,17600
 mvaa 224,176,48
 rta 198,5,17856
 maaa 96,176,56
 ds_write_b128 v14, v[176:179] offset:4096
 maaa 96,180,60
 v_mul_f32 v216, s88, v216
 v_mul_f32 v217, s88, v217
 maaa 128,180,68
 v_mul_f32 v218, s88, v218
 v_mul_f32 v219, s88, v219
 maaa 128,176,64
 v_mul_f32 v220, s88, v220
 v_mul_f32 v221, s88, v221
 maaa 160,176,72
 v_mul_f32 v222, s88, v222
 v_mul_f32 v223, s88, v223
 maaa 160,180,76
 s_waitcnt lgkmcnt(4)
 pk 216,216
 pk 217,218
 maaa 164,188,76
 rta 200,5,17096
 pk 218,220
 maaa 164,184,72
 rta 202,5,17352
 pk 219,222
 maaa 132,184,64
 rta 204,5,17608
 maaa 132,188,68
 rta 206,5,17864
 maaa 100,188,60
 ds_write_b128 v14, v[216:219] offset:1024
 v_mul_f32 v184, s88, v184
 maaa 100,184,56
 v_mul_f32 v185, s88, v185
 v_mul_f32 v186, s88, v186
 mvaa 228,184,48
 v_mul_f32 v187, s88, v187
 v_mul_f32 v188, s88, v188
 mvaa 228,188,52
 v_mul_f32 v189, s88, v189
 v_mul_f32 v190, s88, v190
 mvaa 196,188,44
 v_mul_f32 v191, s88, v191
 pk 240,184
 mvaa 196,184,40
 s_waitcnt lgkmcnt(4)
 pk 241,186
 pk 242,188
 mvaa 200,192,40
 s_waitcnt vmcnt(21) lgkmcnt(0)
 s_barrier
 mvaa 200,196,44
 rta 176,5,33792
 pk 243,190
 mvaa 232,196,52
 rta 178,5,34048
 v_mul_f32 v224, s88, v224
 mvaa 232,192,48
 rta 180,5,34304
 v_mul_f32 v225, s88, v225
 maaa 104,192,56
 s_add_u32 m0, s92, 16896
 s_xor_b32 s93, s39, 32768
 rta 182,5,34560
 maaa 104,196,60
 buffer_load_dwordx4 v1, s[56:59], s93 offen offset:0 nt lds
 v_mul_f32 v226, s88, v226
 maaa 136,196,68
 s_add_u32 m0, s92, 16928
 v_mul_f32 v227, s88, v227
 v_mul_f32 v228, s88, v228
 maaa 136,192,64
 buffer_load_dwordx4 v1, s[56:59], s93 offen offset:1024 nt lds
 v_mul_f32 v229, s88, v229
 maaa 168,192,72
 v_mul_f32 v230, s88, v230
 v_mul_f32 v231, s88, v231
 maaa 168,196,76
 pk 224,224
 pk 225,226
 maaa 172,204,76
 rta 184,5,33800
 pk 226,228
 maaa 172,200,72
 rta 186,5,34056
 pk 227,230
 maaa 140,200,64
 rta 188,5,34312
 maaa 140,204,68
 rta 190,5,34568
 maaa 108,204,60
 s_add_u32 m0, s92, 16960
 ds_write_b128 v14, v[224:227] offset:2048
 v_mul_f32 v192, s88, v192
 maaa 108,200,56
 buffer_load_dwordx4 v1, s[56:59], s93 offen offset:2048 nt lds
 v_mul_f32 v193, s88, v193
 mvaa 236,200,48
 s_add_u32 m0, s92, 16992
 v_mul_f32 v194, s88, v194
 v_mul_f32 v195, s88, v195
 mvaa 236,204,52
 buffer_load_dwordx4 v1, s[56:59], s93 offen offset:3072 nt lds
 v_mul_f32 v196, s88, v196
 mvaa 204,204,44
 v_mul_f32 v197, s88, v197
 v_mul_f32 v198, s88, v198
 mvaa 204,200,40
 s_waitcnt lgkmcnt(4)
 v_mul_f32 v199, s88, v199
 pk 244,192
 mvaa 16,176,0
 rta 192,5,33856
 pk 245,194
 mvaa 16,180,4
 rta 194,5,34112
 pk 246,196
 mvaa 48,180,12
 rta 196,5,34368
 pk 247,198
 mvaa 48,176,8
 rta 198,5,34624
 v_mul_f32 v232, s88, v232
 mvaa 80,176,16
 v_mul_f32 v233, s88, v233
 v_mul_f32 v234, s88, v234
 mvaa 80,180,20
 v_mul_f32 v235, s88, v235
 v_mul_f32 v236, s88, v236
 mvaa 112,180,28
 v_mul_f32 v237, s88, v237
 v_mul_f32 v238, s88, v238
 mvaa 112,176,24
 v_mul_f32 v239, s88, v239
 pk 232,232
 mvaa 144,176,32
 pk 233,234
 pk 234,236
 mvaa 144,180,36
 s_waitcnt lgkmcnt(3)
 pk 235,238
 mvaa 148,188,36
 rta 200,5,33864
 mvaa 148,184,32
 rta 202,5,34120
 mvaa 116,184,24
 rta 204,5,34376
 mvaa 116,188,28
 rta 206,5,34632
 mvaa 84,188,20
 ds_write_b128 v14, v[232:235] offset:3072
 v_mul_f32 v200, s88, v200
 mvaa 84,184,16
 v_mul_f32 v201, s88, v201
 v_mul_f32 v202, s88, v202
 mvaa 52,184,8
 v_mul_f32 v203, s88, v203
 v_mul_f32 v204, s88, v204
 mvaa 52,188,12
 v_mul_f32 v205, s88, v205
 v_mul_f32 v206, s88, v206
 mvaa 20,188,4
 v_mul_f32 v207, s88, v207
 pk 248,200
 mvaa 20,184,0
 s_waitcnt lgkmcnt(4)
 pk 249,202
 pk 250,204
 mvaa 24,192,0
 rta 176,5,33920
 pk 251,206
 mvaa 24,196,4
 rta 178,5,34176
 v_accvgpr_read_b32 v192, a80
 mvaa 56,196,12
 rta 180,5,34432
 v_accvgpr_read_b32 v193, a81
 mvaa 56,192,8
 rta 182,5,34688
 v_accvgpr_read_b32 v194, a82
 mvaa 88,192,16
 v_accvgpr_read_b32 v195, a83
 v_accvgpr_read_b32 v196, a84
 mvaa 88,196,20
 v_accvgpr_read_b32 v197, a85
 v_accvgpr_read_b32 v198, a86
 mvaa 120,196,28
 v_accvgpr_read_b32 v199, a87
 v_mul_f32 v192, s88, v192
 mvaa 120,192,24
 v_mul_f32 v193, s88, v193
 v_mul_f32 v194, s88, v194
 mvaa 152,192,32
 v_mul_f32 v195, s88, v195
 v_mul_f32 v196, s88, v196
 mvaa 152,196,36
 s_waitcnt lgkmcnt(3)
 v_mul_f32 v197, s88, v197
 v_mul_f32 v198, s88, v198
 mvaa 156,204,36
 rta 184,5,33928
 v_mul_f32 v199, s88, v199
 mvaa 156,200,32
 rta 186,5,34184
 pk 228,192
 mvaa 124,200,24
 rta 188,5,34440
 pk 229,194
 mvaa 124,204,28
 rta 190,5,34696
 pk 230,196
 mvaa 92,204,20
 pk 231,198
 v_accvgpr_read_b32 v200, a88
 mvaa 92,200,16
 v_accvgpr_read_b32 v201, a89
 v_accvgpr_read_b32 v202, a90
 mvaa 60,200,8
 v_accvgpr_read_b32 v203, a91
 v_accvgpr_read_b32 v204, a92
 mvaa 60,204,12
 v_accvgpr_read_b32 v205, a93
 v_accvgpr_read_b32 v206, a94
 mvaa 28,204,4
 v_accvgpr_read_b32 v207, a95
 v_mul_f32 v200, s88, v200
 mvaa 28,200,0
 s_waitcnt lgkmcnt(3)
 v_mul_f32 v201, s88, v201
 v_mul_f32 v202, s88, v202
 mvaa 32,176,0
 rta 192,5,33984
 v_mul_f32 v203, s88, v203
 mvaa 32,180,4
 rta 194,5,34240
 v_mul_f32 v204, s88, v204
 mvaa 64,180,12
 rta 196,5,34496
 v_mul_f32 v205, s88, v205
 mvaa 64,176,8
 rta 198,5,34752
 v_mul_f32 v206, s88, v206
 mvaa 96,176,16
 v_mul_f32 v207, s88, v207
 pk 232,200
 mvaa 96,180,20
 pk 233,202
 pk 234,204
 mvaa 128,180,28
 pk 235,206
 v_accvgpr_read_b32 v176, a96
 mvaa 128,176,24
 v_accvgpr_read_b32 v177, a97
 v_accvgpr_read_b32 v178, a98
 mvaa 160,176,32
 v_accvgpr_read_b32 v179, a99
 v_accvgpr_read_b32 v180, a100
 mvaa 160,180,36
 s_waitcnt lgkmcnt(3)
 v_accvgpr_read_b32 v181, a101
 v_accvgpr_read_b32 v182, a102
 mvaa 164,188,36
 rta 200,5,33992
 v_accvgpr_read_b32 v183, a103
 mvaa 164,184,32
 rta 202,5,34248
 v_mul_f32 v176, s88, v176
 mvaa 132,184,24
 rta 204,5,34504
 v_mul_f32 v177, s88, v177
 mvaa 132,188,28
 rta 206,5,34760
 v_mul_f32 v178, s88, v178
 mvaa 100,188,20
 v_mul_f32 v179, s88, v179
 v_mul_f32 v180, s88, v180
 mvaa 100,184,16
 v_mul_f32 v181, s88, v181
 v_mul_f32 v182, s88, v182
 mvaa 68,184,8
 v_mul_f32 v183, s88, v183
 pk 236,176
 mvaa 68,188,12
 pk 237,178
 pk 238,180
 mvaa 36,188,4
 pk 239,182
 v_accvgpr_read_b32 v184, a104
 mvaa 36,184,0
 s_waitcnt lgkmcnt(3)
 v_accvgpr_read_b32 v185, a105
 v_accvgpr_read_b32 v186, a106
 mvaa 40,192,0
 s_waitcnt vmcnt(13) lgkmcnt(0)
 s_barrier
 mvaa 40,196,4
 rta 176,5,50688
 v_accvgpr_read_b32 v187, a107
 mvaa 72,196,12
 rta 178,5,50944
 v_accvgpr_read_b32 v188, a108
 mvaa 72,192,8
 rta 180,5,51200
 v_accvgpr_read_b32 v189, a109
 mvaa 104,192,16
 s_add_u32 m0, s92, 33792
 s_xor_b32 s93, s39, 49152
 rta 182,5,51456
 mvaa 104,196,20
 buffer_load_dwordx4 v1, s[52:55], s93 offen offset:0 nt lds
 v_accvgpr_read_b32 v190, a110
 mvaa 136,196,28
 s_add_u32 m0, s92, 33824
 v_accvgpr_read_b32 v191, a111
 v_mul_f32 v184, s88, v184
 mvaa 136,192,24
 buffer_load_dwordx4 v1, s[52:55], s93 offen offset:1024 nt lds
 v_mul_f32 v185, s88, v185
 mvaa 168,192,32
 v_mul_f32 v186, s88, v186
 v_mul_f32 v187, s88, v187
 mvaa 168,196,36
 v_mul_f32 v188, s88, v188
 v_mul_f32 v189, s88, v189
 mvaa 172,204,36
 rta 184,5,50696
 v_mul_f32 v190, s88, v190
 mvaa 172,200,32
 rta 186,5,50952
 v_mul_f32 v191, s88, v191
 mvaa 140,200,24
 rta 188,5,51208
 pk 184,184
 mvaa 140,204,28
 rta 190,5,51464
 pk 185,186
 mvaa 108,204,20
 s_add_u32 m0, s92, 33856
 pk 186,188
 pk 187,190
 mvaa 108,200,16
 buffer_load_dwordx4 v1, s[52:55], s93 offen offset:2048 nt lds
 v_accvgpr_write_b32 a220, v184
 mvaa 76,200,8
 s_add_u32 m0, s92, 33888
 v_accvgpr_write_b32 a221, v185
 v_accvgpr_write_b32 a222, v186
 mvaa 76,204,12
 buffer_load_dwordx4 v1, s[52:55], s93 offen offset:3072 nt lds
 v_accvgpr_write_b32 a223, v187
 mvaa 44,204,4
 v_accvgpr_read_b32 v192, a112
 v_accvgpr_read_b32 v193, a113
 mvaa 44,200,0
 s_waitcnt lgkmcnt(3)
 v_accvgpr_read_b32 v194, a114
 v_accvgpr_read_b32 v195, a115
 mvaa 16,176,40
 rta 192,5,50752
 v_accvgpr_read_b32 v196, a116
 mvaa 16,180,44
 rta 194,5,51008
 v_accvgpr_read_b32 v197, a117
 mvaa 48,180,52
 rta 196,5,51264
 v_accvgpr_read_b32 v198, a118
 mvaa 48,176,48
 rta 198,5,51520
 v_accvgpr_read_b32 v199, a119
 mvaa 80,176,56
 v_mul_f32 v192, s88, v192
 v_mul_f32 v193, s88, v193
 mvaa 80,180,60
 v_mul_f32 v194, s88, v194
 v_mul_f32 v195, s88, v195
 mvaa 112,180,68
 v_mul_f32 v196, s88, v196
 v_mul_f32 v197, s88, v197
 mvaa 112,176,64
 v_mul_f32 v198, s88, v198
 v_mul_f32 v199, s88, v199
 mvaa 144,176,72
 pk 192,192
 pk 193,194
 mvaa 144,180,76
 s_waitcnt lgkmcnt(3)
 pk 194,196
 pk 195,198
 mvaa 148,188,76
 rta 200,5,50760
 v_accvgpr_write_b32 a224, v192
 mvaa 148,184,72
 rta 202,5,51016
 v_accvgpr_write_b32 a225, v193
 mvaa 116,184,64
 rta 204,5,51272
 v_accvgpr_write_b32 a226, v194
 mvaa 116,188,68
 rta 206,5,51528
 v_accvgpr_write_b32 a227, v195
 mvaa 84,188,60
 v_accvgpr_read_b32 v200, a120
 v_accvgpr_read_b32 v201, a121
 mvaa 84,184,56
 v_accvgpr_read_b32 v202, a122
 v_accvgpr_read_b32 v203, a123
 mvaa 52,184,48
 v_accvgpr_read_b32 v204, a124
 v_accvgpr_read_b32 v205, a125
 mvaa 52,188,52
 v_accvgpr_read_b32 v206, a126
 v_accvgpr_read_b32 v207, a127
 mvaa 20,188,44
 v_mul_f32 v200, s88, v200
 v_mul_f32 v201, s88, v201
 mvaa 20,184,40
 s_waitcnt lgkmcnt(3)
 v_mul_f32 v202, s88, v202
 v_mul_f32 v203, s88, v203
 mvaa 24,192,40
 rta 176,5,50816
 v_mul_f32 v204, s88, v204
 mvaa 24,196,44
 rta 178,5,51072
 v_mul_f32 v205, s88, v205
 mvaa 56,196,52
 rta 180,5,51328
 v_mul_f32 v206, s88, v206
 mvaa 56,192,48
 rta 182,5,51584
 v_mul_f32 v207, s88, v207
 mvaa 88,192,56
 pk 200,200
 pk 201,202
 mvaa 88,196,60
 pk 202,204
 pk 203,206
 mvaa 120,196,68
 v_accvgpr_write_b32 a228, v200
 v_accvgpr_write_b32 a229, v201
 mvaa 120,192,64
 v_accvgpr_write_b32 a230, v202
 v_accvgpr_write_b32 a231, v203
 mvaa 152,192,72
 v_accvgpr_read_b32 v176, a128
 v_accvgpr_read_b32 v177, a129
 mvaa 152,196,76
 s_waitcnt lgkmcnt(3)
 v_accvgpr_read_b32 v178, a130
 v_accvgpr_read_b32 v179, a131
 mvaa 156,204,76
 rta 184,5,50824
 v_accvgpr_read_b32 v180, a132
 mvaa 156,200,72
 rta 186,5,51080
 v_accvgpr_read_b32 v181, a133
 mvaa 124,200,64
 rta 188,5,51336
 v_accvgpr_read_b32 v182, a134
 mvaa 124,204,68
 rta 190,5,51592
 v_accvgpr_read_b32 v183, a135
 mvaa 92,204,60
 v_mul_f32 v176, s88, v176
 v_mul_f32 v177, s88, v177
 mvaa 92,200,56
 v_mul_f32 v178, s88, v178
 v_mul_f32 v179, s88, v179
 mvaa 60,200,48
 v_mul_f32 v180, s88, v180
 v_mul_f32 v181, s88, v181
 mvaa 60,204,52
 v_mul_f32 v182, s88, v182
 v_mul_f32 v183, s88, v183
 mvaa 28,204,44
 pk 176,176
 pk 177,178
 mvaa 28,200,40
 s_waitcnt lgkmcnt(3)
 pk 178,180
 pk 179,182
 mvaa 32,176,40
 rta 192,5,50880
 v_accvgpr_write_b32 a232, v176
 mvaa 32,180,44
 rta 194,5,51136
 v_accvgpr_write_b32 a233, v177
 mvaa 64,180,52
 rta 196,5,51392
 v_accvgpr_write_b32 a234, v178
 mvaa 64,176,48
 rta 198,5,51648
 v_accvgpr_write_b32 a235, v179
 mvaa 96,176,56
 v_accvgpr_read_b32 v184, a136
 v_accvgpr_read_b32 v185, a137
 mvaa 96,180,60
 v_accvgpr_read_b32 v186, a138
 v_accvgpr_read_b32 v187, a139
 mvaa 128,180,68
 v_accvgpr_read_b32 v188, a140
 v_accvgpr_read_b32 v189, a141
 mvaa 128,176,64
 v_accvgpr_read_b32 v190, a142
 v_accvgpr_read_b32 v191, a143
 mvaa 160,176,72
 v_mul_f32 v184, s88, v184
 v_mul_f32 v185, s88, v185
 mvaa 160,180,76
 s_waitcnt lgkmcnt(3)
 v_mul_f32 v186, s88, v186
 v_mul_f32 v187, s88, v187
 mvaa 164,188,76
 rta 200,5,50888
 v_mul_f32 v188, s88, v188
 mvaa 164,184,72
 rta 202,5,51144
 v_mul_f32 v189, s88, v189
 mvaa 132,184,64
 rta 204,5,51400
 v_mul_f32 v190, s88, v190
 mvaa 132,188,68
 rta 206,5,51656
 v_mul_f32 v191, s88, v191
 mvaa 100,188,60
 pk 184,184
 pk 185,186
 mvaa 100,184,56
 pk 186,188
 pk 187,190
 mvaa 68,184,48
 v_accvgpr_write_b32 a236, v184
 v_accvgpr_write_b32 a237, v185
 mvaa 68,188,52
 v_accvgpr_write_b32 a238, v186
 v_accvgpr_write_b32 a239, v187
 mvaa 36,188,44
 v_accvgpr_read_b32 v192, a144
 v_accvgpr_read_b32 v193, a145
 mvaa 36,184,40
 s_waitcnt lgkmcnt(3)
 v_accvgpr_read_b32 v194, a146
 v_accvgpr_read_b32 v195, a147
 mvaa 40,192,40
 s_waitcnt lgkmcnt(0)
 s_barrier
 mvaa 40,196,44
 v_accvgpr_read_b32 v196, a148
 v_accvgpr_read_b32 v197, a149
 mvaa 72,196,52
 v_accvgpr_read_b32 v198, a150
 v_accvgpr_read_b32 v199, a151
 mvaa 72,192,48
 v_mul_f32 v192, s88, v192
 v_mul_f32 v193, s88, v193
 mvaa 104,192,56
 s_add_u32 m0, s92, 50688
 s_xor_b32 s93, s39, 49152
 v_mul_f32 v194, s88, v194
 mvaa 104,196,60
 buffer_load_dwordx4 v1, s[56:59], s93 offen offset:0 nt lds
 v_mul_f32 v195, s88, v195
 mvaa 136,196,68
 s_add_u32 m0, s92, 50720
 v_mul_f32 v196, s88, v196
 v_mul_f32 v197, s88, v197
 mvaa 136,192,64
 buffer_load_dwordx4 v1, s[56:59], s93 offen offset:1024 nt lds
 v_mul_f32 v198, s88, v198
 mvaa 168,192,72
 v_mul_f32 v199, s88, v199
 pk 192,192
 mvaa 168,196,76
 pk 193,194
 pk 194,196
 mvaa 172,204,76
 pk 195,198
 v_accvgpr_write_b32 a240, v192
 mvaa 172,200,72
 v_accvgpr_write_b32 a241, v193
 v_accvgpr_write_b32 a242, v194
 mvaa 140,200,64
 v_accvgpr_write_b32 a243, v195
 v_accvgpr_read_b32 v200, a152
 mvaa 140,204,68
 v_accvgpr_read_b32 v201, a153
 v_accvgpr_read_b32 v202, a154
 mvaa 108,204,60
 s_add_u32 m0, s92, 50752
 v_accvgpr_read_b32 v203, a155
 v_accvgpr_read_b32 v204, a156
 mvaa 108,200,56
 buffer_load_dwordx4 v1, s[56:59], s93 offen offset:2048 nt lds
 v_accvgpr_read_b32 v205, a157
 mvaa 76,200,48
 s_add_u32 m0, s92, 50784
 v_accvgpr_read_b32 v206, a158
 v_accvgpr_read_b32 v207, a159
 mvaa 76,204,52
 buffer_load_dwordx4 v1, s[56:59], s93 offen offset:3072 nt lds
 v_mul_f32 v200, s88, v200
 mvaa 44,204,44
 v_mul_f32 v201, s88, v201
 v_mul_f32 v202, s88, v202
 mvaa 44,200,40
 v_mul_f32 v203, s88, v203
 v_mul_f32 v204, s88, v204
 v_mul_f32 v205, s88, v205
 v_mul_f32 v206, s88, v206
 v_mul_f32 v207, s88, v207
 pk 200,200
 pk 201,202
 pk 202,204
 pk 203,206
 v_accvgpr_write_b32 a244, v200
 v_accvgpr_write_b32 a245, v201
 v_accvgpr_write_b32 a246, v202
 v_accvgpr_write_b32 a247, v203
 v_accvgpr_read_b32 v176, a160
 v_accvgpr_read_b32 v177, a161
 v_accvgpr_read_b32 v178, a162
 v_accvgpr_read_b32 v179, a163
 v_accvgpr_read_b32 v180, a164
 v_accvgpr_read_b32 v181, a165
 v_accvgpr_read_b32 v182, a166
 v_accvgpr_read_b32 v183, a167
 v_pk_mul_f32 v[176:177], v[176:177], s[88:89]
 v_pk_mul_f32 v[178:179], v[178:179], s[88:89]
 v_pk_mul_f32 v[180:181], v[180:181], s[88:89]
 v_pk_mul_f32 v[182:183], v[182:183], s[88:89]
 pk 176,176
 pk 177,178
 pk 178,180
 pk 179,182
 v_accvgpr_write_b32 a248, v176
 v_accvgpr_write_b32 a249, v177
 v_accvgpr_write_b32 a250, v178
 v_accvgpr_write_b32 a251, v179
 v_accvgpr_read_b32 v184, a168
 v_accvgpr_read_b32 v185, a169
 v_accvgpr_read_b32 v186, a170
 v_accvgpr_read_b32 v187, a171
 v_accvgpr_read_b32 v188, a172
 v_accvgpr_read_b32 v189, a173
 v_accvgpr_read_b32 v190, a174
 v_accvgpr_read_b32 v191, a175
 v_pk_mul_f32 v[184:185], v[184:185], s[88:89]
 v_pk_mul_f32 v[186:187], v[186:187], s[88:89]
 v_pk_mul_f32 v[188:189], v[188:189], s[88:89]
 v_pk_mul_f32 v[190:191], v[190:191], s[88:89]
 pk 184,184
 pk 185,186
 pk 186,188
 pk 187,190
 v_accvgpr_write_b32 a252, v184
 v_accvgpr_write_b32 a253, v185
 v_accvgpr_write_b32 a254, v186
 v_accvgpr_write_b32 a255, v187
 s_mov_b32 s3, 67584
 v_lshrrev_b32 v15, 2, v0
 v_and_or_b32 v15, v15, 48, s3
 ds_read_b128 v[176:179], v15 offset:0
 ds_read_b128 v[180:183], v15 offset:64
 ds_read_b128 v[184:187], v15 offset:128
 ds_read_b128 v[188:191], v15 offset:192
 ds_read_b128 a[80:83], v3 offset:0
 ds_read_b128 a[84:87], v3 offset:64
 ds_read_b128 a[88:91], v3 offset:128
 ds_read_b128 a[92:95], v3 offset:192
 ds_read_b128 a[96:99], v3 offset:256
 ds_read_b128 a[100:103], v3 offset:320
 ds_read_b128 a[104:107], v3 offset:384
 ds_read_b128 a[108:111], v3 offset:448
 ds_read_b128 a[112:115], v3 offset:512
 ds_read_b128 a[116:119], v3 offset:576
 ds_read_b128 a[120:123], v3 offset:640
 ds_read_b128 a[124:127], v3 offset:704
 ds_read_b128 a[128:131], v3 offset:768
 ds_read_b128 a[132:135], v3 offset:832
 ds_read_b128 a[136:139], v3 offset:896
 ds_read_b128 a[140:143], v3 offset:960
 v_pk_mul_f32 v[16:17], v[16:17], s[88:89]
 v_pk_mul_f32 v[18:19], v[18:19], s[88:89]
 v_pk_mul_f32 v[20:21], v[20:21], s[88:89]
 v_pk_mul_f32 v[22:23], v[22:23], s[88:89]
 pk 16,16
 pk 17,18
 pk 18,20
 pk 19,22
 v_accvgpr_write_b32 a0, v16
 v_accvgpr_write_b32 a1, v17
 v_accvgpr_write_b32 a2, v18
 v_accvgpr_write_b32 a3, v19
 v_pk_mul_f32 v[24:25], v[24:25], s[88:89]
 v_pk_mul_f32 v[26:27], v[26:27], s[88:89]
 v_pk_mul_f32 v[28:29], v[28:29], s[88:89]
 v_pk_mul_f32 v[30:31], v[30:31], s[88:89]
 pk 24,24
 pk 25,26
 pk 26,28
 pk 27,30
 v_accvgpr_write_b32 a4, v24
 v_accvgpr_write_b32 a5, v25
 v_accvgpr_write_b32 a6, v26
 v_accvgpr_write_b32 a7, v27
 v_pk_mul_f32 v[32:33], v[32:33], s[88:89]
 v_pk_mul_f32 v[34:35], v[34:35], s[88:89]
 v_pk_mul_f32 v[36:37], v[36:37], s[88:89]
 v_pk_mul_f32 v[38:39], v[38:39], s[88:89]
 pk 32,32
 pk 33,34
 pk 34,36
 pk 35,38
 v_accvgpr_write_b32 a8, v32
 v_accvgpr_write_b32 a9, v33
 v_accvgpr_write_b32 a10, v34
 v_accvgpr_write_b32 a11, v35
 s_waitcnt lgkmcnt(15)
 v_xor_b32 v176, 0x80008000, v176
 v_xor_b32 v177, 0x80008000, v177
 v_xor_b32 v178, 0x80008000, v178
 v_xor_b32 v179, 0x80008000, v179
 v_xor_b32 v180, 0x80008000, v180
 v_xor_b32 v181, 0x80008000, v181
 v_xor_b32 v182, 0x80008000, v182
 v_xor_b32 v183, 0x80008000, v183
 v_xor_b32 v184, 0x80008000, v184
 v_xor_b32 v185, 0x80008000, v185
 v_xor_b32 v186, 0x80008000, v186
 v_xor_b32 v187, 0x80008000, v187
 v_xor_b32 v188, 0x80008000, v188
 v_xor_b32 v189, 0x80008000, v189
 v_xor_b32 v190, 0x80008000, v190
 v_xor_b32 v191, 0x80008000, v191
 v_pk_mul_f32 v[40:41], v[40:41], s[88:89]
 v_pk_mul_f32 v[42:43], v[42:43], s[88:89]
 v_pk_mul_f32 v[44:45], v[44:45], s[88:89]
 v_pk_mul_f32 v[46:47], v[46:47], s[88:89]
 pk 40,40
 pk 41,42
 pk 42,44
 pk 43,46
 v_accvgpr_write_b32 a12, v40
 v_accvgpr_write_b32 a13, v41
 v_accvgpr_write_b32 a14, v42
 v_accvgpr_write_b32 a15, v43
 v_pk_mul_f32 v[48:49], v[48:49], s[88:89]
 v_pk_mul_f32 v[50:51], v[50:51], s[88:89]
 v_pk_mul_f32 v[52:53], v[52:53], s[88:89]
 v_pk_mul_f32 v[54:55], v[54:55], s[88:89]
 mvvaz 208,176,0
 pk 48,48
 pk 49,50
 pk 50,52
 pk 51,54
 v_accvgpr_write_b32 a16, v48
 v_accvgpr_write_b32 a17, v49
 v_accvgpr_write_b32 a18, v50
 v_accvgpr_write_b32 a19, v51
 v_pk_mul_f32 v[56:57], v[56:57], s[88:89]
 v_pk_mul_f32 v[58:59], v[58:59], s[88:89]
 v_pk_mul_f32 v[60:61], v[60:61], s[88:89]
 v_pk_mul_f32 v[62:63], v[62:63], s[88:89]
 mvva 208,180,4
 pk 56,56
 pk 57,58
 pk 58,60
 pk 59,62
 v_accvgpr_write_b32 a20, v56
 v_accvgpr_write_b32 a21, v57
 v_accvgpr_write_b32 a22, v58
 v_accvgpr_write_b32 a23, v59
 v_pk_mul_f32 v[64:65], v[64:65], s[88:89]
 v_pk_mul_f32 v[66:67], v[66:67], s[88:89]
 v_pk_mul_f32 v[68:69], v[68:69], s[88:89]
 v_pk_mul_f32 v[70:71], v[70:71], s[88:89]
 mvva 208,184,8
 pk 64,64
 pk 65,66
 pk 66,68
 pk 67,70
 v_accvgpr_write_b32 a24, v64
 v_accvgpr_write_b32 a25, v65
 v_accvgpr_write_b32 a26, v66
 v_accvgpr_write_b32 a27, v67
 v_pk_mul_f32 v[72:73], v[72:73], s[88:89]
 v_pk_mul_f32 v[74:75], v[74:75], s[88:89]
 v_pk_mul_f32 v[76:77], v[76:77], s[88:89]
 v_pk_mul_f32 v[78:79], v[78:79], s[88:89]
 mvva 208,188,12
 pk 72,72
 pk 73,74
 pk 74,76
 pk 75,78
 v_accvgpr_write_b32 a28, v72
 v_accvgpr_write_b32 a29, v73
 v_accvgpr_write_b32 a30, v74
 v_accvgpr_write_b32 a31, v75
 v_pk_mul_f32 v[80:81], v[80:81], s[88:89]
 v_pk_mul_f32 v[82:83], v[82:83], s[88:89]
 v_pk_mul_f32 v[84:85], v[84:85], s[88:89]
 v_pk_mul_f32 v[86:87], v[86:87], s[88:89]
 mvvaz 212,176,16
 pk 80,80
 pk 81,82
 pk 82,84
 pk 83,86
 v_accvgpr_write_b32 a32, v80
 v_accvgpr_write_b32 a33, v81
 v_accvgpr_write_b32 a34, v82
 v_accvgpr_write_b32 a35, v83
 v_pk_mul_f32 v[88:89], v[88:89], s[88:89]
 v_pk_mul_f32 v[90:91], v[90:91], s[88:89]
 v_pk_mul_f32 v[92:93], v[92:93], s[88:89]
 v_pk_mul_f32 v[94:95], v[94:95], s[88:89]
 mvva 212,180,20
 pk 88,88
 pk 89,90
 pk 90,92
 pk 91,94
 v_accvgpr_write_b32 a36, v88
 v_accvgpr_write_b32 a37, v89
 v_accvgpr_write_b32 a38, v90
 v_accvgpr_write_b32 a39, v91
 v_pk_mul_f32 v[96:97], v[96:97], s[88:89]
 v_pk_mul_f32 v[98:99], v[98:99], s[88:89]
 v_pk_mul_f32 v[100:101], v[100:101], s[88:89]
 v_pk_mul_f32 v[102:103], v[102:103], s[88:89]
 mvva 212,184,24
 pk 96,96
 pk 97,98
 pk 98,100
 pk 99,102
 v_accvgpr_write_b32 a40, v96
 v_accvgpr_write_b32 a41, v97
 v_accvgpr_write_b32 a42, v98
 v_accvgpr_write_b32 a43, v99
 v_pk_mul_f32 v[104:105], v[104:105], s[88:89]
 v_pk_mul_f32 v[106:107], v[106:107], s[88:89]
 v_pk_mul_f32 v[108:109], v[108:109], s[88:89]
 v_pk_mul_f32 v[110:111], v[110:111], s[88:89]
 mvva 212,188,28
 pk 104,104
 pk 105,106
 pk 106,108
 pk 107,110
 v_accvgpr_write_b32 a44, v104
 v_accvgpr_write_b32 a45, v105
 v_accvgpr_write_b32 a46, v106
 v_accvgpr_write_b32 a47, v107
 v_pk_mul_f32 v[112:113], v[112:113], s[88:89]
 v_pk_mul_f32 v[114:115], v[114:115], s[88:89]
 v_pk_mul_f32 v[116:117], v[116:117], s[88:89]
 v_pk_mul_f32 v[118:119], v[118:119], s[88:89]
 mvvaz 216,176,32
 pk 112,112
 pk 113,114
 pk 114,116
 pk 115,118
 v_accvgpr_write_b32 a48, v112
 v_accvgpr_write_b32 a49, v113
 v_accvgpr_write_b32 a50, v114
 v_accvgpr_write_b32 a51, v115
 v_pk_mul_f32 v[120:121], v[120:121], s[88:89]
 v_pk_mul_f32 v[122:123], v[122:123], s[88:89]
 v_pk_mul_f32 v[124:125], v[124:125], s[88:89]
 v_pk_mul_f32 v[126:127], v[126:127], s[88:89]
 mvva 216,180,36
 pk 120,120
 pk 121,122
 pk 122,124
 pk 123,126
 v_accvgpr_write_b32 a52, v120
 v_accvgpr_write_b32 a53, v121
 v_accvgpr_write_b32 a54, v122
 v_accvgpr_write_b32 a55, v123
 v_pk_mul_f32 v[128:129], v[128:129], s[88:89]
 v_pk_mul_f32 v[130:131], v[130:131], s[88:89]
 v_pk_mul_f32 v[132:133], v[132:133], s[88:89]
 v_pk_mul_f32 v[134:135], v[134:135], s[88:89]
 mvva 216,184,40
 pk 128,128
 pk 129,130
 pk 130,132
 pk 131,134
 v_accvgpr_write_b32 a56, v128
 v_accvgpr_write_b32 a57, v129
 v_accvgpr_write_b32 a58, v130
 v_accvgpr_write_b32 a59, v131
 v_pk_mul_f32 v[136:137], v[136:137], s[88:89]
 v_pk_mul_f32 v[138:139], v[138:139], s[88:89]
 v_pk_mul_f32 v[140:141], v[140:141], s[88:89]
 v_pk_mul_f32 v[142:143], v[142:143], s[88:89]
 mvva 216,188,44
 pk 136,136
 pk 137,138
 pk 138,140
 pk 139,142
 v_accvgpr_write_b32 a60, v136
 v_accvgpr_write_b32 a61, v137
 v_accvgpr_write_b32 a62, v138
 v_accvgpr_write_b32 a63, v139
 v_pk_mul_f32 v[144:145], v[144:145], s[88:89]
 v_pk_mul_f32 v[146:147], v[146:147], s[88:89]
 v_pk_mul_f32 v[148:149], v[148:149], s[88:89]
 v_pk_mul_f32 v[150:151], v[150:151], s[88:89]
 mvvaz 220,176,48
 pk 144,144
 pk 145,146
 pk 146,148
 pk 147,150
 v_accvgpr_write_b32 a64, v144
 v_accvgpr_write_b32 a65, v145
 v_accvgpr_write_b32 a66, v146
 v_accvgpr_write_b32 a67, v147
 v_pk_mul_f32 v[152:153], v[152:153], s[88:89]
 v_pk_mul_f32 v[154:155], v[154:155], s[88:89]
 v_pk_mul_f32 v[156:157], v[156:157], s[88:89]
 v_pk_mul_f32 v[158:159], v[158:159], s[88:89]
 mvva 220,180,52
 pk 152,152
 pk 153,154
 pk 154,156
 pk 155,158
 v_accvgpr_write_b32 a68, v152
 v_accvgpr_write_b32 a69, v153
 v_accvgpr_write_b32 a70, v154
 v_accvgpr_write_b32 a71, v155
 v_pk_mul_f32 v[160:161], v[160:161], s[88:89]
 v_pk_mul_f32 v[162:163], v[162:163], s[88:89]
 v_pk_mul_f32 v[164:165], v[164:165], s[88:89]
 v_pk_mul_f32 v[166:167], v[166:167], s[88:89]
 mvva 220,184,56
 pk 160,160
 pk 161,162
 pk 162,164
 pk 163,166
 v_accvgpr_write_b32 a72, v160
 v_accvgpr_write_b32 a73, v161
 v_accvgpr_write_b32 a74, v162
 v_accvgpr_write_b32 a75, v163
 v_pk_mul_f32 v[168:169], v[168:169], s[88:89]
 v_pk_mul_f32 v[170:171], v[170:171], s[88:89]
 v_pk_mul_f32 v[172:173], v[172:173], s[88:89]
 v_pk_mul_f32 v[174:175], v[174:175], s[88:89]
 mvva 220,188,60
 pk 168,168
 pk 169,170
 pk 170,172
 pk 171,174
 v_accvgpr_write_b32 a76, v168
 v_accvgpr_write_b32 a77, v169
 v_accvgpr_write_b32 a78, v170
 v_accvgpr_write_b32 a79, v171
 v_and_b32 v14, 12, v0
 v_cmp_eq_u32 vcc, 0, v14
 v_mov_b32 v15, 0x3f803f80
 s_nop 0
 v_cndmask_b32 v14, 0, v15, vcc
 v_accvgpr_write_b32 a216, v14
 v_accvgpr_write_b32 a217, v14
 v_accvgpr_write_b32 a218, v14
 v_accvgpr_write_b32 a219, v14
 s_mov_b32 s81, 16384
 s_mov_b64 s[44:45], s[40:41]
 s_mov_b32 s46, 2048
 v_mov_b32 v14, 0
 s_lshl_b32 s3, s9, 6
 s_mov_b64 exec, 7
 buffer_store_dword v14, v0, s[44:47], s3 offen sc1
 s_mov_b64 exec, -1
 v_mov_b32 v255, 0
 v_mov_b32 v254, 0
 v_mov_b32 v253, 0
 v_mov_b32 v252, 0
 mvvaz 224,176,64
 mvva 224,180,68
 mvva 224,184,72
 mvva 224,188,76
 s_mov_b32 s84, 0
L15_head:
 mvaac 176,80,0,208
 s_waitcnt lgkmcnt(0)
 rta 144,4,16896
 rta 146,4,17152
 mvaa 176,84,4
 rta 148,4,17408
 rta 150,4,17664
 mvaa 176,88,8
 rta 152,4,16928
 rta 154,4,17184
 mvaa 176,92,12
 rta 156,4,17440
 rta 158,4,17696
 mvaac 180,108,12,208
 rta 160,4,16960
 rta 162,4,17216
 mvaa 180,104,8
 rta 164,4,17472
 rta 166,4,17728
 mvaa 180,100,4
 rta 168,4,16992
 rta 170,4,17248
 mvaa 180,96,0
 rta 172,4,17504
 rta 174,4,17760
 mvaac 184,112,0,208
 v_exp_f32 v176, v176
 mvaa 184,116,4
 v_exp_f32 v177, v177
 mvaa 184,120,8
 rta 176,4,17024
 pk 176,176
 mvaa 184,124,12
 v_exp_f32 v178, v178
 mvaac 188,140,12,208
 v_exp_f32 v179, v179
 mvaa 188,136,8
 rta 178,4,17280
 pk 177,178
 mvaa 188,132,4
 v_exp_f32 v180, v180
 mvaa 188,128,0
 v_exp_f32 v181, v181
 mvaac 192,80,16,212
 rta 180,4,17536
 pk 178,180
 mvaa 192,84,20
 v_exp_f32 v182, v182
 mvaa 192,88,24
 v_exp_f32 v183, v183
 mvaa 192,92,28
 rta 182,4,17792
 pk 179,182
 mvaac 196,108,28,212
 v_exp_f32 v184, v184
 mvaa 196,104,24
 v_exp_f32 v185, v185
 mvaa 196,100,20
 rta 184,4,17056
 pk 184,184
 mvaa 196,96,16
 v_exp_f32 v186, v186
 mvaac 200,112,16,212
 v_exp_f32 v187, v187
 mvaa 200,116,20
 rta 186,4,17312
 pk 185,186
 mvaa 200,120,24
 v_exp_f32 v188, v188
 mvaa 200,124,28
 v_exp_f32 v189, v189
 mvaac 204,140,28,212
 rta 188,4,17568
 pk 186,188
 mvaa 204,136,24
 v_exp_f32 v190, v190
 mvaa 204,132,20
 v_exp_f32 v191, v191
 s_nop 0
 pk 187,190
 mvaa 204,128,16
 s_waitcnt lgkmcnt(2)
 rta 190,4,17824
 rta 192,4,17088
 mvavz 16,144,176
 rta 194,4,17344
 rta 196,4,17600
 mvav 16,148,184
 rta 198,4,17856
 rta 200,4,17120
 mvavz 20,152,176
 rta 202,4,17376
 rta 204,4,17632
 mvav 20,156,184
 v_exp_f32 v192, v192
 mvavz 24,160,176
 v_exp_f32 v193, v193
 mvav 24,164,184
 rta 206,4,17888
 pk 192,192
 mvavz 28,168,176
 v_exp_f32 v194, v194
 mvav 28,172,184
 v_exp_f32 v195, v195
 mvavz 32,176,176
 v_exp_f32 v196, v196
 mvav 32,180,184
 s_waitcnt lgkmcnt(5)
 v_exp_f32 v197, v197
 mvavz 36,184,176
 pk 193,194
 pk 194,196
 mvav 36,188,184
 v_exp_f32 v198, v198
 mvavz 40,192,176
 s_waitcnt lgkmcnt(1)
 v_exp_f32 v199, v199
 mvav 40,196,184
 v_exp_f32 v200, v200
 mvavz 44,200,176
 s_waitcnt lgkmcnt(0)
 pk 195,198
 v_add_f32 v255, v255, v200
 mvav 44,204,184
 v_exp_f32 v201, v201
 maavz 208,216,176
 pk 200,200
 v_add_f32 v255, v255, v201
 maav 208,216,184
 v_exp_f32 v202, v202
 mvaac 176,80,32,216
 s_waitcnt vmcnt(13)
 s_barrier
 v_add_f32 v255, v255, v202
 mvaa 176,84,36
 v_exp_f32 v203, v203
 mvaa 176,88,40
 pk 201,202
 v_add_f32 v255, v255, v203
 mvaa 176,92,44
 v_exp_f32 v204, v204
 mvaac 180,108,44,216
 v_exp_f32 v205, v205
 mvaa 180,104,40
 pk 202,204
 v_add_f32 v255, v255, v204
 mvaa 180,100,36
 v_exp_f32 v206, v206
 mvaa 180,96,32
 v_exp_f32 v207, v207
 mvaac 184,112,32,216
 pk 203,206
 v_add_f32 v255, v255, v205
 mvaa 184,116,36
 v_exp_f32 v176, v176
 mvaa 184,120,40
 v_exp_f32 v177, v177
 mvaa 184,124,44
 v_add_f32 v254, v254, v176
 pk 176,176
 mvaac 188,140,44,216
 v_exp_f32 v178, v178
 mvaa 188,136,40
 v_exp_f32 v179, v179
 mvaa 188,132,36
 v_add_f32 v254, v254, v177
 pk 177,178
 mvaa 188,128,32
 v_exp_f32 v180, v180
 mvavz 48,144,192
 v_exp_f32 v181, v181
 mvav 48,148,200
 v_add_f32 v254, v254, v178
 pk 178,180
 mvavz 52,152,192
 v_exp_f32 v182, v182
 mvav 52,156,200
 v_exp_f32 v183, v183
 mvavz 56,160,192
 v_add_f32 v254, v254, v179
 pk 179,182
 mvav 56,164,200
 v_exp_f32 v184, v184
 mvavz 60,168,192
 v_exp_f32 v185, v185
 mvav 60,172,200
 v_add_f32 v254, v254, v184
 pk 184,184
 mvavz 64,176,192
 v_exp_f32 v186, v186
 mvav 64,180,200
 v_exp_f32 v187, v187
 mvavz 68,184,192
 v_add_f32 v254, v254, v185
 pk 185,186
 mvav 68,188,200
 v_exp_f32 v188, v188
 mvavz 72,192,192
 v_exp_f32 v189, v189
 mvav 72,196,200
 v_add_f32 v255, v255, v206
 v_add_f32 v255, v255, v207
 mvavz 76,200,192
 v_add_f32 v254, v254, v186
 pk 186,188
 mvav 76,204,200
 v_exp_f32 v190, v190
 maavz 212,216,192
 s_add_u32 m0, s77, 0
 v_exp_f32 v191, v191
 mvaac 192,80,48,220
 buffer_load_dwordx4 v1, s[52:55], s76 offen offset:0 nt lds
 v_add_f32 v254, v254, v187
 mvaa 192,84,52
 s_add_u32 m0, s77, 32
 pk 187,190
 v_add_f32 v254, v254, v180
 mvaa 192,88,56
 buffer_load_dwordx4 v1, s[52:55], s76 offen offset:1024 nt lds
 v_add_f32 v254, v254, v181
 mvaa 192,92,60
 s_add_u32 m0, s77, 64
 v_add_f32 v254, v254, v182
 v_add_f32 v254, v254, v183
 mvaac 196,108,60,220
 buffer_load_dwordx4 v1, s[52:55], s76 offen offset:2048 nt lds
 v_add_f32 v254, v254, v188
 mvaa 196,104,56
 s_add_u32 m0, s77, 96
 v_add_f32 v254, v254, v189
 v_add_f32 v254, v254, v190
 mvaa 196,100,52
 buffer_load_dwordx4 v1, s[52:55], s76 offen offset:3072 nt lds
 v_add_f32 v254, v254, v191
 mvaa 196,96,48
 mvaac 200,112,48,220
 s_add_u32 m0, s77, 16896
 v_exp_f32 v192, v192
 mvaa 200,116,52
 buffer_load_dwordx4 v1, s[56:59], s76 offen offset:0 nt lds
 v_add_f32 v253, v253, v192
 mvaa 200,120,56
 s_add_u32 m0, s77, 16928
 v_exp_f32 v193, v193
 mvaa 200,124,60
 buffer_load_dwordx4 v1, s[56:59], s76 offen offset:1024 nt lds
 pk 192,192
 mvaac 204,140,60,220
 s_add_u32 m0, s77, 16960
 v_exp_f32 v194, v194
 mvaa 204,136,56
 buffer_load_dwordx4 v1, s[56:59], s76 offen offset:2048 nt lds
 v_add_f32 v253, v253, v193
 mvaa 204,132,52
 s_add_u32 m0, s77, 16992
 v_exp_f32 v195, v195
 mvaa 204,128,48
 buffer_load_dwordx4 v1, s[56:59], s76 offen offset:3072 nt lds
 pk 193,194
 mvavz 80,144,176
 v_exp_f32 v196, v196
 mvav 80,148,184
 v_exp_f32 v197, v197
 mvavz 84,152,176
 v_add_f32 v253, v253, v194
 pk 194,196
 mvav 84,156,184
 v_exp_f32 v198, v198
 mvavz 88,160,176
 v_exp_f32 v199, v199
 mvav 88,164,184
 v_add_f32 v253, v253, v195
 pk 195,198
 mvavz 92,168,176
 v_exp_f32 v200, v200
 mvav 92,172,184
 v_exp_f32 v201, v201
 mvavz 96,176,176
 v_add_f32 v253, v253, v200
 pk 200,200
 mvav 96,180,184
 v_exp_f32 v202, v202
 mvavz 100,184,176
 v_exp_f32 v203, v203
 mvav 100,188,184
 v_add_f32 v253, v253, v201
 pk 201,202
 mvavz 104,192,176
 v_exp_f32 v204, v204
 mvav 104,196,184
 v_exp_f32 v205, v205
 mvavz 108,200,176
 v_add_f32 v253, v253, v202
 pk 202,204
 mvav 108,204,184
 v_exp_f32 v206, v206
 mvaac 176,80,64,224
 s_add_u32 s5, s5, s81
 v_exp_f32 v207, v207
 mvaa 176,84,68
 v_add_f32 v253, v253, v203
 pk 203,206
 mvaa 176,88,72
 ds_read_b128 a[80:83], v3 offset:33792
 ds_read_b128 a[84:87], v3 offset:33856
 mvaa 176,92,76
 ds_read_b128 a[88:91], v3 offset:33920
 v_add_f32 v253, v253, v196
 mvaac 180,108,76,224
 ds_read_b128 a[92:95], v3 offset:33984
 v_add_f32 v253, v253, v197
 mvaa 180,104,72
 s_xor_b32 s76, s5, s39
 ds_read_b128 a[108:111], v3 offset:34240
 v_add_f32 v253, v253, v198
 mvaa 180,100,68
 ds_read_b128 a[104:107], v3 offset:34176
 v_add_f32 v253, v253, v199
 mvaa 180,96,64
 ds_read_b128 a[100:103], v3 offset:34112
 v_add_f32 v253, v253, v204
 mvaac 184,112,64,224
 v_exp_f32 v176, v176
 mvaa 184,116,68
 v_exp_f32 v177, v177
 mvaa 184,120,72
 v_add_f32 v252, v252, v176
 pk 176,176
 mvaa 184,124,76
 v_exp_f32 v178, v178
 mvaac 188,140,76,224
 v_exp_f32 v179, v179
 mvaa 188,136,72
 v_add_f32 v252, v252, v177
 pk 177,178
 mvaa 188,132,68
 v_exp_f32 v180, v180
 mvaa 188,128,64
 v_exp_f32 v181, v181
 mvavz 112,144,192
 ds_read_b128 a[96:99], v3 offset:34048
 v_add_f32 v252, v252, v178
 mvav 112,148,200
 ds_read_b128 a[112:115], v3 offset:34304
 pk 178,180
 mvavz 116,152,192
 v_exp_f32 v182, v182
 mvav 116,156,200
 ds_read_b128 a[116:119], v3 offset:34368
 ds_read_b128 a[120:123], v3 offset:34432
 mvavz 120,160,192
 v_exp_f32 v183, v183
 mvav 120,164,200
 ds_read_b128 a[124:127], v3 offset:34496
 v_add_f32 v252, v252, v179
 mvavz 124,168,192
 ds_read_b128 a[140:143], v3 offset:34752
 pk 179,182
 mvav 124,172,200
 v_exp_f32 v184, v184
 mvavz 128,176,192
 v_exp_f32 v185, v185
 mvav 128,180,200
 ds_read_b128 a[136:139], v3 offset:34688
 ds_read_b128 a[132:135], v3 offset:34624
 mvavz 132,184,192
 v_add_f32 v252, v252, v184
 pk 184,184
 mvav 132,188,200
 v_exp_f32 v186, v186
 mvavz 136,192,192
 ds_read_b128 a[128:131], v3 offset:34560
 v_add_f32 v252, v252, v185
 mvav 136,196,200
 v_exp_f32 v187, v187
 mvavz 140,200,192
 pk 185,186
 v_add_f32 v253, v253, v205
 mvav 140,204,200
 s_waitcnt lgkmcnt(3)
 v_exp_f32 v188, v188
 mvaac 192,80,0,208
 v_exp_f32 v189, v189
 mvaa 192,84,4
 v_add_f32 v253, v253, v206
 v_add_f32 v253, v253, v207
 mvaa 192,88,8
 v_add_f32 v252, v252, v186
 pk 186,188
 mvaa 192,92,12
 v_exp_f32 v190, v190
 mvaac 196,108,12,208
 v_exp_f32 v191, v191
 mvaa 196,104,8
 v_add_f32 v252, v252, v187
 pk 187,190
 mvaa 196,100,4
 v_add_f32 v252, v252, v180
 v_add_f32 v252, v252, v181
 mvaa 196,96,0
 v_add_f32 v252, v252, v182
 v_add_f32 v252, v252, v183
 mvaac 200,112,0,208
 v_exp_f32 v192, v192
 mvaa 200,116,4
 v_exp_f32 v193, v193
 mvaa 200,120,8
 pk 192,192
 v_add_f32 v252, v252, v188
 mvaa 200,124,12
 v_exp_f32 v194, v194
 mvaac 204,140,12,208
 s_waitcnt lgkmcnt(0)
 v_exp_f32 v195, v195
 mvaa 204,136,8
 pk 193,194
 v_add_f32 v252, v252, v189
 mvaa 204,132,4
 v_exp_f32 v196, v196
 mvaa 204,128,0
 v_exp_f32 v197, v197
 mvavz 144,144,176
 pk 194,196
 v_add_f32 v252, v252, v190
 mvav 144,148,184
 v_exp_f32 v198, v198
 mvavz 148,152,176
 v_exp_f32 v199, v199
 mvav 148,156,184
 rta 144,4,50688
 pk 195,198
 mvavz 152,160,176
 v_exp_f32 v200, v200
 mvav 152,164,184
 v_exp_f32 v201, v201
 mvavz 156,168,176
 rta 146,4,50944
 pk 200,200
 mvav 156,172,184
 v_exp_f32 v202, v202
 mvavz 160,176,176
 rta 148,4,51200
 rta 150,4,51456
 mvav 160,180,184
 v_exp_f32 v203, v203
 mvavz 164,184,176
 rta 152,4,50720
 pk 201,202
 mvav 164,188,184
 rta 154,4,50976
 rta 156,4,51232
 mvavz 168,192,176
 v_exp_f32 v204, v204
 mvav 168,196,184
 rta 158,4,51488
 v_add_f32 v252, v252, v191
 mvavz 172,200,176
 v_exp_f32 v205, v205
 mvav 172,204,184
 rta 160,4,50752
 rta 162,4,51008
 mvaac 176,80,16,212
 rta 164,4,51264
 pk 202,204
 mvaa 176,84,20
 rta 166,4,51520
 rta 168,4,50784
 mvaa 176,88,24
 v_exp_f32 v206, v206
 mvaa 176,92,28
 rta 170,4,51040
 rta 172,4,51296
 mvaac 180,108,28,212
 v_exp_f32 v207, v207
 mvaa 180,104,24
 rta 174,4,51552
 pk 203,206
 mvaa 180,100,20
 rta 176,4,50816
 rta 178,4,51072
 mvaa 180,96,16
 rta 180,4,51328
 rta 182,4,51584
 mvaac 184,112,16,212
 rta 184,4,50848
 rta 186,4,51104
 mvaa 184,116,20
 rta 188,4,51360
 rta 190,4,51616
 mvaa 184,120,24
 rta 192,4,50880
 rta 194,4,51136
 mvaa 184,124,28
 rta 196,4,51392
 rta 198,4,51648
 mvaac 188,140,28,212
 rta 200,4,50912
 rta 202,4,51168
 mvaa 188,136,24
 rta 204,4,51424
 rta 206,4,51680
 mvaa 188,132,20
 v_exp_f32 v176, v176
 mvaa 188,128,16
 s_waitcnt lgkmcnt(14)
 v_exp_f32 v177, v177
 mvav 16,144,192
 v_exp_f32 v178, v178
 mvav 16,148,200
 v_exp_f32 v179, v179
 mvav 20,152,192
 pk 176,176
 pk 177,178
 mvav 20,156,200
 v_exp_f32 v180, v180
 mvav 24,160,192
 v_exp_f32 v181, v181
 mvav 24,164,200
 v_exp_f32 v182, v182
 mvav 28,168,192
 v_exp_f32 v183, v183
 mvav 28,172,200
 pk 178,180
 pk 179,182
 mvav 32,176,192
 s_waitcnt lgkmcnt(0)
 v_exp_f32 v184, v184
 mvav 32,180,200
 v_exp_f32 v185, v185
 mvav 36,184,192
 v_add_f32 v255, v255, v184
 pk 184,184
 mvav 36,188,200
 v_exp_f32 v186, v186
 mvav 40,192,192
 v_exp_f32 v187, v187
 mvav 40,196,200
 v_add_f32 v255, v255, v185
 pk 185,186
 mvav 44,200,192
 v_exp_f32 v188, v188
 mvav 44,204,200
 v_exp_f32 v189, v189
 maav 208,216,192
 v_add_f32 v255, v255, v186
 pk 186,188
 maav 208,216,200
 v_exp_f32 v190, v190
 mvaac 192,80,32,216
 s_waitcnt vmcnt(17)
 s_barrier
 v_add_f32 v255, v255, v187
 mvaa 192,84,36
 v_exp_f32 v191, v191
 mvaa 192,88,40
 pk 187,190
 v_add_f32 v255, v255, v188
 mvaa 192,92,44
 s_add_u32 m0, s77, 33792
 v_add_f32 v255, v255, v189
 v_add_f32 v255, v255, v190
 mvaac 196,108,44,216
 buffer_load_dwordx4 v1, s[52:55], s76 offen offset:0 nt lds
 v_add_f32 v255, v255, v191
 mvaa 196,104,40
 s_add_u32 m0, s77, 33824
 v_add_u32 v3, s78, v3
 v_add_u32 v4, s78, v4
 mvaa 196,100,36
 buffer_load_dwordx4 v1, s[52:55], s76 offen offset:1024 nt lds
 mvaa 196,96,32
 mvaac 200,112,32,216
 v_exp_f32 v192, v192
 mvaa 200,116,36
 v_exp_f32 v193, v193
 mvaa 200,120,40
 v_add_f32 v254, v254, v192
 pk 192,192
 mvaa 200,124,44
 v_exp_f32 v194, v194
 mvaac 204,140,44,216
 v_exp_f32 v195, v195
 mvaa 204,136,40
 v_add_f32 v254, v254, v193
 pk 193,194
 mvaa 204,132,36
 v_exp_f32 v196, v196
 mvaa 204,128,32
 v_exp_f32 v197, v197
 mvav 48,144,176
 v_add_f32 v254, v254, v194
 pk 194,196
 mvav 48,148,184
 v_exp_f32 v198, v198
 mvav 52,152,176
 v_exp_f32 v199, v199
 mvav 52,156,184
 v_add_f32 v254, v254, v195
 pk 195,198
 mvav 56,160,176
 v_exp_f32 v200, v200
 mvav 56,164,184
 v_exp_f32 v201, v201
 mvav 60,168,176
 v_add_f32 v254, v254, v200
 pk 200,200
 mvav 60,172,184
 v_exp_f32 v202, v202
 mvav 64,176,176
 v_exp_f32 v203, v203
 mvav 64,180,184
 v_add_f32 v254, v254, v201
 pk 201,202
 mvav 68,184,176
 v_exp_f32 v204, v204
 mvav 68,188,184
 v_exp_f32 v205, v205
 mvav 72,192,176
 v_add_f32 v254, v254, v202
 pk 202,204
 mvav 72,196,184
 v_exp_f32 v206, v206
 mvav 76,200,176
 v_exp_f32 v207, v207
 mvav 76,204,184
 s_add_u32 m0, s77, 33856
 v_add_f32 v254, v254, v203
 pk 203,206
 maav 212,216,176
 buffer_load_dwordx4 v1, s[52:55], s76 offen offset:2048 nt lds
 v_add_f32 v254, v254, v196
 mvaac 176,80,48,220
 s_add_u32 m0, s77, 33888
 v_add_f32 v254, v254, v197
 v_add_f32 v254, v254, v198
 mvaa 176,84,52
 buffer_load_dwordx4 v1, s[52:55], s76 offen offset:3072 nt lds
 v_add_f32 v254, v254, v199
 mvaa 176,88,56
 s_add_u32 m0, s77, 50688
 v_add_f32 v254, v254, v204
 v_add_f32 v254, v254, v205
 mvaa 176,92,60
 buffer_load_dwordx4 v1, s[56:59], s76 offen offset:0 nt lds
 v_add_f32 v254, v254, v206
 mvaac 180,108,60,220
 s_add_u32 m0, s77, 50720
 v_add_f32 v254, v254, v207
 mvaa 180,104,56
 buffer_load_dwordx4 v1, s[56:59], s76 offen offset:1024 nt lds
 mvaa 180,100,52
 s_add_u32 m0, s77, 50752
 mvaa 180,96,48
 buffer_load_dwordx4 v1, s[56:59], s76 offen offset:2048 nt lds
 mvaac 184,112,48,220
 v_exp_f32 v176, v176
 mvaa 184,116,52
 v_exp_f32 v177, v177
 mvaa 184,120,56
 v_add_f32 v253, v253, v176
 pk 176,176
 mvaa 184,124,60
 v_exp_f32 v178, v178
 mvaac 188,140,60,220
 s_add_u32 m0, s77, 50784
 v_exp_f32 v179, v179
 mvaa 188,136,56
 buffer_load_dwordx4 v1, s[56:59], s76 offen offset:3072 nt lds
 v_add_f32 v253, v253, v177
 mvaa 188,132,52
 pk 177,178
 v_add_f32 v253, v253, v178
 mvaa 188,128,48
 v_exp_f32 v180, v180
 mvav 80,144,192
 v_exp_f32 v181, v181
 mvav 80,148,200
 pk 178,180
 v_add_f32 v253, v253, v179
 mvav 84,152,192
 v_exp_f32 v182, v182
 mvav 84,156,200
 v_exp_f32 v183, v183
 mvav 88,160,192
 pk 179,182
 v_add_f32 v253, v253, v180
 mvav 88,164,200
 v_exp_f32 v184, v184
 mvav 92,168,192
 v_exp_f32 v185, v185
 mvav 92,172,200
 v_add_f32 v253, v253, v184
 pk 184,184
 mvav 96,176,192
 v_exp_f32 v186, v186
 mvav 96,180,200
 v_exp_f32 v187, v187
 mvav 100,184,192
 v_add_f32 v253, v253, v185
 pk 185,186
 mvav 100,188,200
 v_exp_f32 v188, v188
 mvav 104,192,192
 v_exp_f32 v189, v189
 mvav 104,196,200
 v_add_f32 v253, v253, v186
 pk 186,188
 mvav 108,200,192
 v_exp_f32 v190, v190
 mvav 108,204,200
 v_exp_f32 v191, v191
 mvaac 192,80,64,224
 s_add_u32 s5, s5, s81
 v_add_f32 v253, v253, v187
 pk 187,190
 mvaa 192,84,68
 s_add_u32 s77, s77, s78
 ds_read_b128 a[80:83], v3 offset:0
 v_add_f32 v253, v253, v181
 mvaa 192,88,72
 s_sub_u32 s78, 0, s78
 ds_read_b128 a[84:87], v3 offset:64
 v_add_f32 v253, v253, v182
 mvaa 192,92,76
 ds_read_b128 a[88:91], v3 offset:128
 v_add_f32 v253, v253, v183
 mvaac 196,108,76,224
 ds_read_b128 a[92:95], v3 offset:192
 v_add_f32 v253, v253, v188
 mvaa 196,104,72
 s_xor_b32 s76, s5, s39
 ds_read_b128 a[108:111], v3 offset:448
 v_add_f32 v253, v253, v189
 mvaa 196,100,68
 ds_read_b128 a[104:107], v3 offset:384
 v_add_f32 v253, v253, v190
 mvaa 196,96,64
 ds_read_b128 a[100:103], v3 offset:320
 v_add_f32 v253, v253, v191
 mvaac 200,112,64,224
 v_exp_f32 v192, v192
 mvaa 200,116,68
 v_exp_f32 v193, v193
 mvaa 200,120,72
 v_add_f32 v252, v252, v192
 pk 192,192
 mvaa 200,124,76
 v_exp_f32 v194, v194
 mvaac 204,140,76,224
 v_exp_f32 v195, v195
 mvaa 204,136,72
 v_add_f32 v252, v252, v193
 pk 193,194
 mvaa 204,132,68
 v_exp_f32 v196, v196
 mvaa 204,128,64
 v_exp_f32 v197, v197
 mvav 112,144,176
 ds_read_b128 a[96:99], v3 offset:256
 v_add_f32 v252, v252, v194
 mvav 112,148,184
 v_exp_f32 v198, v198
 mvav 116,152,176
 v_exp_f32 v199, v199
 mvav 116,156,184
 v_exp_f32 v200, v200
 mvav 120,160,176
 v_exp_f32 v201, v201
 mvav 120,164,184
 v_exp_f32 v202, v202
 mvav 124,168,176
 v_exp_f32 v203, v203
 mvav 124,172,184
 ds_read_b128 a[112:115], v3 offset:512
 v_add_f32 v252, v252, v195
 mvav 128,176,176
 ds_read_b128 a[116:119], v3 offset:576
 ds_read_b128 a[120:123], v3 offset:640
 mvav 128,180,184
 ds_read_b128 a[124:127], v3 offset:704
 pk 194,196
 mvav 132,184,176
 ds_read_b128 a[140:143], v3 offset:960
 pk 195,198
 mvav 132,188,184
 ds_read_b128 a[136:139], v3 offset:896
 ds_read_b128 a[132:135], v3 offset:832
 mvav 136,192,176
 ds_read_b128 a[128:131], v3 offset:768
 v_add_f32 v252, v252, v200
 mvav 136,196,184
 pk 200,200
 v_add_f32 v252, v252, v201
 mvav 140,200,176
 pk 201,202
 v_add_f32 v252, v252, v202
 mvav 140,204,184
 s_cmp_eq_u32 s43, 0
 s_cbranch_scc1 L15_pre
L15_pre:
 s_mov_b32 s79, 7
L15_loop:
 s_waitcnt lgkmcnt(8)
 mvaac 176,80,0,208
 v_exp_f32 v204, v204
 mvaa 176,84,4
 v_exp_f32 v205, v205
 mvaa 176,88,8
 pk 202,204
 v_add_f32 v252, v252, v203
 mvaa 176,92,12
 v_exp_f32 v206, v206
 mvaac 180,108,12,208
 v_exp_f32 v207, v207
 mvaa 180,104,8
 pk 203,206
 v_add_f32 v252, v252, v196
 mvaa 180,100,4
 v_add_f32 v252, v252, v197
 v_add_f32 v252, v252, v198
 mvaa 180,96,0
 s_waitcnt lgkmcnt(0)
 v_add_f32 v252, v252, v199
 v_add_f32 v252, v252, v204
 mvaac 184,112,0,208
 v_exp_f32 v176, v176
 mvaa 184,116,4
 v_exp_f32 v177, v177
 mvaa 184,120,8
 pk 176,176
 v_add_f32 v252, v252, v205
 mvaa 184,124,12
 v_exp_f32 v178, v178
 mvaac 188,140,12,208
 v_exp_f32 v179, v179
 mvaa 188,136,8
 pk 177,178
 v_add_f32 v252, v252, v206
 mvaa 188,132,4
 v_exp_f32 v180, v180
 mvaa 188,128,0
 v_exp_f32 v181, v181
 mvav 144,144,192
 pk 178,180
 v_add_f32 v252, v252, v207
 mvav 144,148,200
 v_exp_f32 v182, v182
 mvav 148,152,192
 v_exp_f32 v183, v183
 mvav 148,156,200
 rta 144,4,16896
 pk 179,182
 mvav 152,160,192
 v_exp_f32 v184, v184
 mvav 152,164,200
 v_exp_f32 v185, v185
 mvav 156,168,192
 rta 146,4,17152
 pk 184,184
 mvav 156,172,200
 v_exp_f32 v186, v186
 mvav 160,176,192
 rta 148,4,17408
 rta 150,4,17664
 mvav 160,180,200
 v_exp_f32 v187, v187
 mvav 164,184,192
 rta 152,4,16928
 pk 185,186
 mvav 164,188,200
 rta 154,4,17184
 rta 156,4,17440
 mvav 168,192,192
 v_exp_f32 v188, v188
 mvav 168,196,200
 rta 158,4,17696
 rta 160,4,16960
 mvav 172,200,192
 v_exp_f32 v189, v189
 mvav 172,204,200
 rta 162,4,17216
 pk 186,188
 mvaac 192,80,16,212
 rta 164,4,17472
 rta 166,4,17728
 mvaa 192,84,20
 v_exp_f32 v190, v190
 mvaa 192,88,24
 rta 168,4,16992
 rta 170,4,17248
 mvaa 192,92,28
 v_exp_f32 v191, v191
 mvaac 196,108,28,212
 rta 172,4,17504
 pk 187,190
 mvaa 196,104,24
 rta 174,4,17760
 rta 176,4,17024
 mvaa 196,100,20
 rta 178,4,17280
 rta 180,4,17536
 mvaa 196,96,16
 rta 182,4,17792
 rta 184,4,17056
 mvaac 200,112,16,212
 rta 186,4,17312
 rta 188,4,17568
 mvaa 200,116,20
 rta 190,4,17824
 rta 192,4,17088
 mvaa 200,120,24
 rta 194,4,17344
 rta 196,4,17600
 mvaa 200,124,28
 rta 198,4,17856
 rta 200,4,17120
 mvaac 204,140,28,212
 rta 202,4,17376
 rta 204,4,17632
 mvaa 204,136,24
 v_exp_f32 v192, v192
 mvaa 204,132,20
 v_exp_f32 v193, v193
 mvaa 204,128,16
 s_waitcnt lgkmcnt(12)
 rta 206,4,17888
 pk 192,192
 mvav 16,144,176
 v_exp_f32 v194, v194
 mvav 16,148,184
 v_exp_f32 v195, v195
 mvav 20,152,176
 v_exp_f32 v196, v196
 mvav 20,156,184
 v_exp_f32 v197, v197
 mvav 24,160,176
 pk 193,194
 pk 194,196
 mvav 24,164,184
 v_exp_f32 v198, v198
 mvav 28,168,176
 v_exp_f32 v199, v199
 mvav 28,172,184
 v_exp_f32 v200, v200
 mvav 32,176,176
 s_waitcnt lgkmcnt(0)
 pk 195,198
 v_add_f32 v255, v255, v200
 mvav 32,180,184
 v_exp_f32 v201, v201
 mvav 36,184,176
 pk 200,200
 v_add_f32 v255, v255, v201
 mvav 36,188,184
 v_exp_f32 v202, v202
 mvav 40,192,176
 v_exp_f32 v203, v203
 mvav 40,196,184
 pk 201,202
 v_add_f32 v255, v255, v202
 mvav 44,200,176
 v_exp_f32 v204, v204
 mvav 44,204,184
 v_exp_f32 v205, v205
 maav 208,216,176
 pk 202,204
 v_add_f32 v255, v255, v203
 maav 208,216,184
 v_exp_f32 v206, v206
 mvaac 176,80,32,216
 s_waitcnt vmcnt(16)
 s_barrier
 v_add_f32 v255, v255, v204
 mvaa 176,84,36
 v_exp_f32 v207, v207
 mvaa 176,88,40
 pk 203,206
 v_add_f32 v255, v255, v205
 mvaa 176,92,44
 s_add_u32 m0, s77, 0
 v_add_f32 v255, v255, v206
 v_add_f32 v255, v255, v207
 mvaac 180,108,44,216
 buffer_load_dwordx4 v1, s[52:55], s76 offen offset:0 nt lds
 mvaa 180,104,40
 s_add_u32 m0, s77, 32
 mvaa 180,100,36
 buffer_load_dwordx4 v1, s[52:55], s76 offen offset:1024 nt lds
 mvaa 180,96,32
 mvaac 184,112,32,216
 v_exp_f32 v176, v176
 mvaa 184,116,36
 v_exp_f32 v177, v177
 mvaa 184,120,40
 v_add_f32 v254, v254, v176
 pk 176,176
 mvaa 184,124,44
 v_exp_f32 v178, v178
 mvaac 188,140,44,216
 v_exp_f32 v179, v179
 mvaa 188,136,40
 v_add_f32 v254, v254, v177
 pk 177,178
 mvaa 188,132,36
 v_exp_f32 v180, v180
 mvaa 188,128,32
 v_exp_f32 v181, v181
 mvav 48,144,192
 v_add_f32 v254, v254, v178
 pk 178,180
 mvav 48,148,200
 v_exp_f32 v182, v182
 mvav 52,152,192
 v_exp_f32 v183, v183
 mvav 52,156,200
 v_add_f32 v254, v254, v179
 pk 179,182
 mvav 56,160,192
 v_exp_f32 v184, v184
 mvav 56,164,200
 v_exp_f32 v185, v185
 mvav 60,168,192
 v_add_f32 v254, v254, v184
 pk 184,184
 mvav 60,172,200
 v_exp_f32 v186, v186
 mvav 64,176,192
 v_exp_f32 v187, v187
 mvav 64,180,200
 v_add_f32 v254, v254, v185
 pk 185,186
 mvav 68,184,192
 v_exp_f32 v188, v188
 mvav 68,188,200
 v_exp_f32 v189, v189
 mvav 72,192,192
 v_add_f32 v254, v254, v186
 pk 186,188
 mvav 72,196,200
 v_exp_f32 v190, v190
 mvav 76,200,192
 v_exp_f32 v191, v191
 mvav 76,204,200
 s_add_u32 m0, s77, 64
 v_add_f32 v254, v254, v187
 pk 187,190
 maav 212,216,192
 buffer_load_dwordx4 v1, s[52:55], s76 offen offset:2048 nt lds
 v_add_f32 v254, v254, v180
 mvaac 192,80,48,220
 s_add_u32 m0, s77, 96
 v_add_f32 v254, v254, v181
 v_add_f32 v254, v254, v182
 mvaa 192,84,52
 buffer_load_dwordx4 v1, s[52:55], s76 offen offset:3072 nt lds
 v_add_f32 v254, v254, v183
 mvaa 192,88,56
 s_add_u32 m0, s77, 16896
 v_add_f32 v254, v254, v188
 v_add_f32 v254, v254, v189
 mvaa 192,92,60
 buffer_load_dwordx4 v1, s[56:59], s76 offen offset:0 nt lds
 v_add_f32 v254, v254, v190
 mvaac 196,108,60,220
 s_add_u32 m0, s77, 16928
 v_add_f32 v254, v254, v191
 mvaa 196,104,56
 buffer_load_dwordx4 v1, s[56:59], s76 offen offset:1024 nt lds
 mvaa 196,100,52
 s_add_u32 m0, s77, 16960
 mvaa 196,96,48
 buffer_load_dwordx4 v1, s[56:59], s76 offen offset:2048 nt lds
 mvaac 200,112,48,220
 v_exp_f32 v192, v192
 mvaa 200,116,52
 v_exp_f32 v193, v193
 mvaa 200,120,56
 v_add_f32 v253, v253, v192
 pk 192,192
 mvaa 200,124,60
 v_exp_f32 v194, v194
 mvaac 204,140,60,220
 s_add_u32 m0, s77, 16992
 v_exp_f32 v195, v195
 mvaa 204,136,56
 buffer_load_dwordx4 v1, s[56:59], s76 offen offset:3072 nt lds
 v_add_f32 v253, v253, v193
 mvaa 204,132,52
 pk 193,194
 v_add_f32 v253, v253, v194
 mvaa 204,128,48
 v_exp_f32 v196, v196
 mvav 80,144,176
 v_exp_f32 v197, v197
 mvav 80,148,184
 pk 194,196
 v_add_f32 v253, v253, v195
 mvav 84,152,176
 v_exp_f32 v198, v198
 mvav 84,156,184
 v_exp_f32 v199, v199
 mvav 88,160,176
 pk 195,198
 v_add_f32 v253, v253, v196
 mvav 88,164,184
 v_exp_f32 v200, v200
 mvav 92,168,176
 v_exp_f32 v201, v201
 mvav 92,172,184
 v_add_f32 v253, v253, v200
 pk 200,200
 mvav 96,176,176
 v_exp_f32 v202, v202
 mvav 96,180,184
 v_exp_f32 v203, v203
 mvav 100,184,176
 v_add_f32 v253, v253, v201
 pk 201,202
 mvav 100,188,184
 v_exp_f32 v204, v204
 mvav 104,192,176
 v_exp_f32 v205, v205
 mvav 104,196,184
 v_add_f32 v253, v253, v202
 pk 202,204
 mvav 108,200,176
 v_exp_f32 v206, v206
 mvav 108,204,184
 v_exp_f32 v207, v207
 mvaac 176,80,64,224
 s_add_u32 s5, s5, s81
 v_add_f32 v253, v253, v203
 pk 203,206
 mvaa 176,84,68
 ds_read_b128 a[80:83], v3 offset:33792
 v_add_f32 v253, v253, v197
 mvaa 176,88,72
 ds_read_b128 a[84:87], v3 offset:33856
 v_add_f32 v253, v253, v198
 mvaa 176,92,76
 ds_read_b128 a[88:91], v3 offset:33920
 v_add_f32 v253, v253, v199
 mvaac 180,108,76,224
 ds_read_b128 a[92:95], v3 offset:33984
 v_add_f32 v253, v253, v204
 mvaa 180,104,72
 s_xor_b32 s76, s5, s39
 ds_read_b128 a[108:111], v3 offset:34240
 v_add_f32 v253, v253, v205
 mvaa 180,100,68
 ds_read_b128 a[104:107], v3 offset:34176
 v_add_f32 v253, v253, v206
 mvaa 180,96,64
 ds_read_b128 a[100:103], v3 offset:34112
 v_add_f32 v253, v253, v207
 mvaac 184,112,64,224
 v_exp_f32 v176, v176
 mvaa 184,116,68
 v_exp_f32 v177, v177
 mvaa 184,120,72
 v_add_f32 v252, v252, v176
 pk 176,176
 mvaa 184,124,76
 v_exp_f32 v178, v178
 mvaac 188,140,76,224
 v_exp_f32 v179, v179
 mvaa 188,136,72
 v_add_f32 v252, v252, v177
 pk 177,178
 mvaa 188,132,68
 v_exp_f32 v180, v180
 mvaa 188,128,64
 v_exp_f32 v181, v181
 mvav 112,144,192
 ds_read_b128 a[96:99], v3 offset:34048
 v_add_f32 v252, v252, v178
 mvav 112,148,200
 ds_read_b128 a[112:115], v3 offset:34304
 pk 178,180
 mvav 116,152,192
 v_exp_f32 v182, v182
 mvav 116,156,200
 ds_read_b128 a[116:119], v3 offset:34368
 ds_read_b128 a[120:123], v3 offset:34432
 mvav 120,160,192
 v_exp_f32 v183, v183
 mvav 120,164,200
 ds_read_b128 a[124:127], v3 offset:34496
 v_add_f32 v252, v252, v179
 mvav 124,168,192
 ds_read_b128 a[140:143], v3 offset:34752
 pk 179,182
 mvav 124,172,200
 v_exp_f32 v184, v184
 mvav 128,176,192
 v_exp_f32 v185, v185
 mvav 128,180,200
 ds_read_b128 a[136:139], v3 offset:34688
 ds_read_b128 a[132:135], v3 offset:34624
 mvav 132,184,192
 v_add_f32 v252, v252, v184
 pk 184,184
 mvav 132,188,200
 v_exp_f32 v186, v186
 mvav 136,192,192
 ds_read_b128 a[128:131], v3 offset:34560
 v_add_f32 v252, v252, v185
 mvav 136,196,200
 v_exp_f32 v187, v187
 mvav 140,200,192
 pk 185,186
 v_add_f32 v252, v252, v186
 mvav 140,204,200
 s_waitcnt lgkmcnt(3)
 v_exp_f32 v188, v188
 mvaac 192,80,0,208
 v_exp_f32 v189, v189
 mvaa 192,84,4
 pk 186,188
 v_add_f32 v252, v252, v187
 mvaa 192,88,8
 v_exp_f32 v190, v190
 mvaa 192,92,12
 v_exp_f32 v191, v191
 mvaac 196,108,12,208
 pk 187,190
 v_add_f32 v252, v252, v180
 mvaa 196,104,8
 v_add_f32 v252, v252, v181
 v_add_f32 v252, v252, v182
 mvaa 196,100,4
 v_add_f32 v252, v252, v183
 v_add_f32 v252, v252, v188
 mvaa 196,96,0
 v_add_f32 v252, v252, v189
 v_add_f32 v252, v252, v190
 mvaac 200,112,0,208
 v_exp_f32 v192, v192
 mvaa 200,116,4
 v_exp_f32 v193, v193
 mvaa 200,120,8
 pk 192,192
 v_add_f32 v252, v252, v191
 mvaa 200,124,12
 v_exp_f32 v194, v194
 mvaac 204,140,12,208
 s_waitcnt lgkmcnt(0)
 v_exp_f32 v195, v195
 mvaa 204,136,8
 v_exp_f32 v196, v196
 mvaa 204,132,4
 v_exp_f32 v197, v197
 mvaa 204,128,0
 pk 193,194
 pk 194,196
 mvav 144,144,176
 v_exp_f32 v198, v198
 mvav 144,148,184
 v_exp_f32 v199, v199
 mvav 148,152,176
 rta 144,4,50688
 pk 195,198
 mvav 148,156,184
 v_exp_f32 v200, v200
 mvav 152,160,176
 v_exp_f32 v201, v201
 mvav 152,164,184
 rta 146,4,50944
 pk 200,200
 mvav 156,168,176
 v_exp_f32 v202, v202
 mvav 156,172,184
 rta 148,4,51200
 rta 150,4,51456
 mvav 160,176,176
 v_exp_f32 v203, v203
 mvav 160,180,184
 rta 152,4,50720
 pk 201,202
 mvav 164,184,176
 rta 154,4,50976
 rta 156,4,51232
 mvav 164,188,184
 v_exp_f32 v204, v204
 mvav 168,192,176
 rta 158,4,51488
 rta 160,4,50752
 mvav 168,196,184
 v_exp_f32 v205, v205
 mvav 172,200,176
 rta 162,4,51008
 pk 202,204
 mvav 172,204,184
 rta 164,4,51264
 rta 166,4,51520
 mvaac 176,80,16,212
 v_exp_f32 v206, v206
 mvaa 176,84,20
 rta 168,4,50784
 rta 170,4,51040
 mvaa 176,88,24
 v_exp_f32 v207, v207
 mvaa 176,92,28
 rta 172,4,51296
 pk 203,206
 mvaac 180,108,28,212
 rta 174,4,51552
 rta 176,4,50816
 mvaa 180,104,24
 rta 178,4,51072
 rta 180,4,51328
 mvaa 180,100,20
 rta 182,4,51584
 rta 184,4,50848
 mvaa 180,96,16
 rta 186,4,51104
 rta 188,4,51360
 mvaac 184,112,16,212
 rta 190,4,51616
 rta 192,4,50880
 mvaa 184,116,20
 rta 194,4,51136
 rta 196,4,51392
 mvaa 184,120,24
 rta 198,4,51648
 rta 200,4,50912
 mvaa 184,124,28
 rta 202,4,51168
 rta 204,4,51424
 mvaac 188,140,28,212
 v_exp_f32 v176, v176
 mvaa 188,136,24
 v_exp_f32 v177, v177
 mvaa 188,132,20
 rta 206,4,51680
 pk 176,176
 mvaa 188,128,16
 s_waitcnt lgkmcnt(11)
 v_exp_f32 v178, v178
 mvav 16,144,192
 v_exp_f32 v179, v179
 mvav 16,148,200
 v_exp_f32 v180, v180
 mvav 20,152,192
 v_exp_f32 v181, v181
 mvav 20,156,200
 pk 177,178
 pk 178,180
 mvav 24,160,192
 v_exp_f32 v182, v182
 mvav 24,164,200
 v_exp_f32 v183, v183
 mvav 28,168,192
 v_exp_f32 v184, v184
 mvav 28,172,200
 pk 179,182
 v_add_f32 v255, v255, v184
 mvav 32,176,192
 v_exp_f32 v185, v185
 mvav 32,180,200
 s_waitcnt lgkmcnt(0)
 pk 184,184
 v_add_f32 v255, v255, v185
 mvav 36,184,192
 v_exp_f32 v186, v186
 mvav 36,188,200
 v_exp_f32 v187, v187
 mvav 40,192,192
 pk 185,186
 v_add_f32 v255, v255, v186
 mvav 40,196,200
 v_exp_f32 v188, v188
 mvav 44,200,192
 v_exp_f32 v189, v189
 mvav 44,204,200
 pk 186,188
 v_add_f32 v255, v255, v187
 maav 208,216,192
 v_exp_f32 v190, v190
 maav 208,216,200
 v_exp_f32 v191, v191
 mvaac 192,80,32,216
 s_waitcnt vmcnt(16)
 s_barrier
 pk 187,190
 mvaa 192,84,36
 v_add_f32 v255, v255, v188
 v_add_f32 v255, v255, v189
 mvaa 192,88,40
 s_add_u32 m0, s77, 33792
 v_add_f32 v255, v255, v190
 v_add_f32 v255, v255, v191
 mvaa 192,92,44
 buffer_load_dwordx4 v1, s[52:55], s76 offen offset:0 nt lds
 v_add_u32 v3, s78, v3
 mvaac 196,108,44,216
 s_add_u32 m0, s77, 33824
 v_add_u32 v4, s78, v4
 mvaa 196,104,40
 buffer_load_dwordx4 v1, s[52:55], s76 offen offset:1024 nt lds
 mvaa 196,100,36
 s_add_u32 m0, s77, 33856
 mvaa 196,96,32
 buffer_load_dwordx4 v1, s[52:55], s76 offen offset:2048 nt lds
 mvaac 200,112,32,216
 v_exp_f32 v192, v192
 mvaa 200,116,36
 v_exp_f32 v193, v193
 mvaa 200,120,40
 v_add_f32 v254, v254, v192
 pk 192,192
 mvaa 200,124,44
 v_exp_f32 v194, v194
 mvaac 204,140,44,216
 v_exp_f32 v195, v195
 mvaa 204,136,40
 v_add_f32 v254, v254, v193
 pk 193,194
 mvaa 204,132,36
 v_exp_f32 v196, v196
 mvaa 204,128,32
 v_exp_f32 v197, v197
 mvav 48,144,176
 v_add_f32 v254, v254, v194
 pk 194,196
 mvav 48,148,184
 v_exp_f32 v198, v198
 mvav 52,152,176
 v_exp_f32 v199, v199
 mvav 52,156,184
 v_add_f32 v254, v254, v195
 pk 195,198
 mvav 56,160,176
 v_exp_f32 v200, v200
 mvav 56,164,184
 v_exp_f32 v201, v201
 mvav 60,168,176
 v_add_f32 v254, v254, v200
 pk 200,200
 mvav 60,172,184
 v_exp_f32 v202, v202
 mvav 64,176,176
 v_exp_f32 v203, v203
 mvav 64,180,184
 v_add_f32 v254, v254, v201
 pk 201,202
 mvav 68,184,176
 v_exp_f32 v204, v204
 mvav 68,188,184
 v_exp_f32 v205, v205
 mvav 72,192,176
 v_add_f32 v254, v254, v202
 pk 202,204
 mvav 72,196,184
 v_exp_f32 v206, v206
 mvav 76,200,176
 v_exp_f32 v207, v207
 mvav 76,204,184
 s_add_u32 m0, s77, 33888
 v_add_f32 v254, v254, v203
 pk 203,206
 maav 212,216,176
 buffer_load_dwordx4 v1, s[52:55], s76 offen offset:3072 nt lds
 v_add_f32 v254, v254, v196
 mvaac 176,80,48,220
 s_add_u32 m0, s77, 50688
 v_add_f32 v254, v254, v197
 v_add_f32 v254, v254, v198
 mvaa 176,84,52
 buffer_load_dwordx4 v1, s[56:59], s76 offen offset:0 nt lds
 v_add_f32 v254, v254, v199
 mvaa 176,88,56
 s_add_u32 m0, s77, 50720
 v_add_f32 v254, v254, v204
 v_add_f32 v254, v254, v205
 mvaa 176,92,60
 buffer_load_dwordx4 v1, s[56:59], s76 offen offset:1024 nt lds
 v_add_f32 v254, v254, v206
 mvaac 180,108,60,220
 s_add_u32 m0, s77, 50752
 v_add_f32 v254, v254, v207
 mvaa 180,104,56
 buffer_load_dwordx4 v1, s[56:59], s76 offen offset:2048 nt lds
 mvaa 180,100,52
 s_add_u32 m0, s77, 50784
 mvaa 180,96,48
 buffer_load_dwordx4 v1, s[56:59], s76 offen offset:3072 nt lds
 mvaac 184,112,48,220
 v_exp_f32 v176, v176
 mvaa 184,116,52
 v_exp_f32 v177, v177
 mvaa 184,120,56
 v_add_f32 v253, v253, v176
 pk 176,176
 mvaa 184,124,60
 v_exp_f32 v178, v178
 mvaac 188,140,60,220
 v_exp_f32 v179, v179
 mvaa 188,136,56
 v_add_f32 v253, v253, v177
 pk 177,178
 mvaa 188,132,52
 v_exp_f32 v180, v180
 mvaa 188,128,48
 v_exp_f32 v181, v181
 mvav 80,144,192
 v_add_f32 v253, v253, v178
 pk 178,180
 mvav 80,148,200
 v_exp_f32 v182, v182
 mvav 84,152,192
 v_exp_f32 v183, v183
 mvav 84,156,200
 v_add_f32 v253, v253, v179
 pk 179,182
 mvav 88,160,192
 v_exp_f32 v184, v184
 mvav 88,164,200
 v_exp_f32 v185, v185
 mvav 92,168,192
 v_add_f32 v253, v253, v184
 pk 184,184
 mvav 92,172,200
 v_exp_f32 v186, v186
 mvav 96,176,192
 v_exp_f32 v187, v187
 mvav 96,180,200
 v_add_f32 v253, v253, v185
 pk 185,186
 mvav 100,184,192
 v_exp_f32 v188, v188
 mvav 100,188,200
 v_exp_f32 v189, v189
 mvav 104,192,192
 v_add_f32 v253, v253, v186
 pk 186,188
 mvav 104,196,200
 v_exp_f32 v190, v190
 mvav 108,200,192
 v_exp_f32 v191, v191
 mvav 108,204,200
 v_add_f32 v253, v253, v187
 pk 187,190
 mvaac 192,80,64,224
 s_add_u32 s5, s5, s81
 v_add_f32 v253, v253, v180
 v_add_f32 v253, v253, v181
 mvaa 192,84,68
 s_add_u32 s77, s77, s78
 ds_read_b128 a[80:83], v3 offset:0
 v_add_f32 v253, v253, v182
 mvaa 192,88,72
 s_sub_u32 s78, 0, s78
 ds_read_b128 a[84:87], v3 offset:64
 v_add_f32 v253, v253, v183
 mvaa 192,92,76
 s_sub_u32 s79, s79, 1
 ds_read_b128 a[88:91], v3 offset:128
 v_add_f32 v253, v253, v188
 mvaac 196,108,76,224
 ds_read_b128 a[92:95], v3 offset:192
 v_add_f32 v253, v253, v189
 mvaa 196,104,72
 s_xor_b32 s76, s5, s39
 ds_read_b128 a[108:111], v3 offset:448
 v_add_f32 v253, v253, v190
 mvaa 196,100,68
 s_cmp_gt_u32 s79, s84
 ds_read_b128 a[104:107], v3 offset:384
 v_add_f32 v253, v253, v191
 mvaa 196,96,64
 ds_read_b128 a[100:103], v3 offset:320
 mvaac 200,112,64,224
 v_exp_f32 v192, v192
 mvaa 200,116,68
 v_exp_f32 v193, v193
 mvaa 200,120,72
 v_add_f32 v252, v252, v192
 pk 192,192
 mvaa 200,124,76
 v_exp_f32 v194, v194
 mvaac 204,140,76,224
 v_exp_f32 v195, v195
 mvaa 204,136,72
 v_add_f32 v252, v252, v193
 pk 193,194
 mvaa 204,132,68
 v_exp_f32 v196, v196
 mvaa 204,128,64
 v_exp_f32 v197, v197
 mvav 112,144,176
 ds_read_b128 a[96:99], v3 offset:256
 v_add_f32 v252, v252, v194
 mvav 112,148,184
 ds_read_b128 a[112:115], v3 offset:512
 pk 194,196
 mvav 116,152,176
 v_exp_f32 v198, v198
 mvav 116,156,184
 ds_read_b128 a[116:119], v3 offset:576
 ds_read_b128 a[120:123], v3 offset:640
 mvav 120,160,176
 v_exp_f32 v199, v199
 mvav 120,164,184
 ds_read_b128 a[124:127], v3 offset:704
 v_add_f32 v252, v252, v195
 mvav 124,168,176
 ds_read_b128 a[140:143], v3 offset:960
 pk 195,198
 mvav 124,172,184
 v_exp_f32 v200, v200
 mvav 128,176,176
 v_exp_f32 v201, v201
 mvav 128,180,184
 ds_read_b128 a[136:139], v3 offset:896
 ds_read_b128 a[132:135], v3 offset:832
 mvav 132,184,176
 v_add_f32 v252, v252, v200
 pk 200,200
 mvav 132,188,184
 v_exp_f32 v202, v202
 mvav 136,192,176
 ds_read_b128 a[128:131], v3 offset:768
 v_add_f32 v252, v252, v201
 mvav 136,196,184
 v_exp_f32 v203, v203
 mvav 140,200,176
 pk 201,202
 v_add_f32 v252, v252, v202
 mvav 140,204,184
 s_cbranch_scc1 L15_loop
 s_cmp_eq_u32 s79, 3
 s_cbranch_scc1 L15_hk3
L15_tail:
 v_exp_f32 v204, v204
 v_exp_f32 v205, v205
 s_nop 0
 pk 202,204
 v_add_f32 v252, v252, v203
 v_exp_f32 v206, v206
 v_exp_f32 v207, v207
 s_nop 0
 pk 203,206
 mvav 144,144,192
 v_add_f32 v252, v252, v196
 v_add_f32 v252, v252, v197
 mvav 144,148,200
 v_add_f32 v252, v252, v198
 v_add_f32 v252, v252, v199
 mvav 148,152,192
 v_add_f32 v252, v252, v204
 v_add_f32 v252, v252, v205
 mvav 148,156,200
 v_add_f32 v252, v252, v206
 v_add_f32 v252, v252, v207
 mvav 152,160,192
 v_mov_b32 v209, v255
 v_mov_b32 v210, v254
 mvav 152,164,200
 v_mov_b32 v211, v253
 v_mov_b32 v212, v252
 mvav 156,168,192
 v_permlane32_swap_b32 v255, v209
 v_permlane32_swap_b32 v254, v210
 mvav 156,172,200
 v_permlane32_swap_b32 v253, v211
 v_permlane32_swap_b32 v252, v212
 mvav 160,176,192
 v_add_f32 v255, v255, v209
 v_add_f32 v254, v254, v210
 mvav 160,180,200
 v_add_f32 v253, v253, v211
 v_add_f32 v252, v252, v212
 mvav 164,184,192
 v_mov_b32 v209, v255
 v_mov_b32 v210, v254
 mvav 164,188,200
 v_mov_b32 v211, v253
 v_mov_b32 v212, v252
 mvav 168,192,192
 v_permlane16_swap_b32 v255, v209
 v_permlane16_swap_b32 v254, v210
 mvav 168,196,200
 v_permlane16_swap_b32 v253, v211
 v_permlane16_swap_b32 v252, v212
 mvav 172,200,192
 v_add_f32 v255, v255, v209
 v_add_f32 v254, v254, v210
 mvav 172,204,200
 v_add_f32 v253, v253, v211
 v_add_f32 v252, v252, v212
 v_accvgpr_read_b32 v6, a208
 v_accvgpr_read_b32 v7, a212
 v_add_f32 v7, v7, v255
 v_mov_b32 v8, v254
 v_mov_b32 v9, v253
 v_mov_b32 v10, v252
 v_add_f32 v14, v6, v7
 v_add_f32 v14, v14, v8
 v_add_f32 v14, v14, v9
 v_add_f32 v14, v14, v10
 v_cmp_ngt_f32 s[94:95], s91, v14
 v_rcp_f32 v6, v6
 v_rcp_f32 v7, v7
 v_rcp_f32 v8, v8
 v_rcp_f32 v9, v9
 v_rcp_f32 v10, v10
 s_cmp_eq_u64 s[94:95], 0
 s_cbranch_scc1 L15_ok
 s_lshl_b32 s3, 1, s43
 s_or_b32 s87, s87, s3
 s_add_u32 s86, s90, 0
 buffer_store_dwordx4 a[0:3], v2, s[64:67], s86 offen offset:0
 buffer_store_dwordx4 a[4:7], v2, s[64:67], s86 offen offset:1024
 buffer_store_dwordx4 a[8:11], v2, s[64:67], s86 offen offset:2048
 buffer_store_dwordx4 a[12:15], v2, s[64:67], s86 offen offset:3072
 s_add_u32 s86, s90, 4096
 buffer_store_dwordx4 a[16:19], v2, s[64:67], s86 offen offset:0
 buffer_store_dwordx4 a[20:23], v2, s[64:67], s86 offen offset:1024
 buffer_store_dwordx4 a[24:27], v2, s[64:67], s86 offen offset:2048
 buffer_store_dwordx4 a[28:31], v2, s[64:67], s86 offen offset:3072
 s_add_u32 s86, s90, 8192
 buffer_store_dwordx4 a[32:35], v2, s[64:67], s86 offen offset:0
 buffer_store_dwordx4 a[36:39], v2, s[64:67], s86 offen offset:1024
 buffer_store_dwordx4 a[40:43], v2, s[64:67], s86 offen offset:2048
 buffer_store_dwordx4 a[44:47], v2, s[64:67], s86 offen offset:3072
 s_add_u32 s86, s90, 12288
 buffer_store_dwordx4 a[48:51], v2, s[64:67], s86 offen offset:0
 buffer_store_dwordx4 a[52:55], v2, s[64:67], s86 offen offset:1024
 buffer_store_dwordx4 a[56:59], v2, s[64:67], s86 offen offset:2048
 buffer_store_dwordx4 a[60:63], v2, s[64:67], s86 offen offset:3072
 s_add_u32 s86, s90, 16384
 buffer_store_dwordx4 a[64:67], v2, s[64:67], s86 offen offset:0
 buffer_store_dwordx4 a[68:71], v2, s[64:67], s86 offen offset:1024
 buffer_store_dwordx4 a[72:75], v2, s[64:67], s86 offen offset:2048
 buffer_store_dwordx4 a[76:79], v2, s[64:67], s86 offen offset:3072
 s_waitcnt vmcnt(0) lgkmcnt(0)
 s_nop 7
L15_ok:
 s_lshl_b32 s3, s42, 1
 s_add_u32 s3, s3, 163776
 v_mov_b32 v14, s3
 v_mov_b32 v15, s87
 ds_write_b16 v14, v15
 s_cmp_lg_u32 s43, 0
 s_cbranch_scc1 L15_last
 s_mov_b32 s3, 67584
 v_lshrrev_b32 v15, 2, v0
 v_and_or_b32 v15, v15, 48, s3
 ds_read_b128 v[176:179], v15 offset:0
 ds_read_b128 v[180:183], v15 offset:64
 ds_read_b128 v[184:187], v15 offset:128
 ds_read_b128 v[188:191], v15 offset:192
 s_mul_i32 s3, s42, 7168
 s_add_u32 s3, s3, 135168
 v_add_u32 v14, s3, v2
 ds_read_b128 a[0:3], v14 offset:4096
 ds_read_b128 a[16:19], v14 offset:0
 ds_read_b128 a[20:23], v14 offset:1024
 ds_read_b128 a[24:27], v14 offset:2048
 ds_read_b128 a[28:31], v14 offset:3072
 v_accvgpr_write_b32 a4, v240
 v_accvgpr_write_b32 a5, v241
 v_accvgpr_write_b32 a6, v242
 v_accvgpr_write_b32 a7, v243
 v_accvgpr_write_b32 a8, v244
 v_accvgpr_write_b32 a9, v245
 v_accvgpr_write_b32 a10, v246
 v_accvgpr_write_b32 a11, v247
 v_accvgpr_write_b32 a12, v248
 v_accvgpr_write_b32 a13, v249
 v_accvgpr_write_b32 a14, v250
 v_accvgpr_write_b32 a15, v251
 v_accvgpr_write_b32 a32, v228
 v_accvgpr_write_b32 a33, v229
 v_accvgpr_write_b32 a34, v230
 v_accvgpr_write_b32 a35, v231
 v_accvgpr_write_b32 a36, v232
 v_accvgpr_write_b32 a37, v233
 v_accvgpr_write_b32 a38, v234
 v_accvgpr_write_b32 a39, v235
 v_accvgpr_write_b32 a40, v236
 v_accvgpr_write_b32 a41, v237
 v_accvgpr_write_b32 a42, v238
 v_accvgpr_write_b32 a43, v239
 v_accvgpr_mov_b32 a44, a220
 v_accvgpr_mov_b32 a45, a221
 v_accvgpr_mov_b32 a46, a222
 v_accvgpr_mov_b32 a47, a223
 v_accvgpr_mov_b32 a48, a224
 v_accvgpr_mov_b32 a49, a225
 v_accvgpr_mov_b32 a50, a226
 v_accvgpr_mov_b32 a51, a227
 v_accvgpr_mov_b32 a52, a228
 v_accvgpr_mov_b32 a53, a229
 v_accvgpr_mov_b32 a54, a230
 v_accvgpr_mov_b32 a55, a231
 v_accvgpr_mov_b32 a56, a232
 v_accvgpr_mov_b32 a57, a233
 v_accvgpr_mov_b32 a58, a234
 v_accvgpr_mov_b32 a59, a235
 v_accvgpr_mov_b32 a60, a236
 v_accvgpr_mov_b32 a61, a237
 v_accvgpr_mov_b32 a62, a238
 v_accvgpr_mov_b32 a63, a239
 v_accvgpr_mov_b32 a64, a240
 v_accvgpr_mov_b32 a65, a241
 v_accvgpr_mov_b32 a66, a242
 v_accvgpr_mov_b32 a67, a243
 v_accvgpr_mov_b32 a68, a244
 v_accvgpr_mov_b32 a69, a245
 v_accvgpr_mov_b32 a70, a246
 v_accvgpr_mov_b32 a71, a247
 v_accvgpr_mov_b32 a72, a248
 v_accvgpr_mov_b32 a73, a249
 v_accvgpr_mov_b32 a74, a250
 v_accvgpr_mov_b32 a75, a251
 v_accvgpr_mov_b32 a76, a252
 v_accvgpr_mov_b32 a77, a253
 v_accvgpr_mov_b32 a78, a254
 v_accvgpr_mov_b32 a79, a255
 s_waitcnt lgkmcnt(8)
 v_xor_b32 v176, 0x80008000, v176
 v_xor_b32 v177, 0x80008000, v177
 v_xor_b32 v178, 0x80008000, v178
 v_xor_b32 v179, 0x80008000, v179
 s_waitcnt lgkmcnt(7)
 v_xor_b32 v180, 0x80008000, v180
 v_xor_b32 v181, 0x80008000, v181
 v_xor_b32 v182, 0x80008000, v182
 v_xor_b32 v183, 0x80008000, v183
 s_waitcnt lgkmcnt(6)
 v_xor_b32 v184, 0x80008000, v184
 v_xor_b32 v185, 0x80008000, v185
 v_xor_b32 v186, 0x80008000, v186
 v_xor_b32 v187, 0x80008000, v187
 s_waitcnt lgkmcnt(5)
 v_xor_b32 v188, 0x80008000, v188
 v_xor_b32 v189, 0x80008000, v189
 v_xor_b32 v190, 0x80008000, v190
 v_xor_b32 v191, 0x80008000, v191
 v_pk_mul_f32 v[16:17], v[16:17], v[6:7] op_sel_hi:[1,0]
 v_pk_mul_f32 v[18:19], v[18:19], v[6:7] op_sel_hi:[1,0]
 v_pk_mul_f32 v[20:21], v[20:21], v[6:7] op_sel_hi:[1,0]
 v_pk_mul_f32 v[22:23], v[22:23], v[6:7] op_sel_hi:[1,0]
 s_waitcnt lgkmcnt(4)
 mvvaz 208,176,0
 pk 16,16
 pk 17,18
 pk 18,20
 pk 19,22
 s_mov_b32 s86, 0
 buffer_store_dwordx4 v[16:19], v2, s[60:63], s86 offen offset:0 sc1
 ds_write_b128 v14, v[16:19] offset:0
 v_pk_mul_f32 v[48:49], v[48:49], v[6:7] op_sel:[0,1]
 v_pk_mul_f32 v[50:51], v[50:51], v[6:7] op_sel:[0,1]
 v_pk_mul_f32 v[52:53], v[52:53], v[6:7] op_sel:[0,1]
 v_pk_mul_f32 v[54:55], v[54:55], v[6:7] op_sel:[0,1]
 mvva 208,180,4
 pk 48,48
 pk 49,50
 pk 50,52
 pk 51,54
 s_mov_b32 s86, 0
 buffer_store_dwordx4 v[48:51], v2, s[60:63], s86 offen offset:1024 sc1
 ds_write_b128 v14, v[48:51] offset:1024
 v_pk_mul_f32 v[80:81], v[80:81], v[8:9] op_sel_hi:[1,0]
 v_pk_mul_f32 v[82:83], v[82:83], v[8:9] op_sel_hi:[1,0]
 v_pk_mul_f32 v[84:85], v[84:85], v[8:9] op_sel_hi:[1,0]
 v_pk_mul_f32 v[86:87], v[86:87], v[8:9] op_sel_hi:[1,0]
 mvva 208,184,8
 pk 80,80
 pk 81,82
 pk 82,84
 pk 83,86
 s_mov_b32 s86, 0
 buffer_store_dwordx4 v[80:83], v2, s[60:63], s86 offen offset:2048 sc1
 ds_write_b128 v14, v[80:83] offset:2048
 v_pk_mul_f32 v[112:113], v[112:113], v[8:9] op_sel:[0,1]
 v_pk_mul_f32 v[114:115], v[114:115], v[8:9] op_sel:[0,1]
 v_pk_mul_f32 v[116:117], v[116:117], v[8:9] op_sel:[0,1]
 v_pk_mul_f32 v[118:119], v[118:119], v[8:9] op_sel:[0,1]
 mvva 208,188,12
 pk 112,112
 pk 113,114
 pk 114,116
 pk 115,118
 s_mov_b32 s86, 0
 buffer_store_dwordx4 v[112:115], v2, s[60:63], s86 offen offset:3072 sc1
 ds_write_b128 v14, v[112:115] offset:3072
 v_pk_mul_f32 v[144:145], v[144:145], v[10:11] op_sel_hi:[1,0]
 v_pk_mul_f32 v[146:147], v[146:147], v[10:11] op_sel_hi:[1,0]
 v_pk_mul_f32 v[148:149], v[148:149], v[10:11] op_sel_hi:[1,0]
 v_pk_mul_f32 v[150:151], v[150:151], v[10:11] op_sel_hi:[1,0]
 s_waitcnt lgkmcnt(7)
 mvvaz 212,176,16
 pk 144,144
 pk 145,146
 pk 146,148
 pk 147,150
 s_mov_b32 s86, 4096
 buffer_store_dwordx4 v[144:147], v2, s[60:63], s86 offen offset:0 sc1
 ds_write_b128 v14, v[144:147] offset:4096
 v_pk_mul_f32 v[24:25], v[24:25], v[6:7] op_sel_hi:[1,0]
 v_pk_mul_f32 v[26:27], v[26:27], v[6:7] op_sel_hi:[1,0]
 v_pk_mul_f32 v[28:29], v[28:29], v[6:7] op_sel_hi:[1,0]
 v_pk_mul_f32 v[30:31], v[30:31], v[6:7] op_sel_hi:[1,0]
 s_waitcnt lgkmcnt(7)
 mvva 212,180,20
 pk 240,24
 pk 241,26
 pk 242,28
 pk 243,30
 v_pk_mul_f32 v[56:57], v[56:57], v[6:7] op_sel:[0,1]
 v_pk_mul_f32 v[58:59], v[58:59], v[6:7] op_sel:[0,1]
 v_pk_mul_f32 v[60:61], v[60:61], v[6:7] op_sel:[0,1]
 v_pk_mul_f32 v[62:63], v[62:63], v[6:7] op_sel:[0,1]
 s_waitcnt lgkmcnt(6)
 mvva 212,184,24
 pk 244,56
 pk 245,58
 pk 246,60
 pk 247,62
 v_pk_mul_f32 v[88:89], v[88:89], v[8:9] op_sel_hi:[1,0]
 v_pk_mul_f32 v[90:91], v[90:91], v[8:9] op_sel_hi:[1,0]
 v_pk_mul_f32 v[92:93], v[92:93], v[8:9] op_sel_hi:[1,0]
 v_pk_mul_f32 v[94:95], v[94:95], v[8:9] op_sel_hi:[1,0]
 s_waitcnt lgkmcnt(5)
 mvva 212,188,28
 pk 248,88
 pk 249,90
 pk 250,92
 pk 251,94
 v_pk_mul_f32 v[120:121], v[120:121], v[8:9] op_sel:[0,1]
 v_pk_mul_f32 v[122:123], v[122:123], v[8:9] op_sel:[0,1]
 v_pk_mul_f32 v[124:125], v[124:125], v[8:9] op_sel:[0,1]
 v_pk_mul_f32 v[126:127], v[126:127], v[8:9] op_sel:[0,1]
 mvvaz 216,176,32
 pk 228,120
 pk 229,122
 pk 230,124
 pk 231,126
 v_pk_mul_f32 v[152:153], v[152:153], v[10:11] op_sel_hi:[1,0]
 v_pk_mul_f32 v[154:155], v[154:155], v[10:11] op_sel_hi:[1,0]
 v_pk_mul_f32 v[156:157], v[156:157], v[10:11] op_sel_hi:[1,0]
 v_pk_mul_f32 v[158:159], v[158:159], v[10:11] op_sel_hi:[1,0]
 mvva 216,180,36
 pk 232,152
 pk 233,154
 pk 234,156
 pk 235,158
 v_pk_mul_f32 v[32:33], v[32:33], v[6:7] op_sel_hi:[1,0]
 v_pk_mul_f32 v[34:35], v[34:35], v[6:7] op_sel_hi:[1,0]
 v_pk_mul_f32 v[36:37], v[36:37], v[6:7] op_sel_hi:[1,0]
 v_pk_mul_f32 v[38:39], v[38:39], v[6:7] op_sel_hi:[1,0]
 mvva 216,184,40
 pk 236,32
 pk 237,34
 pk 238,36
 pk 239,38
 v_pk_mul_f32 v[64:65], v[64:65], v[6:7] op_sel:[0,1]
 v_pk_mul_f32 v[66:67], v[66:67], v[6:7] op_sel:[0,1]
 v_pk_mul_f32 v[68:69], v[68:69], v[6:7] op_sel:[0,1]
 v_pk_mul_f32 v[70:71], v[70:71], v[6:7] op_sel:[0,1]
 mvva 216,188,44
 pk 64,64
 pk 65,66
 pk 66,68
 pk 67,70
 v_accvgpr_write_b32 a220, v64
 v_accvgpr_write_b32 a221, v65
 v_accvgpr_write_b32 a222, v66
 v_accvgpr_write_b32 a223, v67
 v_pk_mul_f32 v[96:97], v[96:97], v[8:9] op_sel_hi:[1,0]
 v_pk_mul_f32 v[98:99], v[98:99], v[8:9] op_sel_hi:[1,0]
 v_pk_mul_f32 v[100:101], v[100:101], v[8:9] op_sel_hi:[1,0]
 v_pk_mul_f32 v[102:103], v[102:103], v[8:9] op_sel_hi:[1,0]
 mvvaz 220,176,48
 pk 96,96
 pk 97,98
 pk 98,100
 pk 99,102
 v_accvgpr_write_b32 a224, v96
 v_accvgpr_write_b32 a225, v97
 v_accvgpr_write_b32 a226, v98
 v_accvgpr_write_b32 a227, v99
 v_pk_mul_f32 v[128:129], v[128:129], v[8:9] op_sel:[0,1]
 v_pk_mul_f32 v[130:131], v[130:131], v[8:9] op_sel:[0,1]
 v_pk_mul_f32 v[132:133], v[132:133], v[8:9] op_sel:[0,1]
 v_pk_mul_f32 v[134:135], v[134:135], v[8:9] op_sel:[0,1]
 mvva 220,180,52
 pk 128,128
 pk 129,130
 pk 130,132
 pk 131,134
 v_accvgpr_write_b32 a228, v128
 v_accvgpr_write_b32 a229, v129
 v_accvgpr_write_b32 a230, v130
 v_accvgpr_write_b32 a231, v131
 v_pk_mul_f32 v[160:161], v[160:161], v[10:11] op_sel_hi:[1,0]
 v_pk_mul_f32 v[162:163], v[162:163], v[10:11] op_sel_hi:[1,0]
 v_pk_mul_f32 v[164:165], v[164:165], v[10:11] op_sel_hi:[1,0]
 v_pk_mul_f32 v[166:167], v[166:167], v[10:11] op_sel_hi:[1,0]
 mvva 220,184,56
 pk 160,160
 pk 161,162
 pk 162,164
 pk 163,166
 v_accvgpr_write_b32 a232, v160
 v_accvgpr_write_b32 a233, v161
 v_accvgpr_write_b32 a234, v162
 v_accvgpr_write_b32 a235, v163
 v_pk_mul_f32 v[40:41], v[40:41], v[6:7] op_sel_hi:[1,0]
 v_pk_mul_f32 v[42:43], v[42:43], v[6:7] op_sel_hi:[1,0]
 v_pk_mul_f32 v[44:45], v[44:45], v[6:7] op_sel_hi:[1,0]
 v_pk_mul_f32 v[46:47], v[46:47], v[6:7] op_sel_hi:[1,0]
 mvva 220,188,60
 pk 40,40
 pk 41,42
 pk 42,44
 pk 43,46
 v_accvgpr_write_b32 a236, v40
 v_accvgpr_write_b32 a237, v41
 v_accvgpr_write_b32 a238, v42
 v_accvgpr_write_b32 a239, v43
 v_pk_mul_f32 v[72:73], v[72:73], v[6:7] op_sel:[0,1]
 v_pk_mul_f32 v[74:75], v[74:75], v[6:7] op_sel:[0,1]
 v_pk_mul_f32 v[76:77], v[76:77], v[6:7] op_sel:[0,1]
 v_pk_mul_f32 v[78:79], v[78:79], v[6:7] op_sel:[0,1]
 mvvaz 224,176,64
 pk 72,72
 pk 73,74
 pk 74,76
 pk 75,78
 v_accvgpr_write_b32 a240, v72
 v_accvgpr_write_b32 a241, v73
 v_accvgpr_write_b32 a242, v74
 v_accvgpr_write_b32 a243, v75
 v_pk_mul_f32 v[104:105], v[104:105], v[8:9] op_sel_hi:[1,0]
 v_pk_mul_f32 v[106:107], v[106:107], v[8:9] op_sel_hi:[1,0]
 v_pk_mul_f32 v[108:109], v[108:109], v[8:9] op_sel_hi:[1,0]
 v_pk_mul_f32 v[110:111], v[110:111], v[8:9] op_sel_hi:[1,0]
 mvva 224,180,68
 pk 104,104
 pk 105,106
 pk 106,108
 pk 107,110
 v_accvgpr_write_b32 a244, v104
 v_accvgpr_write_b32 a245, v105
 v_accvgpr_write_b32 a246, v106
 v_accvgpr_write_b32 a247, v107
 v_pk_mul_f32 v[136:137], v[136:137], v[8:9] op_sel:[0,1]
 v_pk_mul_f32 v[138:139], v[138:139], v[8:9] op_sel:[0,1]
 v_pk_mul_f32 v[140:141], v[140:141], v[8:9] op_sel:[0,1]
 v_pk_mul_f32 v[142:143], v[142:143], v[8:9] op_sel:[0,1]
 mvva 224,184,72
 pk 136,136
 pk 137,138
 pk 138,140
 pk 139,142
 v_accvgpr_write_b32 a248, v136
 v_accvgpr_write_b32 a249, v137
 v_accvgpr_write_b32 a250, v138
 v_accvgpr_write_b32 a251, v139
 v_pk_mul_f32 v[168:169], v[168:169], v[10:11] op_sel_hi:[1,0]
 v_pk_mul_f32 v[170:171], v[170:171], v[10:11] op_sel_hi:[1,0]
 v_pk_mul_f32 v[172:173], v[172:173], v[10:11] op_sel_hi:[1,0]
 v_pk_mul_f32 v[174:175], v[174:175], v[10:11] op_sel_hi:[1,0]
 mvva 224,188,76
 pk 168,168
 pk 169,170
 pk 170,172
 pk 171,174
 v_accvgpr_write_b32 a252, v168
 v_accvgpr_write_b32 a253, v169
 v_accvgpr_write_b32 a254, v170
 v_accvgpr_write_b32 a255, v171
 v_mov_b32 v255, 0
 v_mov_b32 v254, 0
 v_mov_b32 v253, 0
 v_mov_b32 v252, 0
 s_mov_b32 s84, 3
 s_mov_b32 s90, 20480
 s_mov_b32 s43, 1
 s_branch L15_head
L15_last:
 s_mul_i32 s3, s42, 7168
 s_add_u32 s3, s3, 135168
 v_add_u32 v14, s3, v2
 ds_read_b128 a[160:163], v14 offset:0
 ds_read_b128 a[164:167], v14 offset:1024
 ds_read_b128 a[168:171], v14 offset:2048
 ds_read_b128 a[172:175], v14 offset:3072
 ds_read_b128 a[176:179], v14 offset:4096
 s_and_b32 s3, s98, 0x10001
 s_cbranch_scc1 L15_careful
 s_waitcnt vmcnt(17)
 v_cmp_ne_u32 vcc, 65535, v13
 s_nop 1
 s_and_b64 vcc, vcc, 1
 s_cbranch_scc1 L15_spin1
L15_s1:
L15_op:
 s_add_u32 s3, s8, 0
 s_and_b32 s3, s3, 3
 s_lshl_b32 s3, s3, 6
 s_add_u32 s3, s3, 67584
 v_add_u32 v208, s3, v5
 rtv 176,208,0
 rtv 178,208,256
 rtv 180,208,512
 rtv 182,208,768
 rtv 184,208,8
 rtv 186,208,264
 rtv 188,208,520
 rtv 190,208,776
 s_andn2_b32 s4, 1, s87
 v_mov_b32 v14, s4
 s_lshl_b32 s3, s9, 6
 s_mov_b64 exec, 1
 s_waitcnt vmcnt(16)
 buffer_store_dword v14, off, s[44:47], s3 offset:4 sc1
 s_mov_b64 exec, -1
 s_nop 2
 s_add_u32 s3, s8, 1
 s_and_b32 s3, s3, 3
 s_lshl_b32 s3, s3, 6
 s_add_u32 s3, s3, 67584
 v_add_u32 v209, s3, v5
 s_add_u32 s3, s8, 2
 s_and_b32 s3, s3, 3
 s_lshl_b32 s3, s3, 6
 s_add_u32 s3, s3, 67584
 v_add_u32 v210, s3, v5
 s_add_u32 s3, s8, 3
 s_and_b32 s3, s3, 3
 s_lshl_b32 s3, s3, 6
 s_add_u32 s3, s3, 67584
 v_add_u32 v211, s3, v5
 v_lshlrev_b32 v14, 5, v0
 s_and_b32 s3, s85, 12
 s_lshr_b32 s3, 0x7536, s3
 s_and_b32 s3, s3, 7
 s_xor_b32 s3, s3, s9
 s_lshl_b32 s3, s3, 17
 s_lshl_b32 s4, s42, 15
 s_add_u32 s3, s3, s4
 v_and_b32 v15, 128, v14
 v_lshrrev_b32 v14, 3, v0
 v_lshl_add_u32 v14, v14, 10, v15
 s_mov_b32 exec_lo, 0
 buffer_load_dword v13, v14, s[68:71], s3 offen
 s_mov_b32 exec_lo, -1
 s_nop 2
 s_lshl_b32 s3, s9, 6
 v_mov_b32 v219, s3
 v_cmp_eq_u32 vcc, 0, v0
 s_lshr_b32 s4, s87, 1
 s_xor_b32 s4, s4, 1
 v_mov_b32 v218, s4
 v_cndmask_b32 v219, 0x40000000, v219, vcc
L15_16_op:
 s_waitcnt lgkmcnt(6)
 mavaz 0,176,160
 s_waitcnt lgkmcnt(4)
 rtv 192,209,0
 v_mul_f32 v16, v6, v16
 mavv 0,180,240
 rtv 194,209,256
 v_mul_f32 v17, v6, v17
 mavvz 32,180,244
 rtv 196,209,512
 v_mul_f32 v18, v6, v18
 mava 32,176,164
 rtv 198,209,768
 v_mul_f32 v19, v6, v19
 mavaz 64,176,168
 v_mul_f32 v20, v6, v20
 v_mul_f32 v21, v6, v21
 mavv 64,180,248
 v_mul_f32 v22, v6, v22
 v_mul_f32 v23, v6, v23
 mavvz 96,180,228
 pk 16,16
 pk 17,18
 mava 96,176,172
 pk 18,20
 pk 19,22
 mavaz 128,176,176
 v_mul_f32 v48, v7, v48
 v_mul_f32 v49, v7, v49
 mavv 128,180,232
 s_waitcnt lgkmcnt(3)
 s_mov_b32 s86, 20480
 buffer_store_dwordx4 v[16:19], v2, s[60:63], s86 offen offset:0 sc1
 v_mul_f32 v50, v7, v50
 mavvz 132,188,232
 rtv 200,209,8
 v_mul_f32 v51, v7, v51
 mava 132,184,176
 rtv 202,209,264
 v_mul_f32 v52, v7, v52
 mavaz 100,184,172
 rtv 204,209,520
 v_mul_f32 v53, v7, v53
 mavv 100,188,228
 rtv 206,209,776
 v_mul_f32 v54, v7, v54
 mavvz 68,188,248
 v_mul_f32 v55, v7, v55
 pk 48,48
 mava 68,184,168
 pk 49,50
 pk 50,52
 mavaz 36,184,164
 pk 51,54
 v_mul_f32 v80, v8, v80
 mavv 36,188,244
 v_mul_f32 v81, v8, v81
 v_mul_f32 v82, v8, v82
 mavvz 4,188,240
 s_mov_b32 s86, 20480
 buffer_store_dwordx4 v[48:51], v2, s[60:63], s86 offen offset:1024 sc1
 v_mul_f32 v83, v8, v83
 mava 4,184,160
 s_waitcnt lgkmcnt(3)
 v_mul_f32 v84, v8, v84
 v_mul_f32 v85, v8, v85
 mavaz 8,192,160
 rtv 176,210,0
 v_mul_f32 v86, v8, v86
 mavv 8,196,240
 rtv 178,210,256
 v_mul_f32 v87, v8, v87
 mavvz 40,196,244
 rtv 180,210,512
 pk 80,80
 mava 40,192,164
 rtv 182,210,768
 pk 81,82
 mavaz 72,192,168
 pk 82,84
 pk 83,86
 mavv 72,196,248
 v_mul_f32 v112, v9, v112
 v_mul_f32 v113, v9, v113
 mavvz 104,196,228
 v_mul_f32 v114, v9, v114
 v_mul_f32 v115, v9, v115
 mava 104,192,172
 s_mov_b32 s86, 20480
 buffer_store_dwordx4 v[80:83], v2, s[60:63], s86 offen offset:2048 sc1
 v_mul_f32 v116, v9, v116
 mavaz 136,192,176
 v_mul_f32 v117, v9, v117
 v_mul_f32 v118, v9, v118
 mavv 136,196,232
 s_waitcnt lgkmcnt(3)
 v_mul_f32 v119, v9, v119
 pk 112,112
 mavvz 140,204,232
 rtv 184,210,8
 pk 113,114
 mava 140,200,176
 rtv 186,210,264
 pk 114,116
 mavaz 108,200,172
 rtv 188,210,520
 pk 115,118
 mavv 108,204,228
 rtv 190,210,776
 v_mul_f32 v144, v10, v144
 mavvz 76,204,248
 v_mul_f32 v145, v10, v145
 v_mul_f32 v146, v10, v146
 mava 76,200,168
 v_mul_f32 v147, v10, v147
 v_mul_f32 v148, v10, v148
 mavaz 44,200,164
 s_mov_b32 s86, 20480
 buffer_store_dwordx4 v[112:115], v2, s[60:63], s86 offen offset:3072 sc1
 v_mul_f32 v149, v10, v149
 mavv 44,204,244
 v_mul_f32 v150, v10, v150
 v_mul_f32 v151, v10, v151
 mavvz 12,204,240
 pk 144,144
 pk 145,146
 mava 12,200,160
 s_waitcnt lgkmcnt(3)
 pk 146,148
 pk 147,150
 mavaz 16,176,160
 rtv 192,211,0
 v_mul_f32 v24, v6, v24
 mavv 16,180,240
 rtv 194,211,256
 v_mul_f32 v25, v6, v25
 mavvz 48,180,244
 rtv 196,211,512
 v_mul_f32 v26, v6, v26
 mava 48,176,164
 rtv 198,211,768
 v_mul_f32 v27, v6, v27
 mavaz 80,176,168
 v_mul_f32 v28, v6, v28
 v_mul_f32 v29, v6, v29
 mavv 80,180,248
 s_mov_b32 s86, 24576
 buffer_store_dwordx4 v[144:147], v2, s[60:63], s86 offen offset:0 sc1
 v_mul_f32 v30, v6, v30
 mavvz 112,180,228
 v_mul_f32 v31, v6, v31
 pk 24,24
 mava 112,176,172
 pk 25,26
 pk 26,28
 mavaz 144,176,176
 pk 27,30
 v_mul_f32 v56, v7, v56
 mavv 144,180,232
 s_waitcnt lgkmcnt(3)
 v_mul_f32 v57, v7, v57
 v_mul_f32 v58, v7, v58
 mavvz 148,188,232
 rtv 200,211,8
 v_mul_f32 v59, v7, v59
 mava 148,184,176
 rtv 202,211,264
 v_mul_f32 v60, v7, v60
 mavaz 116,184,172
 rtv 204,211,520
 v_mul_f32 v61, v7, v61
 mavv 116,188,228
 rtv 206,211,776
 v_mul_f32 v62, v7, v62
 mavvz 84,188,248
 s_mov_b32 s86, 24576
 buffer_store_dwordx4 v[24:27], v2, s[60:63], s86 offen offset:1024 sc1
 v_mul_f32 v63, v7, v63
 mava 84,184,168
 pk 56,56
 pk 57,58
 mavaz 52,184,164
 pk 58,60
 pk 59,62
 mavv 52,188,244
 v_mul_f32 v88, v8, v88
 v_mul_f32 v89, v8, v89
 mavvz 20,188,240
 v_mul_f32 v90, v8, v90
 v_mul_f32 v91, v8, v91
 mava 20,184,160
 s_waitcnt lgkmcnt(3)
 v_mul_f32 v92, v8, v92
 v_mul_f32 v93, v8, v93
 mavaz 24,192,160
 s_waitcnt lgkmcnt(0)
 s_barrier
 mavv 24,196,240
 rtv 176,208,16896
 v_mul_f32 v94, v8, v94
 mavvz 56,196,244
 rtv 178,208,17152
 v_mul_f32 v95, v8, v95
 mava 56,192,164
 s_add_u32 m0, s92, 67584
 rtv 180,208,17408
 pk 88,88
 mavaz 88,192,168
 s_xor_b32 s83, s9, 6
 s_mul_i32 s83, s83, 131072
 rtv 182,208,17664
 mavv 88,196,248
 buffer_load_dwordx4 v11, s[68:71], s83 offen offset:0 lds
 pk 89,90
 mavvz 120,196,228
 s_add_u32 m0, s92, 67616
 pk 90,92
 pk 91,94
 mava 120,192,172
 buffer_load_dwordx4 v11, s[68:71], s83 offen offset:1024 lds
 v_mul_f32 v120, v9, v120
 mavaz 152,192,176
 s_mov_b32 s86, 24576
 buffer_store_dwordx4 v[56:59], v2, s[60:63], s86 offen offset:2048 sc1
 v_mul_f32 v121, v9, v121
 mavv 152,196,232
 v_mul_f32 v122, v9, v122
 v_mul_f32 v123, v9, v123
 mavvz 156,204,232
 rtv 184,208,16904
 v_mul_f32 v124, v9, v124
 mava 156,200,176
 rtv 186,208,17160
 v_mul_f32 v125, v9, v125
 mavaz 124,200,172
 rtv 188,208,17416
 v_mul_f32 v126, v9, v126
 mavv 124,204,228
 rtv 190,208,17672
 v_mul_f32 v127, v9, v127
 mavvz 92,204,248
 s_add_u32 m0, s92, 67648
 pk 120,120
 pk 121,122
 mava 92,200,168
 buffer_load_dwordx4 v11, s[68:71], s83 offen offset:2048 lds
 pk 122,124
 mavaz 60,200,164
 s_add_u32 m0, s92, 67680
 pk 123,126
 v_mul_f32 v152, v10, v152
 mavv 60,204,244
 buffer_load_dwordx4 v11, s[68:71], s83 offen offset:3072 lds
 v_mul_f32 v153, v10, v153
 mavvz 28,204,240
 s_mov_b32 s86, 24576
 buffer_store_dwordx4 v[88:91], v2, s[60:63], s86 offen offset:3072 sc1
 v_mul_f32 v154, v10, v154
 mava 28,200,160
 s_waitcnt lgkmcnt(3)
 v_mul_f32 v155, v10, v155
 v_mul_f32 v156, v10, v156
 mavv 0,176,236
 rtv 192,209,16896
 v_mul_f32 v157, v10, v157
 mava 0,180,236
 rtv 194,209,17152
 v_mul_f32 v158, v10, v158
 mava 32,180,240
 rtv 196,209,17408
 v_mul_f32 v159, v10, v159
 mava 32,176,220
 rtv 198,209,17664
 pk 152,152
 mava 64,176,224
 pk 153,154
 pk 154,156
 mava 64,180,244
 pk 155,158
 v_mul_f32 v32, v6, v32
 mava 96,180,248
 v_mul_f32 v33, v6, v33
 v_mul_f32 v34, v6, v34
 mava 96,176,228
 s_mov_b32 s86, 28672
 buffer_store_dwordx4 v[120:123], v2, s[60:63], s86 offen offset:0 sc1
 v_mul_f32 v35, v6, v35
 mava 128,176,232
 v_mul_f32 v36, v6, v36
 v_mul_f32 v37, v6, v37
 mava 128,180,252
 s_waitcnt lgkmcnt(3)
 v_mul_f32 v38, v6, v38
 v_mul_f32 v39, v6, v39
 mava 132,188,252
 rtv 200,209,16904
 pk 32,32
 mava 132,184,232
 rtv 202,209,17160
 pk 33,34
 mava 100,184,228
 rtv 204,209,17416
 pk 34,36
 mava 100,188,248
 rtv 206,209,17672
 pk 35,38
 mava 68,188,244
 v_mul_f32 v64, v7, v64
 v_mul_f32 v65, v7, v65
 mava 68,184,224
 v_mul_f32 v66, v7, v66
 v_mul_f32 v67, v7, v67
 mava 36,184,220
 s_mov_b32 s86, 28672
 buffer_store_dwordx4 v[152:155], v2, s[60:63], s86 offen offset:1024 sc1
 v_mul_f32 v68, v7, v68
 mava 36,188,240
 v_mul_f32 v69, v7, v69
 v_mul_f32 v70, v7, v70
 mava 4,188,236
 v_mul_f32 v71, v7, v71
 pk 64,64
 mavv 4,184,236
 s_waitcnt lgkmcnt(3)
 pk 65,66
 pk 66,68
 mavv 8,192,236
 rtv 176,210,16896
 pk 67,70
 mava 8,196,236
 rtv 178,210,17152
 v_mul_f32 v96, v8, v96
 mava 40,196,240
 rtv 180,210,17408
 v_mul_f32 v97, v8, v97
 mava 40,192,220
 rtv 182,210,17664
 v_mul_f32 v98, v8, v98
 mava 72,192,224
 v_mul_f32 v99, v8, v99
 v_mul_f32 v100, v8, v100
 mava 72,196,244
 s_mov_b32 s86, 28672
 buffer_store_dwordx4 v[32:35], v2, s[60:63], s86 offen offset:2048 sc1
 v_mul_f32 v101, v8, v101
 mava 104,196,248
 v_mul_f32 v102, v8, v102
 v_mul_f32 v103, v8, v103
 mava 104,192,228
 pk 96,96
 pk 97,98
 mava 136,192,232
 pk 98,100
 pk 99,102
 mava 136,196,252
 s_waitcnt lgkmcnt(3)
 v_mul_f32 v128, v9, v128
 v_mul_f32 v129, v9, v129
 mava 140,204,252
 rtv 184,210,16904
 v_mul_f32 v130, v9, v130
 mava 140,200,232
 rtv 186,210,17160
 v_mul_f32 v131, v9, v131
 mava 108,200,228
 rtv 188,210,17416
 v_mul_f32 v132, v9, v132
 mava 108,204,248
 rtv 190,210,17672
 v_mul_f32 v133, v9, v133
 mava 76,204,244
 s_mov_b32 s86, 28672
 buffer_store_dwordx4 v[64:67], v2, s[60:63], s86 offen offset:3072 sc1
 v_mul_f32 v134, v9, v134
 mava 76,200,224
 v_mul_f32 v135, v9, v135
 pk 128,128
 mava 44,200,220
 pk 129,130
 pk 130,132
 mava 44,204,240
 pk 131,134
 v_mul_f32 v160, v10, v160
 mava 12,204,236
 v_mul_f32 v161, v10, v161
 v_mul_f32 v162, v10, v162
 mavv 12,200,236
 s_waitcnt lgkmcnt(3)
 v_mul_f32 v163, v10, v163
 v_mul_f32 v164, v10, v164
 mavv 16,176,236
 rtv 192,211,16896
 v_mul_f32 v165, v10, v165
 mava 16,180,236
 rtv 194,211,17152
 v_mul_f32 v166, v10, v166
 mava 48,180,240
 rtv 196,211,17408
 v_mul_f32 v167, v10, v167
 mava 48,176,220
 rtv 198,211,17664
 pk 160,160
 mava 80,176,224
 s_xor_b32 s94, s8, 0
 s_lshl_b32 s94, s94, 9
 pk 161,162
 mava 80,180,244
 v_min_u32 v15, 12, v0
 v_lshl_add_u32 v15, v15, 5, s94
 mava 112,180,248
 s_mov_b32 s86, 32768
 buffer_store_dwordx4 v[96:99], v2, s[60:63], s86 offen offset:0 sc1
 pk 162,164
 mava 112,176,228
 buffer_load_dword v13, v15, s[44:47], 0 offen offset:4 sc1
 pk 163,166
 mava 144,176,232
 v_mul_f32 v40, v6, v40
 v_mul_f32 v41, v6, v41
 mava 144,180,252
 s_waitcnt lgkmcnt(3)
 v_mul_f32 v42, v6, v42
 v_mul_f32 v43, v6, v43
 mava 148,188,252
 rtv 200,211,16904
 v_mul_f32 v44, v6, v44
 mava 148,184,232
 rtv 202,211,17160
 v_mul_f32 v45, v6, v45
 mava 116,184,228
 rtv 204,211,17416
 v_mul_f32 v46, v6, v46
 mava 116,188,248
 rtv 206,211,17672
 v_mul_f32 v47, v6, v47
 mava 84,188,244
 pk 40,40
 pk 41,42
 mava 84,184,224
 s_mov_b32 s86, 32768
 buffer_store_dwordx4 v[128:131], v2, s[60:63], s86 offen offset:1024 sc1
 pk 42,44
 mava 52,184,220
 pk 43,46
 v_mul_f32 v72, v7, v72
 mava 52,188,240
 v_mul_f32 v73, v7, v73
 v_mul_f32 v74, v7, v74
 mava 20,188,236
 v_mul_f32 v75, v7, v75
 v_mul_f32 v76, v7, v76
 mavv 20,184,236
 s_waitcnt lgkmcnt(3)
 v_mul_f32 v77, v7, v77
 v_mul_f32 v78, v7, v78
 mavv 24,192,236
 s_waitcnt lgkmcnt(0)
 s_barrier
 mava 24,196,236
 rtv 176,208,33792
 v_mul_f32 v79, v7, v79
 mava 56,196,240
 rtv 178,208,34048
 pk 72,72
 mava 56,192,220
 rtv 180,208,34304
 pk 73,74
 mava 88,192,224
 s_add_u32 m0, s92, 84480
 s_add_u32 s83, s83, 65536
 rtv 182,208,34560
 mava 88,196,244
 buffer_load_dwordx4 v11, s[68:71], s83 offen offset:0 lds
 pk 74,76
 mava 120,196,248
 s_add_u32 m0, s92, 84512
 pk 75,78
 v_mul_f32 v104, v8, v104
 mava 120,192,228
 buffer_load_dwordx4 v11, s[68:71], s83 offen offset:1024 lds
 v_mul_f32 v105, v8, v105
 mava 152,192,232
 s_mov_b32 s86, 32768
 buffer_store_dwordx4 v[160:163], v2, s[60:63], s86 offen offset:2048 sc1
 v_mul_f32 v106, v8, v106
 mava 152,196,252
 v_mul_f32 v107, v8, v107
 v_mul_f32 v108, v8, v108
 mava 156,204,252
 rtv 184,208,33800
 v_mul_f32 v109, v8, v109
 mava 156,200,232
 rtv 186,208,34056
 v_mul_f32 v110, v8, v110
 mava 124,200,228
 rtv 188,208,34312
 v_mul_f32 v111, v8, v111
 mava 124,204,248
 rtv 190,208,34568
 pk 104,104
 mava 92,204,244
 s_add_u32 m0, s92, 84544
 pk 105,106
 pk 106,108
 mava 92,200,224
 buffer_load_dwordx4 v11, s[68:71], s83 offen offset:2048 lds
 pk 107,110
 mava 60,200,220
 s_add_u32 m0, s92, 84576
 v_mul_f32 v136, v9, v136
 v_mul_f32 v137, v9, v137
 mava 60,204,240
 buffer_load_dwordx4 v11, s[68:71], s83 offen offset:3072 lds
 v_mul_f32 v138, v9, v138
 mava 28,204,236
 s_mov_b32 s86, 32768
 buffer_store_dwordx4 v[40:43], v2, s[60:63], s86 offen offset:3072 sc1
 v_mul_f32 v139, v9, v139
 mavv 28,200,236
 s_waitcnt lgkmcnt(3)
 v_mul_f32 v140, v9, v140
 v_mul_f32 v141, v9, v141
 mavv 0,176,16
 rtv 192,209,33792
 v_mul_f32 v142, v9, v142
 mavv 0,180,24
 rtv 194,209,34048
 v_mul_f32 v143, v9, v143
 mavv 32,180,56
 rtv 196,209,34304
 pk 136,136
 mavv 32,176,48
 rtv 198,209,34560
 pk 137,138
 mavv 64,176,80
 pk 138,140
 pk 139,142
 mavv 64,180,88
 v_mul_f32 v168, v10, v168
 v_mul_f32 v169, v10, v169
 mavv 96,180,120
 v_mul_f32 v170, v10, v170
 v_mul_f32 v171, v10, v171
 mavv 96,176,112
 s_mov_b32 s86, 36864
 buffer_store_dwordx4 v[72:75], v2, s[60:63], s86 offen offset:0 sc1
 v_mul_f32 v172, v10, v172
 mavv 128,176,144
 v_mul_f32 v173, v10, v173
 v_mul_f32 v174, v10, v174
 mavv 128,180,152
 s_waitcnt lgkmcnt(3)
 v_mul_f32 v175, v10, v175
 pk 168,168
 mavv 132,188,152
 rtv 200,209,33800
 pk 169,170
 mavv 132,184,144
 rtv 202,209,34056
 pk 170,172
 mavv 100,184,112
 rtv 204,209,34312
 pk 171,174
 mavv 100,188,120
 rtv 206,209,34568
 mavv 68,188,88
 mavv 68,184,80
 mavv 36,184,48
 s_mov_b32 s86, 36864
 buffer_store_dwordx4 v[104:107], v2, s[60:63], s86 offen offset:1024 sc1
 mavv 36,188,56
 mavv 4,188,24
 mavv 4,184,16
 s_waitcnt lgkmcnt(3)
 mavv 8,192,16
 rtv 176,210,33792
 mavv 8,196,24
 rtv 178,210,34048
 mavv 40,196,56
 rtv 180,210,34304
 mavv 40,192,48
 rtv 182,210,34560
 mavv 72,192,80
 mavv 72,196,88
 s_mov_b32 s86, 36864
 buffer_store_dwordx4 v[136:139], v2, s[60:63], s86 offen offset:2048 sc1
 mavv 104,196,120
 mavv 104,192,112
 mavv 136,192,144
 mavv 136,196,152
 s_waitcnt lgkmcnt(3)
 mavv 140,204,152
 rtv 184,210,33800
 mavv 140,200,144
 rtv 186,210,34056
 mavv 108,200,112
 rtv 188,210,34312
 mavv 108,204,120
 rtv 190,210,34568
 mavv 76,204,88
 s_mov_b32 s86, 36864
 buffer_store_dwordx4 v[168:171], v2, s[60:63], s86 offen offset:3072 sc1
 mavv 76,200,80
 mavv 44,200,48
 mavv 44,204,56
 mavv 12,204,24
 mavv 12,200,16
 s_waitcnt vmcnt(11)
 v_cmp_ne_u32 vcc, 1, v13
 s_nop 1
 s_and_b64 vcc, vcc, 15
 s_cbranch_scc1 L15_16_wgroup1
L15_16_ggroup1:
 s_waitcnt lgkmcnt(3)
 mavv 16,176,16
 rtv 192,211,33792
 mavv 16,180,24
 rtv 194,211,34048
 mavv 48,180,56
 rtv 196,211,34304
 mavv 48,176,48
 s_xor_b32 s82, s9, 2
 rtv 198,211,34560
 mavv 80,176,80
 s_mul_i32 s82, s82, 20480
 s_add_u32 s93, s82, 0
 buffer_load_dwordx4 a[180:183], v2, s[16:19], s93 offen offset:0 sc1
 mavv 80,180,88
 mavv 112,180,120
 mavv 112,176,112
 mavv 144,176,144
 mavv 144,180,152
 s_waitcnt lgkmcnt(3)
 mavv 148,188,152
 rtv 200,211,33800
 mavv 148,184,144
 rtv 202,211,34056
 mavv 116,184,112
 rtv 204,211,34312
 mavv 116,188,120
 rtv 206,211,34568
 mavv 84,188,88
 buffer_load_dwordx4 a[184:187], v2, s[16:19], s93 offen offset:1024 sc1
 mavv 84,184,80
 mavv 52,184,48
 mavv 52,188,56
 buffer_load_dwordx4 a[188:191], v2, s[16:19], s93 offen offset:2048 sc1
 mavv 20,188,24
 mavv 20,184,16
 s_waitcnt lgkmcnt(3)
 mavv 24,192,16
 s_waitcnt lgkmcnt(0)
 s_barrier
 mavv 24,196,24
 rtv 176,208,50688
 mavv 56,196,56
 rtv 178,208,50944
 mavv 56,192,48
 s_add_u32 m0, s92, 101376
 rtv 180,208,51200
 mavv 88,192,80
 s_xor_b32 s83, s9, 3
 s_mul_i32 s83, s83, 131072
 rtv 182,208,51456
 mavv 88,196,88
 buffer_load_dwordx4 v11, s[68:71], s83 offen offset:0 lds
 mavv 120,196,120
 s_add_u32 m0, s92, 101408
 mavv 120,192,112
 buffer_load_dwordx4 v11, s[68:71], s83 offen offset:1024 lds
 mavv 152,192,144
 mavv 152,196,152
 buffer_load_dwordx4 a[192:195], v2, s[16:19], s93 offen offset:3072 sc1
 mavv 156,204,152
 rtv 184,208,50696
 mavv 156,200,144
 rtv 186,208,50952
 mavv 124,200,112
 rtv 188,208,51208
 mavv 124,204,120
 rtv 190,208,51464
 mavv 92,204,88
 s_add_u32 m0, s92, 101440
 mavv 92,200,80
 buffer_load_dwordx4 v11, s[68:71], s83 offen offset:2048 lds
 mavv 60,200,48
 s_add_u32 m0, s92, 101472
 mavv 60,204,56
 buffer_load_dwordx4 v11, s[68:71], s83 offen offset:3072 lds
 mavv 28,204,24
 mavv 28,200,16
 s_waitcnt lgkmcnt(3)
 s_add_u32 s93, s82, 4096
 buffer_load_dwordx4 a[196:199], v2, s[16:19], s93 offen offset:0 sc1
 mavv 0,176,32
 rtv 192,209,50688
 mavv 0,180,40
 rtv 194,209,50944
 mavv 32,180,72
 rtv 196,209,51200
 mavv 32,176,64
 rtv 198,209,51456
 mavv 64,176,96
 buffer_load_dwordx4 a[200:203], v2, s[16:19], s93 offen offset:1024 sc1
 mavv 64,180,104
 mavv 96,180,136
 buffer_load_dwordx4 a[204:207], v2, s[16:19], s93 offen offset:2048 sc1
 mavv 96,176,128
 mavv 128,176,160
 mavv 128,180,168
 s_waitcnt lgkmcnt(3)
 mavv 132,188,168
 rtv 200,209,50696
 mavv 132,184,160
 rtv 202,209,50952
 mavv 100,184,128
 rtv 204,209,51208
 mavv 100,188,136
 rtv 206,209,51464
 mavv 68,188,104
 buffer_load_dwordx4 a[208:211], v2, s[16:19], s93 offen offset:3072 sc1
 mavv 68,184,96
 mavv 36,184,64
 mavv 36,188,72
 mavv 4,188,40
 mavv 4,184,32
 s_waitcnt lgkmcnt(3)
 mavv 8,192,32
 rtv 176,210,50688
 mavv 8,196,40
 rtv 178,210,50944
 mavv 40,196,72
 rtv 180,210,51200
 mavv 40,192,64
 rtv 182,210,51456
 mavv 72,192,96
 s_add_u32 s93, s82, 8192
 buffer_load_dwordx4 a[212:215], v2, s[16:19], s93 offen offset:0 sc1
 mavv 72,196,104
 s_waitcnt vmcnt(13)
 buffer_store_dword v218, v219, s[44:47], 0 offen offset:0 sc1
 mavv 104,196,136
 mavv 104,192,128
 mavv 136,192,160
 buffer_load_dwordx4 a[216:219], v2, s[16:19], s93 offen offset:1024 sc1
 mavv 136,196,168
 s_waitcnt lgkmcnt(3)
 mavv 140,204,168
 rtv 184,210,50696
 mavv 140,200,160
 rtv 186,210,50952
 mavv 108,200,128
 rtv 188,210,51208
 mavv 108,204,136
 rtv 190,210,51464
 mavv 76,204,104
 mavv 76,200,96
 s_add_u32 s93, s82, 8192
 buffer_load_dwordx4 v[20:23], v2, s[16:19], s93 offen offset:2048 sc1
 mavv 44,200,64
 mavv 44,204,72
 mavv 12,204,40
 mavv 12,200,32
 s_waitcnt lgkmcnt(3)
 mavv 16,176,32
 rtv 192,211,50688
 mavv 16,180,40
 rtv 194,211,50944
 mavv 48,180,72
 rtv 196,211,51200
 mavv 48,176,64
 rtv 198,211,51456
 mavv 80,176,96
 buffer_load_dwordx4 v[52:55], v2, s[16:19], s93 offen offset:3072 sc1
 mavv 80,180,104
 mavv 112,180,136
 mavv 112,176,128
 mavv 144,176,160
 mavv 144,180,168
 s_waitcnt lgkmcnt(3)
 mavv 148,188,168
 rtv 200,211,50696
 mavv 148,184,160
 rtv 202,211,50952
 mavv 116,184,128
 rtv 204,211,51208
 mavv 116,188,136
 rtv 206,211,51464
 mavv 84,188,104
 s_add_u32 s93, s82, 12288
 buffer_load_dwordx4 v[84:87], v2, s[16:19], s93 offen offset:0 sc1
 mavv 84,184,96
 mavv 52,184,64
 mavv 52,188,72
 buffer_load_dwordx4 v[116:119], v2, s[16:19], s93 offen offset:1024 sc1
 mavv 20,188,40
 v_add_u32 v208, 4294899712, v208
 mavv 20,184,32
 s_waitcnt lgkmcnt(3)
 mavv 24,192,32
 s_waitcnt lgkmcnt(0)
 s_barrier
 mavv 24,196,40
 rtv 176,208,0
 mavv 56,196,72
 rtv 178,208,256
 mavv 56,192,64
 rtv 180,208,512
 mavv 88,192,96
 s_add_u32 m0, s92, 118272
 s_add_u32 s83, s83, 65536
 rtv 182,208,768
 mavv 88,196,104
 buffer_load_dwordx4 v11, s[68:71], s83 offen offset:0 lds
 mavv 120,196,136
 s_add_u32 m0, s92, 118304
 mavv 120,192,128
 buffer_load_dwordx4 v11, s[68:71], s83 offen offset:1024 lds
 mavv 152,192,160
 mavv 152,196,168
 buffer_load_dwordx4 v[148:151], v2, s[16:19], s93 offen offset:2048 sc1
 mavv 156,204,168
 rtv 184,208,8
 mavv 156,200,160
 rtv 186,208,264
 mavv 124,200,128
 rtv 188,208,520
 mavv 124,204,136
 rtv 190,208,776
 mavv 92,204,104
 s_add_u32 m0, s92, 118336
 mavv 92,200,96
 buffer_load_dwordx4 v11, s[68:71], s83 offen offset:2048 lds
 mavv 60,200,64
 s_add_u32 m0, s92, 118368
 mavv 60,204,72
 buffer_load_dwordx4 v11, s[68:71], s83 offen offset:3072 lds
 mavv 28,204,40
 v_add_u32 v209, 4294899712, v209
 mavv 28,200,32
 buffer_load_dwordx4 v[28:31], v2, s[16:19], s93 offen offset:3072 sc1
 s_cmp_lg_u32 s38, 0
 s_cbranch_scc1 L15_16_skip
L15_16_flags:
 s_mov_b32 s38, 1
 v_mov_b32 v14, 163776
 ds_read_b64 v[14:15], v14
 s_waitcnt lgkmcnt(0)
 v_or_b32 v14, v14, v15
 s_nop 0
 v_readfirstlane_b32 s98, v14
 s_nop 1
 s_lshr_b32 s4, s98, 16
 s_or_b32 s98, s98, s4
 s_and_b32 s98, s98, 3
 s_cbranch_scc1 L15_slow
L15_16_go:
 s_waitcnt vmcnt(24)
 mava 0,176,180
 s_waitcnt vmcnt(15)
 rtv 192,209,0
 mava 0,180,200
 s_waitcnt vmcnt(14)
 rtv 194,209,256
 mava 32,180,204
 rtv 196,209,512
 mava 32,176,184
 rtv 198,209,768
 mava 64,176,188
 s_waitcnt vmcnt(13)
 s_add_u32 s93, s82, 16384
 buffer_load_dwordx4 v[60:63], v2, s[16:19], s93 offen offset:0 sc1
 mava 64,180,208
 s_waitcnt vmcnt(13)
 mava 96,180,212
 buffer_load_dwordx4 v[92:95], v2, s[16:19], s93 offen offset:1024 sc1
 mava 96,176,192
 mava 128,176,196
 s_waitcnt vmcnt(12)
 mava 128,180,216
 mava 132,188,216
 rtv 200,209,8
 mava 132,184,196
 rtv 202,209,264
 mava 100,184,192
 rtv 204,209,520
 mava 100,188,212
 rtv 206,209,776
 mava 68,188,208
 buffer_load_dwordx4 v[124:127], v2, s[16:19], s93 offen offset:2048 sc1
 mava 68,184,188
 mava 36,184,184
 mava 36,188,204
 mava 4,188,200
 v_add_u32 v210, 4294899712, v210
 mava 4,184,180
 s_waitcnt lgkmcnt(3)
 mava 8,192,180
 rtv 176,210,0
 mava 8,196,200
 rtv 178,210,256
 mava 40,196,204
 rtv 180,210,512
 mava 40,192,184
 rtv 182,210,768
 mava 72,192,188
 buffer_load_dwordx4 v[156:159], v2, s[16:19], s93 offen offset:3072 sc1
 mava 72,196,208
 mava 104,196,212
 mava 104,192,192
 s_xor_b32 s82, s9, 4
 mava 136,192,196
 s_mul_i32 s82, s82, 20480
 s_add_u32 s93, s82, 0
 buffer_load_dwordx4 v[36:39], v2, s[16:19], s93 offen offset:0 sc1
 mava 136,196,216
 s_waitcnt lgkmcnt(3)
 mava 140,204,216
 rtv 184,210,8
 mava 140,200,196
 rtv 186,210,264
 mava 108,200,192
 rtv 188,210,520
 mava 108,204,212
 rtv 190,210,776
 mava 76,204,208
 mava 76,200,188
 buffer_load_dwordx4 v[68:71], v2, s[16:19], s93 offen offset:1024 sc1
 mava 44,200,184
 mava 44,204,204
 mava 12,204,200
 v_add_u32 v211, 4294899712, v211
 mava 12,200,180
 s_waitcnt lgkmcnt(3)
 mava 16,176,180
 rtv 192,211,0
 mava 16,180,200
 rtv 194,211,256
 mava 48,180,204
 rtv 196,211,512
 mava 48,176,184
 rtv 198,211,768
 mava 80,176,188
 buffer_load_dwordx4 v[100:103], v2, s[16:19], s93 offen offset:2048 sc1
 mava 80,180,208
 mava 112,180,212
 mava 112,176,192
 mava 144,176,196
 mava 144,180,216
 s_waitcnt lgkmcnt(3)
 mava 148,188,216
 rtv 200,211,8
 mava 148,184,196
 rtv 202,211,264
 mava 116,184,192
 rtv 204,211,520
 mava 116,188,212
 rtv 206,211,776
 mava 84,188,208
 buffer_load_dwordx4 v[132:135], v2, s[16:19], s93 offen offset:3072 sc1
 mava 84,184,188
 mava 52,184,184
 mava 52,188,204
 s_add_u32 s93, s82, 4096
 buffer_load_dwordx4 v[164:167], v2, s[16:19], s93 offen offset:0 sc1
 mava 20,188,200
 mava 20,184,180
 s_waitcnt lgkmcnt(3)
 mava 24,192,180
 s_waitcnt lgkmcnt(0)
 s_barrier
 mava 24,196,200
 rtv 176,208,16896
 mava 56,196,204
 rtv 178,208,17152
 mava 56,192,184
 s_add_u32 m0, s92, 0
 rtv 180,208,17408
 mava 88,192,188
 s_xor_b32 s83, s9, 5
 s_mul_i32 s83, s83, 131072
 rtv 182,208,17664
 mava 88,196,208
 buffer_load_dwordx4 v11, s[68:71], s83 offen offset:0 lds
 mava 120,196,212
 s_add_u32 m0, s92, 32
 mava 120,192,192
 buffer_load_dwordx4 v11, s[68:71], s83 offen offset:1024 lds
 mava 152,192,196
 mava 152,196,216
 buffer_load_dwordx4 v[44:47], v2, s[16:19], s93 offen offset:1024 sc1
 mava 156,204,216
 rtv 184,208,16904
 mava 156,200,196
 rtv 186,208,17160
 mava 124,200,192
 rtv 188,208,17416
 mava 124,204,212
 rtv 190,208,17672
 mava 92,204,208
 s_add_u32 m0, s92, 64
 mava 92,200,188
 buffer_load_dwordx4 v11, s[68:71], s83 offen offset:2048 lds
 mava 60,200,184
 s_add_u32 m0, s92, 96
 mava 60,204,204
 buffer_load_dwordx4 v11, s[68:71], s83 offen offset:3072 lds
 mava 28,204,200
 mava 28,200,180
 s_waitcnt vmcnt(23) lgkmcnt(3)
 buffer_load_dwordx4 v[76:79], v2, s[16:19], s93 offen offset:2048 sc1
 mavv 0,176,20
 s_waitcnt vmcnt(15)
 rtv 192,209,16896
 mavv 0,180,28
 s_waitcnt vmcnt(14)
 rtv 194,209,17152
 mavv 32,180,60
 rtv 196,209,17408
 mavv 32,176,52
 rtv 198,209,17664
 mavv 64,176,84
 s_waitcnt vmcnt(13)
 buffer_load_dwordx4 v[108:111], v2, s[16:19], s93 offen offset:3072 sc1
 mavv 64,180,92
 s_waitcnt vmcnt(13)
 mavv 96,180,124
 s_add_u32 s93, s82, 8192
 buffer_load_dwordx4 v[140:143], v2, s[16:19], s93 offen offset:0 sc1
 mavv 96,176,116
 mavv 128,176,148
 s_waitcnt vmcnt(13)
 mavv 128,180,156
 s_waitcnt lgkmcnt(3)
 mavv 132,188,156
 rtv 200,209,16904
 mavv 132,184,148
 rtv 202,209,17160
 mavv 100,184,116
 rtv 204,209,17416
 mavv 100,188,124
 rtv 206,209,17672
 mavv 68,188,92
 buffer_load_dwordx4 v[172:175], v2, s[16:19], s93 offen offset:1024 sc1
 mavv 68,184,84
 mavv 36,184,52
 mavv 36,188,60
 mavv 4,188,28
 mavv 4,184,20
 s_waitcnt lgkmcnt(3)
 mavv 8,192,20
 rtv 176,210,16896
 mavv 8,196,28
 rtv 178,210,17152
 mavv 40,196,60
 rtv 180,210,17408
 mavv 40,192,52
 rtv 182,210,17664
 mavv 72,192,84
 s_add_u32 s93, s82, 8192
 buffer_load_dwordx4 a[160:163], v2, s[16:19], s93 offen offset:2048 sc1
 mavv 72,196,92
 mavv 104,196,124
 mavv 104,192,116
 mavv 136,192,148
 buffer_load_dwordx4 a[164:167], v2, s[16:19], s93 offen offset:3072 sc1
 mavv 136,196,156
 s_waitcnt lgkmcnt(3)
 mavv 140,204,156
 rtv 184,210,16904
 mavv 140,200,148
 rtv 186,210,17160
 mavv 108,200,116
 rtv 188,210,17416
 mavv 108,204,124
 rtv 190,210,17672
 mavv 76,204,92
 mavv 76,200,84
 s_add_u32 s93, s82, 12288
 buffer_load_dwordx4 a[168:171], v2, s[16:19], s93 offen offset:0 sc1
 mavv 44,200,52
 mavv 44,204,60
 mavv 12,204,28
 mavv 12,200,20
 s_waitcnt lgkmcnt(3)
 mavv 16,176,20
 rtv 192,211,16896
 mavv 16,180,28
 rtv 194,211,17152
 mavv 48,180,60
 rtv 196,211,17408
 mavv 48,176,52
 rtv 198,211,17664
 mavv 80,176,84
 buffer_load_dwordx4 a[172:175], v2, s[16:19], s93 offen offset:1024 sc1
 mavv 80,180,92
 mavv 112,180,124
 mavv 112,176,116
 mavv 144,176,148
 mavv 144,180,156
 s_waitcnt lgkmcnt(3)
 mavv 148,188,156
 rtv 200,211,16904
 mavv 148,184,148
 rtv 202,211,17160
 mavv 116,184,116
 rtv 204,211,17416
 mavv 116,188,124
 rtv 206,211,17672
 mavv 84,188,92
 buffer_load_dwordx4 a[176:179], v2, s[16:19], s93 offen offset:2048 sc1
 mavv 84,184,84
 mavv 52,184,52
 mavv 52,188,60
 buffer_load_dwordx4 v[240:243], v2, s[16:19], s93 offen offset:3072 sc1
 mavv 20,188,28
 mavv 20,184,20
 s_waitcnt lgkmcnt(3)
 mavv 24,192,20
 s_waitcnt lgkmcnt(0)
 s_barrier
 mavv 24,196,28
 rtv 176,208,33792
 mavv 56,196,60
 rtv 178,208,34048
 mavv 56,192,52
 rtv 180,208,34304
 mavv 88,192,84
 s_add_u32 m0, s92, 16896
 s_add_u32 s83, s83, 65536
 rtv 182,208,34560
 mavv 88,196,92
 buffer_load_dwordx4 v11, s[68:71], s83 offen offset:0 lds
 mavv 120,196,124
 s_add_u32 m0, s92, 16928
 mavv 120,192,116
 buffer_load_dwordx4 v11, s[68:71], s83 offen offset:1024 lds
 mavv 152,192,148
 mavv 152,196,156
 s_add_u32 s93, s82, 16384
 buffer_load_dwordx4 v[244:247], v2, s[16:19], s93 offen offset:0 sc1
 mavv 156,204,156
 rtv 184,208,33800
 mavv 156,200,148
 rtv 186,208,34056
 mavv 124,200,116
 rtv 188,208,34312
 mavv 124,204,124
 rtv 190,208,34568
 mavv 92,204,92
 s_add_u32 m0, s92, 16960
 mavv 92,200,84
 buffer_load_dwordx4 v11, s[68:71], s83 offen offset:2048 lds
 mavv 60,200,52
 s_add_u32 m0, s92, 16992
 mavv 60,204,60
 buffer_load_dwordx4 v11, s[68:71], s83 offen offset:3072 lds
 mavv 28,204,28
 mavv 28,200,20
 s_waitcnt vmcnt(24) lgkmcnt(3)
 buffer_load_dwordx4 v[248:251], v2, s[16:19], s93 offen offset:1024 sc1
 mavv 0,176,36
 s_waitcnt vmcnt(18)
 rtv 192,209,33792
 mavv 0,180,44
 s_waitcnt vmcnt(15)
 rtv 194,209,34048
 mavv 32,180,76
 rtv 196,209,34304
 mavv 32,176,68
 rtv 198,209,34560
 mavv 64,176,100
 s_waitcnt vmcnt(14)
 buffer_load_dwordx4 v[228:231], v2, s[16:19], s93 offen offset:2048 sc1
 mavv 64,180,108
 s_waitcnt vmcnt(14)
 mavv 96,180,140
 buffer_load_dwordx4 v[232:235], v2, s[16:19], s93 offen offset:3072 sc1
 mavv 96,176,132
 mavv 128,176,164
 s_waitcnt vmcnt(14)
 mavv 128,180,172
 s_waitcnt lgkmcnt(3)
 mavv 132,188,172
 rtv 200,209,33800
 mavv 132,184,164
 rtv 202,209,34056
 mavv 100,184,132
 rtv 204,209,34312
 mavv 100,188,140
 s_xor_b32 s82, s9, 6
 rtv 206,209,34568
 mavv 68,188,108
 s_mul_i32 s82, s82, 20480
 s_add_u32 s93, s82, 0
 buffer_load_dwordx4 v[236:239], v2, s[16:19], s93 offen offset:0 sc1
 mavv 68,184,100
 mavv 36,184,68
 mavv 36,188,76
 mavv 4,188,44
 mavv 4,184,36
 s_waitcnt lgkmcnt(3)
 mavv 8,192,36
 rtv 176,210,33792
 mavv 8,196,44
 rtv 178,210,34048
 mavv 40,196,76
 rtv 180,210,34304
 mavv 40,192,68
 rtv 182,210,34560
 mavv 72,192,100
 buffer_load_dwordx4 a[220:223], v2, s[16:19], s93 offen offset:1024 sc1
 mavv 72,196,108
 mavv 104,196,140
 mavv 104,192,132
 mavv 136,192,164
 buffer_load_dwordx4 a[224:227], v2, s[16:19], s93 offen offset:2048 sc1
 mavv 136,196,172
 s_waitcnt lgkmcnt(3)
 mavv 140,204,172
 rtv 184,210,33800
 mavv 140,200,164
 rtv 186,210,34056
 mavv 108,200,132
 rtv 188,210,34312
 mavv 108,204,140
 rtv 190,210,34568
 mavv 76,204,108
 mavv 76,200,100
 buffer_load_dwordx4 a[228:231], v2, s[16:19], s93 offen offset:3072 sc1
 mavv 44,200,68
 mavv 44,204,76
 mavv 12,204,44
 mavv 12,200,36
 s_waitcnt lgkmcnt(3)
 mavv 16,176,36
 rtv 192,211,33792
 mavv 16,180,44
 rtv 194,211,34048
 mavv 48,180,76
 rtv 196,211,34304
 mavv 48,176,68
 rtv 198,211,34560
 mavv 80,176,100
 s_add_u32 s93, s82, 4096
 buffer_load_dwordx4 a[232:235], v2, s[16:19], s93 offen offset:0 sc1
 mavv 80,180,108
 mavv 112,180,140
 mavv 112,176,132
 mavv 144,176,164
 mavv 144,180,172
 s_waitcnt lgkmcnt(3)
 buffer_load_dwordx4 a[236:239], v2, s[16:19], s93 offen offset:1024 sc1
 mavv 148,188,172
 rtv 200,211,33800
 mavv 148,184,164
 rtv 202,211,34056
 mavv 116,184,132
 rtv 204,211,34312
 mavv 116,188,140
 rtv 206,211,34568
 mavv 84,188,108
 mavv 84,184,100
 mavv 52,184,68
 mavv 52,188,76
 buffer_load_dwordx4 a[240:243], v2, s[16:19], s93 offen offset:2048 sc1
 mavv 20,188,44
 mavv 20,184,36
 s_waitcnt lgkmcnt(3)
 mavv 24,192,36
 s_waitcnt lgkmcnt(0)
 s_barrier
 mavv 24,196,44
 rtv 176,208,50688
 mavv 56,196,76
 rtv 178,208,50944
 mavv 56,192,68
 s_add_u32 m0, s92, 33792
 rtv 180,208,51200
 mavv 88,192,100
 s_xor_b32 s83, s9, 7
 s_mul_i32 s83, s83, 131072
 rtv 182,208,51456
 mavv 88,196,108
 buffer_load_dwordx4 v11, s[68:71], s83 offen offset:0 lds
 mavv 120,196,140
 s_add_u32 m0, s92, 33824
 mavv 120,192,132
 buffer_load_dwordx4 v11, s[68:71], s83 offen offset:1024 lds
 mavv 152,192,164
 mavv 152,196,172
 buffer_load_dwordx4 a[244:247], v2, s[16:19], s93 offen offset:3072 sc1
 mavv 156,204,172
 rtv 184,208,50696
 mavv 156,200,164
 rtv 186,208,50952
 mavv 124,200,132
 rtv 188,208,51208
 mavv 124,204,140
 rtv 190,208,51464
 mavv 92,204,108
 s_add_u32 m0, s92, 33856
 mavv 92,200,100
 buffer_load_dwordx4 v11, s[68:71], s83 offen offset:2048 lds
 mavv 60,200,68
 s_add_u32 m0, s92, 33888
 mavv 60,204,76
 buffer_load_dwordx4 v11, s[68:71], s83 offen offset:3072 lds
 mavv 28,204,44
 mavv 28,200,36
 s_waitcnt vmcnt(25) lgkmcnt(3)
 s_add_u32 s93, s82, 8192
 buffer_load_dwordx4 a[248:251], v2, s[16:19], s93 offen offset:0 sc1
 mava 0,176,160
 s_waitcnt vmcnt(21)
 rtv 192,209,50688
 mavv 0,180,240
 s_waitcnt vmcnt(18)
 rtv 194,209,50944
 mavv 32,180,244
 rtv 196,209,51200
 mava 32,176,164
 rtv 198,209,51456
 mava 64,176,168
 s_waitcnt vmcnt(15)
 buffer_load_dwordx4 a[252:255], v2, s[16:19], s93 offen offset:1024 sc1
 mavv 64,180,248
 s_waitcnt vmcnt(15)
 mavv 96,180,228
 s_add_u32 s93, s82, 8192
 buffer_load_dwordx4 a[180:183], v2, s[16:19], s93 offen offset:2048 sc1
 mava 96,176,172
 mava 128,176,176
 s_waitcnt vmcnt(15)
 mavv 128,180,232
 s_waitcnt lgkmcnt(3)
 mavv 132,188,232
 rtv 200,209,50696
 mava 132,184,176
 rtv 202,209,50952
 mava 100,184,172
 rtv 204,209,51208
 mavv 100,188,228
 rtv 206,209,51464
 mavv 68,188,248
 buffer_load_dwordx4 a[184:187], v2, s[16:19], s93 offen offset:3072 sc1
 mava 68,184,168
 mava 36,184,164
 mavv 36,188,244
 mavv 4,188,240
 mava 4,184,160
 s_waitcnt lgkmcnt(3)
 mava 8,192,160
 rtv 176,210,50688
 mavv 8,196,240
 rtv 178,210,50944
 mavv 40,196,244
 rtv 180,210,51200
 mava 40,192,164
 rtv 182,210,51456
 mava 72,192,168
 s_add_u32 s93, s82, 12288
 buffer_load_dwordx4 a[188:191], v2, s[16:19], s93 offen offset:0 sc1
 mavv 72,196,248
 mavv 104,196,228
 mava 104,192,172
 mava 136,192,176
 buffer_load_dwordx4 a[192:195], v2, s[16:19], s93 offen offset:1024 sc1
 mavv 136,196,232
 s_waitcnt lgkmcnt(3)
 mavv 140,204,232
 rtv 184,210,50696
 mava 140,200,176
 rtv 186,210,50952
 mava 108,200,172
 rtv 188,210,51208
 mavv 108,204,228
 rtv 190,210,51464
 mavv 76,204,248
 mava 76,200,168
 buffer_load_dwordx4 a[196:199], v2, s[16:19], s93 offen offset:2048 sc1
 mava 44,200,164
 mavv 44,204,244
 mavv 12,204,240
 mava 12,200,160
 s_waitcnt lgkmcnt(3)
 mava 16,176,160
 rtv 192,211,50688
 mavv 16,180,240
 rtv 194,211,50944
 mavv 48,180,244
 rtv 196,211,51200
 mava 48,176,164
 rtv 198,211,51456
 mava 80,176,168
 buffer_load_dwordx4 a[200:203], v2, s[16:19], s93 offen offset:3072 sc1
 mavv 80,180,248
 mavv 112,180,228
 mava 112,176,172
 mava 144,176,176
 mavv 144,180,232
 s_waitcnt lgkmcnt(3)
 s_add_u32 s93, s82, 16384
 buffer_load_dwordx4 a[204:207], v2, s[16:19], s93 offen offset:0 sc1
 mavv 148,188,232
 rtv 200,211,50696
 mava 148,184,176
 rtv 202,211,50952
 mava 116,184,172
 rtv 204,211,51208
 mavv 116,188,228
 s_xor_b32 s94, s8, 0
 s_lshl_b32 s94, s94, 9
 rtv 206,211,51464
 mavv 84,188,248
 v_min_u32 v15, 12, v0
 v_lshl_add_u32 v15, v15, 5, s94
 mava 84,184,168
 mava 52,184,164
 buffer_load_dword v13, v15, s[44:47], 0 offen offset:0 sc1
 mavv 52,188,244
 buffer_load_dwordx4 a[208:211], v2, s[16:19], s93 offen offset:1024 sc1
 mavv 20,188,240
 v_add_u32 v208, 67584, v208
 mava 20,184,160
 s_waitcnt lgkmcnt(3)
 mava 24,192,160
 s_waitcnt lgkmcnt(0)
 s_barrier
 mavv 24,196,240
 rtv 176,208,0
 mavv 56,196,244
 rtv 178,208,256
 mava 56,192,164
 rtv 180,208,512
 mava 88,192,168
 s_add_u32 m0, s92, 50688
 s_add_u32 s83, s83, 65536
 rtv 182,208,768
 mavv 88,196,248
 buffer_load_dwordx4 v11, s[68:71], s83 offen offset:0 lds
 mavv 120,196,228
 s_add_u32 m0, s92, 50720
 mava 120,192,172
 buffer_load_dwordx4 v11, s[68:71], s83 offen offset:1024 lds
 mava 152,192,176
 mavv 152,196,232
 buffer_load_dwordx4 a[212:215], v2, s[16:19], s93 offen offset:2048 sc1
 mavv 156,204,232
 rtv 184,208,8
 mava 156,200,176
 rtv 186,208,264
 mava 124,200,172
 rtv 188,208,520
 mavv 124,204,228
 rtv 190,208,776
 mavv 92,204,248
 s_add_u32 m0, s92, 50752
 mava 92,200,168
 buffer_load_dwordx4 v11, s[68:71], s83 offen offset:2048 lds
 mava 60,200,164
 s_add_u32 m0, s92, 50784
 mavv 60,204,244
 buffer_load_dwordx4 v11, s[68:71], s83 offen offset:3072 lds
 mavv 28,204,240
 v_add_u32 v209, 67584, v209
 mava 28,200,160
 buffer_load_dwordx4 a[216:219], v2, s[16:19], s93 offen offset:3072 sc1
 s_waitcnt vmcnt(7)
 v_cmp_ne_u32 vcc, 1, v13
 s_nop 1
 s_and_b64 vcc, vcc, 15
 s_cbranch_scc1 L15_16_wgroup
L15_16_ggroup:
 s_waitcnt lgkmcnt(3)
 mavv 0,176,236
 rtv 192,209,0
 mava 0,180,236
 rtv 194,209,256
 mava 32,180,240
 rtv 196,209,512
 mava 32,176,220
 s_xor_b32 s82, s9, 3
 rtv 198,209,768
 mava 64,176,224
 s_mul_i32 s82, s82, 20480
 s_add_u32 s93, s82, 0
 buffer_load_dwordx4 v[16:19], v2, s[16:19], s93 offen offset:0 sc1
 mava 64,180,244
 mava 96,180,248
 buffer_load_dwordx4 v[48:51], v2, s[16:19], s93 offen offset:1024 sc1
 mava 96,176,228
 mava 128,176,232
 mava 128,180,252
 s_waitcnt lgkmcnt(3)
 buffer_load_dwordx4 v[80:83], v2, s[16:19], s93 offen offset:2048 sc1
 mava 132,188,252
 rtv 200,209,8
 mava 132,184,232
 rtv 202,209,264
 mava 100,184,228
 rtv 204,209,520
 mava 100,188,248
 rtv 206,209,776
 mava 68,188,244
 buffer_load_dwordx4 v[112:115], v2, s[16:19], s93 offen offset:3072 sc1
 mava 68,184,224
 mava 36,184,220
 s_add_u32 s93, s82, 4096
 buffer_load_dwordx4 v[144:147], v2, s[16:19], s93 offen offset:0 sc1
 mava 36,188,240
 mava 4,188,236
 v_add_u32 v210, 67584, v210
 mavv 4,184,236
 s_waitcnt lgkmcnt(3)
 buffer_load_dwordx4 v[24:27], v2, s[16:19], s93 offen offset:1024 sc1
 mavv 8,192,236
 rtv 176,210,0
 mava 8,196,236
 rtv 178,210,256
 mava 40,196,240
 rtv 180,210,512
 mava 40,192,220
 rtv 182,210,768
 mava 72,192,224
 buffer_load_dwordx4 v[56:59], v2, s[16:19], s93 offen offset:2048 sc1
 mava 72,196,244
 mava 104,196,248
 buffer_load_dwordx4 v[88:91], v2, s[16:19], s93 offen offset:3072 sc1
 mava 104,192,228
 mava 136,192,232
 mava 136,196,252
 s_waitcnt lgkmcnt(3)
 s_add_u32 s93, s82, 8192
 buffer_load_dwordx4 v[120:123], v2, s[16:19], s93 offen offset:0 sc1
 mava 140,204,252
 rtv 184,210,8
 mava 140,200,232
 rtv 186,210,264
 mava 108,200,228
 rtv 188,210,520
 mava 108,204,248
 rtv 190,210,776
 mava 76,204,244
 buffer_load_dwordx4 v[152:155], v2, s[16:19], s93 offen offset:1024 sc1
 mava 76,200,224
 mava 44,200,220
 s_add_u32 s93, s82, 8192
 buffer_load_dwordx4 v[32:35], v2, s[16:19], s93 offen offset:2048 sc1
 mava 44,204,240
 mava 12,204,236
 v_add_u32 v211, 67584, v211
 mavv 12,200,236
 s_waitcnt lgkmcnt(3)
 buffer_load_dwordx4 v[64:67], v2, s[16:19], s93 offen offset:3072 sc1
 mavv 16,176,236
 rtv 192,211,0
 mava 16,180,236
 rtv 194,211,256
 mava 48,180,240
 rtv 196,211,512
 mava 48,176,220
 rtv 198,211,768
 mava 80,176,224
 s_add_u32 s93, s82, 12288
 buffer_load_dwordx4 v[96:99], v2, s[16:19], s93 offen offset:0 sc1
 mava 80,180,244
 mava 112,180,248
 buffer_load_dwordx4 v[128:131], v2, s[16:19], s93 offen offset:1024 sc1
 mava 112,176,228
 mava 144,176,232
 mava 144,180,252
 s_waitcnt lgkmcnt(3)
 buffer_load_dwordx4 v[160:163], v2, s[16:19], s93 offen offset:2048 sc1
 mava 148,188,252
 rtv 200,211,8
 mava 148,184,232
 rtv 202,211,264
 mava 116,184,228
 rtv 204,211,520
 mava 116,188,248
 rtv 206,211,776
 mava 84,188,244
 buffer_load_dwordx4 v[40:43], v2, s[16:19], s93 offen offset:3072 sc1
 mava 84,184,224
 mava 52,184,220
 s_add_u32 s93, s82, 16384
 buffer_load_dwordx4 v[72:75], v2, s[16:19], s93 offen offset:0 sc1
 mava 52,188,240
 mava 20,188,236
 mavv 20,184,236
 s_waitcnt lgkmcnt(3)
 buffer_load_dwordx4 v[104:107], v2, s[16:19], s93 offen offset:1024 sc1
 mavv 24,192,236
 s_waitcnt lgkmcnt(0)
 s_barrier
 mava 24,196,236
 rtv 176,208,16896
 mava 56,196,240
 rtv 178,208,17152
 mava 56,192,220
 rtv 180,208,17408
 mava 88,192,224
 rtv 182,208,17664
 mava 88,196,244
 buffer_load_dwordx4 v[136:139], v2, s[16:19], s93 offen offset:2048 sc1
 mava 120,196,248
 mava 120,192,228
 buffer_load_dwordx4 v[168:171], v2, s[16:19], s93 offen offset:3072 sc1
 mava 152,192,232
 mava 152,196,252
 mava 156,204,252
 rtv 184,208,16904
 mava 156,200,232
 rtv 186,208,17160
 mava 124,200,228
 rtv 188,208,17416
 mava 124,204,248
 s_xor_b32 s82, s9, 5
 rtv 190,208,17672
 mava 92,204,244
 s_mul_i32 s82, s82, 20480
 s_add_u32 s93, s82, 0
 buffer_load_dwordx4 v[20:23], v2, s[16:19], s93 offen offset:0 sc1
 mava 92,200,224
 mava 60,200,220
 buffer_load_dwordx4 v[52:55], v2, s[16:19], s93 offen offset:1024 sc1
 mava 60,204,240
 mava 28,204,236
 buffer_load_dwordx4 v[84:87], v2, s[16:19], s93 offen offset:2048 sc1
 mavv 28,200,236
 s_waitcnt lgkmcnt(3)
 mava 0,176,180
 rtv 192,209,16896
 mava 0,180,200
 rtv 194,209,17152
 mava 32,180,204
 rtv 196,209,17408
 mava 32,176,184
 rtv 198,209,17664
 mava 64,176,188
 s_waitcnt vmcnt(29)
 buffer_load_dwordx4 v[116:119], v2, s[16:19], s93 offen offset:3072 sc1
 mava 64,180,208
 s_waitcnt vmcnt(27)
 mava 96,180,212
 s_add_u32 s93, s82, 4096
 buffer_load_dwordx4 v[148:151], v2, s[16:19], s93 offen offset:0 sc1
 mava 96,176,192
 mava 128,176,196
 s_waitcnt vmcnt(25)
 buffer_load_dwordx4 v[28:31], v2, s[16:19], s93 offen offset:1024 sc1
 mava 128,180,216
 s_waitcnt lgkmcnt(3)
 mava 132,188,216
 rtv 200,209,16904
 mava 132,184,196
 rtv 202,209,17160
 mava 100,184,192
 rtv 204,209,17416
 mava 100,188,212
 rtv 206,209,17672
 mava 68,188,208
 buffer_load_dwordx4 v[60:63], v2, s[16:19], s93 offen offset:2048 sc1
 mava 68,184,188
 mava 36,184,184
 buffer_load_dwordx4 v[92:95], v2, s[16:19], s93 offen offset:3072 sc1
 mava 36,188,204
 mava 4,188,200
 s_add_u32 s93, s82, 8192
 buffer_load_dwordx4 v[124:127], v2, s[16:19], s93 offen offset:0 sc1
 mava 4,184,180
 s_waitcnt lgkmcnt(3)
 mava 8,192,180
 rtv 176,210,16896
 mava 8,196,200
 rtv 178,210,17152
 mava 40,196,204
 rtv 180,210,17408
 mava 40,192,184
 rtv 182,210,17664
 mava 72,192,188
 buffer_load_dwordx4 v[156:159], v2, s[16:19], s93 offen offset:1024 sc1
 mava 72,196,208
 mava 104,196,212
 s_add_u32 s93, s82, 8192
 buffer_load_dwordx4 v[36:39], v2, s[16:19], s93 offen offset:2048 sc1
 mava 104,192,192
 mava 136,192,196
 buffer_load_dwordx4 v[68:71], v2, s[16:19], s93 offen offset:3072 sc1
 mava 136,196,216
 s_waitcnt lgkmcnt(3)
 mava 140,204,216
 rtv 184,210,16904
 mava 140,200,196
 rtv 186,210,17160
 mava 108,200,192
 rtv 188,210,17416
 mava 108,204,212
 rtv 190,210,17672
 mava 76,204,208
 s_add_u32 s93, s82, 12288
 buffer_load_dwordx4 v[100:103], v2, s[16:19], s93 offen offset:0 sc1
 mava 76,200,188
 mava 44,200,184
 buffer_load_dwordx4 v[132:135], v2, s[16:19], s93 offen offset:1024 sc1
 mava 44,204,204
 mava 12,204,200
 buffer_load_dwordx4 v[164:167], v2, s[16:19], s93 offen offset:2048 sc1
 mava 12,200,180
 s_waitcnt lgkmcnt(3)
 mava 16,176,180
 rtv 192,211,16896
 mava 16,180,200
 rtv 194,211,17152
 mava 48,180,204
 rtv 196,211,17408
 mava 48,176,184
 rtv 198,211,17664
 mava 80,176,188
 buffer_load_dwordx4 v[44:47], v2, s[16:19], s93 offen offset:3072 sc1
 mava 80,180,208
 mava 112,180,212
 s_add_u32 s93, s82, 16384
 buffer_load_dwordx4 v[76:79], v2, s[16:19], s93 offen offset:0 sc1
 mava 112,176,192
 mava 144,176,196
 buffer_load_dwordx4 v[108:111], v2, s[16:19], s93 offen offset:1024 sc1
 mava 144,180,216
 s_waitcnt lgkmcnt(3)
 mava 148,188,216
 rtv 200,211,16904
 mava 148,184,196
 rtv 202,211,17160
 mava 116,184,192
 rtv 204,211,17416
 mava 116,188,212
 rtv 206,211,17672
 mava 84,188,208
 buffer_load_dwordx4 v[140:143], v2, s[16:19], s93 offen offset:2048 sc1
 mava 84,184,188
 mava 52,184,184
 buffer_load_dwordx4 v[172:175], v2, s[16:19], s93 offen offset:3072 sc1
 mava 52,188,204
 mava 20,188,200
 s_xor_b32 s82, s9, 7
 mava 20,184,180
 s_waitcnt lgkmcnt(3)
 s_mul_i32 s82, s82, 20480
 s_add_u32 s93, s82, 0
 buffer_load_dwordx4 a[160:163], v2, s[16:19], s93 offen offset:0 sc1
 mava 24,192,180
 s_waitcnt lgkmcnt(0)
 s_barrier
 mava 24,196,200
 rtv 176,209,33792
 mava 56,196,204
 rtv 178,209,34048
 mava 56,192,184
 rtv 180,209,34304
 mava 88,192,188
 rtv 182,209,34560
 mava 88,196,208
 buffer_load_dwordx4 a[164:167], v2, s[16:19], s93 offen offset:1024 sc1
 mava 120,196,212
 mava 120,192,192
 buffer_load_dwordx4 a[168:171], v2, s[16:19], s93 offen offset:2048 sc1
 mava 152,192,196
 mava 152,196,216
 buffer_load_dwordx4 a[172:175], v2, s[16:19], s93 offen offset:3072 sc1
 mava 156,204,216
 rtv 184,209,33800
 mava 156,200,196
 rtv 186,209,34056
 mava 124,200,192
 rtv 188,209,34312
 mava 124,204,212
 rtv 190,209,34568
 mava 92,204,208
 s_add_u32 s93, s82, 4096
 buffer_load_dwordx4 a[176:179], v2, s[16:19], s93 offen offset:0 sc1
 mava 92,200,188
 mava 60,200,184
 buffer_load_dwordx4 v[240:243], v2, s[16:19], s93 offen offset:1024 sc1
 mava 60,204,204
 mava 28,204,200
 buffer_load_dwordx4 v[244:247], v2, s[16:19], s93 offen offset:2048 sc1
 mava 28,200,180
 s_waitcnt vmcnt(46) lgkmcnt(3)
 mavv 8,176,16
 s_waitcnt vmcnt(41)
 rtv 192,209,50688
 mavv 8,180,24
 s_waitcnt vmcnt(40)
 rtv 194,209,50944
 mavv 40,180,56
 rtv 196,209,51200
 mavv 40,176,48
 rtv 198,209,51456
 mavv 72,176,80
 s_waitcnt vmcnt(39)
 buffer_load_dwordx4 v[248:251], v2, s[16:19], s93 offen offset:3072 sc1
 mavv 72,180,88
 s_waitcnt vmcnt(39)
 mavv 104,180,120
 s_add_u32 s93, s82, 8192
 buffer_load_dwordx4 v[228:231], v2, s[16:19], s93 offen offset:0 sc1
 mavv 104,176,112
 mavv 136,176,144
 s_waitcnt vmcnt(39)
 buffer_load_dwordx4 v[232:235], v2, s[16:19], s93 offen offset:1024 sc1
 mavv 136,180,152
 s_waitcnt lgkmcnt(3)
 mavv 140,188,152
 rtv 200,209,50696
 mavv 140,184,144
 rtv 202,209,50952
 mavv 108,184,112
 rtv 204,209,51208
 mavv 108,188,120
 rtv 206,209,51464
 mavv 76,188,88
 s_add_u32 s93, s82, 8192
 buffer_load_dwordx4 v[236:239], v2, s[16:19], s93 offen offset:2048 sc1
 mavv 76,184,80
 mavv 44,184,48
 buffer_load_dwordx4 a[220:223], v2, s[16:19], s93 offen offset:3072 sc1
 mavv 44,188,56
 mavv 12,188,24
 v_add_u32 v209, 4294899712, v209
 mavv 12,184,16
 s_waitcnt vmcnt(41) lgkmcnt(3)
 s_add_u32 s93, s82, 12288
 buffer_load_dwordx4 a[224:227], v2, s[16:19], s93 offen offset:0 sc1
 mavv 8,192,32
 s_waitcnt vmcnt(37)
 rtv 176,209,0
 mavv 8,196,40
 s_waitcnt vmcnt(36)
 rtv 178,209,256
 mavv 40,196,72
 rtv 180,209,512
 mavv 40,192,64
 rtv 182,209,768
 mavv 72,192,96
 s_waitcnt vmcnt(35)
 buffer_load_dwordx4 a[228:231], v2, s[16:19], s93 offen offset:1024 sc1
 mavv 72,196,104
 s_waitcnt vmcnt(35)
 mavv 104,196,136
 buffer_load_dwordx4 a[232:235], v2, s[16:19], s93 offen offset:2048 sc1
 mavv 104,192,128
 mavv 136,192,160
 s_waitcnt vmcnt(35)
 buffer_load_dwordx4 a[236:239], v2, s[16:19], s93 offen offset:3072 sc1
 mavv 136,196,168
 s_waitcnt lgkmcnt(3)
 mavv 140,204,168
 rtv 184,209,8
 mavv 140,200,160
 rtv 186,209,264
 mavv 108,200,128
 rtv 188,209,520
 mavv 108,204,136
 rtv 190,209,776
 mavv 76,204,104
 s_add_u32 s93, s82, 16384
 buffer_load_dwordx4 a[240:243], v2, s[16:19], s93 offen offset:0 sc1
 mavv 76,200,96
 mavv 44,200,64
 buffer_load_dwordx4 a[244:247], v2, s[16:19], s93 offen offset:1024 sc1
 mavv 44,204,72
 mavv 12,204,40
 buffer_load_dwordx4 a[248:251], v2, s[16:19], s93 offen offset:2048 sc1
 mavv 12,200,32
 s_waitcnt vmcnt(38) lgkmcnt(3)
 mavv 8,176,20
 s_waitcnt vmcnt(33)
 rtv 192,209,16896
 mavv 8,180,28
 s_waitcnt vmcnt(32)
 rtv 194,209,17152
 mavv 40,180,60
 rtv 196,209,17408
 mavv 40,176,52
 rtv 198,209,17664
 mavv 72,176,84
 s_waitcnt vmcnt(31)
 buffer_load_dwordx4 a[252:255], v2, s[16:19], s93 offen offset:3072 sc1
 mavv 72,180,92
 s_waitcnt vmcnt(31)
 mavv 104,180,124
 mavv 104,176,116
 mavv 136,176,148
 s_waitcnt vmcnt(30)
 mavv 136,180,156
 s_waitcnt lgkmcnt(3)
 mavv 140,188,156
 rtv 200,209,16904
 mavv 140,184,148
 rtv 202,209,17160
 mavv 108,184,116
 rtv 204,209,17416
 mavv 108,188,124
 rtv 206,209,17672
 mavv 76,188,92
 mavv 76,184,84
 mavv 44,184,52
 mavv 44,188,60
 mavv 12,188,28
 mavv 12,184,20
 s_waitcnt vmcnt(29) lgkmcnt(3)
 mavv 8,192,36
 s_waitcnt vmcnt(24)
 rtv 176,209,33792
 v_mov_b32 v9, 1
 mavv 8,196,44
 s_waitcnt vmcnt(23)
 rtv 178,209,34048
 v_cmp_eq_u32 vcc, 0, v0
 mavv 40,196,76
 s_add_u32 s4, s8, 1
 s_and_b32 s4, s4, 3
 rtv 180,209,34304
 mavv 40,192,68
 s_lshl_b32 s4, s4, 9
 rtv 182,209,34560
 v_mov_b32 v10, s4
 mavv 72,192,100
 s_waitcnt vmcnt(22)
 v_cndmask_b32 v6, 0x40000000, v10, vcc
 mavv 72,196,108
 s_waitcnt vmcnt(21)
 s_add_u32 s4, s8, 2
 s_and_b32 s4, s4, 3
 s_lshl_b32 s4, s4, 9
 mavv 104,196,140
 v_mov_b32 v10, s4
 v_cndmask_b32 v7, 0x40000000, v10, vcc
 mavv 104,192,132
 s_add_u32 s4, s8, 3
 s_and_b32 s4, s4, 3
 s_lshl_b32 s4, s4, 9
 mavv 136,192,164
 s_waitcnt vmcnt(20)
 v_mov_b32 v10, s4
 v_cndmask_b32 v8, 0x40000000, v10, vcc
 mavv 136,196,172
 s_waitcnt lgkmcnt(3)
 v_min_u32 v10, 8, v0
 mavv 140,204,172
 rtv 184,209,33800
 mavv 140,200,164
 rtv 186,209,34056
 mavv 108,200,132
 rtv 188,209,34312
 mavv 108,204,140
 rtv 190,209,34568
 mavv 76,204,108
 mavv 76,200,100
 mavv 44,200,68
 mavv 44,204,76
 mavv 12,204,44
 mavv 12,200,36
 s_waitcnt vmcnt(19) lgkmcnt(3)
 mava 8,176,160
 s_waitcnt vmcnt(14)
 rtv 192,209,50688
 mavv 8,180,240
 s_waitcnt vmcnt(13)
 rtv 194,209,50944
 mavv 40,180,244
 rtv 196,209,51200
 mava 40,176,164
 rtv 198,209,51456
 mava 72,176,168
 s_waitcnt vmcnt(12)
 mavv 72,180,248
 s_waitcnt vmcnt(11)
 mavv 104,180,228
 mava 104,176,172
 mava 136,176,176
 s_waitcnt vmcnt(10)
 mavv 136,180,232
 s_waitcnt lgkmcnt(3)
 mavv 140,188,232
 rtv 200,209,50696
 mava 140,184,176
 rtv 202,209,50952
 mava 108,184,172
 rtv 204,209,51208
 mavv 108,188,228
 rtv 206,209,51464
 mavv 76,188,248
 mava 76,184,168
 mava 44,184,164
 mavv 44,188,244
 mavv 12,188,240
 mava 12,184,160
 s_waitcnt vmcnt(9) lgkmcnt(3)
 mavv 8,192,236
 s_waitcnt vmcnt(4)
 rtv 176,210,33792
 mava 8,196,236
 s_waitcnt vmcnt(3)
 rtv 178,210,34048
 mava 40,196,240
 rtv 180,210,34304
 mava 40,192,220
 rtv 182,210,34560
 mava 72,192,224
 s_waitcnt vmcnt(2)
 mava 72,196,244
 s_waitcnt vmcnt(1)
 mava 104,196,248
 mava 104,192,228
 mava 136,192,232
 s_waitcnt vmcnt(0)
 mava 136,196,252
 s_waitcnt lgkmcnt(3)
 mava 140,204,252
 rtv 184,210,33800
 mava 140,200,232
 rtv 186,210,34056
 mava 108,200,228
 rtv 188,210,34312
 mava 108,204,248
 rtv 190,210,34568
 mava 76,204,244
 mava 76,200,224
 mava 44,200,220
 mava 44,204,240
 mava 12,204,236
 mavv 12,200,236
 s_waitcnt lgkmcnt(3)
 mavv 16,176,16
 s_add_u32 s3, s8, 1
 s_and_b32 s3, s3, 3
 rtv 192,210,50688
 mavv 16,180,24
 s_mul_i32 s3, s3, 61440
 s_add_u32 s3, s3, 0
 rtv 194,210,50944
 mavv 48,180,56
 rtv 196,210,51200
 v_accvgpr_read_b32 v212, a8
 mavv 48,176,48
 rtv 198,210,51456
 v_accvgpr_read_b32 v213, a9
 mavv 80,176,80
 v_accvgpr_read_b32 v214, a10
 v_accvgpr_read_b32 v215, a11
 mavv 80,180,88
 v_accvgpr_read_b32 v216, a12
 v_accvgpr_read_b32 v217, a13
 mavv 112,180,120
 v_accvgpr_read_b32 v218, a14
 v_accvgpr_read_b32 v219, a15
 mavv 112,176,112
 pk 212,212
 pk 213,214
 mavv 144,176,144
 pk 214,216
 pk 215,218
 mavv 144,180,152
 s_waitcnt lgkmcnt(3)
 s_add_u32 s86, s3, 0
 buffer_store_dwordx4 v[212:215], v2, s[20:23], s86 offen offset:0 sc1
 v_accvgpr_read_b32 v220, a40
 mavv 148,188,152
 rtv 200,210,50696
 v_accvgpr_read_b32 v221, a41
 mavv 148,184,144
 rtv 202,210,50952
 v_accvgpr_read_b32 v222, a42
 mavv 116,184,112
 rtv 204,210,51208
 v_accvgpr_read_b32 v223, a43
 mavv 116,188,120
 rtv 206,210,51464
 v_accvgpr_read_b32 v224, a44
 mavv 84,188,88
 v_accvgpr_read_b32 v225, a45
 v_accvgpr_read_b32 v226, a46
 mavv 84,184,80
 v_accvgpr_read_b32 v227, a47
 pk 220,220
 mavv 52,184,48
 pk 221,222
 pk 222,224
 mavv 52,188,56
 pk 223,226
 mavv 20,188,24
 buffer_store_dwordx4 v[220:223], v2, s[20:23], s86 offen offset:1024 sc1
 v_add_u32 v210, 4294899712, v210
 mavv 20,184,16
 s_waitcnt lgkmcnt(3)
 v_accvgpr_read_b32 v212, a72
 v_accvgpr_read_b32 v213, a73
 mavv 16,192,32
 rtv 176,210,0
 v_accvgpr_read_b32 v214, a74
 mavv 16,196,40
 rtv 178,210,256
 v_accvgpr_read_b32 v215, a75
 mavv 48,196,72
 rtv 180,210,512
 v_accvgpr_read_b32 v216, a76
 mavv 48,192,64
 rtv 182,210,768
 v_accvgpr_read_b32 v217, a77
 mavv 80,192,96
 v_accvgpr_read_b32 v218, a78
 v_accvgpr_read_b32 v219, a79
 mavv 80,196,104
 pk 212,212
 pk 213,214
 mavv 112,196,136
 pk 214,216
 pk 215,218
 mavv 112,192,128
 buffer_store_dwordx4 v[212:215], v2, s[20:23], s86 offen offset:2048 sc1
 v_accvgpr_read_b32 v220, a104
 mavv 144,192,160
 v_accvgpr_read_b32 v221, a105
 v_accvgpr_read_b32 v222, a106
 mavv 144,196,168
 s_waitcnt lgkmcnt(3)
 v_accvgpr_read_b32 v223, a107
 v_accvgpr_read_b32 v224, a108
 mavv 148,204,168
 rtv 184,210,8
 v_accvgpr_read_b32 v225, a109
 mavv 148,200,160
 rtv 186,210,264
 v_accvgpr_read_b32 v226, a110
 mavv 116,200,128
 rtv 188,210,520
 v_accvgpr_read_b32 v227, a111
 mavv 116,204,136
 rtv 190,210,776
 pk 220,220
 mavv 84,204,104
 pk 221,222
 pk 222,224
 mavv 84,200,96
 pk 223,226
 mavv 52,200,64
 buffer_store_dwordx4 v[220:223], v2, s[20:23], s86 offen offset:3072 sc1
 v_accvgpr_read_b32 v212, a136
 mavv 52,204,72
 v_accvgpr_read_b32 v213, a137
 v_accvgpr_read_b32 v214, a138
 mavv 20,204,40
 v_accvgpr_read_b32 v215, a139
 v_accvgpr_read_b32 v216, a140
 mavv 20,200,32
 s_waitcnt lgkmcnt(3)
 v_accvgpr_read_b32 v217, a141
 v_accvgpr_read_b32 v218, a142
 mavv 16,176,20
 rtv 192,210,16896
 v_accvgpr_read_b32 v219, a143
 mavv 16,180,28
 rtv 194,210,17152
 pk 212,212
 mavv 48,180,60
 rtv 196,210,17408
 pk 213,214
 mavv 48,176,52
 rtv 198,210,17664
 pk 214,216
 mavv 80,176,84
 pk 215,218
 mavv 80,180,92
 s_add_u32 s86, s3, 4096
 buffer_store_dwordx4 v[212:215], v2, s[20:23], s86 offen offset:0 sc1
 mavv 112,180,124
 mavv 112,176,116
 mavv 144,176,148
 mavv 144,180,156
 s_waitcnt lgkmcnt(3)
 mavv 148,188,156
 rtv 200,210,16904
 mavv 148,184,148
 rtv 202,210,17160
 mavv 116,184,116
 rtv 204,210,17416
 mavv 116,188,124
 rtv 206,210,17672
 mavv 84,188,92
 mavv 84,184,84
 mavv 52,184,52
 mavv 52,188,60
 mavv 20,188,28
 mavv 20,184,20
 s_waitcnt lgkmcnt(3)
 mavv 16,192,36
 rtv 176,210,33792
 mavv 16,196,44
 rtv 178,210,34048
 mavv 48,196,76
 rtv 180,210,34304
 mavv 48,192,68
 rtv 182,210,34560
 mavv 80,192,100
 mavv 80,196,108
 mavv 112,196,140
 mavv 112,192,132
 mavv 144,192,164
 mavv 144,196,172
 s_waitcnt lgkmcnt(3)
 mavv 148,204,172
 rtv 184,210,33800
 mavv 148,200,164
 rtv 186,210,34056
 mavv 116,200,132
 rtv 188,210,34312
 mavv 116,204,140
 rtv 190,210,34568
 mavv 84,204,108
 mavv 84,200,100
 mavv 52,200,68
 mavv 52,204,76
 mavv 20,204,44
 mavv 20,200,36
 s_waitcnt lgkmcnt(3)
 mava 16,176,160
 rtv 192,210,50688
 mavv 16,180,240
 rtv 194,210,50944
 mavv 48,180,244
 rtv 196,210,51200
 mava 48,176,164
 rtv 198,210,51456
 mava 80,176,168
 mavv 80,180,248
 mavv 112,180,228
 mava 112,176,172
 mava 144,176,176
 mavv 144,180,232
 s_waitcnt lgkmcnt(3)
 s_lshl_b32 s94, s8, 9
 mavv 148,188,232
 buffer_load_dword v13, v10, s[32:35], s94 offen sc1
 rtv 200,210,50696
 mava 148,184,176
 rtv 202,210,50952
 mava 116,184,172
 rtv 204,210,51208
 mavv 116,188,228
 rtv 206,210,51464
 mavv 84,188,248
 mava 84,184,168
 mava 52,184,164
 mavv 52,188,244
 mavv 20,188,240
 mava 20,184,160
 s_waitcnt lgkmcnt(3)
 mavv 16,192,236
 rtv 176,211,33792
 mava 16,196,236
 rtv 178,211,34048
 mava 48,196,240
 rtv 180,211,34304
 mava 48,192,220
 rtv 182,211,34560
 mava 80,192,224
 mava 80,196,244
 mava 112,196,248
 mava 112,192,228
 mava 144,192,232
 mava 144,196,252
 s_waitcnt lgkmcnt(3)
 mava 148,204,252
 rtv 184,211,33800
 mava 148,200,232
 rtv 186,211,34056
 mava 116,200,228
 rtv 188,211,34312
 mava 116,204,248
 rtv 190,211,34568
 mava 84,204,244
 mava 84,200,224
 mava 52,200,220
 mava 52,204,240
 mava 20,204,236
 mavv 20,200,236
 s_waitcnt lgkmcnt(3)
 mavv 24,176,16
 s_add_u32 s3, s8, 2
 s_and_b32 s3, s3, 3
 rtv 192,211,50688
 mavv 24,180,24
 s_mul_i32 s3, s3, 61440
 s_add_u32 s3, s3, 20480
 rtv 194,211,50944
 mavv 56,180,56
 rtv 196,211,51200
 v_accvgpr_read_b32 v212, a16
 mavv 56,176,48
 rtv 198,211,51456
 v_accvgpr_read_b32 v213, a17
 mavv 88,176,80
 v_accvgpr_read_b32 v214, a18
 v_accvgpr_read_b32 v215, a19
 mavv 88,180,88
 v_accvgpr_read_b32 v216, a20
 v_accvgpr_read_b32 v217, a21
 mavv 120,180,120
 v_accvgpr_read_b32 v218, a22
 v_accvgpr_read_b32 v219, a23
 mavv 120,176,112
 pk 212,212
 pk 213,214
 mavv 152,176,144
 pk 214,216
 pk 215,218
 mavv 152,180,152
 s_waitcnt lgkmcnt(3)
 s_add_u32 s86, s3, 0
 buffer_store_dwordx4 v[212:215], v2, s[20:23], s86 offen offset:0 sc1
 v_accvgpr_read_b32 v220, a48
 mavv 156,188,152
 rtv 200,211,50696
 v_accvgpr_read_b32 v221, a49
 mavv 156,184,144
 rtv 202,211,50952
 v_accvgpr_read_b32 v222, a50
 mavv 124,184,112
 rtv 204,211,51208
 v_accvgpr_read_b32 v223, a51
 mavv 124,188,120
 rtv 206,211,51464
 v_accvgpr_read_b32 v224, a52
 mavv 92,188,88
 v_accvgpr_read_b32 v225, a53
 v_accvgpr_read_b32 v226, a54
 mavv 92,184,80
 v_accvgpr_read_b32 v227, a55
 pk 220,220
 mavv 60,184,48
 pk 221,222
 pk 222,224
 mavv 60,188,56
 pk 223,226
 mavv 28,188,24
 buffer_store_dwordx4 v[220:223], v2, s[20:23], s86 offen offset:1024 sc1
 v_add_u32 v211, 4294899712, v211
 mavv 28,184,16
 s_waitcnt lgkmcnt(3)
 v_accvgpr_read_b32 v212, a80
 v_accvgpr_read_b32 v213, a81
 mavv 24,192,32
 rtv 176,211,0
 v_accvgpr_read_b32 v214, a82
 mavv 24,196,40
 rtv 178,211,256
 v_accvgpr_read_b32 v215, a83
 mavv 56,196,72
 rtv 180,211,512
 v_accvgpr_read_b32 v216, a84
 mavv 56,192,64
 rtv 182,211,768
 v_accvgpr_read_b32 v217, a85
 mavv 88,192,96
 v_accvgpr_read_b32 v218, a86
 v_accvgpr_read_b32 v219, a87
 mavv 88,196,104
 pk 212,212
 pk 213,214
 mavv 120,196,136
 pk 214,216
 pk 215,218
 mavv 120,192,128
 buffer_store_dwordx4 v[212:215], v2, s[20:23], s86 offen offset:2048 sc1
 v_accvgpr_read_b32 v220, a112
 mavv 152,192,160
 v_accvgpr_read_b32 v221, a113
 v_accvgpr_read_b32 v222, a114
 mavv 152,196,168
 s_waitcnt lgkmcnt(3)
 v_accvgpr_read_b32 v223, a115
 v_accvgpr_read_b32 v224, a116
 mavv 156,204,168
 rtv 184,211,8
 v_accvgpr_read_b32 v225, a117
 mavv 156,200,160
 rtv 186,211,264
 v_accvgpr_read_b32 v226, a118
 mavv 124,200,128
 rtv 188,211,520
 v_accvgpr_read_b32 v227, a119
 mavv 124,204,136
 rtv 190,211,776
 pk 220,220
 mavv 92,204,104
 pk 221,222
 pk 222,224
 mavv 92,200,96
 pk 223,226
 mavv 60,200,64
 buffer_store_dwordx4 v[220:223], v2, s[20:23], s86 offen offset:3072 sc1
 v_accvgpr_read_b32 v212, a144
 mavv 60,204,72
 v_accvgpr_read_b32 v213, a145
 v_accvgpr_read_b32 v214, a146
 mavv 28,204,40
 v_accvgpr_read_b32 v215, a147
 v_accvgpr_read_b32 v216, a148
 mavv 28,200,32
 s_waitcnt lgkmcnt(3)
 v_accvgpr_read_b32 v217, a149
 v_accvgpr_read_b32 v218, a150
 mavv 24,176,20
 rtv 192,211,16896
 v_accvgpr_read_b32 v219, a151
 mavv 24,180,28
 rtv 194,211,17152
 pk 212,212
 mavv 56,180,60
 rtv 196,211,17408
 pk 213,214
 mavv 56,176,52
 rtv 198,211,17664
 pk 214,216
 mavv 88,176,84
 pk 215,218
 mavv 88,180,92
 s_add_u32 s86, s3, 4096
 buffer_store_dwordx4 v[212:215], v2, s[20:23], s86 offen offset:0 sc1
 mavv 120,180,124
 s_waitcnt vmcnt(6)
 buffer_store_dword v9, v6, s[32:35], 0 offen offset:0 sc1
 mavv 120,176,116
 mavv 152,176,148
 mavv 152,180,156
 s_waitcnt lgkmcnt(3)
 mavv 156,188,156
 rtv 200,211,16904
 mavv 156,184,148
 rtv 202,211,17160
 mavv 124,184,116
 rtv 204,211,17416
 mavv 124,188,124
 rtv 206,211,17672
 mavv 92,188,92
 mavv 92,184,84
 mavv 60,184,52
 mavv 60,188,60
 mavv 28,188,28
 mavv 28,184,20
 s_waitcnt lgkmcnt(3)
 mavv 24,192,36
 rtv 176,211,33792
 mavv 24,196,44
 rtv 178,211,34048
 mavv 56,196,76
 rtv 180,211,34304
 mavv 56,192,68
 rtv 182,211,34560
 mavv 88,192,100
 mavv 88,196,108
 mavv 120,196,140
 mavv 120,192,132
 mavv 152,192,164
 mavv 152,196,172
 s_waitcnt lgkmcnt(3)
 mavv 156,204,172
 rtv 184,211,33800
 mavv 156,200,164
 rtv 186,211,34056
 mavv 124,200,132
 rtv 188,211,34312
 mavv 124,204,140
 rtv 190,211,34568
 mavv 92,204,108
 mavv 92,200,100
 mavv 60,200,68
 mavv 60,204,76
 mavv 28,204,44
 mavv 28,200,36
 s_waitcnt lgkmcnt(3)
 mava 24,176,160
 rtv 192,211,50688
 mavv 24,180,240
 rtv 194,211,50944
 mavv 56,180,244
 rtv 196,211,51200
 mava 56,176,164
 rtv 198,211,51456
 mava 88,176,168
 mavv 88,180,248
 mavv 120,180,228
 mava 120,176,172
 mava 152,176,176
 mavv 152,180,232
 s_waitcnt lgkmcnt(3)
 mavv 156,188,232
 rtv 200,211,50696
 mava 156,184,176
 rtv 202,211,50952
 mava 124,184,172
 rtv 204,211,51208
 mavv 124,188,228
 rtv 206,211,51464
 mavv 92,188,248
 mava 92,184,168
 mava 60,184,164
 mavv 60,188,244
 mavv 28,188,240
 mava 28,184,160
 s_waitcnt lgkmcnt(3)
 mavv 24,192,236
 rtv 176,208,33792
 mava 24,196,236
 rtv 178,208,34048
 mava 56,196,240
 rtv 180,208,34304
 mava 56,192,220
 rtv 182,208,34560
 mava 88,192,224
 mava 88,196,244
 mava 120,196,248
 mava 120,192,228
 mava 152,192,232
 mava 152,196,252
 s_waitcnt lgkmcnt(3)
 mava 156,204,252
 rtv 184,208,33800
 mava 156,200,232
 rtv 186,208,34056
 mava 124,200,228
 rtv 188,208,34312
 mava 124,204,248
 rtv 190,208,34568
 mava 92,204,244
 mava 92,200,224
 mava 60,200,220
 mava 60,204,240
 mava 28,204,236
 mavv 28,200,236
 s_waitcnt lgkmcnt(3)
 mavv 0,176,16
 s_add_u32 s3, s8, 3
 s_and_b32 s3, s3, 3
 rtv 192,208,50688
 mavv 0,180,24
 s_mul_i32 s3, s3, 61440
 s_add_u32 s3, s3, 40960
 rtv 194,208,50944
 mavv 32,180,56
 rtv 196,208,51200
 v_accvgpr_read_b32 v212, a24
 mavv 32,176,48
 rtv 198,208,51456
 v_accvgpr_read_b32 v213, a25
 mavv 64,176,80
 v_accvgpr_read_b32 v214, a26
 v_accvgpr_read_b32 v215, a27
 mavv 64,180,88
 v_accvgpr_read_b32 v216, a28
 v_accvgpr_read_b32 v217, a29
 mavv 96,180,120
 v_accvgpr_read_b32 v218, a30
 v_accvgpr_read_b32 v219, a31
 mavv 96,176,112
 pk 212,212
 pk 213,214
 mavv 128,176,144
 pk 214,216
 pk 215,218
 mavv 128,180,152
 s_waitcnt lgkmcnt(3)
 s_add_u32 s86, s3, 0
 buffer_store_dwordx4 v[212:215], v2, s[20:23], s86 offen offset:0 sc1
 v_accvgpr_read_b32 v220, a56
 mavv 132,188,152
 rtv 200,208,50696
 v_accvgpr_read_b32 v221, a57
 mavv 132,184,144
 rtv 202,208,50952
 v_accvgpr_read_b32 v222, a58
 mavv 100,184,112
 rtv 204,208,51208
 v_accvgpr_read_b32 v223, a59
 mavv 100,188,120
 rtv 206,208,51464
 v_accvgpr_read_b32 v224, a60
 mavv 68,188,88
 v_accvgpr_read_b32 v225, a61
 v_accvgpr_read_b32 v226, a62
 mavv 68,184,80
 v_accvgpr_read_b32 v227, a63
 pk 220,220
 mavv 36,184,48
 pk 221,222
 pk 222,224
 mavv 36,188,56
 pk 223,226
 mavv 4,188,24
 buffer_store_dwordx4 v[220:223], v2, s[20:23], s86 offen offset:1024 sc1
 v_add_u32 v208, 4294899712, v208
 mavv 4,184,16
 s_waitcnt lgkmcnt(3)
 v_accvgpr_read_b32 v212, a88
 v_accvgpr_read_b32 v213, a89
 mavv 0,192,32
 rtv 176,208,0
 v_accvgpr_read_b32 v214, a90
 mavv 0,196,40
 rtv 178,208,256
 v_accvgpr_read_b32 v215, a91
 mavv 32,196,72
 rtv 180,208,512
 v_accvgpr_read_b32 v216, a92
 mavv 32,192,64
 rtv 182,208,768
 v_accvgpr_read_b32 v217, a93
 mavv 64,192,96
 v_accvgpr_read_b32 v218, a94
 v_accvgpr_read_b32 v219, a95
 mavv 64,196,104
 pk 212,212
 pk 213,214
 mavv 96,196,136
 pk 214,216
 pk 215,218
 mavv 96,192,128
 buffer_store_dwordx4 v[212:215], v2, s[20:23], s86 offen offset:2048 sc1
 v_accvgpr_read_b32 v220, a120
 mavv 128,192,160
 v_accvgpr_read_b32 v221, a121
 v_accvgpr_read_b32 v222, a122
 mavv 128,196,168
 s_waitcnt lgkmcnt(3)
 v_accvgpr_read_b32 v223, a123
 v_accvgpr_read_b32 v224, a124
 mavv 132,204,168
 rtv 184,208,8
 v_accvgpr_read_b32 v225, a125
 mavv 132,200,160
 rtv 186,208,264
 v_accvgpr_read_b32 v226, a126
 mavv 100,200,128
 rtv 188,208,520
 v_accvgpr_read_b32 v227, a127
 mavv 100,204,136
 rtv 190,208,776
 pk 220,220
 mavv 68,204,104
 pk 221,222
 pk 222,224
 mavv 68,200,96
 pk 223,226
 mavv 36,200,64
 buffer_store_dwordx4 v[220:223], v2, s[20:23], s86 offen offset:3072 sc1
 v_accvgpr_read_b32 v212, a152
 mavv 36,204,72
 v_accvgpr_read_b32 v213, a153
 v_accvgpr_read_b32 v214, a154
 mavv 4,204,40
 v_accvgpr_read_b32 v215, a155
 v_accvgpr_read_b32 v216, a156
 mavv 4,200,32
 s_waitcnt lgkmcnt(3)
 v_accvgpr_read_b32 v217, a157
 v_accvgpr_read_b32 v218, a158
 mavv 0,176,20
 rtv 192,208,16896
 v_accvgpr_read_b32 v219, a159
 mavv 0,180,28
 rtv 194,208,17152
 pk 212,212
 mavv 32,180,60
 rtv 196,208,17408
 pk 213,214
 mavv 32,176,52
 rtv 198,208,17664
 pk 214,216
 mavv 64,176,84
 pk 215,218
 mavv 64,180,92
 s_add_u32 s86, s3, 4096
 buffer_store_dwordx4 v[212:215], v2, s[20:23], s86 offen offset:0 sc1
 mavv 96,180,124
 s_mov_b32 s91, 0x3f80
 s_waitcnt vmcnt(6)
 buffer_store_dword v9, v7, s[32:35], 0 offen offset:4 sc1
 mavv 96,176,116
 mavv 128,176,148
 v_mov_b32 v212, 0
 v_mov_b32 v213, 0
 mavv 128,180,156
 s_waitcnt lgkmcnt(3)
 v_mov_b32 v216, 0
 v_mov_b32 v217, 0
 mavv 132,188,156
 rtv 200,208,16904
 v_lshrrev_b32 v14, 6, v0
 mavv 132,184,148
 rtv 202,208,17160
 v_bfe_u32 v15, v0, 4, 2
 mavv 100,184,116
 rtv 204,208,17416
 v_cmp_eq_u32 vcc, v14, v15
 mavv 100,188,124
 rtv 206,208,17672
 v_and_b32 v14, 4, v0
 mavv 68,188,92
 v_lshlrev_b32 v14, 2, v14
 v_lshlrev_b32 v14, v14, s91
 mavv 68,184,84
 v_cndmask_b32 v14, 0, v14, vcc
 v_and_b32 v15, 8, v0
 mavv 36,184,52
 v_cmp_eq_u32 vcc, 0, v15
 s_nop 1
 v_cndmask_b32 v214, 0, v14, vcc
 mavv 36,188,60
 v_cndmask_b32 v215, v14, 0, vcc
 v_and_b32 v14, 60, v0
 mavv 4,188,28
 v_lshlrev_b32 v14, 9, v14
 v_lshrrev_b32 v15, 6, v0
 mavv 4,184,20
 s_waitcnt lgkmcnt(3)
 v_lshl_add_u32 v218, v15, 4, v14
 mavv 0,192,36
 rtv 176,208,33792
 v_cmp_eq_u32 vcc, 1, v13
 s_nop 1
 s_and_b32 s37, vcc_lo, 7
 s_mul_i32 s4, s8, 61440
 mavv 0,196,44
 s_bitcmp1_b32 s37, 0
 s_cselect_b32 s22, 230400, 0
 rtv 178,208,34048
 mavv 32,196,76
 s_add_u32 s86, s4, 0
 rtv 180,208,34304
 mavv 32,192,68
 rtv 182,208,34560
 mavv 64,192,100
 buffer_load_dwordx4 v[16:19], v2, s[20:23], s86 offen offset:0 sc1
 mavv 64,196,108
 mavv 96,196,140
 buffer_load_dwordx4 v[48:51], v2, s[20:23], s86 offen offset:1024 sc1
 mavv 96,192,132
 mavv 128,192,164
 buffer_load_dwordx4 v[80:83], v2, s[20:23], s86 offen offset:2048 sc1
 mavv 128,196,172
 s_waitcnt lgkmcnt(3)
 mavv 132,204,172
 rtv 184,208,33800
 mavv 132,200,164
 rtv 186,208,34056
 mavv 100,200,132
 rtv 188,208,34312
 mavv 100,204,140
 rtv 190,208,34568
 mavv 68,204,108
 buffer_load_dwordx4 v[112:115], v2, s[20:23], s86 offen offset:3072 sc1
 mavv 68,200,100
 mavv 36,200,68
 s_add_u32 s86, s4, 4096
 buffer_load_dwordx4 v[144:147], v2, s[20:23], s86 offen offset:0 sc1
 mavv 36,204,76
 mavv 4,204,44
 s_bitcmp1_b32 s37, 1
 s_cselect_b32 s22, 230400, 0
 mavv 4,200,36
 s_waitcnt lgkmcnt(3)
 s_add_u32 s86, s4, 20480
 buffer_load_dwordx4 v[24:27], v2, s[20:23], s86 offen offset:0 sc1
 mava 0,176,160
 rtv 192,208,50688
 mavv 0,180,240
 rtv 194,208,50944
 mavv 32,180,244
 rtv 196,208,51200
 mava 32,176,164
 rtv 198,208,51456
 mava 64,176,168
 buffer_load_dwordx4 v[56:59], v2, s[20:23], s86 offen offset:1024 sc1
 mavv 64,180,248
 mavv 96,180,228
 buffer_load_dwordx4 v[88:91], v2, s[20:23], s86 offen offset:2048 sc1
 mava 96,176,172
 mava 128,176,176
 buffer_load_dwordx4 v[120:123], v2, s[20:23], s86 offen offset:3072 sc1
 mavv 128,180,232
 s_waitcnt lgkmcnt(3)
 mavv 132,188,232
 s_add_u32 s86, s4, 24576
 rtv 200,208,50696
 mava 132,184,176
 rtv 202,208,50952
 mava 100,184,172
 rtv 204,208,51208
 mavv 100,188,228
 rtv 206,208,51464
 mavv 68,188,248
 buffer_load_dwordx4 v[152:155], v2, s[20:23], s86 offen offset:0 sc1
 mava 68,184,168
 mava 36,184,164
 s_bitcmp1_b32 s37, 2
 s_cselect_b32 s22, 230400, 0
 mavv 36,188,244
 s_add_u32 s86, s4, 40960
 buffer_load_dwordx4 v[32:35], v2, s[20:23], s86 offen offset:0 sc1
 mavv 4,188,240
 mava 4,184,160
 s_waitcnt lgkmcnt(3)
 buffer_load_dwordx4 v[64:67], v2, s[20:23], s86 offen offset:1024 sc1
 mavv 0,192,236
 mava 0,196,236
 buffer_load_dwordx4 v[96:99], v2, s[20:23], s86 offen offset:2048 sc1
 mava 32,196,240
 mava 32,192,220
 buffer_load_dwordx4 v[128:131], v2, s[20:23], s86 offen offset:3072 sc1
 mava 64,192,224
 mava 64,196,244
 s_add_u32 s86, s4, 45056
 buffer_load_dwordx4 v[160:163], v2, s[20:23], s86 offen offset:0 sc1
 mava 96,196,248
 mava 96,192,228
 mava 128,192,232
 mava 128,196,252
 s_waitcnt lgkmcnt(0)
 mava 132,204,252
 mava 132,200,232
 mava 100,200,228
 mava 100,204,248
 mava 68,204,244
 mava 68,200,224
 mava 36,200,220
 mava 36,204,240
 mava 4,204,236
 mavv 4,200,236
 s_waitcnt vmcnt(16)
 buffer_store_dword v9, v8, s[32:35], 0 offen offset:8 sc1
 s_cmp_lg_u32 s37, 7
 s_cbranch_scc1 L15_16_more
 s_waitcnt vmcnt(1)
L15_16_fin:
 mavv 0,214,16
 mavv 0,214,24
 mavv 0,214,32
 mavv 4,212,16
 mavv 4,212,24
 mavv 4,212,32
 mavv 32,214,48
 mavv 32,214,56
 s_nop 2
 v_accvgpr_read_b32 v176, a0
 v_accvgpr_read_b32 v177, a1
 mavv 32,214,64
 v_accvgpr_read_b32 v178, a2
 v_accvgpr_read_b32 v179, a3
 mavv 36,212,48
 v_accvgpr_read_b32 v180, a4
 v_accvgpr_read_b32 v181, a5
 mavv 36,212,56
 v_accvgpr_read_b32 v182, a6
 v_accvgpr_read_b32 v183, a7
 mavv 36,212,64
 pk 176,176
 pk 177,178
 mavv 64,214,80
 pk 178,180
 pk 179,182
 mavv 64,214,88
 s_mov_b32 s86, 0
 buffer_store_dwordx4 v[176:179], v218, s[24:27], s86 offen nt
 v_accvgpr_read_b32 v184, a32
 mavv 64,214,96
 v_accvgpr_read_b32 v185, a33
 v_accvgpr_read_b32 v186, a34
 mavv 68,212,80
 v_accvgpr_read_b32 v187, a35
 v_accvgpr_read_b32 v188, a36
 mavv 68,212,88
 v_accvgpr_read_b32 v189, a37
 v_accvgpr_read_b32 v190, a38
 mavv 68,212,96
 v_accvgpr_read_b32 v191, a39
 pk 184,184
 mavv 96,214,112
 pk 185,186
 pk 186,188
 mavv 96,214,120
 pk 187,190
 v_accvgpr_read_b32 v192, a64
 mavv 96,214,128
 s_mov_b32 s86, 32768
 buffer_store_dwordx4 v[184:187], v218, s[24:27], s86 offen nt
 v_accvgpr_read_b32 v193, a65
 mavv 100,212,112
 v_accvgpr_read_b32 v194, a66
 v_accvgpr_read_b32 v195, a67
 mavv 100,212,120
 v_accvgpr_read_b32 v196, a68
 v_accvgpr_read_b32 v197, a69
 mavv 100,212,128
 v_accvgpr_read_b32 v198, a70
 v_accvgpr_read_b32 v199, a71
 mavv 128,214,144
 pk 192,192
 pk 193,194
 mavv 128,214,152
 pk 194,196
 pk 195,198
 mavv 128,214,160
 s_mov_b32 s86, 65536
 buffer_store_dwordx4 v[192:195], v218, s[24:27], s86 offen nt
 v_accvgpr_read_b32 v200, a96
 mavv 132,212,144
 v_accvgpr_read_b32 v201, a97
 v_accvgpr_read_b32 v202, a98
 mavv 132,212,152
 v_accvgpr_read_b32 v203, a99
 v_accvgpr_read_b32 v204, a100
 mavv 132,212,160
 v_accvgpr_read_b32 v205, a101
 v_accvgpr_read_b32 v206, a102
 v_accvgpr_read_b32 v207, a103
 pk 200,200
 pk 201,202
 pk 202,204
 pk 203,206
 s_mov_b32 s86, 98304
 buffer_store_dwordx4 v[200:203], v218, s[24:27], s86 offen nt
 v_accvgpr_read_b32 v220, a128
 v_accvgpr_read_b32 v221, a129
 v_accvgpr_read_b32 v222, a130
 v_accvgpr_read_b32 v223, a131
 v_accvgpr_read_b32 v224, a132
 v_accvgpr_read_b32 v225, a133
 v_accvgpr_read_b32 v226, a134
 v_accvgpr_read_b32 v227, a135
 pk 220,220
 pk 221,222
 pk 222,224
 pk 223,226
 s_mov_b32 s86, 131072
 buffer_store_dwordx4 v[220:223], v218, s[24:27], s86 offen nt
 s_endpgm
L15_16_skip:
 s_waitcnt vmcnt(0) lgkmcnt(0)
 s_nop 7
 s_branch L15_16_go
L15_16_wgroup1:
 s_xor_b32 s94, s8, 0
 s_lshl_b32 s94, s94, 9
 v_min_u32 v15, 12, v0
 v_lshl_add_u32 v15, v15, 5, s94
 s_mov_b32 s79, 0x40000
L15_16_sgroup1:
 s_sub_u32 s79, s79, 1
 s_cbranch_scc1 L15_16_sgroup1_end
 s_sleep 2
 buffer_load_dword v13, v15, s[44:47], 0 offen offset:4 sc1
 s_waitcnt vmcnt(0)
 v_cmp_ne_u32 vcc, 1, v13
 s_nop 1
 s_and_b64 vcc, vcc, 15
 s_cbranch_scc1 L15_16_sgroup1
L15_16_sgroup1_end:
 s_waitcnt vmcnt(0) lgkmcnt(0)
 s_nop 7
 s_branch L15_16_ggroup1
L15_16_wgroup:
 s_xor_b32 s94, s8, 0
 s_lshl_b32 s94, s94, 9
 v_min_u32 v15, 12, v0
 v_lshl_add_u32 v15, v15, 5, s94
 s_mov_b32 s79, 0x40000
L15_16_sgroup:
 s_sub_u32 s79, s79, 1
 s_cbranch_scc1 L15_16_sgroup_end
 s_sleep 2
 buffer_load_dword v13, v15, s[44:47], 0 offen offset:0 sc1
 s_waitcnt vmcnt(0)
 v_cmp_ne_u32 vcc, 1, v13
 s_nop 1
 s_and_b64 vcc, vcc, 15
 s_cbranch_scc1 L15_16_sgroup
L15_16_sgroup_end:
 s_waitcnt vmcnt(0) lgkmcnt(0)
 s_nop 7
 s_branch L15_16_ggroup
L15_16_more:
 s_mov_b32 s22, 230400
 s_mov_b32 s81, s37
 s_mov_b32 s79, 0x40000
L15_16_ask:
 s_mov_b32 s37, 7
 s_sub_u32 s79, s79, 1
 s_cbranch_scc1 L15_16_get
 s_sleep 1
 buffer_load_dword v13, v10, s[32:35], s94 offen sc1
 s_waitcnt vmcnt(0)
L15_16_look:
 v_cmp_eq_u32 vcc, 1, v13
 s_nop 1
 s_and_b32 s37, vcc_lo, 7
L15_16_get:
 s_andn2_b32 s37, s37, s81
 s_cbranch_scc0 L15_16_ask
 s_bitcmp0_b32 s37, 0
 s_cbranch_scc1 L15_16_l0
 s_add_u32 s86, s4, 0
 buffer_load_dwordx4 v[16:19], v2, s[20:23], s86 offen offset:0 sc1
 buffer_load_dwordx4 v[48:51], v2, s[20:23], s86 offen offset:1024 sc1
 buffer_load_dwordx4 v[80:83], v2, s[20:23], s86 offen offset:2048 sc1
 buffer_load_dwordx4 v[112:115], v2, s[20:23], s86 offen offset:3072 sc1
 s_add_u32 s86, s4, 4096
 buffer_load_dwordx4 v[144:147], v2, s[20:23], s86 offen offset:0 sc1
L15_16_l0:
 s_bitcmp0_b32 s37, 1
 s_cbranch_scc1 L15_16_l1
 s_add_u32 s86, s4, 20480
 buffer_load_dwordx4 v[24:27], v2, s[20:23], s86 offen offset:0 sc1
 buffer_load_dwordx4 v[56:59], v2, s[20:23], s86 offen offset:1024 sc1
 buffer_load_dwordx4 v[88:91], v2, s[20:23], s86 offen offset:2048 sc1
 buffer_load_dwordx4 v[120:123], v2, s[20:23], s86 offen offset:3072 sc1
 s_add_u32 s86, s4, 24576
 buffer_load_dwordx4 v[152:155], v2, s[20:23], s86 offen offset:0 sc1
L15_16_l1:
 s_bitcmp0_b32 s37, 2
 s_cbranch_scc1 L15_16_l2
 s_add_u32 s86, s4, 40960
 buffer_load_dwordx4 v[32:35], v2, s[20:23], s86 offen offset:0 sc1
 buffer_load_dwordx4 v[64:67], v2, s[20:23], s86 offen offset:1024 sc1
 buffer_load_dwordx4 v[96:99], v2, s[20:23], s86 offen offset:2048 sc1
 buffer_load_dwordx4 v[128:131], v2, s[20:23], s86 offen offset:3072 sc1
 s_add_u32 s86, s4, 45056
 buffer_load_dwordx4 v[160:163], v2, s[20:23], s86 offen offset:0 sc1
L15_16_l2:
 s_or_b32 s81, s81, s37
 s_cmp_lg_u32 s81, 7
 s_cbranch_scc1 L15_16_ask
 s_waitcnt vmcnt(0)
 s_branch L15_16_fin
L15_hk3:
 s_waitcnt lgkmcnt(3)
 mvaac 176,80,0,208
 v_exp_f32 v204, v204
 mvaa 176,84,4
 v_exp_f32 v205, v205
 mvaa 176,88,8
 pk 202,204
 v_add_f32 v252, v252, v203
 mvaa 176,92,12
 v_exp_f32 v206, v206
 mvaac 180,108,12,208
 v_exp_f32 v207, v207
 mvaa 180,104,8
 pk 203,206
 v_add_f32 v252, v252, v196
 mvaa 180,100,4
 v_add_f32 v252, v252, v197
 v_add_f32 v252, v252, v198
 mvaa 180,96,0
 v_add_f32 v252, v252, v199
 v_add_f32 v252, v252, v204
 mvaac 184,112,0,208
 v_exp_f32 v176, v176
 mvaa 184,116,4
 v_exp_f32 v177, v177
 mvaa 184,120,8
 pk 176,176
 v_add_f32 v252, v252, v205
 mvaa 184,124,12
 v_exp_f32 v178, v178
 mvaac 188,140,12,208
 s_waitcnt lgkmcnt(0)
 v_exp_f32 v179, v179
 mvaa 188,136,8
 s_mov_b32 s86, 4096
 buffer_store_dwordx4 v[244:247], v2, s[60:63], s86 offen offset:2048 sc1
 pk 177,178
 v_add_f32 v252, v252, v206
 mvaa 188,132,4
 v_exp_f32 v180, v180
 mvaa 188,128,0
 v_exp_f32 v181, v181
 mvav 144,144,192
 pk 178,180
 v_add_f32 v252, v252, v207
 mvav 144,148,200
 v_exp_f32 v182, v182
 mvav 148,152,192
 v_exp_f32 v183, v183
 mvav 148,156,200
 rta 144,4,16896
 pk 179,182
 mvav 152,160,192
 v_exp_f32 v184, v184
 mvav 152,164,200
 v_exp_f32 v185, v185
 mvav 156,168,192
 rta 146,4,17152
 pk 184,184
 mvav 156,172,200
 v_exp_f32 v186, v186
 mvav 160,176,192
 rta 148,4,17408
 rta 150,4,17664
 mvav 160,180,200
 v_exp_f32 v187, v187
 mvav 164,184,192
 rta 152,4,16928
 pk 185,186
 mvav 164,188,200
 rta 154,4,17184
 rta 156,4,17440
 mvav 168,192,192
 v_exp_f32 v188, v188
 mvav 168,196,200
 rta 158,4,17696
 rta 160,4,16960
 mvav 172,200,192
 v_exp_f32 v189, v189
 mvav 172,204,200
 rta 162,4,17216
 pk 186,188
 mvaac 192,80,16,212
 rta 164,4,17472
 rta 166,4,17728
 mvaa 192,84,20
 v_exp_f32 v190, v190
 mvaa 192,88,24
 rta 168,4,16992
 rta 170,4,17248
 mvaa 192,92,28
 s_mov_b32 s86, 4096
 buffer_store_dwordx4 v[248:251], v2, s[60:63], s86 offen offset:3072 sc1
 v_exp_f32 v191, v191
 mvaac 196,108,28,212
 rta 172,4,17504
 pk 187,190
 mvaa 196,104,24
 rta 174,4,17760
 rta 176,4,17024
 mvaa 196,100,20
 rta 178,4,17280
 rta 180,4,17536
 mvaa 196,96,16
 rta 182,4,17792
 rta 184,4,17056
 mvaac 200,112,16,212
 rta 186,4,17312
 rta 188,4,17568
 mvaa 200,116,20
 rta 190,4,17824
 rta 192,4,17088
 mvaa 200,120,24
 rta 194,4,17344
 rta 196,4,17600
 mvaa 200,124,28
 rta 198,4,17856
 rta 200,4,17120
 mvaac 204,140,28,212
 rta 202,4,17376
 rta 204,4,17632
 mvaa 204,136,24
 v_exp_f32 v192, v192
 mvaa 204,132,20
 v_exp_f32 v193, v193
 mvaa 204,128,16
 s_waitcnt lgkmcnt(12)
 rta 206,4,17888
 pk 192,192
 mvav 16,144,176
 v_exp_f32 v194, v194
 mvav 16,148,184
 v_exp_f32 v195, v195
 mvav 20,152,176
 v_exp_f32 v196, v196
 mvav 20,156,184
 v_exp_f32 v197, v197
 mvav 24,160,176
 pk 193,194
 pk 194,196
 mvav 24,164,184
 v_exp_f32 v198, v198
 mvav 28,168,176
 v_exp_f32 v199, v199
 mvav 28,172,184
 v_exp_f32 v200, v200
 mvav 32,176,176
 s_waitcnt lgkmcnt(0)
 pk 195,198
 v_add_f32 v255, v255, v200
 mvav 32,180,184
 s_mov_b32 s86, 8192
 buffer_store_dwordx4 v[228:231], v2, s[60:63], s86 offen offset:0 sc1
 v_exp_f32 v201, v201
 mvav 36,184,176
 pk 200,200
 v_add_f32 v255, v255, v201
 mvav 36,188,184
 v_exp_f32 v202, v202
 mvav 40,192,176
 v_exp_f32 v203, v203
 mvav 40,196,184
 s_mov_b32 s86, 4096
 buffer_store_dwordx4 v[240:243], v2, s[60:63], s86 offen offset:1024 sc1
 pk 201,202
 v_add_f32 v255, v255, v202
 mvav 44,200,176
 v_exp_f32 v204, v204
 mvav 44,204,184
 v_exp_f32 v205, v205
 maav 208,216,176
 pk 202,204
 v_add_f32 v255, v255, v203
 maav 208,216,184
 v_exp_f32 v206, v206
 mvaac 176,80,32,216
 s_waitcnt vmcnt(20)
 s_barrier
 v_add_f32 v255, v255, v204
 mvaa 176,84,36
 v_exp_f32 v207, v207
 mvaa 176,88,40
 pk 203,206
 v_add_f32 v255, v255, v205
 mvaa 176,92,44
 s_add_u32 m0, s77, 0
 v_add_f32 v255, v255, v206
 v_add_f32 v255, v255, v207
 mvaac 180,108,44,216
 buffer_load_dwordx4 v1, s[52:55], s76 offen offset:0 nt lds
 mvaa 180,104,40
 s_add_u32 m0, s77, 32
 mvaa 180,100,36
 buffer_load_dwordx4 v1, s[52:55], s76 offen offset:1024 nt lds
 mvaa 180,96,32
 mvaac 184,112,32,216
 v_exp_f32 v176, v176
 mvaa 184,116,36
 v_exp_f32 v177, v177
 mvaa 184,120,40
 v_add_f32 v254, v254, v176
 pk 176,176
 mvaa 184,124,44
 v_exp_f32 v178, v178
 mvaac 188,140,44,216
 v_exp_f32 v179, v179
 mvaa 188,136,40
 v_add_f32 v254, v254, v177
 pk 177,178
 mvaa 188,132,36
 v_exp_f32 v180, v180
 mvaa 188,128,32
 v_exp_f32 v181, v181
 mvav 48,144,192
 v_add_f32 v254, v254, v178
 pk 178,180
 mvav 48,148,200
 v_exp_f32 v182, v182
 mvav 52,152,192
 v_exp_f32 v183, v183
 mvav 52,156,200
 v_add_f32 v254, v254, v179
 pk 179,182
 mvav 56,160,192
 v_exp_f32 v184, v184
 mvav 56,164,200
 v_exp_f32 v185, v185
 mvav 60,168,192
 v_add_f32 v254, v254, v184
 pk 184,184
 mvav 60,172,200
 v_exp_f32 v186, v186
 mvav 64,176,192
 v_exp_f32 v187, v187
 mvav 64,180,200
 v_add_f32 v254, v254, v185
 pk 185,186
 mvav 68,184,192
 v_exp_f32 v188, v188
 mvav 68,188,200
 v_exp_f32 v189, v189
 mvav 72,192,192
 v_add_f32 v254, v254, v186
 pk 186,188
 mvav 72,196,200
 v_exp_f32 v190, v190
 mvav 76,200,192
 v_exp_f32 v191, v191
 mvav 76,204,200
 s_add_u32 m0, s77, 64
 v_add_f32 v254, v254, v187
 pk 187,190
 maav 212,216,192
 buffer_load_dwordx4 v1, s[52:55], s76 offen offset:2048 nt lds
 v_add_f32 v254, v254, v180
 mvaac 192,80,48,220
 s_add_u32 m0, s77, 96
 v_add_f32 v254, v254, v181
 v_add_f32 v254, v254, v182
 mvaa 192,84,52
 buffer_load_dwordx4 v1, s[52:55], s76 offen offset:3072 nt lds
 v_add_f32 v254, v254, v183
 mvaa 192,88,56
 s_add_u32 m0, s77, 16896
 v_add_f32 v254, v254, v188
 v_add_f32 v254, v254, v189
 mvaa 192,92,60
 buffer_load_dwordx4 v1, s[56:59], s76 offen offset:0 nt lds
 v_add_f32 v254, v254, v190
 mvaac 196,108,60,220
 s_add_u32 m0, s77, 16928
 v_add_f32 v254, v254, v191
 mvaa 196,104,56
 buffer_load_dwordx4 v1, s[56:59], s76 offen offset:1024 nt lds
 mvaa 196,100,52
 s_add_u32 m0, s77, 16960
 mvaa 196,96,48
 buffer_load_dwordx4 v1, s[56:59], s76 offen offset:2048 nt lds
 mvaac 200,112,48,220
 v_exp_f32 v192, v192
 mvaa 200,116,52
 v_exp_f32 v193, v193
 mvaa 200,120,56
 v_add_f32 v253, v253, v192
 pk 192,192
 mvaa 200,124,60
 v_exp_f32 v194, v194
 mvaac 204,140,60,220
 s_add_u32 m0, s77, 16992
 v_exp_f32 v195, v195
 mvaa 204,136,56
 buffer_load_dwordx4 v1, s[56:59], s76 offen offset:3072 nt lds
 v_add_f32 v253, v253, v193
 mvaa 204,132,52
 pk 193,194
 v_add_f32 v253, v253, v194
 mvaa 204,128,48
 v_exp_f32 v196, v196
 mvav 80,144,176
 v_exp_f32 v197, v197
 mvav 80,148,184
 pk 194,196
 v_add_f32 v253, v253, v195
 mvav 84,152,176
 v_exp_f32 v198, v198
 mvav 84,156,184
 v_exp_f32 v199, v199
 mvav 88,160,176
 pk 195,198
 v_add_f32 v253, v253, v196
 mvav 88,164,184
 v_exp_f32 v200, v200
 mvav 92,168,176
 v_exp_f32 v201, v201
 mvav 92,172,184
 v_add_f32 v253, v253, v200
 pk 200,200
 mvav 96,176,176
 v_exp_f32 v202, v202
 mvav 96,180,184
 v_exp_f32 v203, v203
 mvav 100,184,176
 v_add_f32 v253, v253, v201
 pk 201,202
 mvav 100,188,184
 v_exp_f32 v204, v204
 mvav 104,192,176
 v_exp_f32 v205, v205
 mvav 104,196,184
 v_add_f32 v253, v253, v202
 pk 202,204
 mvav 108,200,176
 v_exp_f32 v206, v206
 mvav 108,204,184
 v_exp_f32 v207, v207
 mvaac 176,80,64,224
 s_add_u32 s5, s5, s81
 v_add_f32 v253, v253, v203
 pk 203,206
 mvaa 176,84,68
 ds_read_b128 a[80:83], v3 offset:33792
 v_add_f32 v253, v253, v197
 mvaa 176,88,72
 ds_read_b128 a[84:87], v3 offset:33856
 v_add_f32 v253, v253, v198
 mvaa 176,92,76
 ds_read_b128 a[88:91], v3 offset:33920
 v_add_f32 v253, v253, v199
 mvaac 180,108,76,224
 ds_read_b128 a[92:95], v3 offset:33984
 v_add_f32 v253, v253, v204
 mvaa 180,104,72
 s_xor_b32 s76, s5, s39
 ds_read_b128 a[108:111], v3 offset:34240
 v_add_f32 v253, v253, v205
 mvaa 180,100,68
 ds_read_b128 a[104:107], v3 offset:34176
 v_add_f32 v253, v253, v206
 mvaa 180,96,64
 ds_read_b128 a[100:103], v3 offset:34112
 v_add_f32 v253, v253, v207
 mvaac 184,112,64,224
 v_exp_f32 v176, v176
 mvaa 184,116,68
 v_exp_f32 v177, v177
 mvaa 184,120,72
 v_add_f32 v252, v252, v176
 pk 176,176
 mvaa 184,124,76
 v_exp_f32 v178, v178
 mvaac 188,140,76,224
 v_exp_f32 v179, v179
 mvaa 188,136,72
 v_add_f32 v252, v252, v177
 pk 177,178
 mvaa 188,132,68
 v_exp_f32 v180, v180
 mvaa 188,128,64
 v_exp_f32 v181, v181
 mvav 112,144,192
 ds_read_b128 a[96:99], v3 offset:34048
 v_add_f32 v252, v252, v178
 mvav 112,148,200
 ds_read_b128 a[112:115], v3 offset:34304
 pk 178,180
 mvav 116,152,192
 v_exp_f32 v182, v182
 mvav 116,156,200
 ds_read_b128 a[116:119], v3 offset:34368
 ds_read_b128 a[120:123], v3 offset:34432
 mvav 120,160,192
 s_mov_b32 s86, 8192
 buffer_store_dwordx4 v[232:235], v2, s[60:63], s86 offen offset:1024 sc1
 v_exp_f32 v183, v183
 mvav 120,164,200
 ds_read_b128 a[124:127], v3 offset:34496
 v_add_f32 v252, v252, v179
 mvav 124,168,192
 ds_read_b128 a[140:143], v3 offset:34752
 pk 179,182
 mvav 124,172,200
 v_exp_f32 v184, v184
 mvav 128,176,192
 v_exp_f32 v185, v185
 mvav 128,180,200
 ds_read_b128 a[136:139], v3 offset:34688
 ds_read_b128 a[132:135], v3 offset:34624
 mvav 132,184,192
 v_add_f32 v252, v252, v184
 pk 184,184
 mvav 132,188,200
 v_exp_f32 v186, v186
 mvav 136,192,192
 ds_read_b128 a[128:131], v3 offset:34560
 v_add_f32 v252, v252, v185
 mvav 136,196,200
 v_exp_f32 v187, v187
 mvav 140,200,192
 pk 185,186
 v_add_f32 v252, v252, v186
 mvav 140,204,200
 s_waitcnt lgkmcnt(3)
 v_exp_f32 v188, v188
 mvaac 192,80,0,208
 v_exp_f32 v189, v189
 mvaa 192,84,4
 pk 186,188
 v_add_f32 v252, v252, v187
 mvaa 192,88,8
 v_exp_f32 v190, v190
 mvaa 192,92,12
 v_exp_f32 v191, v191
 mvaac 196,108,12,208
 pk 187,190
 v_add_f32 v252, v252, v180
 mvaa 196,104,8
 v_add_f32 v252, v252, v181
 v_add_f32 v252, v252, v182
 mvaa 196,100,4
 v_add_f32 v252, v252, v183
 v_add_f32 v252, v252, v188
 mvaa 196,96,0
 v_add_f32 v252, v252, v189
 v_add_f32 v252, v252, v190
 mvaac 200,112,0,208
 v_exp_f32 v192, v192
 mvaa 200,116,4
 v_exp_f32 v193, v193
 mvaa 200,120,8
 pk 192,192
 v_add_f32 v252, v252, v191
 mvaa 200,124,12
 v_exp_f32 v194, v194
 mvaac 204,140,12,208
 s_waitcnt lgkmcnt(0)
 s_mov_b32 s86, 8192
 buffer_store_dwordx4 v[236:239], v2, s[60:63], s86 offen offset:2048 sc1
 v_exp_f32 v195, v195
 mvaa 204,136,8
 v_exp_f32 v196, v196
 mvaa 204,132,4
 v_exp_f32 v197, v197
 mvaa 204,128,0
 pk 193,194
 pk 194,196
 mvav 144,144,176
 v_exp_f32 v198, v198
 mvav 144,148,184
 v_exp_f32 v199, v199
 mvav 148,152,176
 rta 144,4,50688
 pk 195,198
 mvav 148,156,184
 v_exp_f32 v200, v200
 mvav 152,160,176
 v_exp_f32 v201, v201
 mvav 152,164,184
 rta 146,4,50944
 pk 200,200
 mvav 156,168,176
 v_exp_f32 v202, v202
 mvav 156,172,184
 rta 148,4,51200
 rta 150,4,51456
 mvav 160,176,176
 v_exp_f32 v203, v203
 mvav 160,180,184
 rta 152,4,50720
 pk 201,202
 mvav 164,184,176
 rta 154,4,50976
 rta 156,4,51232
 mvav 164,188,184
 v_exp_f32 v204, v204
 mvav 168,192,176
 rta 158,4,51488
 rta 160,4,50752
 mvav 168,196,184
 v_exp_f32 v205, v205
 mvav 172,200,176
 rta 162,4,51008
 pk 202,204
 mvav 172,204,184
 rta 164,4,51264
 rta 166,4,51520
 mvaac 176,80,16,212
 v_exp_f32 v206, v206
 mvaa 176,84,20
 rta 168,4,50784
 rta 170,4,51040
 mvaa 176,88,24
 s_mov_b32 s86, 8192
 buffer_store_dwordx4 a[220:223], v2, s[60:63], s86 offen offset:3072 sc1
 v_exp_f32 v207, v207
 mvaa 176,92,28
 rta 172,4,51296
 pk 203,206
 mvaac 180,108,28,212
 rta 174,4,51552
 rta 176,4,50816
 mvaa 180,104,24
 rta 178,4,51072
 rta 180,4,51328
 mvaa 180,100,20
 rta 182,4,51584
 rta 184,4,50848
 mvaa 180,96,16
 rta 186,4,51104
 rta 188,4,51360
 mvaac 184,112,16,212
 rta 190,4,51616
 rta 192,4,50880
 mvaa 184,116,20
 rta 194,4,51136
 rta 196,4,51392
 mvaa 184,120,24
 rta 198,4,51648
 rta 200,4,50912
 mvaa 184,124,28
 rta 202,4,51168
 rta 204,4,51424
 mvaac 188,140,28,212
 v_exp_f32 v176, v176
 mvaa 188,136,24
 v_exp_f32 v177, v177
 mvaa 188,132,20
 rta 206,4,51680
 pk 176,176
 mvaa 188,128,16
 s_waitcnt lgkmcnt(11)
 v_exp_f32 v178, v178
 mvav 16,144,192
 v_exp_f32 v179, v179
 mvav 16,148,200
 v_exp_f32 v180, v180
 mvav 20,152,192
 v_exp_f32 v181, v181
 mvav 20,156,200
 pk 177,178
 pk 178,180
 mvav 24,160,192
 v_exp_f32 v182, v182
 mvav 24,164,200
 v_exp_f32 v183, v183
 mvav 28,168,192
 v_exp_f32 v184, v184
 mvav 28,172,200
 pk 179,182
 v_add_f32 v255, v255, v184
 mvav 32,176,192
 s_mov_b32 s86, 12288
 buffer_store_dwordx4 a[224:227], v2, s[60:63], s86 offen offset:0 sc1
 v_exp_f32 v185, v185
 mvav 32,180,200
 s_waitcnt lgkmcnt(0)
 pk 184,184
 v_add_f32 v255, v255, v185
 mvav 36,184,192
 v_exp_f32 v186, v186
 mvav 36,188,200
 v_exp_f32 v187, v187
 mvav 40,192,192
 pk 185,186
 v_add_f32 v255, v255, v186
 mvav 40,196,200
 v_exp_f32 v188, v188
 mvav 44,200,192
 v_exp_f32 v189, v189
 mvav 44,204,200
 pk 186,188
 v_add_f32 v255, v255, v187
 maav 208,216,192
 v_exp_f32 v190, v190
 maav 208,216,200
 v_exp_f32 v191, v191
 mvaac 192,80,32,216
 s_waitcnt vmcnt(24)
 s_barrier
 pk 187,190
 mvaa 192,84,36
 v_add_f32 v255, v255, v188
 v_add_f32 v255, v255, v189
 mvaa 192,88,40
 s_add_u32 m0, s77, 33792
 v_add_f32 v255, v255, v190
 v_add_f32 v255, v255, v191
 mvaa 192,92,44
 buffer_load_dwordx4 v1, s[52:55], s76 offen offset:0 nt lds
 v_add_u32 v3, s78, v3
 mvaac 196,108,44,216
 s_add_u32 m0, s77, 33824
 v_add_u32 v4, s78, v4
 mvaa 196,104,40
 buffer_load_dwordx4 v1, s[52:55], s76 offen offset:1024 nt lds
 mvaa 196,100,36
 s_add_u32 m0, s77, 33856
 mvaa 196,96,32
 buffer_load_dwordx4 v1, s[52:55], s76 offen offset:2048 nt lds
 mvaac 200,112,32,216
 v_exp_f32 v192, v192
 mvaa 200,116,36
 v_exp_f32 v193, v193
 mvaa 200,120,40
 v_add_f32 v254, v254, v192
 pk 192,192
 mvaa 200,124,44
 v_exp_f32 v194, v194
 mvaac 204,140,44,216
 v_exp_f32 v195, v195
 mvaa 204,136,40
 v_add_f32 v254, v254, v193
 pk 193,194
 mvaa 204,132,36
 v_exp_f32 v196, v196
 mvaa 204,128,32
 v_exp_f32 v197, v197
 mvav 48,144,176
 v_add_f32 v254, v254, v194
 pk 194,196
 mvav 48,148,184
 v_exp_f32 v198, v198
 mvav 52,152,176
 v_exp_f32 v199, v199
 mvav 52,156,184
 v_add_f32 v254, v254, v195
 pk 195,198
 mvav 56,160,176
 v_exp_f32 v200, v200
 mvav 56,164,184
 v_exp_f32 v201, v201
 mvav 60,168,176
 v_add_f32 v254, v254, v200
 pk 200,200
 mvav 60,172,184
 v_exp_f32 v202, v202
 mvav 64,176,176
 v_exp_f32 v203, v203
 mvav 64,180,184
 v_add_f32 v254, v254, v201
 pk 201,202
 mvav 68,184,176
 v_exp_f32 v204, v204
 mvav 68,188,184
 v_exp_f32 v205, v205
 mvav 72,192,176
 v_add_f32 v254, v254, v202
 pk 202,204
 mvav 72,196,184
 v_exp_f32 v206, v206
 mvav 76,200,176
 v_exp_f32 v207, v207
 mvav 76,204,184
 s_add_u32 m0, s77, 33888
 v_add_f32 v254, v254, v203
 pk 203,206
 maav 212,216,176
 buffer_load_dwordx4 v1, s[52:55], s76 offen offset:3072 nt lds
 v_add_f32 v254, v254, v196
 mvaac 176,80,48,220
 s_add_u32 m0, s77, 50688
 v_add_f32 v254, v254, v197
 v_add_f32 v254, v254, v198
 mvaa 176,84,52
 buffer_load_dwordx4 v1, s[56:59], s76 offen offset:0 nt lds
 v_add_f32 v254, v254, v199
 mvaa 176,88,56
 s_add_u32 m0, s77, 50720
 v_add_f32 v254, v254, v204
 v_add_f32 v254, v254, v205
 mvaa 176,92,60
 buffer_load_dwordx4 v1, s[56:59], s76 offen offset:1024 nt lds
 v_add_f32 v254, v254, v206
 mvaac 180,108,60,220
 s_add_u32 m0, s77, 50752
 v_add_f32 v254, v254, v207
 mvaa 180,104,56
 buffer_load_dwordx4 v1, s[56:59], s76 offen offset:2048 nt lds
 mvaa 180,100,52
 s_add_u32 m0, s77, 50784
 mvaa 180,96,48
 buffer_load_dwordx4 v1, s[56:59], s76 offen offset:3072 nt lds
 mvaac 184,112,48,220
 v_exp_f32 v176, v176
 mvaa 184,116,52
 v_exp_f32 v177, v177
 mvaa 184,120,56
 v_add_f32 v253, v253, v176
 pk 176,176
 mvaa 184,124,60
 v_exp_f32 v178, v178
 mvaac 188,140,60,220
 v_exp_f32 v179, v179
 mvaa 188,136,56
 v_add_f32 v253, v253, v177
 pk 177,178
 mvaa 188,132,52
 v_exp_f32 v180, v180
 mvaa 188,128,48
 v_exp_f32 v181, v181
 mvav 80,144,192
 v_add_f32 v253, v253, v178
 pk 178,180
 mvav 80,148,200
 v_exp_f32 v182, v182
 mvav 84,152,192
 v_exp_f32 v183, v183
 mvav 84,156,200
 v_add_f32 v253, v253, v179
 pk 179,182
 mvav 88,160,192
 v_exp_f32 v184, v184
 mvav 88,164,200
 v_exp_f32 v185, v185
 mvav 92,168,192
 v_add_f32 v253, v253, v184
 pk 184,184
 mvav 92,172,200
 v_exp_f32 v186, v186
 mvav 96,176,192
 v_exp_f32 v187, v187
 mvav 96,180,200
 v_add_f32 v253, v253, v185
 pk 185,186
 mvav 100,184,192
 v_exp_f32 v188, v188
 mvav 100,188,200
 v_exp_f32 v189, v189
 mvav 104,192,192
 v_add_f32 v253, v253, v186
 pk 186,188
 mvav 104,196,200
 v_exp_f32 v190, v190
 mvav 108,200,192
 v_exp_f32 v191, v191
 mvav 108,204,200
 v_add_f32 v253, v253, v187
 pk 187,190
 mvaac 192,80,64,224
 s_add_u32 s5, s5, s81
 v_add_f32 v253, v253, v180
 v_add_f32 v253, v253, v181
 mvaa 192,84,68
 s_add_u32 s77, s77, s78
 ds_read_b128 a[80:83], v3 offset:0
 v_add_f32 v253, v253, v182
 mvaa 192,88,72
 s_sub_u32 s78, 0, s78
 ds_read_b128 a[84:87], v3 offset:64
 v_add_f32 v253, v253, v183
 mvaa 192,92,76
 ds_read_b128 a[88:91], v3 offset:128
 v_add_f32 v253, v253, v188
 mvaac 196,108,76,224
 ds_read_b128 a[92:95], v3 offset:192
 v_add_f32 v253, v253, v189
 mvaa 196,104,72
 s_xor_b32 s76, s5, s39
 ds_read_b128 a[108:111], v3 offset:448
 v_add_f32 v253, v253, v190
 mvaa 196,100,68
 ds_read_b128 a[104:107], v3 offset:384
 v_add_f32 v253, v253, v191
 mvaa 196,96,64
 ds_read_b128 a[100:103], v3 offset:320
 mvaac 200,112,64,224
 v_exp_f32 v192, v192
 mvaa 200,116,68
 v_exp_f32 v193, v193
 mvaa 200,120,72
 v_add_f32 v252, v252, v192
 pk 192,192
 mvaa 200,124,76
 v_exp_f32 v194, v194
 mvaac 204,140,76,224
 v_exp_f32 v195, v195
 mvaa 204,136,72
 v_add_f32 v252, v252, v193
 pk 193,194
 mvaa 204,132,68
 v_exp_f32 v196, v196
 mvaa 204,128,64
 v_exp_f32 v197, v197
 mvav 112,144,176
 ds_read_b128 a[96:99], v3 offset:256
 v_add_f32 v252, v252, v194
 mvav 112,148,184
 ds_read_b128 a[112:115], v3 offset:512
 pk 194,196
 mvav 116,152,176
 v_exp_f32 v198, v198
 mvav 116,156,184
 ds_read_b128 a[116:119], v3 offset:576
 ds_read_b128 a[120:123], v3 offset:640
 mvav 120,160,176
 v_exp_f32 v199, v199
 mvav 120,164,184
 ds_read_b128 a[124:127], v3 offset:704
 v_add_f32 v252, v252, v195
 mvav 124,168,176
 ds_read_b128 a[140:143], v3 offset:960
 pk 195,198
 mvav 124,172,184
 v_exp_f32 v200, v200
 mvav 128,176,176
 v_exp_f32 v201, v201
 mvav 128,180,184
 ds_read_b128 a[136:139], v3 offset:896
 ds_read_b128 a[132:135], v3 offset:832
 mvav 132,184,176
 v_add_f32 v252, v252, v200
 pk 200,200
 mvav 132,188,184
 v_exp_f32 v202, v202
 mvav 136,192,176
 ds_read_b128 a[128:131], v3 offset:768
 v_add_f32 v252, v252, v201
 mvav 136,196,184
 v_exp_f32 v203, v203
 mvav 140,200,176
 pk 201,202
 v_add_f32 v252, v252, v202
 mvav 140,204,184
L15_hk2:
 v_lshlrev_b32 v14, 5, v0
 s_mov_b32 s3, 0
 s_mov_b32 exec_hi, 0
 buffer_load_dword v13, v14, s[60:63], s3 offen sc1
 s_mov_b32 exec_hi, -1
 s_nop 2
 s_mov_b64 s[52:53], s[68:69]
 s_mov_b32 s54, s70
 s_add_u32 s56, s68, 65536
 s_addc_u32 s57, s69, 0
 s_sub_u32 s58, s70, 65536
 v_mov_b32 v1, v11
 s_xor_b32 s76, s9, 0
 s_mul_i32 s76, s76, 131072
 s_xor_b32 s81, s9, 1
 s_mul_i32 s81, s81, 131072
 s_sub_u32 s81, s81, s76
 s_mov_b32 s5, s76
 s_mov_b32 s39, 0
 s_waitcnt lgkmcnt(3)
 mvaac 176,80,0,208
 v_exp_f32 v204, v204
 mvaa 176,84,4
 v_exp_f32 v205, v205
 mvaa 176,88,8
 pk 202,204
 v_add_f32 v252, v252, v203
 mvaa 176,92,12
 v_exp_f32 v206, v206
 mvaac 180,108,12,208
 v_exp_f32 v207, v207
 mvaa 180,104,8
 pk 203,206
 v_add_f32 v252, v252, v196
 mvaa 180,100,4
 v_add_f32 v252, v252, v197
 v_add_f32 v252, v252, v198
 mvaa 180,96,0
 v_add_f32 v252, v252, v199
 v_add_f32 v252, v252, v204
 mvaac 184,112,0,208
 v_exp_f32 v176, v176
 mvaa 184,116,4
 v_exp_f32 v177, v177
 mvaa 184,120,8
 pk 176,176
 v_add_f32 v252, v252, v205
 mvaa 184,124,12
 v_exp_f32 v178, v178
 mvaac 188,140,12,208
 s_waitcnt lgkmcnt(0)
 v_exp_f32 v179, v179
 mvaa 188,136,8
 s_mov_b32 s86, 12288
 buffer_store_dwordx4 a[228:231], v2, s[60:63], s86 offen offset:1024 sc1
 pk 177,178
 v_add_f32 v252, v252, v206
 mvaa 188,132,4
 v_exp_f32 v180, v180
 mvaa 188,128,0
 v_exp_f32 v181, v181
 mvav 144,144,192
 pk 178,180
 v_add_f32 v252, v252, v207
 mvav 144,148,200
 v_exp_f32 v182, v182
 mvav 148,152,192
 v_exp_f32 v183, v183
 mvav 148,156,200
 rta 144,4,16896
 pk 179,182
 mvav 152,160,192
 v_exp_f32 v184, v184
 mvav 152,164,200
 v_exp_f32 v185, v185
 mvav 156,168,192
 rta 146,4,17152
 pk 184,184
 mvav 156,172,200
 v_exp_f32 v186, v186
 mvav 160,176,192
 rta 148,4,17408
 rta 150,4,17664
 mvav 160,180,200
 v_exp_f32 v187, v187
 mvav 164,184,192
 rta 152,4,16928
 pk 185,186
 mvav 164,188,200
 rta 154,4,17184
 rta 156,4,17440
 mvav 168,192,192
 v_exp_f32 v188, v188
 mvav 168,196,200
 rta 158,4,17696
 rta 160,4,16960
 mvav 172,200,192
 v_exp_f32 v189, v189
 mvav 172,204,200
 rta 162,4,17216
 pk 186,188
 mvaac 192,80,16,212
 rta 164,4,17472
 rta 166,4,17728
 mvaa 192,84,20
 v_exp_f32 v190, v190
 mvaa 192,88,24
 rta 168,4,16992
 rta 170,4,17248
 mvaa 192,92,28
 s_mov_b32 s86, 12288
 buffer_store_dwordx4 a[232:235], v2, s[60:63], s86 offen offset:2048 sc1
 v_exp_f32 v191, v191
 mvaac 196,108,28,212
 rta 172,4,17504
 pk 187,190
 mvaa 196,104,24
 rta 174,4,17760
 rta 176,4,17024
 mvaa 196,100,20
 rta 178,4,17280
 rta 180,4,17536
 mvaa 196,96,16
 rta 182,4,17792
 rta 184,4,17056
 mvaac 200,112,16,212
 rta 186,4,17312
 rta 188,4,17568
 mvaa 200,116,20
 rta 190,4,17824
 rta 192,4,17088
 mvaa 200,120,24
 rta 194,4,17344
 rta 196,4,17600
 mvaa 200,124,28
 rta 198,4,17856
 rta 200,4,17120
 mvaac 204,140,28,212
 rta 202,4,17376
 rta 204,4,17632
 mvaa 204,136,24
 v_exp_f32 v192, v192
 mvaa 204,132,20
 v_exp_f32 v193, v193
 mvaa 204,128,16
 s_waitcnt lgkmcnt(12)
 rta 206,4,17888
 pk 192,192
 mvav 16,144,176
 v_exp_f32 v194, v194
 mvav 16,148,184
 v_exp_f32 v195, v195
 mvav 20,152,176
 v_exp_f32 v196, v196
 mvav 20,156,184
 v_exp_f32 v197, v197
 mvav 24,160,176
 pk 193,194
 pk 194,196
 mvav 24,164,184
 v_exp_f32 v198, v198
 mvav 28,168,176
 v_exp_f32 v199, v199
 mvav 28,172,184
 v_exp_f32 v200, v200
 mvav 32,176,176
 s_waitcnt lgkmcnt(0)
 pk 195,198
 v_add_f32 v255, v255, v200
 mvav 32,180,184
 s_mov_b32 s86, 12288
 buffer_store_dwordx4 a[236:239], v2, s[60:63], s86 offen offset:3072 sc1
 v_exp_f32 v201, v201
 mvav 36,184,176
 pk 200,200
 v_add_f32 v255, v255, v201
 mvav 36,188,184
 v_exp_f32 v202, v202
 mvav 40,192,176
 v_exp_f32 v203, v203
 mvav 40,196,184
 pk 201,202
 v_add_f32 v255, v255, v202
 mvav 44,200,176
 v_exp_f32 v204, v204
 mvav 44,204,184
 v_exp_f32 v205, v205
 maav 208,216,176
 pk 202,204
 v_add_f32 v255, v255, v203
 maav 208,216,184
 v_exp_f32 v206, v206
 mvaac 176,80,32,216
 s_waitcnt vmcnt(28)
 s_barrier
 v_add_f32 v255, v255, v204
 mvaa 176,84,36
 v_exp_f32 v207, v207
 mvaa 176,88,40
 pk 203,206
 v_add_f32 v255, v255, v205
 mvaa 176,92,44
 s_add_u32 m0, s77, 0
 v_add_f32 v255, v255, v206
 v_add_f32 v255, v255, v207
 mvaac 180,108,44,216
 buffer_load_dwordx4 v1, s[52:55], s76 offen offset:0 lds
 mvaa 180,104,40
 s_add_u32 m0, s77, 32
 mvaa 180,100,36
 buffer_load_dwordx4 v1, s[52:55], s76 offen offset:1024 lds
 mvaa 180,96,32
 mvaac 184,112,32,216
 v_exp_f32 v176, v176
 mvaa 184,116,36
 v_exp_f32 v177, v177
 mvaa 184,120,40
 v_add_f32 v254, v254, v176
 pk 176,176
 mvaa 184,124,44
 v_exp_f32 v178, v178
 mvaac 188,140,44,216
 v_exp_f32 v179, v179
 mvaa 188,136,40
 v_add_f32 v254, v254, v177
 pk 177,178
 mvaa 188,132,36
 v_exp_f32 v180, v180
 mvaa 188,128,32
 v_exp_f32 v181, v181
 mvav 48,144,192
 v_add_f32 v254, v254, v178
 pk 178,180
 mvav 48,148,200
 v_exp_f32 v182, v182
 mvav 52,152,192
 v_exp_f32 v183, v183
 mvav 52,156,200
 v_add_f32 v254, v254, v179
 pk 179,182
 mvav 56,160,192
 v_exp_f32 v184, v184
 mvav 56,164,200
 v_exp_f32 v185, v185
 mvav 60,168,192
 v_add_f32 v254, v254, v184
 pk 184,184
 mvav 60,172,200
 v_exp_f32 v186, v186
 mvav 64,176,192
 v_exp_f32 v187, v187
 mvav 64,180,200
 v_add_f32 v254, v254, v185
 pk 185,186
 mvav 68,184,192
 v_exp_f32 v188, v188
 mvav 68,188,200
 v_exp_f32 v189, v189
 mvav 72,192,192
 v_add_f32 v254, v254, v186
 pk 186,188
 mvav 72,196,200
 v_exp_f32 v190, v190
 mvav 76,200,192
 v_exp_f32 v191, v191
 mvav 76,204,200
 s_add_u32 m0, s77, 64
 v_add_f32 v254, v254, v187
 pk 187,190
 maav 212,216,192
 buffer_load_dwordx4 v1, s[52:55], s76 offen offset:2048 lds
 v_add_f32 v254, v254, v180
 mvaac 192,80,48,220
 s_add_u32 m0, s77, 96
 v_add_f32 v254, v254, v181
 v_add_f32 v254, v254, v182
 mvaa 192,84,52
 buffer_load_dwordx4 v1, s[52:55], s76 offen offset:3072 lds
 v_add_f32 v254, v254, v183
 mvaa 192,88,56
 s_add_u32 m0, s77, 16896
 v_add_f32 v254, v254, v188
 v_add_f32 v254, v254, v189
 mvaa 192,92,60
 buffer_load_dwordx4 v1, s[56:59], s76 offen offset:0 lds
 v_add_f32 v254, v254, v190
 mvaac 196,108,60,220
 s_add_u32 m0, s77, 16928
 v_add_f32 v254, v254, v191
 mvaa 196,104,56
 buffer_load_dwordx4 v1, s[56:59], s76 offen offset:1024 lds
 mvaa 196,100,52
 s_add_u32 m0, s77, 16960
 mvaa 196,96,48
 buffer_load_dwordx4 v1, s[56:59], s76 offen offset:2048 lds
 mvaac 200,112,48,220
 v_exp_f32 v192, v192
 mvaa 200,116,52
 v_exp_f32 v193, v193
 mvaa 200,120,56
 v_add_f32 v253, v253, v192
 pk 192,192
 mvaa 200,124,60
 v_exp_f32 v194, v194
 mvaac 204,140,60,220
 s_add_u32 m0, s77, 16992
 v_exp_f32 v195, v195
 mvaa 204,136,56
 buffer_load_dwordx4 v1, s[56:59], s76 offen offset:3072 lds
 v_add_f32 v253, v253, v193
 mvaa 204,132,52
 pk 193,194
 v_add_f32 v253, v253, v194
 mvaa 204,128,48
 v_exp_f32 v196, v196
 mvav 80,144,176
 v_exp_f32 v197, v197
 mvav 80,148,184
 pk 194,196
 v_add_f32 v253, v253, v195
 mvav 84,152,176
 v_exp_f32 v198, v198
 mvav 84,156,184
 v_exp_f32 v199, v199
 mvav 88,160,176
 pk 195,198
 v_add_f32 v253, v253, v196
 mvav 88,164,184
 v_exp_f32 v200, v200
 mvav 92,168,176
 v_exp_f32 v201, v201
 mvav 92,172,184
 v_add_f32 v253, v253, v200
 pk 200,200
 mvav 96,176,176
 v_exp_f32 v202, v202
 mvav 96,180,184
 v_exp_f32 v203, v203
 mvav 100,184,176
 v_add_f32 v253, v253, v201
 pk 201,202
 mvav 100,188,184
 v_exp_f32 v204, v204
 mvav 104,192,176
 v_exp_f32 v205, v205
 mvav 104,196,184
 v_add_f32 v253, v253, v202
 pk 202,204
 mvav 108,200,176
 v_exp_f32 v206, v206
 mvav 108,204,184
 v_exp_f32 v207, v207
 mvaac 176,80,64,224
 s_add_u32 s5, s5, s81
 v_add_f32 v253, v253, v203
 pk 203,206
 mvaa 176,84,68
 ds_read_b128 a[80:83], v3 offset:33792
 v_add_f32 v253, v253, v197
 mvaa 176,88,72
 ds_read_b128 a[84:87], v3 offset:33856
 v_add_f32 v253, v253, v198
 mvaa 176,92,76
 ds_read_b128 a[88:91], v3 offset:33920
 v_add_f32 v253, v253, v199
 mvaac 180,108,76,224
 ds_read_b128 a[92:95], v3 offset:33984
 v_add_f32 v253, v253, v204
 mvaa 180,104,72
 s_xor_b32 s76, s5, s39
 ds_read_b128 a[108:111], v3 offset:34240
 v_add_f32 v253, v253, v205
 mvaa 180,100,68
 ds_read_b128 a[104:107], v3 offset:34176
 v_add_f32 v253, v253, v206
 mvaa 180,96,64
 ds_read_b128 a[100:103], v3 offset:34112
 v_add_f32 v253, v253, v207
 mvaac 184,112,64,224
 v_exp_f32 v176, v176
 mvaa 184,116,68
 v_exp_f32 v177, v177
 mvaa 184,120,72
 v_add_f32 v252, v252, v176
 pk 176,176
 mvaa 184,124,76
 v_exp_f32 v178, v178
 mvaac 188,140,76,224
 v_exp_f32 v179, v179
 mvaa 188,136,72
 v_add_f32 v252, v252, v177
 pk 177,178
 mvaa 188,132,68
 v_exp_f32 v180, v180
 mvaa 188,128,64
 v_exp_f32 v181, v181
 mvav 112,144,192
 ds_read_b128 a[96:99], v3 offset:34048
 v_add_f32 v252, v252, v178
 mvav 112,148,200
 ds_read_b128 a[112:115], v3 offset:34304
 pk 178,180
 mvav 116,152,192
 v_exp_f32 v182, v182
 mvav 116,156,200
 ds_read_b128 a[116:119], v3 offset:34368
 ds_read_b128 a[120:123], v3 offset:34432
 mvav 120,160,192
 v_exp_f32 v183, v183
 mvav 120,164,200
 ds_read_b128 a[124:127], v3 offset:34496
 v_add_f32 v252, v252, v179
 mvav 124,168,192
 ds_read_b128 a[140:143], v3 offset:34752
 pk 179,182
 mvav 124,172,200
 v_exp_f32 v184, v184
 mvav 128,176,192
 v_exp_f32 v185, v185
 mvav 128,180,200
 ds_read_b128 a[136:139], v3 offset:34688
 ds_read_b128 a[132:135], v3 offset:34624
 mvav 132,184,192
 v_add_f32 v252, v252, v184
 pk 184,184
 mvav 132,188,200
 v_exp_f32 v186, v186
 mvav 136,192,192
 ds_read_b128 a[128:131], v3 offset:34560
 v_add_f32 v252, v252, v185
 mvav 136,196,200
 v_exp_f32 v187, v187
 mvav 140,200,192
 pk 185,186
 v_add_f32 v252, v252, v186
 mvav 140,204,200
 s_waitcnt lgkmcnt(3)
 v_exp_f32 v188, v188
 mvaac 192,80,0,208
 v_exp_f32 v189, v189
 mvaa 192,84,4
 pk 186,188
 v_add_f32 v252, v252, v187
 mvaa 192,88,8
 v_exp_f32 v190, v190
 mvaa 192,92,12
 v_exp_f32 v191, v191
 mvaac 196,108,12,208
 pk 187,190
 v_add_f32 v252, v252, v180
 mvaa 196,104,8
 v_add_f32 v252, v252, v181
 v_add_f32 v252, v252, v182
 mvaa 196,100,4
 v_add_f32 v252, v252, v183
 v_add_f32 v252, v252, v188
 mvaa 196,96,0
 v_add_f32 v252, v252, v189
 v_add_f32 v252, v252, v190
 mvaac 200,112,0,208
 v_exp_f32 v192, v192
 mvaa 200,116,4
 v_exp_f32 v193, v193
 mvaa 200,120,8
 pk 192,192
 v_add_f32 v252, v252, v191
 mvaa 200,124,12
 v_exp_f32 v194, v194
 mvaac 204,140,12,208
 s_waitcnt lgkmcnt(0)
 s_mov_b32 s86, 16384
 buffer_store_dwordx4 a[240:243], v2, s[60:63], s86 offen offset:0 sc1
 v_exp_f32 v195, v195
 mvaa 204,136,8
 v_exp_f32 v196, v196
 mvaa 204,132,4
 v_exp_f32 v197, v197
 mvaa 204,128,0
 pk 193,194
 pk 194,196
 mvav 144,144,176
 v_exp_f32 v198, v198
 mvav 144,148,184
 v_exp_f32 v199, v199
 mvav 148,152,176
 rta 144,4,50688
 pk 195,198
 mvav 148,156,184
 v_exp_f32 v200, v200
 mvav 152,160,176
 v_exp_f32 v201, v201
 mvav 152,164,184
 rta 146,4,50944
 pk 200,200
 mvav 156,168,176
 v_exp_f32 v202, v202
 mvav 156,172,184
 rta 148,4,51200
 rta 150,4,51456
 mvav 160,176,176
 v_exp_f32 v203, v203
 mvav 160,180,184
 rta 152,4,50720
 pk 201,202
 mvav 164,184,176
 rta 154,4,50976
 rta 156,4,51232
 mvav 164,188,184
 v_exp_f32 v204, v204
 mvav 168,192,176
 rta 158,4,51488
 rta 160,4,50752
 mvav 168,196,184
 v_exp_f32 v205, v205
 mvav 172,200,176
 rta 162,4,51008
 pk 202,204
 mvav 172,204,184
 rta 164,4,51264
 rta 166,4,51520
 mvaac 176,80,16,212
 v_exp_f32 v206, v206
 mvaa 176,84,20
 rta 168,4,50784
 rta 170,4,51040
 mvaa 176,88,24
 s_mov_b32 s86, 16384
 buffer_store_dwordx4 a[244:247], v2, s[60:63], s86 offen offset:1024 sc1
 v_exp_f32 v207, v207
 mvaa 176,92,28
 rta 172,4,51296
 pk 203,206
 mvaac 180,108,28,212
 rta 174,4,51552
 rta 176,4,50816
 mvaa 180,104,24
 rta 178,4,51072
 rta 180,4,51328
 mvaa 180,100,20
 rta 182,4,51584
 rta 184,4,50848
 mvaa 180,96,16
 rta 186,4,51104
 rta 188,4,51360
 mvaac 184,112,16,212
 rta 190,4,51616
 rta 192,4,50880
 mvaa 184,116,20
 rta 194,4,51136
 rta 196,4,51392
 mvaa 184,120,24
 rta 198,4,51648
 rta 200,4,50912
 mvaa 184,124,28
 rta 202,4,51168
 rta 204,4,51424
 mvaac 188,140,28,212
 v_exp_f32 v176, v176
 mvaa 188,136,24
 v_exp_f32 v177, v177
 mvaa 188,132,20
 rta 206,4,51680
 pk 176,176
 mvaa 188,128,16
 s_waitcnt lgkmcnt(11)
 v_exp_f32 v178, v178
 mvav 16,144,192
 v_exp_f32 v179, v179
 mvav 16,148,200
 v_exp_f32 v180, v180
 mvav 20,152,192
 v_exp_f32 v181, v181
 mvav 20,156,200
 pk 177,178
 pk 178,180
 mvav 24,160,192
 v_exp_f32 v182, v182
 mvav 24,164,200
 v_exp_f32 v183, v183
 mvav 28,168,192
 v_exp_f32 v184, v184
 mvav 28,172,200
 pk 179,182
 v_add_f32 v255, v255, v184
 mvav 32,176,192
 s_mov_b32 s86, 16384
 buffer_store_dwordx4 a[248:251], v2, s[60:63], s86 offen offset:2048 sc1
 v_exp_f32 v185, v185
 mvav 32,180,200
 s_waitcnt lgkmcnt(0)
 pk 184,184
 v_add_f32 v255, v255, v185
 mvav 36,184,192
 v_exp_f32 v186, v186
 mvav 36,188,200
 v_exp_f32 v187, v187
 mvav 40,192,192
 pk 185,186
 v_add_f32 v255, v255, v186
 mvav 40,196,200
 v_exp_f32 v188, v188
 mvav 44,200,192
 v_exp_f32 v189, v189
 mvav 44,204,200
 pk 186,188
 v_add_f32 v255, v255, v187
 maav 208,216,192
 v_exp_f32 v190, v190
 maav 208,216,200
 v_exp_f32 v191, v191
 mvaac 192,80,32,216
 s_waitcnt vmcnt(27)
 s_barrier
 pk 187,190
 mvaa 192,84,36
 v_add_f32 v255, v255, v188
 v_add_f32 v255, v255, v189
 mvaa 192,88,40
 s_add_u32 m0, s77, 33792
 v_add_f32 v255, v255, v190
 v_add_f32 v255, v255, v191
 mvaa 192,92,44
 buffer_load_dwordx4 v1, s[52:55], s76 offen offset:0 lds
 v_add_u32 v3, s78, v3
 mvaac 196,108,44,216
 s_add_u32 m0, s77, 33824
 v_add_u32 v4, s78, v4
 mvaa 196,104,40
 buffer_load_dwordx4 v1, s[52:55], s76 offen offset:1024 lds
 mvaa 196,100,36
 s_add_u32 m0, s77, 33856
 mvaa 196,96,32
 buffer_load_dwordx4 v1, s[52:55], s76 offen offset:2048 lds
 mvaac 200,112,32,216
 v_exp_f32 v192, v192
 mvaa 200,116,36
 v_exp_f32 v193, v193
 mvaa 200,120,40
 v_add_f32 v254, v254, v192
 pk 192,192
 mvaa 200,124,44
 v_exp_f32 v194, v194
 mvaac 204,140,44,216
 v_exp_f32 v195, v195
 mvaa 204,136,40
 v_add_f32 v254, v254, v193
 pk 193,194
 mvaa 204,132,36
 v_exp_f32 v196, v196
 mvaa 204,128,32
 v_exp_f32 v197, v197
 mvav 48,144,176
 v_add_f32 v254, v254, v194
 pk 194,196
 mvav 48,148,184
 v_exp_f32 v198, v198
 mvav 52,152,176
 v_exp_f32 v199, v199
 mvav 52,156,184
 v_add_f32 v254, v254, v195
 pk 195,198
 mvav 56,160,176
 v_exp_f32 v200, v200
 mvav 56,164,184
 v_exp_f32 v201, v201
 mvav 60,168,176
 v_add_f32 v254, v254, v200
 pk 200,200
 mvav 60,172,184
 v_exp_f32 v202, v202
 mvav 64,176,176
 v_exp_f32 v203, v203
 mvav 64,180,184
 v_add_f32 v254, v254, v201
 pk 201,202
 mvav 68,184,176
 v_exp_f32 v204, v204
 mvav 68,188,184
 v_exp_f32 v205, v205
 mvav 72,192,176
 v_add_f32 v254, v254, v202
 pk 202,204
 mvav 72,196,184
 v_exp_f32 v206, v206
 mvav 76,200,176
 v_exp_f32 v207, v207
 mvav 76,204,184
 s_add_u32 m0, s77, 33888
 v_add_f32 v254, v254, v203
 pk 203,206
 maav 212,216,176
 buffer_load_dwordx4 v1, s[52:55], s76 offen offset:3072 lds
 v_add_f32 v254, v254, v196
 mvaac 176,80,48,220
 s_add_u32 m0, s77, 50688
 v_add_f32 v254, v254, v197
 v_add_f32 v254, v254, v198
 mvaa 176,84,52
 buffer_load_dwordx4 v1, s[56:59], s76 offen offset:0 lds
 v_add_f32 v254, v254, v199
 mvaa 176,88,56
 s_add_u32 m0, s77, 50720
 v_add_f32 v254, v254, v204
 v_add_f32 v254, v254, v205
 mvaa 176,92,60
 buffer_load_dwordx4 v1, s[56:59], s76 offen offset:1024 lds
 v_add_f32 v254, v254, v206
 mvaac 180,108,60,220
 s_add_u32 m0, s77, 50752
 v_add_f32 v254, v254, v207
 mvaa 180,104,56
 buffer_load_dwordx4 v1, s[56:59], s76 offen offset:2048 lds
 mvaa 180,100,52
 s_add_u32 m0, s77, 50784
 mvaa 180,96,48
 buffer_load_dwordx4 v1, s[56:59], s76 offen offset:3072 lds
 mvaac 184,112,48,220
 v_exp_f32 v176, v176
 mvaa 184,116,52
 v_exp_f32 v177, v177
 mvaa 184,120,56
 v_add_f32 v253, v253, v176
 pk 176,176
 mvaa 184,124,60
 v_exp_f32 v178, v178
 mvaac 188,140,60,220
 v_exp_f32 v179, v179
 mvaa 188,136,56
 v_add_f32 v253, v253, v177
 pk 177,178
 mvaa 188,132,52
 v_exp_f32 v180, v180
 mvaa 188,128,48
 v_exp_f32 v181, v181
 mvav 80,144,192
 v_add_f32 v253, v253, v178
 pk 178,180
 mvav 80,148,200
 v_exp_f32 v182, v182
 mvav 84,152,192
 v_exp_f32 v183, v183
 mvav 84,156,200
 v_add_f32 v253, v253, v179
 pk 179,182
 mvav 88,160,192
 v_exp_f32 v184, v184
 mvav 88,164,200
 v_exp_f32 v185, v185
 mvav 92,168,192
 v_add_f32 v253, v253, v184
 pk 184,184
 mvav 92,172,200
 v_exp_f32 v186, v186
 mvav 96,176,192
 v_exp_f32 v187, v187
 mvav 96,180,200
 v_add_f32 v253, v253, v185
 pk 185,186
 mvav 100,184,192
 v_exp_f32 v188, v188
 mvav 100,188,200
 v_exp_f32 v189, v189
 mvav 104,192,192
 v_add_f32 v253, v253, v186
 pk 186,188
 mvav 104,196,200
 v_exp_f32 v190, v190
 mvav 108,200,192
 v_exp_f32 v191, v191
 mvav 108,204,200
 v_add_f32 v253, v253, v187
 pk 187,190
 mvaac 192,80,64,224
 s_add_u32 s5, s5, s81
 v_add_f32 v253, v253, v180
 v_add_f32 v253, v253, v181
 mvaa 192,84,68
 s_add_u32 s77, s77, s78
 ds_read_b128 a[80:83], v3 offset:0
 v_add_f32 v253, v253, v182
 mvaa 192,88,72
 s_sub_u32 s78, 0, s78
 ds_read_b128 a[84:87], v3 offset:64
 v_add_f32 v253, v253, v183
 mvaa 192,92,76
 ds_read_b128 a[88:91], v3 offset:128
 v_add_f32 v253, v253, v188
 mvaac 196,108,76,224
 ds_read_b128 a[92:95], v3 offset:192
 v_add_f32 v253, v253, v189
 mvaa 196,104,72
 s_xor_b32 s76, s5, s39
 ds_read_b128 a[108:111], v3 offset:448
 v_add_f32 v253, v253, v190
 mvaa 196,100,68
 ds_read_b128 a[104:107], v3 offset:384
 v_add_f32 v253, v253, v191
 mvaa 196,96,64
 ds_read_b128 a[100:103], v3 offset:320
 mvaac 200,112,64,224
 v_exp_f32 v192, v192
 mvaa 200,116,68
 v_exp_f32 v193, v193
 mvaa 200,120,72
 v_add_f32 v252, v252, v192
 pk 192,192
 mvaa 200,124,76
 v_exp_f32 v194, v194
 mvaac 204,140,76,224
 v_exp_f32 v195, v195
 mvaa 204,136,72
 v_add_f32 v252, v252, v193
 pk 193,194
 mvaa 204,132,68
 v_exp_f32 v196, v196
 mvaa 204,128,64
 v_exp_f32 v197, v197
 mvav 112,144,176
 ds_read_b128 a[96:99], v3 offset:256
 v_add_f32 v252, v252, v194
 mvav 112,148,184
 ds_read_b128 a[112:115], v3 offset:512
 pk 194,196
 mvav 116,152,176
 v_exp_f32 v198, v198
 mvav 116,156,184
 ds_read_b128 a[116:119], v3 offset:576
 ds_read_b128 a[120:123], v3 offset:640
 mvav 120,160,176
 v_exp_f32 v199, v199
 mvav 120,164,184
 ds_read_b128 a[124:127], v3 offset:704
 v_add_f32 v252, v252, v195
 mvav 124,168,176
 ds_read_b128 a[140:143], v3 offset:960
 pk 195,198
 mvav 124,172,184
 v_exp_f32 v200, v200
 mvav 128,176,176
 v_exp_f32 v201, v201
 mvav 128,180,184
 ds_read_b128 a[136:139], v3 offset:896
 ds_read_b128 a[132:135], v3 offset:832
 mvav 132,184,176
 v_add_f32 v252, v252, v200
 pk 200,200
 mvav 132,188,184
 v_exp_f32 v202, v202
 mvav 136,192,176
 ds_read_b128 a[128:131], v3 offset:768
 v_add_f32 v252, v252, v201
 mvav 136,196,184
 v_exp_f32 v203, v203
 mvav 140,200,176
 pk 201,202
 v_add_f32 v252, v252, v202
 mvav 140,204,184
L15_hk1:
 v_mov_b32 v14, 163776
 ds_read_b64 v[6:7], v14
 v_lshlrev_b32 v14, 5, v0
 s_mov_b32 s3, 4096
 s_mov_b32 exec_hi, 0
 buffer_load_dword v13, v14, s[60:63], s3 offen sc1
 s_mov_b32 exec_hi, -1
 s_nop 2
 v_lshlrev_b32 v14, 5, v0
 s_and_b32 s3, s85, 12
 s_lshr_b32 s3, 0x7536, s3
 s_and_b32 s3, s3, 7
 s_xor_b32 s3, s3, s9
 s_lshl_b32 s3, s3, 17
 s_lshl_b32 s4, s42, 15
 s_add_u32 s3, s3, s4
 v_and_b32 v15, 128, v14
 v_lshrrev_b32 v14, 3, v0
 v_lshl_add_u32 v14, v14, 10, v15
 s_mov_b32 exec_hi, 0
 buffer_load_dword v13, v14, s[68:71], s3 offen
 s_mov_b32 exec_hi, -1
 s_nop 2
 s_xor_b32 s76, s9, 2
 s_mul_i32 s76, s76, 131072
 s_xor_b32 s81, s9, 4
 s_mul_i32 s81, s81, 131072
 s_sub_u32 s81, s81, s76
 s_mov_b32 s5, s76
 s_mov_b32 s39, 0
 buffer_load_dword v13, off, s[28:31], s85 sc1
 s_waitcnt lgkmcnt(0)
 v_or_b32 v6, v6, v7
 s_nop 0
 v_readfirstlane_b32 s98, v6
 mvaac 176,80,0,208
 v_exp_f32 v204, v204
 mvaa 176,84,4
 v_exp_f32 v205, v205
 mvaa 176,88,8
 pk 202,204
 v_add_f32 v252, v252, v203
 mvaa 176,92,12
 v_exp_f32 v206, v206
 mvaac 180,108,12,208
 v_exp_f32 v207, v207
 mvaa 180,104,8
 pk 203,206
 v_add_f32 v252, v252, v196
 mvaa 180,100,4
 v_add_f32 v252, v252, v197
 v_add_f32 v252, v252, v198
 mvaa 180,96,0
 v_add_f32 v252, v252, v199
 v_add_f32 v252, v252, v204
 mvaac 184,112,0,208
 v_exp_f32 v176, v176
 mvaa 184,116,4
 v_exp_f32 v177, v177
 mvaa 184,120,8
 pk 176,176
 v_add_f32 v252, v252, v205
 mvaa 184,124,12
 v_exp_f32 v178, v178
 mvaac 188,140,12,208
 v_exp_f32 v179, v179
 mvaa 188,136,8
 pk 177,178
 v_add_f32 v252, v252, v206
 mvaa 188,132,4
 v_exp_f32 v180, v180
 mvaa 188,128,0
 v_exp_f32 v181, v181
 mvav 144,144,192
 pk 178,180
 v_add_f32 v252, v252, v207
 mvav 144,148,200
 v_exp_f32 v182, v182
 mvav 148,152,192
 v_exp_f32 v183, v183
 mvav 148,156,200
 rta 144,4,16896
 pk 179,182
 mvav 152,160,192
 v_exp_f32 v184, v184
 mvav 152,164,200
 v_exp_f32 v185, v185
 mvav 156,168,192
 rta 146,4,17152
 pk 184,184
 mvav 156,172,200
 v_exp_f32 v186, v186
 mvav 160,176,192
 rta 148,4,17408
 rta 150,4,17664
 mvav 160,180,200
 v_exp_f32 v187, v187
 mvav 164,184,192
 rta 152,4,16928
 pk 185,186
 mvav 164,188,200
 rta 154,4,17184
 rta 156,4,17440
 mvav 168,192,192
 v_exp_f32 v188, v188
 mvav 168,196,200
 rta 158,4,17696
 rta 160,4,16960
 mvav 172,200,192
 v_exp_f32 v189, v189
 mvav 172,204,200
 rta 162,4,17216
 pk 186,188
 mvaac 192,80,16,212
 rta 164,4,17472
 rta 166,4,17728
 mvaa 192,84,20
 v_exp_f32 v190, v190
 mvaa 192,88,24
 rta 168,4,16992
 rta 170,4,17248
 mvaa 192,92,28
 v_exp_f32 v191, v191
 mvaac 196,108,28,212
 rta 172,4,17504
 pk 187,190
 mvaa 196,104,24
 rta 174,4,17760
 rta 176,4,17024
 mvaa 196,100,20
 rta 178,4,17280
 rta 180,4,17536
 mvaa 196,96,16
 rta 182,4,17792
 rta 184,4,17056
 mvaac 200,112,16,212
 rta 186,4,17312
 rta 188,4,17568
 mvaa 200,116,20
 rta 190,4,17824
 rta 192,4,17088
 mvaa 200,120,24
 rta 194,4,17344
 rta 196,4,17600
 mvaa 200,124,28
 rta 198,4,17856
 rta 200,4,17120
 mvaac 204,140,28,212
 rta 202,4,17376
 rta 204,4,17632
 mvaa 204,136,24
 v_exp_f32 v192, v192
 mvaa 204,132,20
 v_exp_f32 v193, v193
 mvaa 204,128,16
 s_waitcnt lgkmcnt(12)
 rta 206,4,17888
 pk 192,192
 mvav 16,144,176
 v_exp_f32 v194, v194
 mvav 16,148,184
 v_exp_f32 v195, v195
 mvav 20,152,176
 v_exp_f32 v196, v196
 mvav 20,156,184
 v_exp_f32 v197, v197
 mvav 24,160,176
 pk 193,194
 pk 194,196
 mvav 24,164,184
 v_exp_f32 v198, v198
 mvav 28,168,176
 v_exp_f32 v199, v199
 mvav 28,172,184
 v_exp_f32 v200, v200
 mvav 32,176,176
 s_waitcnt lgkmcnt(0)
 pk 195,198
 v_add_f32 v255, v255, v200
 mvav 32,180,184
 s_mov_b32 s86, 16384
 buffer_store_dwordx4 a[252:255], v2, s[60:63], s86 offen offset:3072 sc1
 v_exp_f32 v201, v201
 mvav 36,184,176
 pk 200,200
 v_add_f32 v255, v255, v201
 mvav 36,188,184
 v_exp_f32 v202, v202
 mvav 40,192,176
 v_exp_f32 v203, v203
 mvav 40,196,184
 pk 201,202
 v_add_f32 v255, v255, v202
 mvav 44,200,176
 v_exp_f32 v204, v204
 mvav 44,204,184
 v_exp_f32 v205, v205
 maav 208,216,176
 pk 202,204
 v_add_f32 v255, v255, v203
 maav 208,216,184
 v_exp_f32 v206, v206
 mvaac 176,80,32,216
 s_waitcnt vmcnt(27)
 s_barrier
 v_add_f32 v255, v255, v204
 mvaa 176,84,36
 v_exp_f32 v207, v207
 mvaa 176,88,40
 pk 203,206
 v_add_f32 v255, v255, v205
 mvaa 176,92,44
 s_add_u32 m0, s77, 0
 v_add_f32 v255, v255, v206
 v_add_f32 v255, v255, v207
 mvaac 180,108,44,216
 buffer_load_dwordx4 v1, s[52:55], s76 offen offset:0 lds
 mvaa 180,104,40
 s_add_u32 m0, s77, 32
 mvaa 180,100,36
 buffer_load_dwordx4 v1, s[52:55], s76 offen offset:1024 lds
 mvaa 180,96,32
 mvaac 184,112,32,216
 v_exp_f32 v176, v176
 mvaa 184,116,36
 v_exp_f32 v177, v177
 mvaa 184,120,40
 v_add_f32 v254, v254, v176
 pk 176,176
 mvaa 184,124,44
 v_exp_f32 v178, v178
 mvaac 188,140,44,216
 v_exp_f32 v179, v179
 mvaa 188,136,40
 v_add_f32 v254, v254, v177
 pk 177,178
 mvaa 188,132,36
 v_exp_f32 v180, v180
 mvaa 188,128,32
 v_exp_f32 v181, v181
 mvav 48,144,192
 v_add_f32 v254, v254, v178
 pk 178,180
 mvav 48,148,200
 v_exp_f32 v182, v182
 mvav 52,152,192
 v_exp_f32 v183, v183
 mvav 52,156,200
 v_add_f32 v254, v254, v179
 pk 179,182
 mvav 56,160,192
 v_exp_f32 v184, v184
 mvav 56,164,200
 v_exp_f32 v185, v185
 mvav 60,168,192
 v_add_f32 v254, v254, v184
 pk 184,184
 mvav 60,172,200
 v_exp_f32 v186, v186
 mvav 64,176,192
 v_exp_f32 v187, v187
 mvav 64,180,200
 v_add_f32 v254, v254, v185
 pk 185,186
 mvav 68,184,192
 v_exp_f32 v188, v188
 mvav 68,188,200
 v_exp_f32 v189, v189
 mvav 72,192,192
 v_add_f32 v254, v254, v186
 pk 186,188
 mvav 72,196,200
 v_exp_f32 v190, v190
 mvav 76,200,192
 v_exp_f32 v191, v191
 mvav 76,204,200
 s_add_u32 m0, s77, 64
 v_add_f32 v254, v254, v187
 pk 187,190
 maav 212,216,192
 buffer_load_dwordx4 v1, s[52:55], s76 offen offset:2048 lds
 v_add_f32 v254, v254, v180
 mvaac 192,80,48,220
 s_add_u32 m0, s77, 96
 v_add_f32 v254, v254, v181
 v_add_f32 v254, v254, v182
 mvaa 192,84,52
 buffer_load_dwordx4 v1, s[52:55], s76 offen offset:3072 lds
 v_add_f32 v254, v254, v183
 mvaa 192,88,56
 s_add_u32 m0, s77, 16896
 v_add_f32 v254, v254, v188
 v_add_f32 v254, v254, v189
 mvaa 192,92,60
 buffer_load_dwordx4 v1, s[56:59], s76 offen offset:0 lds
 v_add_f32 v254, v254, v190
 mvaac 196,108,60,220
 s_add_u32 m0, s77, 16928
 v_add_f32 v254, v254, v191
 mvaa 196,104,56
 buffer_load_dwordx4 v1, s[56:59], s76 offen offset:1024 lds
 mvaa 196,100,52
 s_add_u32 m0, s77, 16960
 mvaa 196,96,48
 buffer_load_dwordx4 v1, s[56:59], s76 offen offset:2048 lds
 mvaac 200,112,48,220
 v_exp_f32 v192, v192
 mvaa 200,116,52
 v_exp_f32 v193, v193
 mvaa 200,120,56
 v_add_f32 v253, v253, v192
 pk 192,192
 mvaa 200,124,60
 v_exp_f32 v194, v194
 mvaac 204,140,60,220
 s_add_u32 m0, s77, 16992
 v_exp_f32 v195, v195
 mvaa 204,136,56
 buffer_load_dwordx4 v1, s[56:59], s76 offen offset:3072 lds
 v_add_f32 v253, v253, v193
 mvaa 204,132,52
 pk 193,194
 v_add_f32 v253, v253, v194
 mvaa 204,128,48
 v_exp_f32 v196, v196
 mvav 80,144,176
 v_exp_f32 v197, v197
 mvav 80,148,184
 pk 194,196
 v_add_f32 v253, v253, v195
 mvav 84,152,176
 v_exp_f32 v198, v198
 mvav 84,156,184
 v_exp_f32 v199, v199
 mvav 88,160,176
 pk 195,198
 v_add_f32 v253, v253, v196
 mvav 88,164,184
 v_exp_f32 v200, v200
 mvav 92,168,176
 v_exp_f32 v201, v201
 mvav 92,172,184
 v_add_f32 v253, v253, v200
 pk 200,200
 mvav 96,176,176
 v_exp_f32 v202, v202
 mvav 96,180,184
 v_exp_f32 v203, v203
 mvav 100,184,176
 v_add_f32 v253, v253, v201
 pk 201,202
 mvav 100,188,184
 v_exp_f32 v204, v204
 mvav 104,192,176
 v_exp_f32 v205, v205
 mvav 104,196,184
 v_add_f32 v253, v253, v202
 pk 202,204
 mvav 108,200,176
 v_exp_f32 v206, v206
 mvav 108,204,184
 v_exp_f32 v207, v207
 mvaac 176,80,64,224
 s_add_u32 s5, s5, s81
 v_add_f32 v253, v253, v203
 pk 203,206
 mvaa 176,84,68
 ds_read_b128 a[80:83], v3 offset:33792
 v_add_f32 v253, v253, v197
 mvaa 176,88,72
 ds_read_b128 a[84:87], v3 offset:33856
 v_add_f32 v253, v253, v198
 mvaa 176,92,76
 ds_read_b128 a[88:91], v3 offset:33920
 v_add_f32 v253, v253, v199
 mvaac 180,108,76,224
 ds_read_b128 a[92:95], v3 offset:33984
 v_add_f32 v253, v253, v204
 mvaa 180,104,72
 s_xor_b32 s76, s5, s39
 ds_read_b128 a[108:111], v3 offset:34240
 v_add_f32 v253, v253, v205
 mvaa 180,100,68
 ds_read_b128 a[104:107], v3 offset:34176
 v_add_f32 v253, v253, v206
 mvaa 180,96,64
 ds_read_b128 a[100:103], v3 offset:34112
 v_add_f32 v253, v253, v207
 mvaac 184,112,64,224
 v_exp_f32 v176, v176
 mvaa 184,116,68
 v_exp_f32 v177, v177
 mvaa 184,120,72
 v_add_f32 v252, v252, v176
 pk 176,176
 mvaa 184,124,76
 v_exp_f32 v178, v178
 mvaac 188,140,76,224
 v_exp_f32 v179, v179
 mvaa 188,136,72
 v_add_f32 v252, v252, v177
 pk 177,178
 mvaa 188,132,68
 v_exp_f32 v180, v180
 mvaa 188,128,64
 v_exp_f32 v181, v181
 mvav 112,144,192
 ds_read_b128 a[96:99], v3 offset:34048
 v_add_f32 v252, v252, v178
 mvav 112,148,200
 ds_read_b128 a[112:115], v3 offset:34304
 pk 178,180
 mvav 116,152,192
 v_exp_f32 v182, v182
 mvav 116,156,200
 ds_read_b128 a[116:119], v3 offset:34368
 ds_read_b128 a[120:123], v3 offset:34432
 mvav 120,160,192
 v_exp_f32 v183, v183
 mvav 120,164,200
 ds_read_b128 a[124:127], v3 offset:34496
 v_add_f32 v252, v252, v179
 mvav 124,168,192
 ds_read_b128 a[140:143], v3 offset:34752
 pk 179,182
 mvav 124,172,200
 v_exp_f32 v184, v184
 mvav 128,176,192
 v_exp_f32 v185, v185
 mvav 128,180,200
 ds_read_b128 a[136:139], v3 offset:34688
 ds_read_b128 a[132:135], v3 offset:34624
 mvav 132,184,192
 v_add_f32 v252, v252, v184
 pk 184,184
 mvav 132,188,200
 v_exp_f32 v186, v186
 mvav 136,192,192
 ds_read_b128 a[128:131], v3 offset:34560
 v_add_f32 v252, v252, v185
 mvav 136,196,200
 v_exp_f32 v187, v187
 mvav 140,200,192
 pk 185,186
 v_add_f32 v252, v252, v186
 mvav 140,204,200
 s_waitcnt lgkmcnt(3)
 v_exp_f32 v188, v188
 mvaac 192,80,0,208
 v_exp_f32 v189, v189
 mvaa 192,84,4
 pk 186,188
 v_add_f32 v252, v252, v187
 mvaa 192,88,8
 v_exp_f32 v190, v190
 mvaa 192,92,12
 v_exp_f32 v191, v191
 mvaac 196,108,12,208
 pk 187,190
 v_add_f32 v252, v252, v180
 mvaa 196,104,8
 v_add_f32 v252, v252, v181
 v_add_f32 v252, v252, v182
 mvaa 196,100,4
 v_add_f32 v252, v252, v183
 v_add_f32 v252, v252, v188
 mvaa 196,96,0
 v_add_f32 v252, v252, v189
 v_add_f32 v252, v252, v190
 mvaac 200,112,0,208
 v_exp_f32 v192, v192
 mvaa 200,116,4
 v_exp_f32 v193, v193
 mvaa 200,120,8
 pk 192,192
 v_add_f32 v252, v252, v191
 mvaa 200,124,12
 v_exp_f32 v194, v194
 mvaac 204,140,12,208
 s_waitcnt lgkmcnt(0)
 v_exp_f32 v195, v195
 mvaa 204,136,8
 v_exp_f32 v196, v196
 mvaa 204,132,4
 v_exp_f32 v197, v197
 mvaa 204,128,0
 pk 193,194
 pk 194,196
 mvav 144,144,176
 v_exp_f32 v198, v198
 mvav 144,148,184
 v_exp_f32 v199, v199
 mvav 148,152,176
 rta 144,4,50688
 pk 195,198
 mvav 148,156,184
 v_exp_f32 v200, v200
 mvav 152,160,176
 v_exp_f32 v201, v201
 mvav 152,164,184
 rta 146,4,50944
 pk 200,200
 mvav 156,168,176
 v_exp_f32 v202, v202
 mvav 156,172,184
 rta 148,4,51200
 rta 150,4,51456
 mvav 160,176,176
 v_exp_f32 v203, v203
 mvav 160,180,184
 rta 152,4,50720
 pk 201,202
 mvav 164,184,176
 rta 154,4,50976
 rta 156,4,51232
 mvav 164,188,184
 v_exp_f32 v204, v204
 mvav 168,192,176
 rta 158,4,51488
 rta 160,4,50752
 mvav 168,196,184
 v_exp_f32 v205, v205
 mvav 172,200,176
 rta 162,4,51008
 pk 202,204
 mvav 172,204,184
 rta 164,4,51264
 rta 166,4,51520
 mvaac 176,80,16,212
 v_exp_f32 v206, v206
 mvaa 176,84,20
 rta 168,4,50784
 rta 170,4,51040
 mvaa 176,88,24
 v_exp_f32 v207, v207
 mvaa 176,92,28
 rta 172,4,51296
 pk 203,206
 mvaac 180,108,28,212
 rta 174,4,51552
 rta 176,4,50816
 mvaa 180,104,24
 rta 178,4,51072
 rta 180,4,51328
 mvaa 180,100,20
 rta 182,4,51584
 rta 184,4,50848
 mvaa 180,96,16
 rta 186,4,51104
 rta 188,4,51360
 mvaac 184,112,16,212
 rta 190,4,51616
 rta 192,4,50880
 mvaa 184,116,20
 rta 194,4,51136
 rta 196,4,51392
 mvaa 184,120,24
 rta 198,4,51648
 rta 200,4,50912
 mvaa 184,124,28
 rta 202,4,51168
 rta 204,4,51424
 mvaac 188,140,28,212
 v_exp_f32 v176, v176
 mvaa 188,136,24
 v_exp_f32 v177, v177
 mvaa 188,132,20
 rta 206,4,51680
 pk 176,176
 mvaa 188,128,16
 s_waitcnt lgkmcnt(11)
 v_exp_f32 v178, v178
 mvav 16,144,192
 v_exp_f32 v179, v179
 mvav 16,148,200
 v_exp_f32 v180, v180
 mvav 20,152,192
 v_exp_f32 v181, v181
 mvav 20,156,200
 pk 177,178
 pk 178,180
 mvav 24,160,192
 v_exp_f32 v182, v182
 mvav 24,164,200
 v_exp_f32 v183, v183
 mvav 28,168,192
 v_exp_f32 v184, v184
 mvav 28,172,200
 pk 179,182
 v_add_f32 v255, v255, v184
 mvav 32,176,192
 v_exp_f32 v185, v185
 mvav 32,180,200
 s_waitcnt lgkmcnt(0)
 pk 184,184
 v_add_f32 v255, v255, v185
 mvav 36,184,192
 v_exp_f32 v186, v186
 mvav 36,188,200
 v_exp_f32 v187, v187
 mvav 40,192,192
 pk 185,186
 v_add_f32 v255, v255, v186
 mvav 40,196,200
 v_exp_f32 v188, v188
 mvav 44,200,192
 v_exp_f32 v189, v189
 mvav 44,204,200
 pk 186,188
 v_add_f32 v255, v255, v187
 maav 208,216,192
 v_exp_f32 v190, v190
 maav 208,216,200
 v_exp_f32 v191, v191
 mvaac 192,80,32,216
 s_waitcnt vmcnt(23)
 s_barrier
 pk 187,190
 mvaa 192,84,36
 v_add_f32 v255, v255, v188
 v_add_f32 v255, v255, v189
 mvaa 192,88,40
 s_add_u32 m0, s77, 33792
 v_add_f32 v255, v255, v190
 v_add_f32 v255, v255, v191
 mvaa 192,92,44
 buffer_load_dwordx4 v1, s[52:55], s76 offen offset:0 lds
 v_add_u32 v3, s78, v3
 mvaac 196,108,44,216
 s_add_u32 m0, s77, 33824
 v_add_u32 v4, s78, v4
 mvaa 196,104,40
 buffer_load_dwordx4 v1, s[52:55], s76 offen offset:1024 lds
 mvaa 196,100,36
 s_add_u32 m0, s77, 33856
 mvaa 196,96,32
 buffer_load_dwordx4 v1, s[52:55], s76 offen offset:2048 lds
 mvaac 200,112,32,216
 v_exp_f32 v192, v192
 mvaa 200,116,36
 v_exp_f32 v193, v193
 mvaa 200,120,40
 v_add_f32 v254, v254, v192
 pk 192,192
 mvaa 200,124,44
 v_exp_f32 v194, v194
 mvaac 204,140,44,216
 v_exp_f32 v195, v195
 mvaa 204,136,40
 v_add_f32 v254, v254, v193
 pk 193,194
 mvaa 204,132,36
 v_exp_f32 v196, v196
 mvaa 204,128,32
 v_exp_f32 v197, v197
 mvav 48,144,176
 v_add_f32 v254, v254, v194
 pk 194,196
 mvav 48,148,184
 v_exp_f32 v198, v198
 mvav 52,152,176
 v_exp_f32 v199, v199
 mvav 52,156,184
 v_add_f32 v254, v254, v195
 pk 195,198
 mvav 56,160,176
 v_exp_f32 v200, v200
 mvav 56,164,184
 v_exp_f32 v201, v201
 mvav 60,168,176
 v_add_f32 v254, v254, v200
 pk 200,200
 mvav 60,172,184
 v_exp_f32 v202, v202
 mvav 64,176,176
 v_exp_f32 v203, v203
 mvav 64,180,184
 v_add_f32 v254, v254, v201
 pk 201,202
 mvav 68,184,176
 v_exp_f32 v204, v204
 mvav 68,188,184
 v_exp_f32 v205, v205
 mvav 72,192,176
 v_add_f32 v254, v254, v202
 pk 202,204
 mvav 72,196,184
 v_exp_f32 v206, v206
 mvav 76,200,176
 v_exp_f32 v207, v207
 mvav 76,204,184
 s_add_u32 m0, s77, 33888
 v_add_f32 v254, v254, v203
 pk 203,206
 maav 212,216,176
 buffer_load_dwordx4 v1, s[52:55], s76 offen offset:3072 lds
 v_add_f32 v254, v254, v196
 mvaac 176,80,48,220
 s_add_u32 m0, s77, 50688
 v_add_f32 v254, v254, v197
 v_add_f32 v254, v254, v198
 mvaa 176,84,52
 buffer_load_dwordx4 v1, s[56:59], s76 offen offset:0 lds
 v_add_f32 v254, v254, v199
 mvaa 176,88,56
 s_add_u32 m0, s77, 50720
 v_add_f32 v254, v254, v204
 v_add_f32 v254, v254, v205
 mvaa 176,92,60
 buffer_load_dwordx4 v1, s[56:59], s76 offen offset:1024 lds
 v_add_f32 v254, v254, v206
 mvaac 180,108,60,220
 s_add_u32 m0, s77, 50752
 v_add_f32 v254, v254, v207
 mvaa 180,104,56
 buffer_load_dwordx4 v1, s[56:59], s76 offen offset:2048 lds
 mvaa 180,100,52
 s_add_u32 m0, s77, 50784
 mvaa 180,96,48
 buffer_load_dwordx4 v1, s[56:59], s76 offen offset:3072 lds
 mvaac 184,112,48,220
 v_exp_f32 v176, v176
 mvaa 184,116,52
 v_exp_f32 v177, v177
 mvaa 184,120,56
 v_add_f32 v253, v253, v176
 pk 176,176
 mvaa 184,124,60
 v_exp_f32 v178, v178
 mvaac 188,140,60,220
 v_exp_f32 v179, v179
 mvaa 188,136,56
 v_add_f32 v253, v253, v177
 pk 177,178
 mvaa 188,132,52
 v_exp_f32 v180, v180
 mvaa 188,128,48
 v_exp_f32 v181, v181
 mvav 80,144,192
 v_add_f32 v253, v253, v178
 pk 178,180
 mvav 80,148,200
 v_exp_f32 v182, v182
 mvav 84,152,192
 v_exp_f32 v183, v183
 mvav 84,156,200
 v_add_f32 v253, v253, v179
 pk 179,182
 mvav 88,160,192
 v_exp_f32 v184, v184
 mvav 88,164,200
 v_exp_f32 v185, v185
 mvav 92,168,192
 v_add_f32 v253, v253, v184
 pk 184,184
 mvav 92,172,200
 v_exp_f32 v186, v186
 mvav 96,176,192
 v_exp_f32 v187, v187
 mvav 96,180,200
 v_add_f32 v253, v253, v185
 pk 185,186
 mvav 100,184,192
 v_exp_f32 v188, v188
 mvav 100,188,200
 v_exp_f32 v189, v189
 mvav 104,192,192
 v_add_f32 v253, v253, v186
 pk 186,188
 mvav 104,196,200
 v_exp_f32 v190, v190
 mvav 108,200,192
 v_exp_f32 v191, v191
 mvav 108,204,200
 v_add_f32 v253, v253, v187
 pk 187,190
 mvaac 192,80,64,224
 s_add_u32 s5, s5, s81
 v_add_f32 v253, v253, v180
 v_add_f32 v253, v253, v181
 mvaa 192,84,68
 s_add_u32 s77, s77, s78
 ds_read_b128 a[80:83], v3 offset:0
 v_add_f32 v253, v253, v182
 mvaa 192,88,72
 s_sub_u32 s78, 0, s78
 ds_read_b128 a[84:87], v3 offset:64
 v_add_f32 v253, v253, v183
 mvaa 192,92,76
 ds_read_b128 a[88:91], v3 offset:128
 v_add_f32 v253, v253, v188
 mvaac 196,108,76,224
 ds_read_b128 a[92:95], v3 offset:192
 v_add_f32 v253, v253, v189
 mvaa 196,104,72
 s_xor_b32 s76, s5, s39
 ds_read_b128 a[108:111], v3 offset:448
 v_add_f32 v253, v253, v190
 mvaa 196,100,68
 ds_read_b128 a[104:107], v3 offset:384
 v_add_f32 v253, v253, v191
 mvaa 196,96,64
 ds_read_b128 a[100:103], v3 offset:320
 mvaac 200,112,64,224
 v_exp_f32 v192, v192
 mvaa 200,116,68
 v_exp_f32 v193, v193
 mvaa 200,120,72
 v_add_f32 v252, v252, v192
 pk 192,192
 mvaa 200,124,76
 v_exp_f32 v194, v194
 mvaac 204,140,76,224
 v_exp_f32 v195, v195
 mvaa 204,136,72
 v_add_f32 v252, v252, v193
 pk 193,194
 mvaa 204,132,68
 v_exp_f32 v196, v196
 mvaa 204,128,64
 v_exp_f32 v197, v197
 mvav 112,144,176
 ds_read_b128 a[96:99], v3 offset:256
 v_add_f32 v252, v252, v194
 mvav 112,148,184
 ds_read_b128 a[112:115], v3 offset:512
 pk 194,196
 mvav 116,152,176
 v_exp_f32 v198, v198
 mvav 116,156,184
 ds_read_b128 a[116:119], v3 offset:576
 ds_read_b128 a[120:123], v3 offset:640
 mvav 120,160,176
 v_exp_f32 v199, v199
 mvav 120,164,184
 ds_read_b128 a[124:127], v3 offset:704
 v_add_f32 v252, v252, v195
 mvav 124,168,176
 ds_read_b128 a[140:143], v3 offset:960
 pk 195,198
 mvav 124,172,184
 v_exp_f32 v200, v200
 mvav 128,176,176
 v_exp_f32 v201, v201
 mvav 128,180,184
 ds_read_b128 a[136:139], v3 offset:896
 ds_read_b128 a[132:135], v3 offset:832
 mvav 132,184,176
 v_add_f32 v252, v252, v200
 pk 200,200
 mvav 132,188,184
 v_exp_f32 v202, v202
 mvav 136,192,176
 ds_read_b128 a[128:131], v3 offset:768
 v_add_f32 v252, v252, v201
 mvav 136,196,184
 v_exp_f32 v203, v203
 mvav 140,200,176
 pk 201,202
 v_add_f32 v252, v252, v202
 mvav 140,204,184
 s_branch L15_tail
L15_careful:
 s_waitcnt lgkmcnt(0)
 v_pk_mul_f32 v[16:17], v[16:17], v[6:7] op_sel_hi:[1,0]
 v_pk_mul_f32 v[18:19], v[18:19], v[6:7] op_sel_hi:[1,0]
 v_pk_mul_f32 v[20:21], v[20:21], v[6:7] op_sel_hi:[1,0]
 v_pk_mul_f32 v[22:23], v[22:23], v[6:7] op_sel_hi:[1,0]
 pk 16,16
 pk 17,18
 pk 18,20
 pk 19,22
 s_add_u32 s86, s90, 0
 buffer_store_dwordx4 v[16:19], v2, s[60:63], s86 offen offset:0 sc1
 v_pk_mul_f32 v[24:25], v[24:25], v[6:7] op_sel_hi:[1,0]
 v_pk_mul_f32 v[26:27], v[26:27], v[6:7] op_sel_hi:[1,0]
 v_pk_mul_f32 v[28:29], v[28:29], v[6:7] op_sel_hi:[1,0]
 v_pk_mul_f32 v[30:31], v[30:31], v[6:7] op_sel_hi:[1,0]
 pk 24,24
 pk 25,26
 pk 26,28
 pk 27,30
 s_add_u32 s86, s90, 4096
 buffer_store_dwordx4 v[24:27], v2, s[60:63], s86 offen offset:1024 sc1
 v_pk_mul_f32 v[32:33], v[32:33], v[6:7] op_sel_hi:[1,0]
 v_pk_mul_f32 v[34:35], v[34:35], v[6:7] op_sel_hi:[1,0]
 v_pk_mul_f32 v[36:37], v[36:37], v[6:7] op_sel_hi:[1,0]
 v_pk_mul_f32 v[38:39], v[38:39], v[6:7] op_sel_hi:[1,0]
 pk 32,32
 pk 33,34
 pk 34,36
 pk 35,38
 s_add_u32 s86, s90, 8192
 buffer_store_dwordx4 v[32:35], v2, s[60:63], s86 offen offset:2048 sc1
 v_pk_mul_f32 v[40:41], v[40:41], v[6:7] op_sel_hi:[1,0]
 v_pk_mul_f32 v[42:43], v[42:43], v[6:7] op_sel_hi:[1,0]
 v_pk_mul_f32 v[44:45], v[44:45], v[6:7] op_sel_hi:[1,0]
 v_pk_mul_f32 v[46:47], v[46:47], v[6:7] op_sel_hi:[1,0]
 pk 40,40
 pk 41,42
 pk 42,44
 pk 43,46
 s_add_u32 s86, s90, 12288
 buffer_store_dwordx4 v[40:43], v2, s[60:63], s86 offen offset:3072 sc1
 v_pk_mul_f32 v[48:49], v[48:49], v[6:7] op_sel:[0,1]
 v_pk_mul_f32 v[50:51], v[50:51], v[6:7] op_sel:[0,1]
 v_pk_mul_f32 v[52:53], v[52:53], v[6:7] op_sel:[0,1]
 v_pk_mul_f32 v[54:55], v[54:55], v[6:7] op_sel:[0,1]
 pk 48,48
 pk 49,50
 pk 50,52
 pk 51,54
 s_add_u32 s86, s90, 0
 buffer_store_dwordx4 v[48:51], v2, s[60:63], s86 offen offset:1024 sc1
 v_pk_mul_f32 v[56:57], v[56:57], v[6:7] op_sel:[0,1]
 v_pk_mul_f32 v[58:59], v[58:59], v[6:7] op_sel:[0,1]
 v_pk_mul_f32 v[60:61], v[60:61], v[6:7] op_sel:[0,1]
 v_pk_mul_f32 v[62:63], v[62:63], v[6:7] op_sel:[0,1]
 pk 56,56
 pk 57,58
 pk 58,60
 pk 59,62
 s_add_u32 s86, s90, 4096
 buffer_store_dwordx4 v[56:59], v2, s[60:63], s86 offen offset:2048 sc1
 v_pk_mul_f32 v[64:65], v[64:65], v[6:7] op_sel:[0,1]
 v_pk_mul_f32 v[66:67], v[66:67], v[6:7] op_sel:[0,1]
 v_pk_mul_f32 v[68:69], v[68:69], v[6:7] op_sel:[0,1]
 v_pk_mul_f32 v[70:71], v[70:71], v[6:7] op_sel:[0,1]
 pk 64,64
 pk 65,66
 pk 66,68
 pk 67,70
 s_add_u32 s86, s90, 8192
 buffer_store_dwordx4 v[64:67], v2, s[60:63], s86 offen offset:3072 sc1
 v_pk_mul_f32 v[72:73], v[72:73], v[6:7] op_sel:[0,1]
 v_pk_mul_f32 v[74:75], v[74:75], v[6:7] op_sel:[0,1]
 v_pk_mul_f32 v[76:77], v[76:77], v[6:7] op_sel:[0,1]
 v_pk_mul_f32 v[78:79], v[78:79], v[6:7] op_sel:[0,1]
 pk 72,72
 pk 73,74
 pk 74,76
 pk 75,78
 s_add_u32 s86, s90, 16384
 buffer_store_dwordx4 v[72:75], v2, s[60:63], s86 offen offset:0 sc1
 v_pk_mul_f32 v[80:81], v[80:81], v[8:9] op_sel_hi:[1,0]
 v_pk_mul_f32 v[82:83], v[82:83], v[8:9] op_sel_hi:[1,0]
 v_pk_mul_f32 v[84:85], v[84:85], v[8:9] op_sel_hi:[1,0]
 v_pk_mul_f32 v[86:87], v[86:87], v[8:9] op_sel_hi:[1,0]
 pk 80,80
 pk 81,82
 pk 82,84
 pk 83,86
 s_add_u32 s86, s90, 0
 buffer_store_dwordx4 v[80:83], v2, s[60:63], s86 offen offset:2048 sc1
 v_pk_mul_f32 v[88:89], v[88:89], v[8:9] op_sel_hi:[1,0]
 v_pk_mul_f32 v[90:91], v[90:91], v[8:9] op_sel_hi:[1,0]
 v_pk_mul_f32 v[92:93], v[92:93], v[8:9] op_sel_hi:[1,0]
 v_pk_mul_f32 v[94:95], v[94:95], v[8:9] op_sel_hi:[1,0]
 pk 88,88
 pk 89,90
 pk 90,92
 pk 91,94
 s_add_u32 s86, s90, 4096
 buffer_store_dwordx4 v[88:91], v2, s[60:63], s86 offen offset:3072 sc1
 v_pk_mul_f32 v[96:97], v[96:97], v[8:9] op_sel_hi:[1,0]
 v_pk_mul_f32 v[98:99], v[98:99], v[8:9] op_sel_hi:[1,0]
 v_pk_mul_f32 v[100:101], v[100:101], v[8:9] op_sel_hi:[1,0]
 v_pk_mul_f32 v[102:103], v[102:103], v[8:9] op_sel_hi:[1,0]
 pk 96,96
 pk 97,98
 pk 98,100
 pk 99,102
 s_add_u32 s86, s90, 12288
 buffer_store_dwordx4 v[96:99], v2, s[60:63], s86 offen offset:0 sc1
 v_pk_mul_f32 v[104:105], v[104:105], v[8:9] op_sel_hi:[1,0]
 v_pk_mul_f32 v[106:107], v[106:107], v[8:9] op_sel_hi:[1,0]
 v_pk_mul_f32 v[108:109], v[108:109], v[8:9] op_sel_hi:[1,0]
 v_pk_mul_f32 v[110:111], v[110:111], v[8:9] op_sel_hi:[1,0]
 pk 104,104
 pk 105,106
 pk 106,108
 pk 107,110
 s_add_u32 s86, s90, 16384
 buffer_store_dwordx4 v[104:107], v2, s[60:63], s86 offen offset:1024 sc1
 v_pk_mul_f32 v[112:113], v[112:113], v[8:9] op_sel:[0,1]
 v_pk_mul_f32 v[114:115], v[114:115], v[8:9] op_sel:[0,1]
 v_pk_mul_f32 v[116:117], v[116:117], v[8:9] op_sel:[0,1]
 v_pk_mul_f32 v[118:119], v[118:119], v[8:9] op_sel:[0,1]
 pk 112,112
 pk 113,114
 pk 114,116
 pk 115,118
 s_add_u32 s86, s90, 0
 buffer_store_dwordx4 v[112:115], v2, s[60:63], s86 offen offset:3072 sc1
 v_pk_mul_f32 v[120:121], v[120:121], v[8:9] op_sel:[0,1]
 v_pk_mul_f32 v[122:123], v[122:123], v[8:9] op_sel:[0,1]
 v_pk_mul_f32 v[124:125], v[124:125], v[8:9] op_sel:[0,1]
 v_pk_mul_f32 v[126:127], v[126:127], v[8:9] op_sel:[0,1]
 pk 120,120
 pk 121,122
 pk 122,124
 pk 123,126
 s_add_u32 s86, s90, 8192
 buffer_store_dwordx4 v[120:123], v2, s[60:63], s86 offen offset:0 sc1
 v_pk_mul_f32 v[128:129], v[128:129], v[8:9] op_sel:[0,1]
 v_pk_mul_f32 v[130:131], v[130:131], v[8:9] op_sel:[0,1]
 v_pk_mul_f32 v[132:133], v[132:133], v[8:9] op_sel:[0,1]
 v_pk_mul_f32 v[134:135], v[134:135], v[8:9] op_sel:[0,1]
 pk 128,128
 pk 129,130
 pk 130,132
 pk 131,134
 s_add_u32 s86, s90, 12288
 buffer_store_dwordx4 v[128:131], v2, s[60:63], s86 offen offset:1024 sc1
 v_pk_mul_f32 v[136:137], v[136:137], v[8:9] op_sel:[0,1]
 v_pk_mul_f32 v[138:139], v[138:139], v[8:9] op_sel:[0,1]
 v_pk_mul_f32 v[140:141], v[140:141], v[8:9] op_sel:[0,1]
 v_pk_mul_f32 v[142:143], v[142:143], v[8:9] op_sel:[0,1]
 pk 136,136
 pk 137,138
 pk 138,140
 pk 139,142
 s_add_u32 s86, s90, 16384
 buffer_store_dwordx4 v[136:139], v2, s[60:63], s86 offen offset:2048 sc1
 v_pk_mul_f32 v[144:145], v[144:145], v[10:11] op_sel_hi:[1,0]
 v_pk_mul_f32 v[146:147], v[146:147], v[10:11] op_sel_hi:[1,0]
 v_pk_mul_f32 v[148:149], v[148:149], v[10:11] op_sel_hi:[1,0]
 v_pk_mul_f32 v[150:151], v[150:151], v[10:11] op_sel_hi:[1,0]
 pk 144,144
 pk 145,146
 pk 146,148
 pk 147,150
 s_add_u32 s86, s90, 4096
 buffer_store_dwordx4 v[144:147], v2, s[60:63], s86 offen offset:0 sc1
 v_pk_mul_f32 v[152:153], v[152:153], v[10:11] op_sel_hi:[1,0]
 v_pk_mul_f32 v[154:155], v[154:155], v[10:11] op_sel_hi:[1,0]
 v_pk_mul_f32 v[156:157], v[156:157], v[10:11] op_sel_hi:[1,0]
 v_pk_mul_f32 v[158:159], v[158:159], v[10:11] op_sel_hi:[1,0]
 pk 152,152
 pk 153,154
 pk 154,156
 pk 155,158
 s_add_u32 s86, s90, 8192
 buffer_store_dwordx4 v[152:155], v2, s[60:63], s86 offen offset:1024 sc1
 v_pk_mul_f32 v[160:161], v[160:161], v[10:11] op_sel_hi:[1,0]
 v_pk_mul_f32 v[162:163], v[162:163], v[10:11] op_sel_hi:[1,0]
 v_pk_mul_f32 v[164:165], v[164:165], v[10:11] op_sel_hi:[1,0]
 v_pk_mul_f32 v[166:167], v[166:167], v[10:11] op_sel_hi:[1,0]
 pk 160,160
 pk 161,162
 pk 162,164
 pk 163,166
 s_add_u32 s86, s90, 12288
 buffer_store_dwordx4 v[160:163], v2, s[60:63], s86 offen offset:2048 sc1
 v_pk_mul_f32 v[168:169], v[168:169], v[10:11] op_sel_hi:[1,0]
 v_pk_mul_f32 v[170:171], v[170:171], v[10:11] op_sel_hi:[1,0]
 v_pk_mul_f32 v[172:173], v[172:173], v[10:11] op_sel_hi:[1,0]
 v_pk_mul_f32 v[174:175], v[174:175], v[10:11] op_sel_hi:[1,0]
 pk 168,168
 pk 169,170
 pk 170,172
 pk 171,174
 s_add_u32 s86, s90, 16384
 buffer_store_dwordx4 v[168:171], v2, s[60:63], s86 offen offset:3072 sc1
 s_waitcnt vmcnt(0) lgkmcnt(0)
 s_barrier
 s_branch L15_16_flags
L15_spin1:
 s_mov_b32 s79, 0x40000
L15_sp1:
 s_sub_u32 s79, s79, 1
 s_cbranch_scc1 L15_sp1_end
 s_sleep 4
 buffer_load_dword v13, off, s[28:31], s85 sc1
 s_waitcnt vmcnt(0)
 v_cmp_ne_u32 vcc, 65535, v13
 s_nop 1
 s_and_b64 vcc, vcc, 1
 s_cbranch_scc1 L15_sp1
L15_sp1_end:
 s_branch L15_s1
L15_slow:
 s_waitcnt vmcnt(0) lgkmcnt(0)
 s_nop 7
 s_mov_b64 s[52:53], s[72:73]
 s_mov_b32 s54, 524288
 s_mov_b64 s[56:57], s[74:75]
 s_mov_b32 s58, 524288
 v_mov_b32 v1, v12
 s_mov_b32 s43, 0
 v_mov_b32 v14, 0x3f803f80
 v_accvgpr_write_b32 a252, v14
 v_accvgpr_write_b32 a253, v14
 v_accvgpr_write_b32 a254, v14
 v_accvgpr_write_b32 a255, v14
L15_slow_head:
 s_lshr_b32 s3, s98, s43
 s_and_b32 s3, s3, 1
 s_cmp_eq_u32 s3, 0
 s_cbranch_scc1 L15_slow_next
 s_mul_i32 s90, s43, 20480
 s_add_u32 s86, s90, 0
 buffer_load_dwordx4 a[0:3], v2, s[64:67], s86 offen offset:0
 buffer_load_dwordx4 a[4:7], v2, s[64:67], s86 offen offset:1024
 buffer_load_dwordx4 a[8:11], v2, s[64:67], s86 offen offset:2048
 buffer_load_dwordx4 a[12:15], v2, s[64:67], s86 offen offset:3072
 s_add_u32 s86, s90, 4096
 buffer_load_dwordx4 a[16:19], v2, s[64:67], s86 offen offset:0
 buffer_load_dwordx4 a[20:23], v2, s[64:67], s86 offen offset:1024
 buffer_load_dwordx4 a[24:27], v2, s[64:67], s86 offen offset:2048
 buffer_load_dwordx4 a[28:31], v2, s[64:67], s86 offen offset:3072
 s_add_u32 s86, s90, 8192
 buffer_load_dwordx4 a[32:35], v2, s[64:67], s86 offen offset:0
 buffer_load_dwordx4 a[36:39], v2, s[64:67], s86 offen offset:1024
 buffer_load_dwordx4 a[40:43], v2, s[64:67], s86 offen offset:2048
 buffer_load_dwordx4 a[44:47], v2, s[64:67], s86 offen offset:3072
 s_add_u32 s86, s90, 12288
 buffer_load_dwordx4 a[48:51], v2, s[64:67], s86 offen offset:0
 buffer_load_dwordx4 a[52:55], v2, s[64:67], s86 offen offset:1024
 buffer_load_dwordx4 a[56:59], v2, s[64:67], s86 offen offset:2048
 buffer_load_dwordx4 a[60:63], v2, s[64:67], s86 offen offset:3072
 s_add_u32 s86, s90, 16384
 buffer_load_dwordx4 a[64:67], v2, s[64:67], s86 offen offset:0
 buffer_load_dwordx4 a[68:71], v2, s[64:67], s86 offen offset:1024
 buffer_load_dwordx4 a[72:75], v2, s[64:67], s86 offen offset:2048
 buffer_load_dwordx4 a[76:79], v2, s[64:67], s86 offen offset:3072
 v_mov_b32 v208, 0xff800000
 v_mov_b32 v212, 0xff800000
 v_mov_b32 v216, 0xff800000
 v_mov_b32 v220, 0xff800000
 v_mov_b32 v224, 0xff800000
 s_lshl_b32 s76, s43, 18
 s_mov_b32 s79, 16
 s_waitcnt vmcnt(0) lgkmcnt(0)
L15_slow_l1:
 s_barrier
 s_add_u32 m0, s92, 67584
 s_nop 0
 buffer_load_dwordx4 v1, s[52:55], s76 offen offset:0 lds
 s_add_u32 m0, s92, 67616
 s_nop 0
 buffer_load_dwordx4 v1, s[52:55], s76 offen offset:1024 lds
 s_add_u32 m0, s92, 67648
 s_nop 0
 buffer_load_dwordx4 v1, s[52:55], s76 offen offset:2048 lds
 s_add_u32 m0, s92, 67680
 s_nop 0
 buffer_load_dwordx4 v1, s[52:55], s76 offen offset:3072 lds
 s_waitcnt vmcnt(0) lgkmcnt(0)
 s_barrier
 ds_read_b128 a[80:83], v3 offset:0
 ds_read_b128 a[84:87], v3 offset:64
 ds_read_b128 a[88:91], v3 offset:128
 ds_read_b128 a[92:95], v3 offset:192
 ds_read_b128 a[96:99], v3 offset:256
 ds_read_b128 a[100:103], v3 offset:320
 ds_read_b128 a[104:107], v3 offset:384
 ds_read_b128 a[108:111], v3 offset:448
 ds_read_b128 a[112:115], v3 offset:512
 ds_read_b128 a[116:119], v3 offset:576
 ds_read_b128 a[120:123], v3 offset:640
 ds_read_b128 a[124:127], v3 offset:704
 ds_read_b128 a[128:131], v3 offset:768
 ds_read_b128 a[132:135], v3 offset:832
 ds_read_b128 a[136:139], v3 offset:896
 ds_read_b128 a[140:143], v3 offset:960
 s_waitcnt lgkmcnt(15)
 mvaaz 176,80,0
 s_waitcnt lgkmcnt(14)
 mvaa 176,84,4
 s_waitcnt lgkmcnt(13)
 mvaa 176,88,8
 s_waitcnt lgkmcnt(12)
 mvaa 176,92,12
 s_waitcnt lgkmcnt(11)
 mvaaz 180,96,0
 s_waitcnt lgkmcnt(10)
 mvaa 180,100,4
 s_waitcnt lgkmcnt(9)
 mvaa 180,104,8
 s_waitcnt lgkmcnt(8)
 mvaa 180,108,12
 s_waitcnt lgkmcnt(7)
 mvaaz 184,112,0
 s_waitcnt lgkmcnt(0)
 mvaa 184,116,4
 mvaa 184,120,8
 mvaa 184,124,12
 mvaaz 188,128,0
 mvaa 188,132,4
 mvaa 188,136,8
 mvaa 188,140,12
 v_max_f32 v208, v208, v176
 v_max_f32 v208, v208, v177
 v_max_f32 v208, v208, v178
 v_max_f32 v208, v208, v179
 v_max_f32 v208, v208, v180
 v_max_f32 v208, v208, v181
 v_max_f32 v208, v208, v182
 v_max_f32 v208, v208, v183
 v_max_f32 v208, v208, v184
 v_max_f32 v208, v208, v185
 v_max_f32 v208, v208, v186
 v_max_f32 v208, v208, v187
 v_max_f32 v208, v208, v188
 v_max_f32 v208, v208, v189
 v_max_f32 v208, v208, v190
 v_max_f32 v208, v208, v191
 mvaaz 176,80,16
 mvaa 176,84,20
 mvaa 176,88,24
 mvaa 176,92,28
 mvaaz 180,96,16
 mvaa 180,100,20
 mvaa 180,104,24
 mvaa 180,108,28
 mvaaz 184,112,16
 mvaa 184,116,20
 mvaa 184,120,24
 mvaa 184,124,28
 mvaaz 188,128,16
 mvaa 188,132,20
 mvaa 188,136,24
 mvaa 188,140,28
 v_max_f32 v212, v212, v176
 v_max_f32 v212, v212, v177
 v_max_f32 v212, v212, v178
 v_max_f32 v212, v212, v179
 v_max_f32 v212, v212, v180
 v_max_f32 v212, v212, v181
 v_max_f32 v212, v212, v182
 v_max_f32 v212, v212, v183
 v_max_f32 v212, v212, v184
 v_max_f32 v212, v212, v185
 v_max_f32 v212, v212, v186
 v_max_f32 v212, v212, v187
 v_max_f32 v212, v212, v188
 v_max_f32 v212, v212, v189
 v_max_f32 v212, v212, v190
 v_max_f32 v212, v212, v191
 mvaaz 176,80,32
 mvaa 176,84,36
 mvaa 176,88,40
 mvaa 176,92,44
 mvaaz 180,96,32
 mvaa 180,100,36
 mvaa 180,104,40
 mvaa 180,108,44
 mvaaz 184,112,32
 mvaa 184,116,36
 mvaa 184,120,40
 mvaa 184,124,44
 mvaaz 188,128,32
 mvaa 188,132,36
 mvaa 188,136,40
 mvaa 188,140,44
 v_max_f32 v216, v216, v176
 v_max_f32 v216, v216, v177
 v_max_f32 v216, v216, v178
 v_max_f32 v216, v216, v179
 v_max_f32 v216, v216, v180
 v_max_f32 v216, v216, v181
 v_max_f32 v216, v216, v182
 v_max_f32 v216, v216, v183
 v_max_f32 v216, v216, v184
 v_max_f32 v216, v216, v185
 v_max_f32 v216, v216, v186
 v_max_f32 v216, v216, v187
 v_max_f32 v216, v216, v188
 v_max_f32 v216, v216, v189
 v_max_f32 v216, v216, v190
 v_max_f32 v216, v216, v191
 mvaaz 176,80,48
 mvaa 176,84,52
 mvaa 176,88,56
 mvaa 176,92,60
 mvaaz 180,96,48
 mvaa 180,100,52
 mvaa 180,104,56
 mvaa 180,108,60
 mvaaz 184,112,48
 mvaa 184,116,52
 mvaa 184,120,56
 mvaa 184,124,60
 mvaaz 188,128,48
 mvaa 188,132,52
 mvaa 188,136,56
 mvaa 188,140,60
 v_max_f32 v220, v220, v176
 v_max_f32 v220, v220, v177
 v_max_f32 v220, v220, v178
 v_max_f32 v220, v220, v179
 v_max_f32 v220, v220, v180
 v_max_f32 v220, v220, v181
 v_max_f32 v220, v220, v182
 v_max_f32 v220, v220, v183
 v_max_f32 v220, v220, v184
 v_max_f32 v220, v220, v185
 v_max_f32 v220, v220, v186
 v_max_f32 v220, v220, v187
 v_max_f32 v220, v220, v188
 v_max_f32 v220, v220, v189
 v_max_f32 v220, v220, v190
 v_max_f32 v220, v220, v191
 mvaaz 176,80,64
 mvaa 176,84,68
 mvaa 176,88,72
 mvaa 176,92,76
 mvaaz 180,96,64
 mvaa 180,100,68
 mvaa 180,104,72
 mvaa 180,108,76
 mvaaz 184,112,64
 mvaa 184,116,68
 mvaa 184,120,72
 mvaa 184,124,76
 mvaaz 188,128,64
 mvaa 188,132,68
 mvaa 188,136,72
 mvaa 188,140,76
 v_max_f32 v224, v224, v176
 v_max_f32 v224, v224, v177
 v_max_f32 v224, v224, v178
 v_max_f32 v224, v224, v179
 v_max_f32 v224, v224, v180
 v_max_f32 v224, v224, v181
 v_max_f32 v224, v224, v182
 v_max_f32 v224, v224, v183
 v_max_f32 v224, v224, v184
 v_max_f32 v224, v224, v185
 v_max_f32 v224, v224, v186
 v_max_f32 v224, v224, v187
 v_max_f32 v224, v224, v188
 v_max_f32 v224, v224, v189
 v_max_f32 v224, v224, v190
 v_max_f32 v224, v224, v191
 s_waitcnt vmcnt(0) lgkmcnt(0)
 s_add_u32 s76, s76, 16384
 s_sub_u32 s79, s79, 1
 s_cmp_lg_u32 s79, 0
 s_cbranch_scc1 L15_slow_l1
 v_mov_b32 v209, v208
 v_mov_b32 v213, v212
 v_mov_b32 v217, v216
 v_mov_b32 v221, v220
 v_mov_b32 v225, v224
 v_permlane32_swap_b32 v208, v209
 v_permlane32_swap_b32 v212, v213
 v_permlane32_swap_b32 v216, v217
 v_permlane32_swap_b32 v220, v221
 v_permlane32_swap_b32 v224, v225
 v_max_f32 v208, v208, v209
 v_max_f32 v212, v212, v213
 v_max_f32 v216, v216, v217
 v_max_f32 v220, v220, v221
 v_max_f32 v224, v224, v225
 v_mov_b32 v209, v208
 v_mov_b32 v213, v212
 v_mov_b32 v217, v216
 v_mov_b32 v221, v220
 v_mov_b32 v225, v224
 v_permlane16_swap_b32 v208, v209
 v_permlane16_swap_b32 v212, v213
 v_permlane16_swap_b32 v216, v217
 v_permlane16_swap_b32 v220, v221
 v_permlane16_swap_b32 v224, v225
 v_max_f32 v208, v208, v209
 v_max_f32 v212, v212, v213
 v_max_f32 v216, v216, v217
 v_max_f32 v220, v220, v221
 v_max_f32 v224, v224, v225
 v_sub_f32 v211, 0, v208
 v_sub_f32 v210, 0, v208
 v_sub_f32 v209, 0, v208
 v_sub_f32 v208, 0, v208
 v_sub_f32 v215, 0, v212
 v_sub_f32 v214, 0, v212
 v_sub_f32 v213, 0, v212
 v_sub_f32 v212, 0, v212
 v_sub_f32 v219, 0, v216
 v_sub_f32 v218, 0, v216
 v_sub_f32 v217, 0, v216
 v_sub_f32 v216, 0, v216
 v_sub_f32 v223, 0, v220
 v_sub_f32 v222, 0, v220
 v_sub_f32 v221, 0, v220
 v_sub_f32 v220, 0, v220
 v_sub_f32 v227, 0, v224
 v_sub_f32 v226, 0, v224
 v_sub_f32 v225, 0, v224
 v_sub_f32 v224, 0, v224
 v_mov_b32 v16, 0
 v_mov_b32 v17, 0
 v_mov_b32 v18, 0
 v_mov_b32 v19, 0
 v_mov_b32 v20, 0
 v_mov_b32 v21, 0
 v_mov_b32 v22, 0
 v_mov_b32 v23, 0
 v_mov_b32 v24, 0
 v_mov_b32 v25, 0
 v_mov_b32 v26, 0
 v_mov_b32 v27, 0
 v_mov_b32 v28, 0
 v_mov_b32 v29, 0
 v_mov_b32 v30, 0
 v_mov_b32 v31, 0
 v_mov_b32 v32, 0
 v_mov_b32 v33, 0
 v_mov_b32 v34, 0
 v_mov_b32 v35, 0
 v_mov_b32 v36, 0
 v_mov_b32 v37, 0
 v_mov_b32 v38, 0
 v_mov_b32 v39, 0
 v_mov_b32 v40, 0
 v_mov_b32 v41, 0
 v_mov_b32 v42, 0
 v_mov_b32 v43, 0
 v_mov_b32 v44, 0
 v_mov_b32 v45, 0
 v_mov_b32 v46, 0
 v_mov_b32 v47, 0
 v_mov_b32 v48, 0
 v_mov_b32 v49, 0
 v_mov_b32 v50, 0
 v_mov_b32 v51, 0
 v_mov_b32 v52, 0
 v_mov_b32 v53, 0
 v_mov_b32 v54, 0
 v_mov_b32 v55, 0
 v_mov_b32 v56, 0
 v_mov_b32 v57, 0
 v_mov_b32 v58, 0
 v_mov_b32 v59, 0
 v_mov_b32 v60, 0
 v_mov_b32 v61, 0
 v_mov_b32 v62, 0
 v_mov_b32 v63, 0
 v_mov_b32 v64, 0
 v_mov_b32 v65, 0
 v_mov_b32 v66, 0
 v_mov_b32 v67, 0
 v_mov_b32 v68, 0
 v_mov_b32 v69, 0
 v_mov_b32 v70, 0
 v_mov_b32 v71, 0
 v_mov_b32 v72, 0
 v_mov_b32 v73, 0
 v_mov_b32 v74, 0
 v_mov_b32 v75, 0
 v_mov_b32 v76, 0
 v_mov_b32 v77, 0
 v_mov_b32 v78, 0
 v_mov_b32 v79, 0
 v_mov_b32 v80, 0
 v_mov_b32 v81, 0
 v_mov_b32 v82, 0
 v_mov_b32 v83, 0
 v_mov_b32 v84, 0
 v_mov_b32 v85, 0
 v_mov_b32 v86, 0
 v_mov_b32 v87, 0
 v_mov_b32 v88, 0
 v_mov_b32 v89, 0
 v_mov_b32 v90, 0
 v_mov_b32 v91, 0
 v_mov_b32 v92, 0
 v_mov_b32 v93, 0
 v_mov_b32 v94, 0
 v_mov_b32 v95, 0
 v_mov_b32 v96, 0
 v_mov_b32 v97, 0
 v_mov_b32 v98, 0
 v_mov_b32 v99, 0
 v_mov_b32 v100, 0
 v_mov_b32 v101, 0
 v_mov_b32 v102, 0
 v_mov_b32 v103, 0
 v_mov_b32 v104, 0
 v_mov_b32 v105, 0
 v_mov_b32 v106, 0
 v_mov_b32 v107, 0
 v_mov_b32 v108, 0
 v_mov_b32 v109, 0
 v_mov_b32 v110, 0
 v_mov_b32 v111, 0
 v_mov_b32 v112, 0
 v_mov_b32 v113, 0
 v_mov_b32 v114, 0
 v_mov_b32 v115, 0
 v_mov_b32 v116, 0
 v_mov_b32 v117, 0
 v_mov_b32 v118, 0
 v_mov_b32 v119, 0
 v_mov_b32 v120, 0
 v_mov_b32 v121, 0
 v_mov_b32 v122, 0
 v_mov_b32 v123, 0
 v_mov_b32 v124, 0
 v_mov_b32 v125, 0
 v_mov_b32 v126, 0
 v_mov_b32 v127, 0
 v_mov_b32 v128, 0
 v_mov_b32 v129, 0
 v_mov_b32 v130, 0
 v_mov_b32 v131, 0
 v_mov_b32 v132, 0
 v_mov_b32 v133, 0
 v_mov_b32 v134, 0
 v_mov_b32 v135, 0
 v_mov_b32 v136, 0
 v_mov_b32 v137, 0
 v_mov_b32 v138, 0
 v_mov_b32 v139, 0
 v_mov_b32 v140, 0
 v_mov_b32 v141, 0
 v_mov_b32 v142, 0
 v_mov_b32 v143, 0
 v_mov_b32 v144, 0
 v_mov_b32 v145, 0
 v_mov_b32 v146, 0
 v_mov_b32 v147, 0
 v_mov_b32 v148, 0
 v_mov_b32 v149, 0
 v_mov_b32 v150, 0
 v_mov_b32 v151, 0
 v_mov_b32 v152, 0
 v_mov_b32 v153, 0
 v_mov_b32 v154, 0
 v_mov_b32 v155, 0
 v_mov_b32 v156, 0
 v_mov_b32 v157, 0
 v_mov_b32 v158, 0
 v_mov_b32 v159, 0
 v_mov_b32 v160, 0
 v_mov_b32 v161, 0
 v_mov_b32 v162, 0
 v_mov_b32 v163, 0
 v_mov_b32 v164, 0
 v_mov_b32 v165, 0
 v_mov_b32 v166, 0
 v_mov_b32 v167, 0
 v_mov_b32 v168, 0
 v_mov_b32 v169, 0
 v_mov_b32 v170, 0
 v_mov_b32 v171, 0
 v_mov_b32 v172, 0
 v_mov_b32 v173, 0
 v_mov_b32 v174, 0
 v_mov_b32 v175, 0
 v_mov_b32 v232, 0
 v_mov_b32 v233, 0
 v_mov_b32 v234, 0
 v_mov_b32 v235, 0
 v_mov_b32 v236, 0
 v_mov_b32 v237, 0
 v_mov_b32 v238, 0
 v_mov_b32 v239, 0
 v_mov_b32 v240, 0
 v_mov_b32 v241, 0
 v_mov_b32 v242, 0
 v_mov_b32 v243, 0
 v_mov_b32 v244, 0
 v_mov_b32 v245, 0
 v_mov_b32 v246, 0
 v_mov_b32 v247, 0
 v_mov_b32 v248, 0
 v_mov_b32 v249, 0
 v_mov_b32 v250, 0
 v_mov_b32 v251, 0
 s_lshl_b32 s76, s43, 18
 s_mov_b32 s79, 16
L15_slow_l2:
 s_barrier
 s_add_u32 m0, s92, 67584
 s_nop 0
 buffer_load_dwordx4 v1, s[52:55], s76 offen offset:0 lds
 s_add_u32 m0, s92, 67616
 s_nop 0
 buffer_load_dwordx4 v1, s[52:55], s76 offen offset:1024 lds
 s_add_u32 m0, s92, 67648
 s_nop 0
 buffer_load_dwordx4 v1, s[52:55], s76 offen offset:2048 lds
 s_add_u32 m0, s92, 67680
 s_nop 0
 buffer_load_dwordx4 v1, s[52:55], s76 offen offset:3072 lds
 s_add_u32 m0, s92, 84480
 s_nop 0
 buffer_load_dwordx4 v1, s[56:59], s76 offen offset:0 lds
 s_add_u32 m0, s92, 84512
 s_nop 0
 buffer_load_dwordx4 v1, s[56:59], s76 offen offset:1024 lds
 s_add_u32 m0, s92, 84544
 s_nop 0
 buffer_load_dwordx4 v1, s[56:59], s76 offen offset:2048 lds
 s_add_u32 m0, s92, 84576
 s_nop 0
 buffer_load_dwordx4 v1, s[56:59], s76 offen offset:3072 lds
 s_waitcnt vmcnt(0) lgkmcnt(0)
 s_barrier
 ds_read_b128 a[80:83], v3 offset:0
 ds_read_b128 a[84:87], v3 offset:64
 ds_read_b128 a[88:91], v3 offset:128
 ds_read_b128 a[92:95], v3 offset:192
 ds_read_b128 a[96:99], v3 offset:256
 ds_read_b128 a[100:103], v3 offset:320
 ds_read_b128 a[104:107], v3 offset:384
 ds_read_b128 a[108:111], v3 offset:448
 ds_read_b128 a[112:115], v3 offset:512
 ds_read_b128 a[116:119], v3 offset:576
 ds_read_b128 a[120:123], v3 offset:640
 ds_read_b128 a[124:127], v3 offset:704
 ds_read_b128 a[128:131], v3 offset:768
 ds_read_b128 a[132:135], v3 offset:832
 ds_read_b128 a[136:139], v3 offset:896
 ds_read_b128 a[140:143], v3 offset:960
 rta 144,4,16896
 rta 146,4,17152
 rta 148,4,17408
 rta 150,4,17664
 rta 152,4,16928
 rta 154,4,17184
 rta 156,4,17440
 rta 158,4,17696
 rta 160,4,16960
 rta 162,4,17216
 rta 164,4,17472
 rta 166,4,17728
 rta 168,4,16992
 rta 170,4,17248
 rta 172,4,17504
 rta 174,4,17760
 rta 176,4,17024
 rta 178,4,17280
 rta 180,4,17536
 rta 182,4,17792
 rta 184,4,17056
 rta 186,4,17312
 rta 188,4,17568
 rta 190,4,17824
 rta 192,4,17088
 rta 194,4,17344
 rta 196,4,17600
 rta 198,4,17856
 rta 200,4,17120
 rta 202,4,17376
 rta 204,4,17632
 rta 206,4,17888
 s_waitcnt lgkmcnt(15)
 mvaac 176,80,0,208
 mvaa 176,84,4
 mvaa 176,88,8
 mvaa 176,92,12
 mvaac 180,96,0,208
 mvaa 180,100,4
 mvaa 180,104,8
 mvaa 180,108,12
 mvaac 184,112,0,208
 mvaa 184,116,4
 mvaa 184,120,8
 mvaa 184,124,12
 mvaac 188,128,0,208
 mvaa 188,132,4
 mvaa 188,136,8
 mvaa 188,140,12
 v_exp_f32 v176, v176
 v_exp_f32 v177, v177
 v_exp_f32 v178, v178
 v_exp_f32 v179, v179
 v_exp_f32 v180, v180
 v_exp_f32 v181, v181
 v_exp_f32 v182, v182
 v_exp_f32 v183, v183
 v_exp_f32 v184, v184
 v_exp_f32 v185, v185
 v_exp_f32 v186, v186
 v_exp_f32 v187, v187
 v_exp_f32 v188, v188
 v_exp_f32 v189, v189
 v_exp_f32 v190, v190
 v_exp_f32 v191, v191
 pk 192,176
 pk 193,178
 pk 194,180
 pk 195,182
 pk 196,184
 pk 197,186
 pk 198,188
 pk 199,190
 mvav 16,144,192
 s_nop 0
 mvav 16,148,196
 mvav 20,152,192
 mvav 20,156,196
 mvav 24,160,192
 mvav 24,164,196
 mvav 28,168,192
 mvav 28,172,196
 s_waitcnt lgkmcnt(0)
 mvav 32,176,192
 mvav 32,180,196
 mvav 36,184,192
 mvav 36,188,196
 mvav 40,192,192
 mvav 40,196,196
 mvav 44,200,192
 mvav 44,204,196
 mvav 232,252,192
 mvav 232,252,196
 mvaac 176,80,16,212
 mvaa 176,84,20
 mvaa 176,88,24
 mvaa 176,92,28
 mvaac 180,96,16,212
 mvaa 180,100,20
 mvaa 180,104,24
 mvaa 180,108,28
 mvaac 184,112,16,212
 mvaa 184,116,20
 mvaa 184,120,24
 mvaa 184,124,28
 mvaac 188,128,16,212
 mvaa 188,132,20
 mvaa 188,136,24
 mvaa 188,140,28
 v_exp_f32 v176, v176
 v_exp_f32 v177, v177
 v_exp_f32 v178, v178
 v_exp_f32 v179, v179
 v_exp_f32 v180, v180
 v_exp_f32 v181, v181
 v_exp_f32 v182, v182
 v_exp_f32 v183, v183
 v_exp_f32 v184, v184
 v_exp_f32 v185, v185
 v_exp_f32 v186, v186
 v_exp_f32 v187, v187
 v_exp_f32 v188, v188
 v_exp_f32 v189, v189
 v_exp_f32 v190, v190
 v_exp_f32 v191, v191
 pk 192,176
 pk 193,178
 pk 194,180
 pk 195,182
 pk 196,184
 pk 197,186
 pk 198,188
 pk 199,190
 mvav 48,144,192
 s_nop 0
 mvav 48,148,196
 mvav 52,152,192
 mvav 52,156,196
 mvav 56,160,192
 mvav 56,164,196
 mvav 60,168,192
 mvav 60,172,196
 mvav 64,176,192
 mvav 64,180,196
 mvav 68,184,192
 mvav 68,188,196
 mvav 72,192,192
 mvav 72,196,196
 mvav 76,200,192
 mvav 76,204,196
 mvav 236,252,192
 mvav 236,252,196
 mvaac 176,80,32,216
 mvaa 176,84,36
 mvaa 176,88,40
 mvaa 176,92,44
 mvaac 180,96,32,216
 mvaa 180,100,36
 mvaa 180,104,40
 mvaa 180,108,44
 mvaac 184,112,32,216
 mvaa 184,116,36
 mvaa 184,120,40
 mvaa 184,124,44
 mvaac 188,128,32,216
 mvaa 188,132,36
 mvaa 188,136,40
 mvaa 188,140,44
 v_exp_f32 v176, v176
 v_exp_f32 v177, v177
 v_exp_f32 v178, v178
 v_exp_f32 v179, v179
 v_exp_f32 v180, v180
 v_exp_f32 v181, v181
 v_exp_f32 v182, v182
 v_exp_f32 v183, v183
 v_exp_f32 v184, v184
 v_exp_f32 v185, v185
 v_exp_f32 v186, v186
 v_exp_f32 v187, v187
 v_exp_f32 v188, v188
 v_exp_f32 v189, v189
 v_exp_f32 v190, v190
 v_exp_f32 v191, v191
 pk 192,176
 pk 193,178
 pk 194,180
 pk 195,182
 pk 196,184
 pk 197,186
 pk 198,188
 pk 199,190
 mvav 80,144,192
 s_nop 0
 mvav 80,148,196
 mvav 84,152,192
 mvav 84,156,196
 mvav 88,160,192
 mvav 88,164,196
 mvav 92,168,192
 mvav 92,172,196
 mvav 96,176,192
 mvav 96,180,196
 mvav 100,184,192
 mvav 100,188,196
 mvav 104,192,192
 mvav 104,196,196
 mvav 108,200,192
 mvav 108,204,196
 mvav 240,252,192
 mvav 240,252,196
 mvaac 176,80,48,220
 mvaa 176,84,52
 mvaa 176,88,56
 mvaa 176,92,60
 mvaac 180,96,48,220
 mvaa 180,100,52
 mvaa 180,104,56
 mvaa 180,108,60
 mvaac 184,112,48,220
 mvaa 184,116,52
 mvaa 184,120,56
 mvaa 184,124,60
 mvaac 188,128,48,220
 mvaa 188,132,52
 mvaa 188,136,56
 mvaa 188,140,60
 v_exp_f32 v176, v176
 v_exp_f32 v177, v177
 v_exp_f32 v178, v178
 v_exp_f32 v179, v179
 v_exp_f32 v180, v180
 v_exp_f32 v181, v181
 v_exp_f32 v182, v182
 v_exp_f32 v183, v183
 v_exp_f32 v184, v184
 v_exp_f32 v185, v185
 v_exp_f32 v186, v186
 v_exp_f32 v187, v187
 v_exp_f32 v188, v188
 v_exp_f32 v189, v189
 v_exp_f32 v190, v190
 v_exp_f32 v191, v191
 pk 192,176
 pk 193,178
 pk 194,180
 pk 195,182
 pk 196,184
 pk 197,186
 pk 198,188
 pk 199,190
 mvav 112,144,192
 s_nop 0
 mvav 112,148,196
 mvav 116,152,192
 mvav 116,156,196
 mvav 120,160,192
 mvav 120,164,196
 mvav 124,168,192
 mvav 124,172,196
 mvav 128,176,192
 mvav 128,180,196
 mvav 132,184,192
 mvav 132,188,196
 mvav 136,192,192
 mvav 136,196,196
 mvav 140,200,192
 mvav 140,204,196
 mvav 244,252,192
 mvav 244,252,196
 mvaac 176,80,64,224
 mvaa 176,84,68
 mvaa 176,88,72
 mvaa 176,92,76
 mvaac 180,96,64,224
 mvaa 180,100,68
 mvaa 180,104,72
 mvaa 180,108,76
 mvaac 184,112,64,224
 mvaa 184,116,68
 mvaa 184,120,72
 mvaa 184,124,76
 mvaac 188,128,64,224
 mvaa 188,132,68
 mvaa 188,136,72
 mvaa 188,140,76
 v_exp_f32 v176, v176
 v_exp_f32 v177, v177
 v_exp_f32 v178, v178
 v_exp_f32 v179, v179
 v_exp_f32 v180, v180
 v_exp_f32 v181, v181
 v_exp_f32 v182, v182
 v_exp_f32 v183, v183
 v_exp_f32 v184, v184
 v_exp_f32 v185, v185
 v_exp_f32 v186, v186
 v_exp_f32 v187, v187
 v_exp_f32 v188, v188
 v_exp_f32 v189, v189
 v_exp_f32 v190, v190
 v_exp_f32 v191, v191
 pk 192,176
 pk 193,178
 pk 194,180
 pk 195,182
 pk 196,184
 pk 197,186
 pk 198,188
 pk 199,190
 mvav 144,144,192
 s_nop 0
 mvav 144,148,196
 mvav 148,152,192
 mvav 148,156,196
 mvav 152,160,192
 mvav 152,164,196
 mvav 156,168,192
 mvav 156,172,196
 mvav 160,176,192
 mvav 160,180,196
 mvav 164,184,192
 mvav 164,188,196
 mvav 168,192,192
 mvav 168,196,196
 mvav 172,200,192
 mvav 172,204,196
 mvav 248,252,192
 mvav 248,252,196
 s_waitcnt vmcnt(0) lgkmcnt(0)
 s_add_u32 s76, s76, 16384
 s_sub_u32 s79, s79, 1
 s_cmp_lg_u32 s79, 0
 s_cbranch_scc1 L15_slow_l2
 s_lshr_b32 s3, s87, s43
 s_and_b32 s3, s3, 1
 s_cmp_eq_u32 s3, 0
 s_cbranch_scc1 L15_slow_next
 s_nop 7
 v_rcp_f32 v6, v232
 v_rcp_f32 v7, v236
 v_rcp_f32 v8, v240
 v_rcp_f32 v9, v244
 v_rcp_f32 v10, v248
 v_pk_mul_f32 v[16:17], v[16:17], v[6:7] op_sel_hi:[1,0]
 v_pk_mul_f32 v[18:19], v[18:19], v[6:7] op_sel_hi:[1,0]
 v_pk_mul_f32 v[20:21], v[20:21], v[6:7] op_sel_hi:[1,0]
 v_pk_mul_f32 v[22:23], v[22:23], v[6:7] op_sel_hi:[1,0]
 pk 16,16
 pk 17,18
 pk 18,20
 pk 19,22
 s_add_u32 s86, s90, 0
 buffer_store_dwordx4 v[16:19], v2, s[60:63], s86 offen offset:0 sc1
 v_pk_mul_f32 v[24:25], v[24:25], v[6:7] op_sel_hi:[1,0]
 v_pk_mul_f32 v[26:27], v[26:27], v[6:7] op_sel_hi:[1,0]
 v_pk_mul_f32 v[28:29], v[28:29], v[6:7] op_sel_hi:[1,0]
 v_pk_mul_f32 v[30:31], v[30:31], v[6:7] op_sel_hi:[1,0]
 pk 24,24
 pk 25,26
 pk 26,28
 pk 27,30
 s_add_u32 s86, s90, 4096
 buffer_store_dwordx4 v[24:27], v2, s[60:63], s86 offen offset:1024 sc1
 v_pk_mul_f32 v[32:33], v[32:33], v[6:7] op_sel_hi:[1,0]
 v_pk_mul_f32 v[34:35], v[34:35], v[6:7] op_sel_hi:[1,0]
 v_pk_mul_f32 v[36:37], v[36:37], v[6:7] op_sel_hi:[1,0]
 v_pk_mul_f32 v[38:39], v[38:39], v[6:7] op_sel_hi:[1,0]
 pk 32,32
 pk 33,34
 pk 34,36
 pk 35,38
 s_add_u32 s86, s90, 8192
 buffer_store_dwordx4 v[32:35], v2, s[60:63], s86 offen offset:2048 sc1
 v_pk_mul_f32 v[40:41], v[40:41], v[6:7] op_sel_hi:[1,0]
 v_pk_mul_f32 v[42:43], v[42:43], v[6:7] op_sel_hi:[1,0]
 v_pk_mul_f32 v[44:45], v[44:45], v[6:7] op_sel_hi:[1,0]
 v_pk_mul_f32 v[46:47], v[46:47], v[6:7] op_sel_hi:[1,0]
 pk 40,40
 pk 41,42
 pk 42,44
 pk 43,46
 s_add_u32 s86, s90, 12288
 buffer_store_dwordx4 v[40:43], v2, s[60:63], s86 offen offset:3072 sc1
 v_pk_mul_f32 v[48:49], v[48:49], v[6:7] op_sel:[0,1]
 v_pk_mul_f32 v[50:51], v[50:51], v[6:7] op_sel:[0,1]
 v_pk_mul_f32 v[52:53], v[52:53], v[6:7] op_sel:[0,1]
 v_pk_mul_f32 v[54:55], v[54:55], v[6:7] op_sel:[0,1]
 pk 48,48
 pk 49,50
 pk 50,52
 pk 51,54
 s_add_u32 s86, s90, 0
 buffer_store_dwordx4 v[48:51], v2, s[60:63], s86 offen offset:1024 sc1
 v_pk_mul_f32 v[56:57], v[56:57], v[6:7] op_sel:[0,1]
 v_pk_mul_f32 v[58:59], v[58:59], v[6:7] op_sel:[0,1]
 v_pk_mul_f32 v[60:61], v[60:61], v[6:7] op_sel:[0,1]
 v_pk_mul_f32 v[62:63], v[62:63], v[6:7] op_sel:[0,1]
 pk 56,56
 pk 57,58
 pk 58,60
 pk 59,62
 s_add_u32 s86, s90, 4096
 buffer_store_dwordx4 v[56:59], v2, s[60:63], s86 offen offset:2048 sc1
 v_pk_mul_f32 v[64:65], v[64:65], v[6:7] op_sel:[0,1]
 v_pk_mul_f32 v[66:67], v[66:67], v[6:7] op_sel:[0,1]
 v_pk_mul_f32 v[68:69], v[68:69], v[6:7] op_sel:[0,1]
 v_pk_mul_f32 v[70:71], v[70:71], v[6:7] op_sel:[0,1]
 pk 64,64
 pk 65,66
 pk 66,68
 pk 67,70
 s_add_u32 s86, s90, 8192
 buffer_store_dwordx4 v[64:67], v2, s[60:63], s86 offen offset:3072 sc1
 v_pk_mul_f32 v[72:73], v[72:73], v[6:7] op_sel:[0,1]
 v_pk_mul_f32 v[74:75], v[74:75], v[6:7] op_sel:[0,1]
 v_pk_mul_f32 v[76:77], v[76:77], v[6:7] op_sel:[0,1]
 v_pk_mul_f32 v[78:79], v[78:79], v[6:7] op_sel:[0,1]
 pk 72,72
 pk 73,74
 pk 74,76
 pk 75,78
 s_add_u32 s86, s90, 16384
 buffer_store_dwordx4 v[72:75], v2, s[60:63], s86 offen offset:0 sc1
 v_pk_mul_f32 v[80:81], v[80:81], v[8:9] op_sel_hi:[1,0]
 v_pk_mul_f32 v[82:83], v[82:83], v[8:9] op_sel_hi:[1,0]
 v_pk_mul_f32 v[84:85], v[84:85], v[8:9] op_sel_hi:[1,0]
 v_pk_mul_f32 v[86:87], v[86:87], v[8:9] op_sel_hi:[1,0]
 pk 80,80
 pk 81,82
 pk 82,84
 pk 83,86
 s_add_u32 s86, s90, 0
 buffer_store_dwordx4 v[80:83], v2, s[60:63], s86 offen offset:2048 sc1
 v_pk_mul_f32 v[88:89], v[88:89], v[8:9] op_sel_hi:[1,0]
 v_pk_mul_f32 v[90:91], v[90:91], v[8:9] op_sel_hi:[1,0]
 v_pk_mul_f32 v[92:93], v[92:93], v[8:9] op_sel_hi:[1,0]
 v_pk_mul_f32 v[94:95], v[94:95], v[8:9] op_sel_hi:[1,0]
 pk 88,88
 pk 89,90
 pk 90,92
 pk 91,94
 s_add_u32 s86, s90, 4096
 buffer_store_dwordx4 v[88:91], v2, s[60:63], s86 offen offset:3072 sc1
 v_pk_mul_f32 v[96:97], v[96:97], v[8:9] op_sel_hi:[1,0]
 v_pk_mul_f32 v[98:99], v[98:99], v[8:9] op_sel_hi:[1,0]
 v_pk_mul_f32 v[100:101], v[100:101], v[8:9] op_sel_hi:[1,0]
 v_pk_mul_f32 v[102:103], v[102:103], v[8:9] op_sel_hi:[1,0]
 pk 96,96
 pk 97,98
 pk 98,100
 pk 99,102
 s_add_u32 s86, s90, 12288
 buffer_store_dwordx4 v[96:99], v2, s[60:63], s86 offen offset:0 sc1
 v_pk_mul_f32 v[104:105], v[104:105], v[8:9] op_sel_hi:[1,0]
 v_pk_mul_f32 v[106:107], v[106:107], v[8:9] op_sel_hi:[1,0]
 v_pk_mul_f32 v[108:109], v[108:109], v[8:9] op_sel_hi:[1,0]
 v_pk_mul_f32 v[110:111], v[110:111], v[8:9] op_sel_hi:[1,0]
 pk 104,104
 pk 105,106
 pk 106,108
 pk 107,110
 s_add_u32 s86, s90, 16384
 buffer_store_dwordx4 v[104:107], v2, s[60:63], s86 offen offset:1024 sc1
 v_pk_mul_f32 v[112:113], v[112:113], v[8:9] op_sel:[0,1]
 v_pk_mul_f32 v[114:115], v[114:115], v[8:9] op_sel:[0,1]
 v_pk_mul_f32 v[116:117], v[116:117], v[8:9] op_sel:[0,1]
 v_pk_mul_f32 v[118:119], v[118:119], v[8:9] op_sel:[0,1]
 pk 112,112
 pk 113,114
 pk 114,116
 pk 115,118
 s_add_u32 s86, s90, 0
 buffer_store_dwordx4 v[112:115], v2, s[60:63], s86 offen offset:3072 sc1
 v_pk_mul_f32 v[120:121], v[120:121], v[8:9] op_sel:[0,1]
 v_pk_mul_f32 v[122:123], v[122:123], v[8:9] op_sel:[0,1]
 v_pk_mul_f32 v[124:125], v[124:125], v[8:9] op_sel:[0,1]
 v_pk_mul_f32 v[126:127], v[126:127], v[8:9] op_sel:[0,1]
 pk 120,120
 pk 121,122
 pk 122,124
 pk 123,126
 s_add_u32 s86, s90, 8192
 buffer_store_dwordx4 v[120:123], v2, s[60:63], s86 offen offset:0 sc1
 v_pk_mul_f32 v[128:129], v[128:129], v[8:9] op_sel:[0,1]
 v_pk_mul_f32 v[130:131], v[130:131], v[8:9] op_sel:[0,1]
 v_pk_mul_f32 v[132:133], v[132:133], v[8:9] op_sel:[0,1]
 v_pk_mul_f32 v[134:135], v[134:135], v[8:9] op_sel:[0,1]
 pk 128,128
 pk 129,130
 pk 130,132
 pk 131,134
 s_add_u32 s86, s90, 12288
 buffer_store_dwordx4 v[128:131], v2, s[60:63], s86 offen offset:1024 sc1
 v_pk_mul_f32 v[136:137], v[136:137], v[8:9] op_sel:[0,1]
 v_pk_mul_f32 v[138:139], v[138:139], v[8:9] op_sel:[0,1]
 v_pk_mul_f32 v[140:141], v[140:141], v[8:9] op_sel:[0,1]
 v_pk_mul_f32 v[142:143], v[142:143], v[8:9] op_sel:[0,1]
 pk 136,136
 pk 137,138
 pk 138,140
 pk 139,142
 s_add_u32 s86, s90, 16384
 buffer_store_dwordx4 v[136:139], v2, s[60:63], s86 offen offset:2048 sc1
 v_pk_mul_f32 v[144:145], v[144:145], v[10:11] op_sel_hi:[1,0]
 v_pk_mul_f32 v[146:147], v[146:147], v[10:11] op_sel_hi:[1,0]
 v_pk_mul_f32 v[148:149], v[148:149], v[10:11] op_sel_hi:[1,0]
 v_pk_mul_f32 v[150:151], v[150:151], v[10:11] op_sel_hi:[1,0]
 pk 144,144
 pk 145,146
 pk 146,148
 pk 147,150
 s_add_u32 s86, s90, 4096
 buffer_store_dwordx4 v[144:147], v2, s[60:63], s86 offen offset:0 sc1
 v_pk_mul_f32 v[152:153], v[152:153], v[10:11] op_sel_hi:[1,0]
 v_pk_mul_f32 v[154:155], v[154:155], v[10:11] op_sel_hi:[1,0]
 v_pk_mul_f32 v[156:157], v[156:157], v[10:11] op_sel_hi:[1,0]
 v_pk_mul_f32 v[158:159], v[158:159], v[10:11] op_sel_hi:[1,0]
 pk 152,152
 pk 153,154
 pk 154,156
 pk 155,158
 s_add_u32 s86, s90, 8192
 buffer_store_dwordx4 v[152:155], v2, s[60:63], s86 offen offset:1024 sc1
 v_pk_mul_f32 v[160:161], v[160:161], v[10:11] op_sel_hi:[1,0]
 v_pk_mul_f32 v[162:163], v[162:163], v[10:11] op_sel_hi:[1,0]
 v_pk_mul_f32 v[164:165], v[164:165], v[10:11] op_sel_hi:[1,0]
 v_pk_mul_f32 v[166:167], v[166:167], v[10:11] op_sel_hi:[1,0]
 pk 160,160
 pk 161,162
 pk 162,164
 pk 163,166
 s_add_u32 s86, s90, 12288
 buffer_store_dwordx4 v[160:163], v2, s[60:63], s86 offen offset:2048 sc1
 v_pk_mul_f32 v[168:169], v[168:169], v[10:11] op_sel_hi:[1,0]
 v_pk_mul_f32 v[170:171], v[170:171], v[10:11] op_sel_hi:[1,0]
 v_pk_mul_f32 v[172:173], v[172:173], v[10:11] op_sel_hi:[1,0]
 v_pk_mul_f32 v[174:175], v[174:175], v[10:11] op_sel_hi:[1,0]
 pk 168,168
 pk 169,170
 pk 170,172
 pk 171,174
 s_add_u32 s86, s90, 16384
 buffer_store_dwordx4 v[168:171], v2, s[60:63], s86 offen offset:3072 sc1
L15_slow_next:
 s_waitcnt vmcnt(0) lgkmcnt(0)
 s_nop 7
 s_add_u32 s43, s43, 1
 s_cmp_lt_u32 s43, 2
 s_cbranch_scc1 L15_slow_head
 s_barrier
 s_add_u32 m0, s92, 67584
 s_xor_b32 s83, s9, 0
 s_mul_i32 s83, s83, 131072
 buffer_load_dwordx4 v11, s[68:71], s83 offen offset:0 lds
 s_add_u32 m0, s92, 67616
 s_nop 0
 buffer_load_dwordx4 v11, s[68:71], s83 offen offset:1024 lds
 s_add_u32 m0, s92, 67648
 s_nop 0
 buffer_load_dwordx4 v11, s[68:71], s83 offen offset:2048 lds
 s_add_u32 m0, s92, 67680
 s_nop 0
 buffer_load_dwordx4 v11, s[68:71], s83 offen offset:3072 lds
 s_add_u32 m0, s92, 84480
 s_add_u32 s83, s83, 65536
 buffer_load_dwordx4 v11, s[68:71], s83 offen offset:0 lds
 s_add_u32 m0, s92, 84512
 s_nop 0
 buffer_load_dwordx4 v11, s[68:71], s83 offen offset:1024 lds
 s_add_u32 m0, s92, 84544
 s_nop 0
 buffer_load_dwordx4 v11, s[68:71], s83 offen offset:2048 lds
 s_add_u32 m0, s92, 84576
 s_nop 0
 buffer_load_dwordx4 v11, s[68:71], s83 offen offset:3072 lds
 s_add_u32 m0, s92, 101376
 s_xor_b32 s83, s9, 1
 s_mul_i32 s83, s83, 131072
 buffer_load_dwordx4 v11, s[68:71], s83 offen offset:0 lds
 s_add_u32 m0, s92, 101408
 s_nop 0
 buffer_load_dwordx4 v11, s[68:71], s83 offen offset:1024 lds
 s_add_u32 m0, s92, 101440
 s_nop 0
 buffer_load_dwordx4 v11, s[68:71], s83 offen offset:2048 lds
 s_add_u32 m0, s92, 101472
 s_nop 0
 buffer_load_dwordx4 v11, s[68:71], s83 offen offset:3072 lds
 s_add_u32 m0, s92, 118272
 s_add_u32 s83, s83, 65536
 buffer_load_dwordx4 v11, s[68:71], s83 offen offset:0 lds
 s_add_u32 m0, s92, 118304
 s_nop 0
 buffer_load_dwordx4 v11, s[68:71], s83 offen offset:1024 lds
 s_add_u32 m0, s92, 118336
 s_nop 0
 buffer_load_dwordx4 v11, s[68:71], s83 offen offset:2048 lds
 s_add_u32 m0, s92, 118368
 s_nop 0
 buffer_load_dwordx4 v11, s[68:71], s83 offen offset:3072 lds
 s_add_u32 m0, s92, 0
 s_xor_b32 s83, s9, 2
 s_mul_i32 s83, s83, 131072
 buffer_load_dwordx4 v11, s[68:71], s83 offen offset:0 lds
 s_add_u32 m0, s92, 32
 s_nop 0
 buffer_load_dwordx4 v11, s[68:71], s83 offen offset:1024 lds
 s_add_u32 m0, s92, 64
 s_nop 0
 buffer_load_dwordx4 v11, s[68:71], s83 offen offset:2048 lds
 s_add_u32 m0, s92, 96
 s_nop 0
 buffer_load_dwordx4 v11, s[68:71], s83 offen offset:3072 lds
 s_add_u32 m0, s92, 16896
 s_add_u32 s83, s83, 65536
 buffer_load_dwordx4 v11, s[68:71], s83 offen offset:0 lds
 s_add_u32 m0, s92, 16928
 s_nop 0
 buffer_load_dwordx4 v11, s[68:71], s83 offen offset:1024 lds
 s_add_u32 m0, s92, 16960
 s_nop 0
 buffer_load_dwordx4 v11, s[68:71], s83 offen offset:2048 lds
 s_add_u32 m0, s92, 16992
 s_nop 0
 buffer_load_dwordx4 v11, s[68:71], s83 offen offset:3072 lds
 s_add_u32 m0, s92, 33792
 s_xor_b32 s83, s9, 4
 s_mul_i32 s83, s83, 131072
 buffer_load_dwordx4 v11, s[68:71], s83 offen offset:0 lds
 s_add_u32 m0, s92, 33824
 s_nop 0
 buffer_load_dwordx4 v11, s[68:71], s83 offen offset:1024 lds
 s_add_u32 m0, s92, 33856
 s_nop 0
 buffer_load_dwordx4 v11, s[68:71], s83 offen offset:2048 lds
 s_add_u32 m0, s92, 33888
 s_nop 0
 buffer_load_dwordx4 v11, s[68:71], s83 offen offset:3072 lds
 s_add_u32 m0, s92, 50688
 s_add_u32 s83, s83, 65536
 buffer_load_dwordx4 v11, s[68:71], s83 offen offset:0 lds
 s_add_u32 m0, s92, 50720
 s_nop 0
 buffer_load_dwordx4 v11, s[68:71], s83 offen offset:1024 lds
 s_add_u32 m0, s92, 50752
 s_nop 0
 buffer_load_dwordx4 v11, s[68:71], s83 offen offset:2048 lds
 s_add_u32 m0, s92, 50784
 s_nop 0
 buffer_load_dwordx4 v11, s[68:71], s83 offen offset:3072 lds
 s_mov_b32 s86, 0
 buffer_load_dwordx4 a[160:163], v2, s[60:63], s86 offen offset:0 sc1
 s_mov_b32 s86, 20480
 buffer_load_dwordx4 v[176:179], v2, s[60:63], s86 offen offset:0 sc1
 s_waitcnt vmcnt(0)
 v_lshlrev_b32 v16, 16, v176
 v_and_b32 v17, 0xffff0000, v176
 v_lshlrev_b32 v18, 16, v177
 v_and_b32 v19, 0xffff0000, v177
 v_lshlrev_b32 v20, 16, v178
 v_and_b32 v21, 0xffff0000, v178
 v_lshlrev_b32 v22, 16, v179
 v_and_b32 v23, 0xffff0000, v179
 s_mov_b32 s86, 0
 buffer_load_dwordx4 a[164:167], v2, s[60:63], s86 offen offset:1024 sc1
 s_mov_b32 s86, 20480
 buffer_load_dwordx4 v[176:179], v2, s[60:63], s86 offen offset:1024 sc1
 s_waitcnt vmcnt(0)
 v_lshlrev_b32 v48, 16, v176
 v_and_b32 v49, 0xffff0000, v176
 v_lshlrev_b32 v50, 16, v177
 v_and_b32 v51, 0xffff0000, v177
 v_lshlrev_b32 v52, 16, v178
 v_and_b32 v53, 0xffff0000, v178
 v_lshlrev_b32 v54, 16, v179
 v_and_b32 v55, 0xffff0000, v179
 s_mov_b32 s86, 0
 buffer_load_dwordx4 a[168:171], v2, s[60:63], s86 offen offset:2048 sc1
 s_mov_b32 s86, 20480
 buffer_load_dwordx4 v[176:179], v2, s[60:63], s86 offen offset:2048 sc1
 s_waitcnt vmcnt(0)
 v_lshlrev_b32 v80, 16, v176
 v_and_b32 v81, 0xffff0000, v176
 v_lshlrev_b32 v82, 16, v177
 v_and_b32 v83, 0xffff0000, v177
 v_lshlrev_b32 v84, 16, v178
 v_and_b32 v85, 0xffff0000, v178
 v_lshlrev_b32 v86, 16, v179
 v_and_b32 v87, 0xffff0000, v179
 s_mov_b32 s86, 0
 buffer_load_dwordx4 a[172:175], v2, s[60:63], s86 offen offset:3072 sc1
 s_mov_b32 s86, 20480
 buffer_load_dwordx4 v[176:179], v2, s[60:63], s86 offen offset:3072 sc1
 s_waitcnt vmcnt(0)
 v_lshlrev_b32 v112, 16, v176
 v_and_b32 v113, 0xffff0000, v176
 v_lshlrev_b32 v114, 16, v177
 v_and_b32 v115, 0xffff0000, v177
 v_lshlrev_b32 v116, 16, v178
 v_and_b32 v117, 0xffff0000, v178
 v_lshlrev_b32 v118, 16, v179
 v_and_b32 v119, 0xffff0000, v179
 s_mov_b32 s86, 4096
 buffer_load_dwordx4 a[176:179], v2, s[60:63], s86 offen offset:0 sc1
 s_mov_b32 s86, 24576
 buffer_load_dwordx4 v[176:179], v2, s[60:63], s86 offen offset:0 sc1
 s_waitcnt vmcnt(0)
 v_lshlrev_b32 v144, 16, v176
 v_and_b32 v145, 0xffff0000, v176
 v_lshlrev_b32 v146, 16, v177
 v_and_b32 v147, 0xffff0000, v177
 v_lshlrev_b32 v148, 16, v178
 v_and_b32 v149, 0xffff0000, v178
 v_lshlrev_b32 v150, 16, v179
 v_and_b32 v151, 0xffff0000, v179
 s_mov_b32 s86, 4096
 buffer_load_dwordx4 v[240:243], v2, s[60:63], s86 offen offset:1024 sc1
 s_mov_b32 s86, 24576
 buffer_load_dwordx4 v[176:179], v2, s[60:63], s86 offen offset:1024 sc1
 s_waitcnt vmcnt(0)
 v_lshlrev_b32 v24, 16, v176
 v_and_b32 v25, 0xffff0000, v176
 v_lshlrev_b32 v26, 16, v177
 v_and_b32 v27, 0xffff0000, v177
 v_lshlrev_b32 v28, 16, v178
 v_and_b32 v29, 0xffff0000, v178
 v_lshlrev_b32 v30, 16, v179
 v_and_b32 v31, 0xffff0000, v179
 s_mov_b32 s86, 4096
 buffer_load_dwordx4 v[244:247], v2, s[60:63], s86 offen offset:2048 sc1
 s_mov_b32 s86, 24576
 buffer_load_dwordx4 v[176:179], v2, s[60:63], s86 offen offset:2048 sc1
 s_waitcnt vmcnt(0)
 v_lshlrev_b32 v56, 16, v176
 v_and_b32 v57, 0xffff0000, v176
 v_lshlrev_b32 v58, 16, v177
 v_and_b32 v59, 0xffff0000, v177
 v_lshlrev_b32 v60, 16, v178
 v_and_b32 v61, 0xffff0000, v178
 v_lshlrev_b32 v62, 16, v179
 v_and_b32 v63, 0xffff0000, v179
 s_mov_b32 s86, 4096
 buffer_load_dwordx4 v[248:251], v2, s[60:63], s86 offen offset:3072 sc1
 s_mov_b32 s86, 24576
 buffer_load_dwordx4 v[176:179], v2, s[60:63], s86 offen offset:3072 sc1
 s_waitcnt vmcnt(0)
 v_lshlrev_b32 v88, 16, v176
 v_and_b32 v89, 0xffff0000, v176
 v_lshlrev_b32 v90, 16, v177
 v_and_b32 v91, 0xffff0000, v177
 v_lshlrev_b32 v92, 16, v178
 v_and_b32 v93, 0xffff0000, v178
 v_lshlrev_b32 v94, 16, v179
 v_and_b32 v95, 0xffff0000, v179
 s_mov_b32 s86, 8192
 buffer_load_dwordx4 v[228:231], v2, s[60:63], s86 offen offset:0 sc1
 s_mov_b32 s86, 28672
 buffer_load_dwordx4 v[176:179], v2, s[60:63], s86 offen offset:0 sc1
 s_waitcnt vmcnt(0)
 v_lshlrev_b32 v120, 16, v176
 v_and_b32 v121, 0xffff0000, v176
 v_lshlrev_b32 v122, 16, v177
 v_and_b32 v123, 0xffff0000, v177
 v_lshlrev_b32 v124, 16, v178
 v_and_b32 v125, 0xffff0000, v178
 v_lshlrev_b32 v126, 16, v179
 v_and_b32 v127, 0xffff0000, v179
 s_mov_b32 s86, 8192
 buffer_load_dwordx4 v[232:235], v2, s[60:63], s86 offen offset:1024 sc1
 s_mov_b32 s86, 28672
 buffer_load_dwordx4 v[176:179], v2, s[60:63], s86 offen offset:1024 sc1
 s_waitcnt vmcnt(0)
 v_lshlrev_b32 v152, 16, v176
 v_and_b32 v153, 0xffff0000, v176
 v_lshlrev_b32 v154, 16, v177
 v_and_b32 v155, 0xffff0000, v177
 v_lshlrev_b32 v156, 16, v178
 v_and_b32 v157, 0xffff0000, v178
 v_lshlrev_b32 v158, 16, v179
 v_and_b32 v159, 0xffff0000, v179
 s_mov_b32 s86, 8192
 buffer_load_dwordx4 v[236:239], v2, s[60:63], s86 offen offset:2048 sc1
 s_mov_b32 s86, 28672
 buffer_load_dwordx4 v[176:179], v2, s[60:63], s86 offen offset:2048 sc1
 s_waitcnt vmcnt(0)
 v_lshlrev_b32 v32, 16, v176
 v_and_b32 v33, 0xffff0000, v176
 v_lshlrev_b32 v34, 16, v177
 v_and_b32 v35, 0xffff0000, v177
 v_lshlrev_b32 v36, 16, v178
 v_and_b32 v37, 0xffff0000, v178
 v_lshlrev_b32 v38, 16, v179
 v_and_b32 v39, 0xffff0000, v179
 s_mov_b32 s86, 8192
 buffer_load_dwordx4 a[220:223], v2, s[60:63], s86 offen offset:3072 sc1
 s_mov_b32 s86, 28672
 buffer_load_dwordx4 v[176:179], v2, s[60:63], s86 offen offset:3072 sc1
 s_waitcnt vmcnt(0)
 v_lshlrev_b32 v64, 16, v176
 v_and_b32 v65, 0xffff0000, v176
 v_lshlrev_b32 v66, 16, v177
 v_and_b32 v67, 0xffff0000, v177
 v_lshlrev_b32 v68, 16, v178
 v_and_b32 v69, 0xffff0000, v178
 v_lshlrev_b32 v70, 16, v179
 v_and_b32 v71, 0xffff0000, v179
 s_mov_b32 s86, 12288
 buffer_load_dwordx4 a[224:227], v2, s[60:63], s86 offen offset:0 sc1
 s_mov_b32 s86, 32768
 buffer_load_dwordx4 v[176:179], v2, s[60:63], s86 offen offset:0 sc1
 s_waitcnt vmcnt(0)
 v_lshlrev_b32 v96, 16, v176
 v_and_b32 v97, 0xffff0000, v176
 v_lshlrev_b32 v98, 16, v177
 v_and_b32 v99, 0xffff0000, v177
 v_lshlrev_b32 v100, 16, v178
 v_and_b32 v101, 0xffff0000, v178
 v_lshlrev_b32 v102, 16, v179
 v_and_b32 v103, 0xffff0000, v179
 s_mov_b32 s86, 12288
 buffer_load_dwordx4 a[228:231], v2, s[60:63], s86 offen offset:1024 sc1
 s_mov_b32 s86, 32768
 buffer_load_dwordx4 v[176:179], v2, s[60:63], s86 offen offset:1024 sc1
 s_waitcnt vmcnt(0)
 v_lshlrev_b32 v128, 16, v176
 v_and_b32 v129, 0xffff0000, v176
 v_lshlrev_b32 v130, 16, v177
 v_and_b32 v131, 0xffff0000, v177
 v_lshlrev_b32 v132, 16, v178
 v_and_b32 v133, 0xffff0000, v178
 v_lshlrev_b32 v134, 16, v179
 v_and_b32 v135, 0xffff0000, v179
 s_mov_b32 s86, 12288
 buffer_load_dwordx4 a[232:235], v2, s[60:63], s86 offen offset:2048 sc1
 s_mov_b32 s86, 32768
 buffer_load_dwordx4 v[176:179], v2, s[60:63], s86 offen offset:2048 sc1
 s_waitcnt vmcnt(0)
 v_lshlrev_b32 v160, 16, v176
 v_and_b32 v161, 0xffff0000, v176
 v_lshlrev_b32 v162, 16, v177
 v_and_b32 v163, 0xffff0000, v177
 v_lshlrev_b32 v164, 16, v178
 v_and_b32 v165, 0xffff0000, v178
 v_lshlrev_b32 v166, 16, v179
 v_and_b32 v167, 0xffff0000, v179
 s_mov_b32 s86, 12288
 buffer_load_dwordx4 a[236:239], v2, s[60:63], s86 offen offset:3072 sc1
 s_mov_b32 s86, 32768
 buffer_load_dwordx4 v[176:179], v2, s[60:63], s86 offen offset:3072 sc1
 s_waitcnt vmcnt(0)
 v_lshlrev_b32 v40, 16, v176
 v_and_b32 v41, 0xffff0000, v176
 v_lshlrev_b32 v42, 16, v177
 v_and_b32 v43, 0xffff0000, v177
 v_lshlrev_b32 v44, 16, v178
 v_and_b32 v45, 0xffff0000, v178
 v_lshlrev_b32 v46, 16, v179
 v_and_b32 v47, 0xffff0000, v179
 s_mov_b32 s86, 16384
 buffer_load_dwordx4 a[240:243], v2, s[60:63], s86 offen offset:0 sc1
 s_mov_b32 s86, 36864
 buffer_load_dwordx4 v[176:179], v2, s[60:63], s86 offen offset:0 sc1
 s_waitcnt vmcnt(0)
 v_lshlrev_b32 v72, 16, v176
 v_and_b32 v73, 0xffff0000, v176
 v_lshlrev_b32 v74, 16, v177
 v_and_b32 v75, 0xffff0000, v177
 v_lshlrev_b32 v76, 16, v178
 v_and_b32 v77, 0xffff0000, v178
 v_lshlrev_b32 v78, 16, v179
 v_and_b32 v79, 0xffff0000, v179
 s_mov_b32 s86, 16384
 buffer_load_dwordx4 a[244:247], v2, s[60:63], s86 offen offset:1024 sc1
 s_mov_b32 s86, 36864
 buffer_load_dwordx4 v[176:179], v2, s[60:63], s86 offen offset:1024 sc1
 s_waitcnt vmcnt(0)
 v_lshlrev_b32 v104, 16, v176
 v_and_b32 v105, 0xffff0000, v176
 v_lshlrev_b32 v106, 16, v177
 v_and_b32 v107, 0xffff0000, v177
 v_lshlrev_b32 v108, 16, v178
 v_and_b32 v109, 0xffff0000, v178
 v_lshlrev_b32 v110, 16, v179
 v_and_b32 v111, 0xffff0000, v179
 s_mov_b32 s86, 16384
 buffer_load_dwordx4 a[248:251], v2, s[60:63], s86 offen offset:2048 sc1
 s_mov_b32 s86, 36864
 buffer_load_dwordx4 v[176:179], v2, s[60:63], s86 offen offset:2048 sc1
 s_waitcnt vmcnt(0)
 v_lshlrev_b32 v136, 16, v176
 v_and_b32 v137, 0xffff0000, v176
 v_lshlrev_b32 v138, 16, v177
 v_and_b32 v139, 0xffff0000, v177
 v_lshlrev_b32 v140, 16, v178
 v_and_b32 v141, 0xffff0000, v178
 v_lshlrev_b32 v142, 16, v179
 v_and_b32 v143, 0xffff0000, v179
 s_mov_b32 s86, 16384
 buffer_load_dwordx4 a[252:255], v2, s[60:63], s86 offen offset:3072 sc1
 s_mov_b32 s86, 36864
 buffer_load_dwordx4 v[176:179], v2, s[60:63], s86 offen offset:3072 sc1
 s_waitcnt vmcnt(0)
 v_lshlrev_b32 v168, 16, v176
 v_and_b32 v169, 0xffff0000, v176
 v_lshlrev_b32 v170, 16, v177
 v_and_b32 v171, 0xffff0000, v177
 v_lshlrev_b32 v172, 16, v178
 v_and_b32 v173, 0xffff0000, v178
 v_lshlrev_b32 v174, 16, v179
 v_and_b32 v175, 0xffff0000, v179
 v_mov_b32 v6, 1.0
 v_mov_b32 v7, 1.0
 v_mov_b32 v8, 1.0
 v_mov_b32 v9, 1.0
 v_mov_b32 v10, 1.0
 v_mov_b32 v14, 1
 s_lshl_b32 s3, s9, 6
 s_mov_b64 exec, 7
 buffer_store_dword v14, v0, s[44:47], s3 offen sc1
 s_mov_b64 exec, -1
 s_mov_b32 s87, 0
 s_mov_b32 s79, 0x40000
L15_sp1b:
 s_sub_u32 s79, s79, 1
 s_cbranch_scc1 L15_sp1b_end
 s_sleep 4
 buffer_load_dword v13, off, s[28:31], s85 sc1
 s_waitcnt vmcnt(0)
 v_cmp_ne_u32 vcc, 65535, v13
 s_nop 1
 s_and_b64 vcc, vcc, 1
 s_cbranch_scc1 L15_sp1b
L15_sp1b_end:
 s_waitcnt vmcnt(0) lgkmcnt(0)
 s_barrier
 s_branch L15_op
L_path4:
 s_add_u32 m0, s80, 0
 s_add_u32 s81, s82, 0
 s_and_b32 s81, s81, 0x380
 buffer_load_dwordx4 v7, s[44:47], s81 offen lds
 s_add_u32 m0, s80, 1024
 s_nop 0
 buffer_load_dwordx4 v8, s[44:47], s81 offen lds
 s_add_u32 m0, s80, 2048
 s_add_u32 s81, s81, 16384
 buffer_load_dwordx4 v7, s[44:47], s81 offen lds
 s_add_u32 m0, s80, 3072
 s_nop 0
 buffer_load_dwordx4 v8, s[44:47], s81 offen lds
 s_add_u32 m0, s80, 4096
 s_add_u32 s81, s81, 16384
 buffer_load_dwordx4 v7, s[44:47], s81 offen lds
 s_add_u32 m0, s80, 5120
 s_nop 0
 buffer_load_dwordx4 v8, s[44:47], s81 offen lds
 s_add_u32 m0, s80, 6144
 s_add_u32 s81, s81, 16384
 buffer_load_dwordx4 v7, s[44:47], s81 offen lds
 s_add_u32 m0, s80, 7168
 s_nop 0
 buffer_load_dwordx4 v8, s[44:47], s81 offen lds
 s_add_u32 m0, s92, 0
 s_add_u32 s86, s83, 256
 s_and_b32 s86, s86, 0x3fffff
 buffer_load_dwordx4 v6, s[48:51], s86 offen lds
 s_add_u32 m0, s92, 1056
 s_add_u32 s86, s86, 8192
 buffer_load_dwordx4 v6, s[48:51], s86 offen lds
 s_add_u32 m0, s92, 2112
 s_add_u32 s86, s86, 8192
 buffer_load_dwordx4 v6, s[48:51], s86 offen lds
 s_add_u32 m0, s92, 3168
 s_add_u32 s86, s86, 8192
 buffer_load_dwordx4 v6, s[48:51], s86 offen lds
 s_add_u32 m0, s92, 16896
 s_add_u32 s86, s83, 0
 s_and_b32 s86, s86, 0x3fffff
 buffer_load_dwordx4 v6, s[48:51], s86 offen lds
 s_add_u32 m0, s92, 17952
 s_add_u32 s86, s86, 8192
 buffer_load_dwordx4 v6, s[48:51], s86 offen lds
 s_add_u32 m0, s92, 19008
 s_add_u32 s86, s86, 8192
 buffer_load_dwordx4 v6, s[48:51], s86 offen lds
 s_add_u32 m0, s92, 20064
 s_add_u32 s86, s86, 8192
 buffer_load_dwordx4 v6, s[48:51], s86 offen lds
 v_lshlrev_b32 v2, 4, v0
 v_lshl_add_u32 v1, v20, 12, v2
 v_mov_b32 v12, v1
 v_lshl_add_u32 v13, v14, 2, v20
 v_lshl_add_u32 v11, v13, 12, v15
 v_mul_u32_u24 v13, 66, v15
 v_lshl_add_u32 v13, v14, 4, v13
 v_add_u32 v3, 67584, v13
 v_and_b32 v16, 14, v0
 v_lshlrev_b32 v16, 1, v16
 v_bfe_u32 v16, s3, v16, 3
 v_lshlrev_b32 v17, 1, v14
 v_xor_b32 v16, v16, v17
 v_lshlrev_b32 v16, 4, v16
 v_lshl_add_u32 v16, v15, 3, v16
 v_add_u32 v9, s80, v16
 v_xor_b32 v10, 16, v9
 v_lshrrev_b32 v13, 2, v0
 v_mul_u32_u24 v13, 1056, v13
 v_and_b32 v16, 3, v0
 v_lshl_add_u32 v5, v16, 4, v13
 v_lshl_add_u32 v13, v16, 3, v13
 v_add_u32 v4, 67584, v13
 v_lshlrev_b32 v0, 2, v0
 s_waitcnt vmcnt(8)
 ds_read_b128 a[0:3], v9 offset:0
 ds_read_b128 a[4:7], v10 offset:0
 ds_read_b128 a[8:11], v9 offset:2048
 ds_read_b128 a[12:15], v10 offset:2048
 ds_read_b128 a[16:19], v9 offset:4096
 ds_read_b128 a[20:23], v10 offset:4096
 ds_read_b128 a[24:27], v9 offset:6144
 ds_read_b128 a[28:31], v10 offset:6144
 s_waitcnt vmcnt(4) lgkmcnt(0)
 s_barrier
 rta 176,5,0
 rta 178,5,256
 rta 180,5,512
 rta 182,5,768
 rta 184,5,8
 rta 186,5,264
 rta 188,5,520
 rta 190,5,776
 s_waitcnt lgkmcnt(6)
 mvaaz 176,176,0
 s_waitcnt lgkmcnt(4)
 rta 192,5,64
 mvaa 176,180,4
 rta 194,5,320
 mvaaz 208,180,12
 rta 196,5,576
 mvaa 208,176,8
 rta 198,5,832
 maaaz 80,176,16
 s_add_u32 m0, s80, 38912
 s_add_u32 s81, s82, 128
 s_and_b32 s81, s81, 0x380
 maaa 80,180,20
 buffer_load_dwordx4 v7, s[44:47], s81 offen lds
 maaaz 112,180,28
 s_add_u32 m0, s80, 39936
 maaa 112,176,24
 s_waitcnt lgkmcnt(6)
 buffer_load_dwordx4 v8, s[44:47], s81 offen lds
 maaaz 116,184,24
 s_waitcnt lgkmcnt(4)
 rta 200,5,72
 maaa 116,188,28
 rta 202,5,328
 maaaz 84,188,20
 rta 204,5,584
 maaa 84,184,16
 rta 206,5,840
 mvaaz 212,184,8
 s_add_u32 m0, s80, 40960
 s_add_u32 s81, s81, 16384
 mvaa 212,188,12
 buffer_load_dwordx4 v7, s[44:47], s81 offen lds
 mvaaz 180,188,4
 s_add_u32 m0, s80, 41984
 mvaa 180,184,0
 s_waitcnt lgkmcnt(4)
 buffer_load_dwordx4 v8, s[44:47], s81 offen lds
 mvaaz 184,192,0
 rta 176,5,128
 mvaa 184,196,4
 rta 178,5,384
 mvaaz 216,196,12
 rta 180,5,640
 mvaa 216,192,8
 rta 182,5,896
 maaaz 88,192,16
 s_add_u32 m0, s80, 43008
 s_add_u32 s81, s81, 16384
 maaa 88,196,20
 buffer_load_dwordx4 v7, s[44:47], s81 offen lds
 maaaz 120,196,28
 s_add_u32 m0, s80, 44032
 maaa 120,192,24
 s_waitcnt lgkmcnt(4)
 buffer_load_dwordx4 v8, s[44:47], s81 offen lds
 maaaz 124,200,24
 rta 184,5,136
 maaa 124,204,28
 rta 186,5,392
 maaaz 92,204,20
 rta 188,5,648
 maaa 92,200,16
 rta 190,5,904
 mvaaz 220,200,8
 s_add_u32 m0, s80, 45056
 s_add_u32 s81, s81, 16384
 mvaa 220,204,12
 buffer_load_dwordx4 v7, s[44:47], s81 offen lds
 mvaaz 188,204,4
 s_add_u32 m0, s80, 46080
 mvaa 188,200,0
 s_waitcnt lgkmcnt(4)
 buffer_load_dwordx4 v8, s[44:47], s81 offen lds
 mvaaz 192,176,0
 rta 192,5,192
 mvaa 192,180,4
 rta 194,5,448
 mvaaz 224,180,12
 rta 196,5,704
 mvaa 224,176,8
 rta 198,5,960
 maaaz 96,176,16
 s_add_u32 m0, s92, 33792
 s_add_u32 s86, s83, 524544
 s_and_b32 s86, s86, 0x3fffff
 maaa 96,180,20
 buffer_load_dwordx4 v6, s[48:51], s86 offen lds
 maaaz 128,180,28
 s_add_u32 m0, s92, 34848
 s_add_u32 s86, s86, 8192
 maaa 128,176,24
 s_waitcnt lgkmcnt(4)
 buffer_load_dwordx4 v6, s[48:51], s86 offen lds
 maaaz 132,184,24
 rta 200,5,200
 maaa 132,188,28
 rta 202,5,456
 maaaz 100,188,20
 rta 204,5,712
 maaa 100,184,16
 rta 206,5,968
 mvaaz 228,184,8
 s_add_u32 m0, s92, 35904
 s_add_u32 s86, s86, 8192
 mvaa 228,188,12
 buffer_load_dwordx4 v6, s[48:51], s86 offen lds
 mvaaz 196,188,4
 s_add_u32 m0, s92, 36960
 s_add_u32 s86, s86, 8192
 mvaa 196,184,0
 s_waitcnt lgkmcnt(4)
 buffer_load_dwordx4 v6, s[48:51], s86 offen lds
 mvaaz 200,192,0
 s_waitcnt vmcnt(12) lgkmcnt(0)
 s_barrier
 mvaa 200,196,4
 rta 176,5,16896
 mvaaz 232,196,12
 rta 178,5,17152
 mvaa 232,192,8
 rta 180,5,17408
 maaaz 104,192,16
 rta 182,5,17664
 maaa 104,196,20
 maaaz 136,196,28
 maaa 136,192,24
 maaaz 140,200,24
 rta 184,5,16904
 maaa 140,204,28
 rta 186,5,17160
 maaaz 108,204,20
 rta 188,5,17416
 maaa 108,200,16
 rta 190,5,17672
 mvaaz 236,200,8
 mvaa 236,204,12
 mvaaz 204,204,4
 mvaa 204,200,0
 s_waitcnt lgkmcnt(4)
 mvaaz 16,176,0
 rta 192,5,16960
 mvaa 16,180,4
 rta 194,5,17216
 mvaaz 48,180,12
 rta 196,5,17472
 mvaa 48,176,8
 rta 198,5,17728
 mvaaz 80,176,16
 s_add_u32 m0, s92, 50688
 s_add_u32 s86, s83, 524288
 s_and_b32 s86, s86, 0x3fffff
 mvaa 80,180,20
 buffer_load_dwordx4 v6, s[48:51], s86 offen lds
 mvaaz 112,180,28
 s_add_u32 m0, s92, 51744
 s_add_u32 s86, s86, 8192
 mvaa 112,176,24
 s_waitcnt lgkmcnt(4)
 buffer_load_dwordx4 v6, s[48:51], s86 offen lds
 mvaaz 116,184,24
 rta 200,5,16968
 mvaa 116,188,28
 rta 202,5,17224
 mvaaz 84,188,20
 rta 204,5,17480
 mvaa 84,184,16
 rta 206,5,17736
 mvaaz 52,184,8
 s_add_u32 m0, s92, 52800
 s_add_u32 s86, s86, 8192
 mvaa 52,188,12
 buffer_load_dwordx4 v6, s[48:51], s86 offen lds
 mvaaz 20,188,4
 s_add_u32 m0, s92, 53856
 s_add_u32 s86, s86, 8192
 mvaa 20,184,0
 s_waitcnt lgkmcnt(4)
 buffer_load_dwordx4 v6, s[48:51], s86 offen lds
 mvaaz 24,192,0
 rta 176,5,17024
 mvaa 24,196,4
 rta 178,5,17280
 mvaaz 56,196,12
 rta 180,5,17536
 mvaa 56,192,8
 rta 182,5,17792
 mvaaz 88,192,16
 s_add_u32 m0, s80, 0
 s_add_u32 s81, s82, 256
 s_and_b32 s81, s81, 0x380
 mvaa 88,196,20
 buffer_load_dwordx4 v7, s[44:47], s81 offen lds
 mvaaz 120,196,28
 s_add_u32 m0, s80, 1024
 mvaa 120,192,24
 s_waitcnt lgkmcnt(4)
 buffer_load_dwordx4 v8, s[44:47], s81 offen lds
 mvaaz 124,200,24
 rta 184,5,17032
 mvaa 124,204,28
 rta 186,5,17288
 mvaaz 92,204,20
 rta 188,5,17544
 mvaa 92,200,16
 s_waitcnt vmcnt(10)
 rta 190,5,17800
 mvaaz 60,200,8
 s_add_u32 m0, s80, 2048
 s_add_u32 s81, s81, 16384
 ds_read_b128 a[40:43], v9 offset:38912
 mvaa 60,204,12
 buffer_load_dwordx4 v7, s[44:47], s81 offen lds
 mvaaz 28,204,4
 s_add_u32 m0, s80, 3072
 ds_read_b128 a[44:47], v10 offset:38912
 mvaa 28,200,0
 s_waitcnt lgkmcnt(6)
 buffer_load_dwordx4 v8, s[44:47], s81 offen lds
 mvaaz 32,176,0
 rta 192,5,17088
 mvaa 32,180,4
 rta 194,5,17344
 mvaaz 64,180,12
 rta 196,5,17600
 mvaa 64,176,8
 rta 198,5,17856
 mvaaz 96,176,16
 s_add_u32 m0, s80, 4096
 s_add_u32 s81, s81, 16384
 ds_read_b128 a[48:51], v9 offset:40960
 mvaa 96,180,20
 buffer_load_dwordx4 v7, s[44:47], s81 offen lds
 mvaaz 128,180,28
 s_add_u32 m0, s80, 5120
 ds_read_b128 a[52:55], v10 offset:40960
 mvaa 128,176,24
 s_waitcnt lgkmcnt(6)
 buffer_load_dwordx4 v8, s[44:47], s81 offen lds
 mvaaz 132,184,24
 rta 200,5,17096
 mvaa 132,188,28
 rta 202,5,17352
 mvaaz 100,188,20
 rta 204,5,17608
 mvaa 100,184,16
 rta 206,5,17864
 mvaaz 68,184,8
 s_add_u32 m0, s80, 6144
 s_add_u32 s81, s81, 16384
 ds_read_b128 a[56:59], v9 offset:43008
 mvaa 68,188,12
 buffer_load_dwordx4 v7, s[44:47], s81 offen lds
 mvaaz 36,188,4
 s_add_u32 m0, s80, 7168
 ds_read_b128 a[60:63], v10 offset:43008
 mvaa 36,184,0
 s_waitcnt lgkmcnt(6)
 buffer_load_dwordx4 v8, s[44:47], s81 offen lds
 mvaaz 40,192,0
 s_waitcnt vmcnt(12) lgkmcnt(0)
 s_barrier
 mvaa 40,196,4
 rta 176,5,33792
 mvaaz 72,196,12
 rta 178,5,34048
 mvaa 72,192,8
 rta 180,5,34304
 mvaaz 104,192,16
 rta 182,5,34560
 mvaa 104,196,20
 mvaaz 136,196,28
 ds_read_b128 a[64:67], v9 offset:45056
 mvaa 136,192,24
 mvaaz 140,200,24
 rta 184,5,33800
 mvaa 140,204,28
 rta 186,5,34056
 mvaaz 108,204,20
 rta 188,5,34312
 mvaa 108,200,16
 rta 190,5,34568
 mvaaz 76,200,8
 ds_read_b128 a[68:71], v10 offset:45056
 mvaa 76,204,12
 mvaaz 44,204,4
 mvaa 44,200,0
 s_waitcnt lgkmcnt(5)
 mvaa 176,176,40
 rta 192,5,33856
 mvaa 176,180,44
 rta 194,5,34112
 mvaa 208,180,52
 rta 196,5,34368
 mvaa 208,176,48
 rta 198,5,34624
 maaa 80,176,56
 s_add_u32 m0, s92, 0
 s_add_u32 s86, s83, 1048832
 s_and_b32 s86, s86, 0x3fffff
 maaa 80,180,60
 s_waitcnt lgkmcnt(4)
 buffer_load_dwordx4 v6, s[48:51], s86 offen lds
 maaa 112,180,68
 s_add_u32 m0, s92, 1056
 s_add_u32 s86, s86, 8192
 maaa 112,176,64
 buffer_load_dwordx4 v6, s[48:51], s86 offen lds
 maaa 116,184,64
 rta 200,5,33864
 maaa 116,188,68
 rta 202,5,34120
 maaa 84,188,60
 rta 204,5,34376
 maaa 84,184,56
 rta 206,5,34632
 mvaa 212,184,48
 s_add_u32 m0, s92, 2112
 s_add_u32 s86, s86, 8192
 mvaa 212,188,52
 buffer_load_dwordx4 v6, s[48:51], s86 offen lds
 mvaa 180,188,44
 s_add_u32 m0, s92, 3168
 s_add_u32 s86, s86, 8192
 mvaa 180,184,40
 s_waitcnt lgkmcnt(4)
 buffer_load_dwordx4 v6, s[48:51], s86 offen lds
 mvaa 184,192,40
 rta 176,5,33920
 mvaa 184,196,44
 rta 178,5,34176
 mvaa 216,196,52
 rta 180,5,34432
 mvaa 216,192,48
 rta 182,5,34688
 maaa 88,192,56
 s_add_u32 m0, s92, 16896
 s_add_u32 s86, s83, 1048576
 s_and_b32 s86, s86, 0x3fffff
 maaa 88,196,60
 buffer_load_dwordx4 v6, s[48:51], s86 offen lds
 maaa 120,196,68
 s_add_u32 m0, s92, 17952
 s_add_u32 s86, s86, 8192
 maaa 120,192,64
 s_waitcnt lgkmcnt(4)
 buffer_load_dwordx4 v6, s[48:51], s86 offen lds
 maaa 124,200,64
 rta 184,5,33928
 maaa 124,204,68
 rta 186,5,34184
 maaa 92,204,60
 rta 188,5,34440
 maaa 92,200,56
 rta 190,5,34696
 mvaa 220,200,48
 s_add_u32 m0, s92, 19008
 s_add_u32 s86, s86, 8192
 mvaa 220,204,52
 buffer_load_dwordx4 v6, s[48:51], s86 offen lds
 mvaa 188,204,44
 s_add_u32 m0, s92, 20064
 s_add_u32 s86, s86, 8192
 mvaa 188,200,40
 s_waitcnt lgkmcnt(4)
 buffer_load_dwordx4 v6, s[48:51], s86 offen lds
 mvaa 192,176,40
 rta 192,5,33984
 mvaa 192,180,44
 rta 194,5,34240
 mvaa 224,180,52
 rta 196,5,34496
 mvaa 224,176,48
 rta 198,5,34752
 maaa 96,176,56
 maaa 96,180,60
 maaa 128,180,68
 maaa 128,176,64
 s_waitcnt lgkmcnt(4)
 maaa 132,184,64
 rta 200,5,33992
 maaa 132,188,68
 rta 202,5,34248
 maaa 100,188,60
 rta 204,5,34504
 maaa 100,184,56
 rta 206,5,34760
 mvaa 228,184,48
 mvaa 228,188,52
 mvaa 196,188,44
 mvaa 196,184,40
 s_waitcnt lgkmcnt(4)
 mvaa 200,192,40
 s_waitcnt vmcnt(16) lgkmcnt(0)
 s_barrier
 mvaa 200,196,44
 rta 176,5,50688
 mvaa 232,196,52
 rta 178,5,50944
 mvaa 232,192,48
 s_add_u32 m0, s92, 33792
 rta 180,5,51200
 maaa 104,192,56
 s_add_u32 s86, s83, 1573120
 s_and_b32 s86, s86, 0x3fffff
 rta 182,5,51456
 maaa 104,196,60
 buffer_load_dwordx4 v6, s[48:51], s86 offen lds
 maaa 136,196,68
 s_add_u32 m0, s92, 34848
 s_add_u32 s86, s86, 8192
 maaa 136,192,64
 buffer_load_dwordx4 v6, s[48:51], s86 offen lds
 maaa 140,200,64
 rta 184,5,50696
 maaa 140,204,68
 rta 186,5,50952
 maaa 108,204,60
 rta 188,5,51208
 maaa 108,200,56
 rta 190,5,51464
 mvaa 236,200,48
 s_add_u32 m0, s92, 35904
 s_add_u32 s86, s86, 8192
 mvaa 236,204,52
 buffer_load_dwordx4 v6, s[48:51], s86 offen lds
 mvaa 204,204,44
 s_add_u32 m0, s92, 36960
 s_add_u32 s86, s86, 8192
 mvaa 204,200,40
 s_waitcnt lgkmcnt(4)
 buffer_load_dwordx4 v6, s[48:51], s86 offen lds
 mvaa 16,176,40
 rta 192,5,50752
 mvaa 16,180,44
 rta 194,5,51008
 mvaa 48,180,52
 rta 196,5,51264
 mvaa 48,176,48
 s_add_u32 m0, s80, 38912
 s_waitcnt vmcnt(12)
 rta 198,5,51520
 mvaa 80,176,56
 s_add_u32 s81, s82, 384
 s_and_b32 s81, s81, 0x380
 ds_read_b128 a[0:3], v9 offset:0
 mvaa 80,180,60
 buffer_load_dwordx4 v7, s[44:47], s81 offen lds
 mvaa 112,180,68
 s_add_u32 m0, s80, 39936
 ds_read_b128 a[4:7], v10 offset:0
 mvaa 112,176,64
 s_waitcnt lgkmcnt(6)
 buffer_load_dwordx4 v8, s[44:47], s81 offen lds
 mvaa 116,184,64
 rta 200,5,50760
 mvaa 116,188,68
 rta 202,5,51016
 mvaa 84,188,60
 rta 204,5,51272
 mvaa 84,184,56
 rta 206,5,51528
 mvaa 52,184,48
 s_add_u32 m0, s80, 40960
 s_add_u32 s81, s81, 16384
 ds_read_b128 a[8:11], v9 offset:2048
 mvaa 52,188,52
 buffer_load_dwordx4 v7, s[44:47], s81 offen lds
 mvaa 20,188,44
 s_add_u32 m0, s80, 41984
 ds_read_b128 a[12:15], v10 offset:2048
 mvaa 20,184,40
 s_waitcnt lgkmcnt(6)
 buffer_load_dwordx4 v8, s[44:47], s81 offen lds
 mvaa 24,192,40
 rta 176,5,50816
 mvaa 24,196,44
 rta 178,5,51072
 mvaa 56,196,52
 rta 180,5,51328
 mvaa 56,192,48
 rta 182,5,51584
 mvaa 88,192,56
 s_add_u32 m0, s80, 43008
 s_add_u32 s81, s81, 16384
 ds_read_b128 a[16:19], v9 offset:4096
 mvaa 88,196,60
 buffer_load_dwordx4 v7, s[44:47], s81 offen lds
 mvaa 120,196,68
 s_add_u32 m0, s80, 44032
 ds_read_b128 a[20:23], v10 offset:4096
 mvaa 120,192,64
 s_waitcnt lgkmcnt(6)
 buffer_load_dwordx4 v8, s[44:47], s81 offen lds
 mvaa 124,200,64
 rta 184,5,50824
 mvaa 124,204,68
 rta 186,5,51080
 mvaa 92,204,60
 rta 188,5,51336
 mvaa 92,200,56
 rta 190,5,51592
 mvaa 60,200,48
 s_add_u32 m0, s80, 45056
 s_add_u32 s81, s81, 16384
 ds_read_b128 a[24:27], v9 offset:6144
 mvaa 60,204,52
 buffer_load_dwordx4 v7, s[44:47], s81 offen lds
 mvaa 28,204,44
 s_add_u32 m0, s80, 46080
 ds_read_b128 a[28:31], v10 offset:6144
 mvaa 28,200,40
 s_waitcnt lgkmcnt(6)
 buffer_load_dwordx4 v8, s[44:47], s81 offen lds
 mvaa 32,176,40
 rta 192,5,50880
 mvaa 32,180,44
 rta 194,5,51136
 mvaa 64,180,52
 rta 196,5,51392
 mvaa 64,176,48
 rta 198,5,51648
 mvaa 96,176,56
 mvaa 96,180,60
 mvaa 128,180,68
 mvaa 128,176,64
 s_waitcnt lgkmcnt(4)
 mvaa 132,184,64
 rta 200,5,50888
 mvaa 132,188,68
 rta 202,5,51144
 mvaa 100,188,60
 rta 204,5,51400
 mvaa 100,184,56
 rta 206,5,51656
 mvaa 68,184,48
 mvaa 68,188,52
 mvaa 36,188,44
 mvaa 36,184,40
 s_waitcnt lgkmcnt(4)
 mvaa 40,192,40
 s_waitcnt vmcnt(16) lgkmcnt(0)
 s_barrier
 mvaa 40,196,44
 rta 176,5,0
 mvaa 72,196,52
 rta 178,5,256
 mvaa 72,192,48
 s_add_u32 m0, s92, 50688
 rta 180,5,512
 mvaa 104,192,56
 s_add_u32 s86, s83, 1572864
 s_and_b32 s86, s86, 0x3fffff
 rta 182,5,768
 mvaa 104,196,60
 buffer_load_dwordx4 v6, s[48:51], s86 offen lds
 mvaa 136,196,68
 s_add_u32 m0, s92, 51744
 s_add_u32 s86, s86, 8192
 mvaa 136,192,64
 buffer_load_dwordx4 v6, s[48:51], s86 offen lds
 mvaa 140,200,64
 rta 184,5,8
 mvaa 140,204,68
 rta 186,5,264
 mvaa 108,204,60
 rta 188,5,520
 mvaa 108,200,56
 rta 190,5,776
 mvaa 76,200,48
 s_add_u32 m0, s92, 52800
 s_add_u32 s86, s86, 8192
 mvaa 76,204,52
 buffer_load_dwordx4 v6, s[48:51], s86 offen lds
 mvaa 44,204,44
 s_add_u32 m0, s92, 53856
 s_add_u32 s86, s86, 8192
 mvaa 44,200,40
 s_waitcnt lgkmcnt(4)
 buffer_load_dwordx4 v6, s[48:51], s86 offen lds
 mvaa 176,176,0
 rta 192,5,64
 mvaa 176,180,4
 rta 194,5,320
 mvaa 208,180,12
 rta 196,5,576
 mvaa 208,176,8
 rta 198,5,832
 maaa 80,176,16
 s_add_u32 m0, s80, 0
 s_add_u32 s81, s82, 512
 s_and_b32 s81, s81, 0x380
 maaa 80,180,20
 buffer_load_dwordx4 v7, s[44:47], s81 offen lds
 maaa 112,180,28
 s_add_u32 m0, s80, 1024
 maaa 112,176,24
 s_waitcnt lgkmcnt(4)
 buffer_load_dwordx4 v8, s[44:47], s81 offen lds
 maaa 116,184,24
 rta 200,5,72
 maaa 116,188,28
 rta 202,5,328
 maaa 84,188,20
 rta 204,5,584
 maaa 84,184,16
 rta 206,5,840
 mvaa 212,184,8
 s_add_u32 m0, s80, 2048
 s_add_u32 s81, s81, 16384
 mvaa 212,188,12
 buffer_load_dwordx4 v7, s[44:47], s81 offen lds
 mvaa 180,188,4
 s_add_u32 m0, s80, 3072
 mvaa 180,184,0
 s_waitcnt lgkmcnt(4)
 buffer_load_dwordx4 v8, s[44:47], s81 offen lds
 mvaa 184,192,0
 rta 176,5,128
 mvaa 184,196,4
 rta 178,5,384
 mvaa 216,196,12
 rta 180,5,640
 mvaa 216,192,8
 rta 182,5,896
 maaa 88,192,16
 s_add_u32 m0, s80, 4096
 s_add_u32 s81, s81, 16384
 maaa 88,196,20
 buffer_load_dwordx4 v7, s[44:47], s81 offen lds
 maaa 120,196,28
 s_add_u32 m0, s80, 5120
 maaa 120,192,24
 s_waitcnt lgkmcnt(4)
 buffer_load_dwordx4 v8, s[44:47], s81 offen lds
 maaa 124,200,24
 rta 184,5,136
 maaa 124,204,28
 rta 186,5,392
 maaa 92,204,20
 rta 188,5,648
 maaa 92,200,16
 rta 190,5,904
 mvaa 220,200,8
 s_add_u32 m0, s80, 6144
 s_add_u32 s81, s81, 16384
 mvaa 220,204,12
 buffer_load_dwordx4 v7, s[44:47], s81 offen lds
 mvaa 188,204,4
 s_add_u32 m0, s80, 7168
 mvaa 188,200,0
 s_waitcnt lgkmcnt(4)
 buffer_load_dwordx4 v8, s[44:47], s81 offen lds
 mvaa 192,176,0
 rta 192,5,192
 mvaa 192,180,4
 rta 194,5,448
 mvaa 224,180,12
 rta 196,5,704
 mvaa 224,176,8
 rta 198,5,960
 maaa 96,176,16
 maaa 96,180,20
 maaa 128,180,28
 maaa 128,176,24
 s_waitcnt lgkmcnt(4)
 maaa 132,184,24
 rta 200,5,200
 maaa 132,188,28
 rta 202,5,456
 maaa 100,188,20
 rta 204,5,712
 maaa 100,184,16
 rta 206,5,968
 mvaa 228,184,8
 mvaa 228,188,12
 mvaa 196,188,4
 mvaa 196,184,0
 s_waitcnt lgkmcnt(4)
 mvaa 200,192,0
 s_waitcnt vmcnt(24) lgkmcnt(0)
 s_barrier
 mvaa 200,196,4
 rta 176,5,16896
 mvaa 232,196,12
 rta 178,5,17152
 mvaa 232,192,8
 s_add_u32 m0, s92, 0
 rta 180,5,17408
 maaa 104,192,16
 s_add_u32 s86, s83, 2097408
 s_and_b32 s86, s86, 0x3fffff
 rta 182,5,17664
 maaa 104,196,20
 buffer_load_dwordx4 v6, s[48:51], s86 offen lds
 maaa 136,196,28
 s_add_u32 m0, s92, 1056
 s_add_u32 s86, s86, 8192
 maaa 136,192,24
 buffer_load_dwordx4 v6, s[48:51], s86 offen lds
 maaa 140,200,24
 rta 184,5,16904
 maaa 140,204,28
 rta 186,5,17160
 maaa 108,204,20
 rta 188,5,17416
 maaa 108,200,16
 rta 190,5,17672
 mvaa 236,200,8
 s_add_u32 m0, s92, 2112
 s_add_u32 s86, s86, 8192
 mvaa 236,204,12
 buffer_load_dwordx4 v6, s[48:51], s86 offen lds
 mvaa 204,204,4
 s_add_u32 m0, s92, 3168
 s_add_u32 s86, s86, 8192
 mvaa 204,200,0
 s_waitcnt lgkmcnt(4)
 buffer_load_dwordx4 v6, s[48:51], s86 offen lds
 mvaa 16,176,0
 rta 192,5,16960
 mvaa 16,180,4
 rta 194,5,17216
 mvaa 48,180,12
 rta 196,5,17472
 mvaa 48,176,8
 s_waitcnt vmcnt(16)
 rta 198,5,17728
 mvaa 80,176,16
 s_lshl_b32 s8, s6, 4
 s_add_u32 s10, s8, s7
 ds_read_b128 a[40:43], v9 offset:38912
 mvaa 80,180,20
 s_lshl_b32 s8, s10, 19
 s_add_u32 s52, s18, s8
 s_addc_u32 s53, s19, 0
 mvaa 112,180,28
 s_mov_b32 s54, 524288
 s_mov_b32 s55, 0x20000
 ds_read_b128 a[44:47], v10 offset:38912
 mvaa 112,176,24
 s_waitcnt lgkmcnt(6)
 s_add_u32 s56, s20, s8
 s_addc_u32 s57, s21, 0
 s_mov_b32 s58, 524288
 mvaa 116,184,24
 s_mov_b32 s59, 0x20000
 s_lshl_b32 s8, s5, 3
 rta 200,5,16968
 mvaa 116,188,28
 s_add_u32 s8, s8, s6
 s_lshl_b32 s85, s8, 2
 rta 202,5,17224
 mvaa 84,188,20
 s_add_u32 s8, s85, s42
 s_mul_i32 s8, s8, 655360
 rta 204,5,17480
 mvaa 84,184,16
 s_add_u32 s8, s8, 0
 s_mul_i32 s9, s7, 40960
 rta 206,5,17736
 mvaa 52,184,8
 s_add_u32 s8, s8, s9
 s_add_u32 s60, s40, s8
 ds_read_b128 a[48:51], v9 offset:40960
 mvaa 52,188,12
 s_addc_u32 s61, s41, 0
 s_mov_b32 s62, 40960
 s_mov_b32 s63, 0x20000
 mvaa 20,188,4
 s_lshl_b32 s8, s2, 2
 s_add_u32 s8, s8, s42
 ds_read_b128 a[52:55], v10 offset:40960
 mvaa 20,184,0
 s_waitcnt lgkmcnt(6)
 s_mul_i32 s8, s8, 40960
 s_add_u32 s8, s8, 41943040
 s_add_u32 s64, s40, s8
 mvaa 24,192,0
 s_addc_u32 s65, s41, 0
 s_mov_b32 s66, 40960
 rta 176,5,17024
 mvaa 24,196,4
 s_mov_b32 s67, 0x20000
 s_mov_b64 s[72:73], s[52:53]
 rta 178,5,17280
 mvaa 56,196,12
 s_mov_b64 s[74:75], s[56:57]
 s_lshr_b32 s10, s7, 2
 rta 180,5,17536
 mvaa 56,192,8
 s_and_b32 s11, s7, 3
 s_lshl_b32 s8, s11, 8
 rta 182,5,17792
 mvaa 88,192,16
 s_sub_u32 s9, 4194304, s8
 s_add_u32 s68, s24, s8
 ds_read_b128 a[56:59], v9 offset:43008
 mvaa 88,196,20
 s_addc_u32 s69, s25, 0
 s_mov_b32 s70, s9
 s_mov_b32 s71, 0x20000
 mvaa 120,196,28
 s_add_u32 s8, s85, s42
 s_mul_i32 s8, s8, 655360
 ds_read_b128 a[60:63], v10 offset:43008
 mvaa 120,192,24
 s_waitcnt lgkmcnt(6)
 s_add_u32 s8, s8, 0
 s_add_u32 s16, s40, s8
 s_addc_u32 s17, s41, 0
 mvaa 124,200,24
 s_mov_b32 s18, 655360
 s_mov_b32 s19, 0x20000
 rta 184,5,17032
 mvaa 124,204,28
 s_add_u32 s12, s85, s11
 s_mul_i32 s8, s12, 245760
 rta 186,5,17288
 mvaa 92,204,20
 s_mul_i32 s9, s42, 5120
 s_add_u32 s8, s8, s9
 rta 188,5,17544
 mvaa 92,200,16
 s_add_u32 s8, s8, 83886080
 s_add_u32 s20, s40, s8
 rta 190,5,17800
 mvaa 60,200,8
 s_addc_u32 s21, s41, 0
 s_mov_b32 s22, 230400
 ds_read_b128 a[64:67], v9 offset:45056
 mvaa 60,204,12
 s_mov_b32 s23, 0x20000
 s_lshl_b32 s8, s12, 11
 s_lshl_b32 s9, s42, 7
 mvaa 28,204,4
 s_add_u32 s8, s8, s9
 s_add_u32 s8, s8, 125829120
 ds_read_b128 a[68:71], v10 offset:45056
 mvaa 28,200,0
 s_waitcnt lgkmcnt(6)
 s_add_u32 s32, s40, s8
 s_addc_u32 s33, s41, 0
 s_mov_b32 s34, 1664
 mvaa 32,176,0
 s_mov_b32 s35, 0x20000
 s_mul_i32 s8, s6, 304
 rta 192,5,17088
 mvaa 32,180,4
 s_mul_i32 s9, s42, 80
 s_add_u32 s8, s8, s9
 rta 194,5,17344
 mvaa 64,180,12
 s_lshl_b32 s8, s8, 11
 s_lshl_b32 s9, s5, 10
 rta 196,5,17600
 mvaa 64,176,8
 s_add_u32 s8, s8, s9
 s_lshl_b32 s9, s11, 8
 rta 198,5,17856
 mvaa 96,176,16
 s_add_u32 s8, s8, s9
 s_lshl_b32 s9, s10, 6
 s_add_u32 s8, s8, s9
 mvaa 96,180,20
 s_sub_u32 s9, 4980736, s8
 s_add_u32 s24, s36, s8
 s_addc_u32 s25, s37, 0
 mvaa 128,180,28
 s_mov_b32 s26, s9
 s_mov_b32 s27, 0x20000
 s_add_u32 s28, s38, 0
 mvaa 128,176,24
 s_waitcnt lgkmcnt(4)
 s_addc_u32 s29, s39, 0
 s_mov_b32 s30, 64
 s_mov_b32 s31, 0x20000
 mvaa 132,184,24
 s_lshl_b32 s36, 1, s7
 s_mov_b32 s38, 0
 rta 200,5,17096
 mvaa 132,188,28
 s_add_u32 s9, s85, s42
 s_lshl_b32 s9, s9, 11
 rta 202,5,17352
 mvaa 100,188,20
 s_add_u32 s9, s9, 126877696
 s_add_u32 s40, s40, s9
 rta 204,5,17608
 mvaa 100,184,16
 s_addc_u32 s41, s41, 0
 s_mov_b32 s8, s10
 rta 206,5,17864
 mvaa 68,184,8
 s_lshl_b32 s9, s7, 1
 s_add_u32 s77, s92, 67584
 s_mov_b32 s78, 4294899712
 mvaa 68,188,12
 s_mov_b32 s88, 0x3e0293ee
 s_mov_b32 s89, 0x3e0293ee
 s_mov_b32 s87, 0
 mvaa 36,188,4
 s_mov_b32 s43, 0
 s_mov_b32 s90, 0
 s_mov_b32 s91, 0x4f800000
 mvaa 36,184,0
 s_waitcnt lgkmcnt(4)
 mvaa 40,192,0
 s_waitcnt lgkmcnt(0)
 s_barrier
 mvaa 40,196,4
 rta 176,5,33792
 mvaa 72,196,12
 rta 178,5,34048
 mvaa 72,192,8
 s_add_u32 m0, s92, 16896
 rta 180,5,34304
 mvaa 104,192,16
 s_add_u32 s86, s83, 2097152
 s_and_b32 s86, s86, 0x3fffff
 rta 182,5,34560
 mvaa 104,196,20
 buffer_load_dwordx4 v6, s[48:51], s86 offen lds
 mvaa 136,196,28
 s_add_u32 m0, s92, 17952
 s_add_u32 s86, s86, 8192
 mvaa 136,192,24
 buffer_load_dwordx4 v6, s[48:51], s86 offen lds
 mvaa 140,200,24
 rta 184,5,33800
 mvaa 140,204,28
 rta 186,5,34056
 mvaa 108,204,20
 rta 188,5,34312
 mvaa 108,200,16
 rta 190,5,34568
 mvaa 76,200,8
 s_add_u32 m0, s92, 19008
 s_add_u32 s86, s86, 8192
 mvaa 76,204,12
 buffer_load_dwordx4 v6, s[48:51], s86 offen lds
 mvaa 44,204,4
 s_add_u32 m0, s92, 20064
 s_add_u32 s86, s86, 8192
 mvaa 44,200,0
 s_waitcnt lgkmcnt(4)
 buffer_load_dwordx4 v6, s[48:51], s86 offen lds
 mvaa 176,176,40
 rta 192,5,33856
 mvaa 176,180,44
 rta 194,5,34112
 mvaa 208,180,52
 rta 196,5,34368
 mvaa 208,176,48
 rta 198,5,34624
 maaa 80,176,56
 s_add_u32 m0, s80, 38912
 s_add_u32 s81, s82, 640
 s_and_b32 s81, s81, 0x380
 maaa 80,180,60
 buffer_load_dwordx4 v7, s[44:47], s81 offen lds
 maaa 112,180,68
 s_add_u32 m0, s80, 39936
 maaa 112,176,64
 s_waitcnt lgkmcnt(4)
 buffer_load_dwordx4 v8, s[44:47], s81 offen lds
 maaa 116,184,64
 rta 200,5,33864
 maaa 116,188,68
 rta 202,5,34120
 maaa 84,188,60
 rta 204,5,34376
 maaa 84,184,56
 rta 206,5,34632
 mvaa 212,184,48
 s_add_u32 m0, s80, 40960
 s_add_u32 s81, s81, 16384
 mvaa 212,188,52
 buffer_load_dwordx4 v7, s[44:47], s81 offen lds
 mvaa 180,188,44
 s_add_u32 m0, s80, 41984
 mvaa 180,184,40
 s_waitcnt lgkmcnt(4)
 buffer_load_dwordx4 v8, s[44:47], s81 offen lds
 mvaa 184,192,40
 rta 176,5,33920
 mvaa 184,196,44
 rta 178,5,34176
 mvaa 216,196,52
 rta 180,5,34432
 mvaa 216,192,48
 rta 182,5,34688
 maaa 88,192,56
 s_add_u32 m0, s80, 43008
 s_add_u32 s81, s81, 16384
 maaa 88,196,60
 buffer_load_dwordx4 v7, s[44:47], s81 offen lds
 maaa 120,196,68
 s_add_u32 m0, s80, 44032
 maaa 120,192,64
 s_waitcnt lgkmcnt(4)
 buffer_load_dwordx4 v8, s[44:47], s81 offen lds
 maaa 124,200,64
 rta 184,5,33928
 maaa 124,204,68
 rta 186,5,34184
 maaa 92,204,60
 rta 188,5,34440
 maaa 92,200,56
 rta 190,5,34696
 mvaa 220,200,48
 s_add_u32 m0, s80, 45056
 s_add_u32 s81, s81, 16384
 mvaa 220,204,52
 buffer_load_dwordx4 v7, s[44:47], s81 offen lds
 mvaa 188,204,44
 s_add_u32 m0, s80, 46080
 mvaa 188,200,40
 s_waitcnt lgkmcnt(4)
 buffer_load_dwordx4 v8, s[44:47], s81 offen lds
 mvaa 192,176,40
 rta 192,5,33984
 mvaa 192,180,44
 rta 194,5,34240
 mvaa 224,180,52
 rta 196,5,34496
 mvaa 224,176,48
 rta 198,5,34752
 maaa 96,176,56
 maaa 96,180,60
 maaa 128,180,68
 maaa 128,176,64
 s_waitcnt lgkmcnt(4)
 maaa 132,184,64
 rta 200,5,33992
 maaa 132,188,68
 rta 202,5,34248
 maaa 100,188,60
 rta 204,5,34504
 maaa 100,184,56
 rta 206,5,34760
 mvaa 228,184,48
 mvaa 228,188,52
 mvaa 196,188,44
 mvaa 196,184,40
 s_waitcnt lgkmcnt(4)
 mvaa 200,192,40
 s_waitcnt vmcnt(24) lgkmcnt(0)
 s_barrier
 mvaa 200,196,44
 rta 176,5,50688
 mvaa 232,196,52
 rta 178,5,50944
 mvaa 232,192,48
 s_add_u32 m0, s92, 33792
 rta 180,5,51200
 maaa 104,192,56
 s_add_u32 s86, s83, 2621696
 s_and_b32 s86, s86, 0x3fffff
 rta 182,5,51456
 maaa 104,196,60
 buffer_load_dwordx4 v6, s[48:51], s86 offen lds
 maaa 136,196,68
 s_add_u32 m0, s92, 34848
 s_add_u32 s86, s86, 8192
 maaa 136,192,64
 buffer_load_dwordx4 v6, s[48:51], s86 offen lds
 maaa 140,200,64
 rta 184,5,50696
 maaa 140,204,68
 rta 186,5,50952
 maaa 108,204,60
 rta 188,5,51208
 maaa 108,200,56
 rta 190,5,51464
 mvaa 236,200,48
 s_add_u32 m0, s92, 35904
 s_add_u32 s86, s86, 8192
 mvaa 236,204,52
 buffer_load_dwordx4 v6, s[48:51], s86 offen lds
 mvaa 204,204,44
 s_add_u32 m0, s92, 36960
 s_add_u32 s86, s86, 8192
 mvaa 204,200,40
 s_waitcnt lgkmcnt(4)
 buffer_load_dwordx4 v6, s[48:51], s86 offen lds
 mvaa 16,176,40
 rta 192,5,50752
 mvaa 16,180,44
 rta 194,5,51008
 mvaa 48,180,52
 rta 196,5,51264
 mvaa 48,176,48
 s_waitcnt vmcnt(20)
 rta 198,5,51520
 mvaa 80,176,56
 s_lshl_b32 s39, s6, 1
 s_add_u32 s39, s39, s7
 ds_read_b128 a[0:3], v9 offset:0
 mvaa 80,180,60
 s_and_b32 s39, s39, 0
 s_lshl_b32 s39, s39, 14
 s_mov_b32 s5, 65536
 mvaa 112,180,68
 s_xor_b32 s76, s5, s39
 s_lshl_b32 s3, s8, 9
 ds_read_b128 a[4:7], v10 offset:0
 mvaa 112,176,64
 s_waitcnt lgkmcnt(6)
 v_mov_b32 v240, 0
 v_mov_b32 v241, 0
 mvaa 116,184,64
 rta 200,5,50760
 v_mov_b32 v242, 0
 mvaa 116,188,68
 rta 202,5,51016
 v_mov_b32 v243, 0
 mvaa 84,188,60
 rta 204,5,51272
 mvaa 84,184,56
 rta 206,5,51528
 mvaa 52,184,48
 ds_read_b128 a[8:11], v9 offset:2048
 mvaa 52,188,52
 buffer_store_dwordx4 v[240:243], off, s[32:35], s3 sc1
 mvaa 20,188,44
 ds_read_b128 a[12:15], v10 offset:2048
 mvaa 20,184,40
 s_waitcnt lgkmcnt(6)
 mvaa 24,192,40
 rta 176,5,50816
 mvaa 24,196,44
 rta 178,5,51072
 mvaa 56,196,52
 rta 180,5,51328
 mvaa 56,192,48
 rta 182,5,51584
 mvaa 88,192,56
 ds_read_b128 a[16:19], v9 offset:4096
 mvaa 88,196,60
 mvaa 120,196,68
 ds_read_b128 a[20:23], v10 offset:4096
 mvaa 120,192,64
 s_waitcnt lgkmcnt(6)
 mvaa 124,200,64
 rta 184,5,50824
 mvaa 124,204,68
 rta 186,5,51080
 mvaa 92,204,60
 rta 188,5,51336
 mvaa 92,200,56
 rta 190,5,51592
 mvaa 60,200,48
 ds_read_b128 a[24:27], v9 offset:6144
 mvaa 60,204,52
 mvaa 28,204,44
 ds_read_b128 a[28:31], v10 offset:6144
 mvaa 28,200,40
 s_waitcnt lgkmcnt(6)
 mvaa 32,176,40
 rta 192,5,50880
 mvaa 32,180,44
 rta 194,5,51136
 mvaa 64,180,52
 rta 196,5,51392
 mvaa 64,176,48
 rta 198,5,51648
 mvaa 96,176,56
 mvaa 96,180,60
 mvaa 128,180,68
 mvaa 128,176,64
 s_waitcnt lgkmcnt(4)
 mvaa 132,184,64
 rta 200,5,50888
 mvaa 132,188,68
 rta 202,5,51144
 mvaa 100,188,60
 rta 204,5,51400
 mvaa 100,184,56
 rta 206,5,51656
 mvaa 68,184,48
 mvaa 68,188,52
 mvaa 36,188,44
 mvaa 36,184,40
 s_waitcnt lgkmcnt(4)
 mvaa 40,192,40
 s_waitcnt vmcnt(17) lgkmcnt(0)
 s_barrier
 mvaa 40,196,44
 rta 176,5,0
 mvaa 72,196,52
 rta 178,5,256
 mvaa 72,192,48
 s_add_u32 m0, s92, 50688
 rta 180,5,512
 mvaa 104,192,56
 s_add_u32 s86, s83, 2621440
 s_and_b32 s86, s86, 0x3fffff
 rta 182,5,768
 mvaa 104,196,60
 buffer_load_dwordx4 v6, s[48:51], s86 offen lds
 mvaa 136,196,68
 s_add_u32 m0, s92, 51744
 s_add_u32 s86, s86, 8192
 mvaa 136,192,64
 buffer_load_dwordx4 v6, s[48:51], s86 offen lds
 mvaa 140,200,64
 rta 184,5,8
 mvaa 140,204,68
 rta 186,5,264
 mvaa 108,204,60
 rta 188,5,520
 mvaa 108,200,56
 rta 190,5,776
 mvaa 76,200,48
 s_add_u32 m0, s92, 52800
 s_add_u32 s86, s86, 8192
 mvaa 76,204,52
 buffer_load_dwordx4 v6, s[48:51], s86 offen lds
 mvaa 44,204,44
 s_add_u32 m0, s92, 53856
 s_add_u32 s86, s86, 8192
 mvaa 44,200,40
 s_waitcnt lgkmcnt(4)
 buffer_load_dwordx4 v6, s[48:51], s86 offen lds
 mvaa 176,176,0
 rta 192,5,64
 mvaa 176,180,4
 rta 194,5,320
 mvaa 208,180,12
 rta 196,5,576
 mvaa 208,176,8
 rta 198,5,832
 maaa 80,176,16
 s_add_u32 m0, s80, 0
 s_add_u32 s81, s82, 768
 s_and_b32 s81, s81, 0x380
 maaa 80,180,20
 buffer_load_dwordx4 v7, s[44:47], s81 offen lds
 maaa 112,180,28
 s_add_u32 m0, s80, 1024
 maaa 112,176,24
 s_waitcnt lgkmcnt(4)
 buffer_load_dwordx4 v8, s[44:47], s81 offen lds
 maaa 116,184,24
 rta 200,5,72
 maaa 116,188,28
 rta 202,5,328
 maaa 84,188,20
 rta 204,5,584
 maaa 84,184,16
 rta 206,5,840
 mvaa 212,184,8
 s_add_u32 m0, s80, 2048
 s_add_u32 s81, s81, 16384
 mvaa 212,188,12
 buffer_load_dwordx4 v7, s[44:47], s81 offen lds
 mvaa 180,188,4
 s_add_u32 m0, s80, 3072
 mvaa 180,184,0
 s_waitcnt lgkmcnt(4)
 buffer_load_dwordx4 v8, s[44:47], s81 offen lds
 mvaa 184,192,0
 rta 176,5,128
 mvaa 184,196,4
 rta 178,5,384
 mvaa 216,196,12
 rta 180,5,640
 mvaa 216,192,8
 rta 182,5,896
 maaa 88,192,16
 s_add_u32 m0, s80, 4096
 s_add_u32 s81, s81, 16384
 maaa 88,196,20
 buffer_load_dwordx4 v7, s[44:47], s81 offen lds
 maaa 120,196,28
 s_add_u32 m0, s80, 5120
 maaa 120,192,24
 s_waitcnt lgkmcnt(4)
 buffer_load_dwordx4 v8, s[44:47], s81 offen lds
 maaa 124,200,24
 rta 184,5,136
 maaa 124,204,28
 rta 186,5,392
 maaa 92,204,20
 rta 188,5,648
 maaa 92,200,16
 rta 190,5,904
 mvaa 220,200,8
 s_add_u32 m0, s80, 6144
 s_add_u32 s81, s81, 16384
 mvaa 220,204,12
 buffer_load_dwordx4 v7, s[44:47], s81 offen lds
 mvaa 188,204,4
 s_add_u32 m0, s80, 7168
 mvaa 188,200,0
 s_waitcnt lgkmcnt(4)
 buffer_load_dwordx4 v8, s[44:47], s81 offen lds
 mvaa 192,176,0
 rta 192,5,192
 mvaa 192,180,4
 rta 194,5,448
 mvaa 224,180,12
 rta 196,5,704
 mvaa 224,176,8
 rta 198,5,960
 maaa 96,176,16
 maaa 96,180,20
 maaa 128,180,28
 maaa 128,176,24
 s_waitcnt lgkmcnt(4)
 maaa 132,184,24
 rta 200,5,200
 maaa 132,188,28
 rta 202,5,456
 maaa 100,188,20
 rta 204,5,712
 maaa 100,184,16
 rta 206,5,968
 mvaa 228,184,8
 mvaa 228,188,12
 mvaa 196,188,4
 mvaa 196,184,0
 s_waitcnt lgkmcnt(4)
 mvaa 200,192,0
 s_waitcnt vmcnt(25) lgkmcnt(0)
 s_barrier
 mvaa 200,196,4
 rta 176,5,16896
 mvaa 232,196,12
 rta 178,5,17152
 mvaa 232,192,8
 s_add_u32 m0, s92, 0
 rta 180,5,17408
 maaa 104,192,16
 s_add_u32 s86, s83, 3145984
 s_and_b32 s86, s86, 0x3fffff
 rta 182,5,17664
 maaa 104,196,20
 buffer_load_dwordx4 v6, s[48:51], s86 offen lds
 maaa 136,196,28
 s_add_u32 m0, s92, 1056
 s_add_u32 s86, s86, 8192
 maaa 136,192,24
 buffer_load_dwordx4 v6, s[48:51], s86 offen lds
 maaa 140,200,24
 rta 184,5,16904
 maaa 140,204,28
 rta 186,5,17160
 maaa 108,204,20
 rta 188,5,17416
 maaa 108,200,16
 rta 190,5,17672
 mvaa 236,200,8
 s_add_u32 m0, s92, 2112
 s_add_u32 s86, s86, 8192
 mvaa 236,204,12
 buffer_load_dwordx4 v6, s[48:51], s86 offen lds
 mvaa 204,204,4
 s_add_u32 m0, s92, 3168
 s_add_u32 s86, s86, 8192
 mvaa 204,200,0
 s_waitcnt lgkmcnt(4)
 buffer_load_dwordx4 v6, s[48:51], s86 offen lds
 mvaa 16,176,0
 rta 192,5,16960
 mvaa 16,180,4
 rta 194,5,17216
 mvaa 48,180,12
 rta 196,5,17472
 mvaa 48,176,8
 s_waitcnt vmcnt(21)
 rta 198,5,17728
 mvaa 80,176,16
 s_add_u32 m0, s92, 67584
 s_xor_b32 s93, s39, 0
 ds_read_b128 a[40:43], v9 offset:38912
 mvaa 80,180,20
 buffer_load_dwordx4 v1, s[52:55], s93 offen offset:0 nt lds
 mvaa 112,180,28
 s_add_u32 m0, s92, 67616
 ds_read_b128 a[44:47], v10 offset:38912
 mvaa 112,176,24
 s_waitcnt lgkmcnt(6)
 buffer_load_dwordx4 v1, s[52:55], s93 offen offset:1024 nt lds
 mvaa 116,184,24
 rta 200,5,16968
 mvaa 116,188,28
 rta 202,5,17224
 mvaa 84,188,20
 rta 204,5,17480
 mvaa 84,184,16
 rta 206,5,17736
 mvaa 52,184,8
 s_add_u32 m0, s92, 67648
 ds_read_b128 a[48:51], v9 offset:40960
 mvaa 52,188,12
 buffer_load_dwordx4 v1, s[52:55], s93 offen offset:2048 nt lds
 mvaa 20,188,4
 s_add_u32 m0, s92, 67680
 ds_read_b128 a[52:55], v10 offset:40960
 mvaa 20,184,0
 s_waitcnt lgkmcnt(6)
 buffer_load_dwordx4 v1, s[52:55], s93 offen offset:3072 nt lds
 mvaa 24,192,0
 rta 176,5,17024
 mvaa 24,196,4
 rta 178,5,17280
 mvaa 56,196,12
 rta 180,5,17536
 mvaa 56,192,8
 rta 182,5,17792
 mvaa 88,192,16
 ds_read_b128 a[56:59], v9 offset:43008
 mvaa 88,196,20
 mvaa 120,196,28
 ds_read_b128 a[60:63], v10 offset:43008
 mvaa 120,192,24
 s_waitcnt lgkmcnt(6)
 mvaa 124,200,24
 rta 184,5,17032
 mvaa 124,204,28
 rta 186,5,17288
 mvaa 92,204,20
 rta 188,5,17544
 mvaa 92,200,16
 rta 190,5,17800
 mvaa 60,200,8
 ds_read_b128 a[64:67], v9 offset:45056
 mvaa 60,204,12
 mvaa 28,204,4
 ds_read_b128 a[68:71], v10 offset:45056
 mvaa 28,200,0
 s_waitcnt lgkmcnt(6)
 mvaa 32,176,0
 rta 192,5,17088
 mvaa 32,180,4
 rta 194,5,17344
 mvaa 64,180,12
 rta 196,5,17600
 mvaa 64,176,8
 rta 198,5,17856
 mvaa 96,176,16
 mvaa 96,180,20
 mvaa 128,180,28
 mvaa 128,176,24
 s_waitcnt lgkmcnt(4)
 mvaa 132,184,24
 rta 200,5,17096
 mvaa 132,188,28
 rta 202,5,17352
 mvaa 100,188,20
 rta 204,5,17608
 mvaa 100,184,16
 rta 206,5,17864
 mvaa 68,184,8
 mvaa 68,188,12
 mvaa 36,188,4
 mvaa 36,184,0
 s_waitcnt lgkmcnt(4)
 mvaa 40,192,0
 s_waitcnt vmcnt(21) lgkmcnt(0)
 s_barrier
 mvaa 40,196,4
 rta 176,5,33792
 mvaa 72,196,12
 rta 178,5,34048
 mvaa 72,192,8
 s_add_u32 m0, s92, 16896
 rta 180,5,34304
 mvaa 104,192,16
 s_add_u32 s86, s83, 3670272
 s_and_b32 s86, s86, 0x3fffff
 rta 182,5,34560
 mvaa 104,196,20
 buffer_load_dwordx4 v6, s[48:51], s86 offen lds
 mvaa 136,196,28
 s_add_u32 m0, s92, 17952
 s_add_u32 s86, s86, 8192
 mvaa 136,192,24
 buffer_load_dwordx4 v6, s[48:51], s86 offen lds
 mvaa 140,200,24
 rta 184,5,33800
 mvaa 140,204,28
 rta 186,5,34056
 mvaa 108,204,20
 rta 188,5,34312
 mvaa 108,200,16
 rta 190,5,34568
 mvaa 76,200,8
 s_add_u32 m0, s92, 19008
 s_add_u32 s86, s86, 8192
 mvaa 76,204,12
 buffer_load_dwordx4 v6, s[48:51], s86 offen lds
 mvaa 44,204,4
 s_add_u32 m0, s92, 20064
 s_add_u32 s86, s86, 8192
 mvaa 44,200,0
 s_waitcnt lgkmcnt(4)
 buffer_load_dwordx4 v6, s[48:51], s86 offen lds
 mvaa 176,176,40
 rta 192,5,33856
 mvaa 176,180,44
 rta 194,5,34112
 mvaa 208,180,52
 rta 196,5,34368
 mvaa 208,176,48
 rta 198,5,34624
 maaa 80,176,56
 s_add_u32 m0, s80, 38912
 s_add_u32 s81, s82, 896
 s_and_b32 s81, s81, 0x380
 maaa 80,180,60
 buffer_load_dwordx4 v7, s[44:47], s81 offen lds
 maaa 112,180,68
 s_add_u32 m0, s80, 39936
 maaa 112,176,64
 s_waitcnt lgkmcnt(4)
 buffer_load_dwordx4 v8, s[44:47], s81 offen lds
 maaa 116,184,64
 rta 200,5,33864
 maaa 116,188,68
 rta 202,5,34120
 maaa 84,188,60
 rta 204,5,34376
 maaa 84,184,56
 s_waitcnt vmcnt(14)
 rta 206,5,34632
 mvaa 212,184,48
 s_add_u32 m0, s80, 40960
 s_add_u32 s81, s81, 16384
 ds_read_b128 a[0:3], v9 offset:0
 mvaa 212,188,52
 buffer_load_dwordx4 v7, s[44:47], s81 offen lds
 mvaa 180,188,44
 s_add_u32 m0, s80, 41984
 ds_read_b128 a[4:7], v10 offset:0
 mvaa 180,184,40
 s_waitcnt lgkmcnt(6)
 buffer_load_dwordx4 v8, s[44:47], s81 offen lds
 mvaa 184,192,40
 rta 176,5,33920
 mvaa 184,196,44
 rta 178,5,34176
 mvaa 216,196,52
 rta 180,5,34432
 mvaa 216,192,48
 rta 182,5,34688
 maaa 88,192,56
 s_add_u32 m0, s80, 43008
 s_add_u32 s81, s81, 16384
 ds_read_b128 a[8:11], v9 offset:2048
 maaa 88,196,60
 buffer_load_dwordx4 v7, s[44:47], s81 offen lds
 maaa 120,196,68
 s_add_u32 m0, s80, 44032
 ds_read_b128 a[12:15], v10 offset:2048
 maaa 120,192,64
 s_waitcnt lgkmcnt(6)
 buffer_load_dwordx4 v8, s[44:47], s81 offen lds
 maaa 124,200,64
 rta 184,5,33928
 maaa 124,204,68
 rta 186,5,34184
 maaa 92,204,60
 rta 188,5,34440
 maaa 92,200,56
 rta 190,5,34696
 mvaa 220,200,48
 s_add_u32 m0, s80, 45056
 s_add_u32 s81, s81, 16384
 ds_read_b128 a[16:19], v9 offset:4096
 mvaa 220,204,52
 buffer_load_dwordx4 v7, s[44:47], s81 offen lds
 mvaa 188,204,44
 s_add_u32 m0, s80, 46080
 ds_read_b128 a[20:23], v10 offset:4096
 mvaa 188,200,40
 s_waitcnt lgkmcnt(6)
 buffer_load_dwordx4 v8, s[44:47], s81 offen lds
 mvaa 192,176,40
 rta 192,5,33984
 mvaa 192,180,44
 rta 194,5,34240
 mvaa 224,180,52
 rta 196,5,34496
 mvaa 224,176,48
 rta 198,5,34752
 maaa 96,176,56
 ds_read_b128 a[24:27], v9 offset:6144
 maaa 96,180,60
 maaa 128,180,68
 ds_read_b128 a[28:31], v10 offset:6144
 maaa 128,176,64
 s_waitcnt lgkmcnt(6)
 maaa 132,184,64
 rta 200,5,33992
 maaa 132,188,68
 rta 202,5,34248
 maaa 100,188,60
 rta 204,5,34504
 maaa 100,184,56
 rta 206,5,34760
 mvaa 228,184,48
 mvaa 228,188,52
 mvaa 196,188,44
 mvaa 196,184,40
 s_waitcnt lgkmcnt(4)
 mvaa 200,192,40
 s_waitcnt lgkmcnt(0)
 s_barrier
 mvaa 200,196,44
 rta 176,5,50688
 mvaa 232,196,52
 rta 178,5,50944
 mvaa 232,192,48
 s_add_u32 m0, s92, 33792
 rta 180,5,51200
 maaa 104,192,56
 s_add_u32 s86, s83, 3145728
 s_and_b32 s86, s86, 0x3fffff
 rta 182,5,51456
 maaa 104,196,60
 buffer_load_dwordx4 v6, s[48:51], s86 offen lds
 maaa 136,196,68
 s_add_u32 m0, s92, 34848
 s_add_u32 s86, s86, 8192
 maaa 136,192,64
 buffer_load_dwordx4 v6, s[48:51], s86 offen lds
 maaa 140,200,64
 rta 184,5,50696
 maaa 140,204,68
 rta 186,5,50952
 maaa 108,204,60
 rta 188,5,51208
 maaa 108,200,56
 rta 190,5,51464
 mvaa 236,200,48
 s_add_u32 m0, s92, 35904
 s_add_u32 s86, s86, 8192
 mvaa 236,204,52
 buffer_load_dwordx4 v6, s[48:51], s86 offen lds
 mvaa 204,204,44
 s_add_u32 m0, s92, 36960
 s_add_u32 s86, s86, 8192
 mvaa 204,200,40
 s_waitcnt lgkmcnt(4)
 buffer_load_dwordx4 v6, s[48:51], s86 offen lds
 mvaa 16,176,40
 rta 192,5,50752
 mvaa 16,180,44
 rta 194,5,51008
 mvaa 48,180,52
 rta 196,5,51264
 mvaa 48,176,48
 rta 198,5,51520
 mvaa 80,176,56
 s_add_u32 m0, s92, 84480
 s_xor_b32 s93, s39, 0
 mvaa 80,180,60
 buffer_load_dwordx4 v1, s[56:59], s93 offen offset:0 nt lds
 mvaa 112,180,68
 s_add_u32 m0, s92, 84512
 mvaa 112,176,64
 s_waitcnt lgkmcnt(4)
 buffer_load_dwordx4 v1, s[56:59], s93 offen offset:1024 nt lds
 mvaa 116,184,64
 rta 200,5,50760
 mvaa 116,188,68
 rta 202,5,51016
 mvaa 84,188,60
 rta 204,5,51272
 mvaa 84,184,56
 rta 206,5,51528
 mvaa 52,184,48
 s_add_u32 m0, s92, 84544
 mvaa 52,188,52
 buffer_load_dwordx4 v1, s[56:59], s93 offen offset:2048 nt lds
 mvaa 20,188,44
 s_add_u32 m0, s92, 84576
 mvaa 20,184,40
 s_waitcnt lgkmcnt(4)
 buffer_load_dwordx4 v1, s[56:59], s93 offen offset:3072 nt lds
 mvaa 24,192,40
 rta 176,5,50816
 mvaa 24,196,44
 rta 178,5,51072
 mvaa 56,196,52
 rta 180,5,51328
 mvaa 56,192,48
 rta 182,5,51584
 mvaa 88,192,56
 s_add_u32 m0, s92, 101376
 s_xor_b32 s93, s39, 16384
 mvaa 88,196,60
 buffer_load_dwordx4 v1, s[52:55], s93 offen offset:0 nt lds
 mvaa 120,196,68
 s_add_u32 m0, s92, 101408
 mvaa 120,192,64
 s_waitcnt lgkmcnt(4)
 buffer_load_dwordx4 v1, s[52:55], s93 offen offset:1024 nt lds
 mvaa 124,200,64
 rta 184,5,50824
 mvaa 124,204,68
 rta 186,5,51080
 mvaa 92,204,60
 rta 188,5,51336
 mvaa 92,200,56
 rta 190,5,51592
 mvaa 60,200,48
 s_add_u32 m0, s92, 101440
 mvaa 60,204,52
 buffer_load_dwordx4 v1, s[52:55], s93 offen offset:2048 nt lds
 mvaa 28,204,44
 s_add_u32 m0, s92, 101472
 mvaa 28,200,40
 s_waitcnt lgkmcnt(4)
 buffer_load_dwordx4 v1, s[52:55], s93 offen offset:3072 nt lds
 mvaa 32,176,40
 rta 192,5,50880
 mvaa 32,180,44
 rta 194,5,51136
 mvaa 64,180,52
 rta 196,5,51392
 mvaa 64,176,48
 rta 198,5,51648
 mvaa 96,176,56
 mvaa 96,180,60
 mvaa 128,180,68
 mvaa 128,176,64
 s_waitcnt lgkmcnt(4)
 mvaa 132,184,64
 rta 200,5,50888
 mvaa 132,188,68
 rta 202,5,51144
 mvaa 100,188,60
 rta 204,5,51400
 mvaa 100,184,56
 rta 206,5,51656
 mvaa 68,184,48
 mvaa 68,188,52
 mvaa 36,188,44
 mvaa 36,184,40
 s_waitcnt lgkmcnt(4)
 mvaa 40,192,40
 s_waitcnt vmcnt(28) lgkmcnt(0)
 s_barrier
 mvaa 40,196,44
 rta 176,5,0
 mvaa 72,196,52
 rta 178,5,256
 mvaa 72,192,48
 s_add_u32 m0, s92, 50688
 rta 180,5,512
 mvaa 104,192,56
 s_add_u32 s86, s83, 3670016
 s_and_b32 s86, s86, 0x3fffff
 rta 182,5,768
 mvaa 104,196,60
 buffer_load_dwordx4 v6, s[48:51], s86 offen lds
 mvaa 136,196,68
 s_add_u32 m0, s92, 51744
 s_add_u32 s86, s86, 8192
 mvaa 136,192,64
 buffer_load_dwordx4 v6, s[48:51], s86 offen lds
 mvaa 140,200,64
 rta 184,5,8
 mvaa 140,204,68
 rta 186,5,264
 mvaa 108,204,60
 rta 188,5,520
 mvaa 108,200,56
 rta 190,5,776
 mvaa 76,200,48
 s_add_u32 m0, s92, 52800
 s_add_u32 s86, s86, 8192
 mvaa 76,204,52
 buffer_load_dwordx4 v6, s[48:51], s86 offen lds
 mvaa 44,204,44
 s_add_u32 m0, s92, 53856
 s_add_u32 s86, s86, 8192
 mvaa 44,200,40
 s_waitcnt lgkmcnt(4)
 buffer_load_dwordx4 v6, s[48:51], s86 offen lds
 mvaa 176,176,0
 rta 192,5,64
 mvaa 176,180,4
 rta 194,5,320
 mvaa 208,180,12
 s_and_b32 s3, s2, 0xf8
 s_lshl_b32 s3, s3, 6
 rta 196,5,576
 mvaa 208,176,8
 s_waitcnt vmcnt(16)
 s_lshl_b32 s4, s42, 7
 rta 198,5,832
 maaa 80,176,16
 s_add_u32 s3, s3, s4
 ds_read_b128 a[40:43], v9 offset:38912
 v_and_b32 v244, 60, v0
 maaa 80,180,20
 v_lshl_add_u32 v244, v244, 12, s3
 v_min_u32 v246, L14_hot_end-L_pc0-4, v244
 maaa 112,180,28
 ds_read_b128 a[44:47], v10 offset:38912
 v_mov_b32 v247, s95
 maaa 112,176,24
 s_waitcnt lgkmcnt(6)
 v_add_co_u32 v246, vcc, s94, v246
 s_nop 1
 v_addc_co_u32 v247, vcc, 0, v247, vcc
 maaa 116,184,24
 rta 200,5,72
 maaa 116,188,28
 rta 202,5,328
 maaa 84,188,20
 rta 204,5,584
 maaa 84,184,16
 rta 206,5,840
 mvaa 212,184,8
 ds_read_b128 a[48:51], v9 offset:40960
 mvaa 212,188,12
 global_load_dword v13, v[246:247], off
 mvaa 180,188,4
 ds_read_b128 a[52:55], v10 offset:40960
 mvaa 180,184,0
 s_waitcnt lgkmcnt(6)
 mvaa 184,192,0
 rta 176,5,128
 mvaa 184,196,4
 rta 178,5,384
 mvaa 216,196,12
 rta 180,5,640
 mvaa 216,192,8
 rta 182,5,896
 maaa 88,192,16
 ds_read_b128 a[56:59], v9 offset:43008
 maaa 88,196,20
 maaa 120,196,28
 ds_read_b128 a[60:63], v10 offset:43008
 maaa 120,192,24
 s_waitcnt lgkmcnt(6)
 maaa 124,200,24
 rta 184,5,136
 maaa 124,204,28
 rta 186,5,392
 maaa 92,204,20
 rta 188,5,648
 maaa 92,200,16
 rta 190,5,904
 mvaa 220,200,8
 ds_read_b128 a[64:67], v9 offset:45056
 mvaa 220,204,12
 mvaa 188,204,4
 ds_read_b128 a[68:71], v10 offset:45056
 mvaa 188,200,0
 s_waitcnt lgkmcnt(6)
 mvaa 192,176,0
 rta 192,5,192
 mvaa 192,180,4
 rta 194,5,448
 mvaa 224,180,12
 rta 196,5,704
 mvaa 224,176,8
 rta 198,5,960
 maaa 96,176,16
 maaa 96,180,20
 maaa 128,180,28
 maaa 128,176,24
 s_waitcnt lgkmcnt(4)
 maaa 132,184,24
 rta 200,5,200
 maaa 132,188,28
 rta 202,5,456
 maaa 100,188,20
 rta 204,5,712
 maaa 100,184,16
 rta 206,5,968
 mvaa 228,184,8
 mvaa 228,188,12
 mvaa 196,188,4
 mvaa 196,184,0
 s_waitcnt lgkmcnt(4)
 mvaa 200,192,0
 s_waitcnt lgkmcnt(0)
 s_barrier
 mvaa 200,196,4
 rta 176,5,16896
 mvaa 232,196,12
 rta 178,5,17152
 mvaa 232,192,8
 rta 180,5,17408
 maaa 104,192,16
 s_add_u32 m0, s92, 0
 s_xor_b32 s93, s39, 32768
 rta 182,5,17664
 maaa 104,196,20
 buffer_load_dwordx4 v1, s[52:55], s93 offen offset:0 nt lds
 maaa 136,196,28
 s_add_u32 m0, s92, 32
 maaa 136,192,24
 buffer_load_dwordx4 v1, s[52:55], s93 offen offset:1024 nt lds
 maaa 140,200,24
 rta 184,5,16904
 maaa 140,204,28
 rta 186,5,17160
 maaa 108,204,20
 rta 188,5,17416
 maaa 108,200,16
 rta 190,5,17672
 mvaa 236,200,8
 s_add_u32 m0, s92, 64
 mvaa 236,204,12
 buffer_load_dwordx4 v1, s[52:55], s93 offen offset:2048 nt lds
 mvaa 204,204,4
 s_add_u32 m0, s92, 96
 mvaa 204,200,0
 s_waitcnt lgkmcnt(4)
 buffer_load_dwordx4 v1, s[52:55], s93 offen offset:3072 nt lds
 mvaa 176,176,40
 rta 192,5,16960
 mvaa 176,180,44
 rta 194,5,17216
 mvaa 208,180,52
 rta 196,5,17472
 mvaa 208,176,48
 rta 198,5,17728
 maaa 80,176,56
 s_add_u32 m0, s92, 118272
 s_xor_b32 s93, s39, 16384
 maaa 80,180,60
 buffer_load_dwordx4 v1, s[56:59], s93 offen offset:0 nt lds
 maaa 112,180,68
 s_add_u32 m0, s92, 118304
 maaa 112,176,64
 s_waitcnt lgkmcnt(4)
 buffer_load_dwordx4 v1, s[56:59], s93 offen offset:1024 nt lds
 maaa 116,184,64
 rta 200,5,16968
 maaa 116,188,68
 rta 202,5,17224
 maaa 84,188,60
 rta 204,5,17480
 maaa 84,184,56
 rta 206,5,17736
 mvaa 212,184,48
 s_add_u32 m0, s92, 118336
 mvaa 212,188,52
 buffer_load_dwordx4 v1, s[56:59], s93 offen offset:2048 nt lds
 mvaa 180,188,44
 s_add_u32 m0, s92, 118368
 mvaa 180,184,40
 s_waitcnt lgkmcnt(4)
 buffer_load_dwordx4 v1, s[56:59], s93 offen offset:3072 nt lds
 mvaa 184,192,40
 rta 176,5,17024
 mvaa 184,196,44
 rta 178,5,17280
 mvaa 216,196,52
 s_mul_i32 s3, s42, 7168
 s_add_u32 s3, s3, 135168
 rta 180,5,17536
 mvaa 216,192,48
 rta 182,5,17792
 v_add_u32 v14, s3, v2
 maaa 88,192,56
 v_mul_f32 v208, s88, v208
 v_mul_f32 v209, s88, v209
 maaa 88,196,60
 v_mul_f32 v210, s88, v210
 v_mul_f32 v211, s88, v211
 maaa 120,196,68
 v_mul_f32 v212, s88, v212
 v_mul_f32 v213, s88, v213
 maaa 120,192,64
 s_waitcnt lgkmcnt(4)
 v_mul_f32 v214, s88, v214
 v_mul_f32 v215, s88, v215
 maaa 124,200,64
 rta 184,5,17032
 pk 208,208
 maaa 124,204,68
 rta 186,5,17288
 pk 209,210
 maaa 92,204,60
 rta 188,5,17544
 pk 210,212
 maaa 92,200,56
 rta 190,5,17800
 pk 211,214
 mvaa 220,200,48
 ds_write_b128 v14, v[208:211] offset:0
 v_mul_f32 v176, s88, v176
 mvaa 220,204,52
 v_mul_f32 v177, s88, v177
 v_mul_f32 v178, s88, v178
 mvaa 188,204,44
 v_mul_f32 v179, s88, v179
 v_mul_f32 v180, s88, v180
 mvaa 188,200,40
 s_waitcnt lgkmcnt(5)
 v_mul_f32 v181, s88, v181
 v_mul_f32 v182, s88, v182
 mvaa 192,176,40
 rta 192,5,17088
 v_mul_f32 v183, s88, v183
 mvaa 192,180,44
 rta 194,5,17344
 pk 240,176
 mvaa 224,180,52
 rta 196,5,17600
 pk 241,178
 mvaa 224,176,48
 rta 198,5,17856
 pk 242,180
 maaa 96,176,56
 pk 243,182
 maaa 96,180,60
 v_mul_f32 v216, s88, v216
 v_mul_f32 v217, s88, v217
 maaa 128,180,68
 v_mul_f32 v218, s88, v218
 v_mul_f32 v219, s88, v219
 maaa 128,176,64
 s_waitcnt lgkmcnt(4)
 v_mul_f32 v220, s88, v220
 v_mul_f32 v221, s88, v221
 maaa 132,184,64
 rta 200,5,17096
 v_mul_f32 v222, s88, v222
 maaa 132,188,68
 rta 202,5,17352
 v_mul_f32 v223, s88, v223
 maaa 100,188,60
 rta 204,5,17608
 pk 216,216
 maaa 100,184,56
 rta 206,5,17864
 pk 217,218
 mvaa 228,184,48
 pk 218,220
 pk 219,222
 mvaa 228,188,52
 ds_write_b128 v14, v[216:219] offset:1024
 v_mul_f32 v184, s88, v184
 mvaa 196,188,44
 v_mul_f32 v185, s88, v185
 v_mul_f32 v186, s88, v186
 mvaa 196,184,40
 s_waitcnt lgkmcnt(5)
 v_mul_f32 v187, s88, v187
 v_mul_f32 v188, s88, v188
 mvaa 200,192,40
 s_waitcnt vmcnt(21) lgkmcnt(0)
 s_barrier
 mvaa 200,196,44
 rta 176,5,33792
 v_mul_f32 v189, s88, v189
 mvaa 232,196,52
 rta 178,5,34048
 v_mul_f32 v190, s88, v190
 mvaa 232,192,48
 rta 180,5,34304
 v_mul_f32 v191, s88, v191
 maaa 104,192,56
 s_add_u32 m0, s92, 16896
 s_xor_b32 s93, s39, 32768
 rta 182,5,34560
 maaa 104,196,60
 buffer_load_dwordx4 v1, s[56:59], s93 offen offset:0 nt lds
 pk 244,184
 maaa 136,196,68
 s_add_u32 m0, s92, 16928
 pk 245,186
 pk 246,188
 maaa 136,192,64
 buffer_load_dwordx4 v1, s[56:59], s93 offen offset:1024 nt lds
 pk 247,190
 maaa 140,200,64
 rta 184,5,33800
 v_mul_f32 v224, s88, v224
 maaa 140,204,68
 rta 186,5,34056
 v_mul_f32 v225, s88, v225
 maaa 108,204,60
 rta 188,5,34312
 v_mul_f32 v226, s88, v226
 maaa 108,200,56
 rta 190,5,34568
 v_mul_f32 v227, s88, v227
 mvaa 236,200,48
 s_add_u32 m0, s92, 16960
 v_mul_f32 v228, s88, v228
 v_mul_f32 v229, s88, v229
 mvaa 236,204,52
 buffer_load_dwordx4 v1, s[56:59], s93 offen offset:2048 nt lds
 v_mul_f32 v230, s88, v230
 mvaa 204,204,44
 s_add_u32 m0, s92, 16992
 v_mul_f32 v231, s88, v231
 pk 224,224
 mvaa 204,200,40
 s_waitcnt lgkmcnt(4)
 buffer_load_dwordx4 v1, s[56:59], s93 offen offset:3072 nt lds
 pk 225,226
 mvaa 16,176,0
 rta 192,5,33856
 pk 226,228
 mvaa 16,180,4
 rta 194,5,34112
 pk 227,230
 mvaa 48,180,12
 rta 196,5,34368
 mvaa 48,176,8
 rta 198,5,34624
 mvaa 80,176,16
 ds_write_b128 v14, v[224:227] offset:2048
 v_mul_f32 v192, s88, v192
 mvaa 80,180,20
 v_mul_f32 v193, s88, v193
 v_mul_f32 v194, s88, v194
 mvaa 112,180,28
 v_mul_f32 v195, s88, v195
 v_mul_f32 v196, s88, v196
 mvaa 112,176,24
 s_waitcnt lgkmcnt(5)
 v_mul_f32 v197, s88, v197
 v_mul_f32 v198, s88, v198
 mvaa 116,184,24
 rta 200,5,33864
 v_mul_f32 v199, s88, v199
 mvaa 116,188,28
 rta 202,5,34120
 pk 248,192
 mvaa 84,188,20
 rta 204,5,34376
 pk 249,194
 mvaa 84,184,16
 rta 206,5,34632
 pk 250,196
 mvaa 52,184,8
 pk 251,198
 mvaa 52,188,12
 v_mul_f32 v232, s88, v232
 v_mul_f32 v233, s88, v233
 mvaa 20,188,4
 v_mul_f32 v234, s88, v234
 v_mul_f32 v235, s88, v235
 mvaa 20,184,0
 s_waitcnt lgkmcnt(4)
 v_mul_f32 v236, s88, v236
 v_mul_f32 v237, s88, v237
 mvaa 24,192,0
 rta 176,5,33920
 v_mul_f32 v238, s88, v238
 mvaa 24,196,4
 rta 178,5,34176
 v_mul_f32 v239, s88, v239
 mvaa 56,196,12
 rta 180,5,34432
 pk 232,232
 mvaa 56,192,8
 rta 182,5,34688
 pk 233,234
 mvaa 88,192,16
 pk 234,236
 pk 235,238
 mvaa 88,196,20
 ds_write_b128 v14, v[232:235] offset:3072
 v_mul_f32 v200, s88, v200
 mvaa 120,196,28
 v_mul_f32 v201, s88, v201
 v_mul_f32 v202, s88, v202
 mvaa 120,192,24
 s_waitcnt lgkmcnt(5)
 v_mul_f32 v203, s88, v203
 v_mul_f32 v204, s88, v204
 mvaa 124,200,24
 rta 184,5,33928
 v_mul_f32 v205, s88, v205
 mvaa 124,204,28
 rta 186,5,34184
 v_mul_f32 v206, s88, v206
 mvaa 92,204,20
 rta 188,5,34440
 v_mul_f32 v207, s88, v207
 mvaa 92,200,16
 rta 190,5,34696
 pk 252,200
 mvaa 60,200,8
 pk 253,202
 pk 254,204
 mvaa 60,204,12
 pk 255,206
 v_accvgpr_read_b32 v192, a80
 mvaa 28,204,4
 v_accvgpr_read_b32 v193, a81
 v_accvgpr_read_b32 v194, a82
 mvaa 28,200,0
 s_waitcnt lgkmcnt(4)
 v_accvgpr_read_b32 v195, a83
 v_accvgpr_read_b32 v196, a84
 mvaa 32,176,0
 rta 192,5,33984
 v_accvgpr_read_b32 v197, a85
 mvaa 32,180,4
 rta 194,5,34240
 v_accvgpr_read_b32 v198, a86
 mvaa 64,180,12
 rta 196,5,34496
 v_accvgpr_read_b32 v199, a87
 mvaa 64,176,8
 rta 198,5,34752
 v_mul_f32 v192, s88, v192
 mvaa 96,176,16
 v_mul_f32 v193, s88, v193
 v_mul_f32 v194, s88, v194
 mvaa 96,180,20
 v_mul_f32 v195, s88, v195
 v_mul_f32 v196, s88, v196
 mvaa 128,180,28
 v_mul_f32 v197, s88, v197
 v_mul_f32 v198, s88, v198
 mvaa 128,176,24
 s_waitcnt lgkmcnt(4)
 v_mul_f32 v199, s88, v199
 pk 228,192
 mvaa 132,184,24
 rta 200,5,33992
 pk 229,194
 mvaa 132,188,28
 rta 202,5,34248
 pk 230,196
 mvaa 100,188,20
 rta 204,5,34504
 pk 231,198
 mvaa 100,184,16
 rta 206,5,34760
 v_accvgpr_read_b32 v200, a88
 mvaa 68,184,8
 v_accvgpr_read_b32 v201, a89
 v_accvgpr_read_b32 v202, a90
 mvaa 68,188,12
 v_accvgpr_read_b32 v203, a91
 v_accvgpr_read_b32 v204, a92
 mvaa 36,188,4
 v_accvgpr_read_b32 v205, a93
 v_accvgpr_read_b32 v206, a94
 mvaa 36,184,0
 s_waitcnt lgkmcnt(4)
 v_accvgpr_read_b32 v207, a95
 v_mul_f32 v200, s88, v200
 mvaa 40,192,0
 s_waitcnt vmcnt(13) lgkmcnt(0)
 s_barrier
 mvaa 40,196,4
 rta 176,5,50688
 v_mul_f32 v201, s88, v201
 mvaa 72,196,12
 rta 178,5,50944
 v_mul_f32 v202, s88, v202
 mvaa 72,192,8
 rta 180,5,51200
 v_mul_f32 v203, s88, v203
 mvaa 104,192,16
 s_add_u32 m0, s92, 33792
 s_xor_b32 s93, s39, 49152
 rta 182,5,51456
 mvaa 104,196,20
 buffer_load_dwordx4 v1, s[52:55], s93 offen offset:0 nt lds
 v_mul_f32 v204, s88, v204
 mvaa 136,196,28
 s_add_u32 m0, s92, 33824
 v_mul_f32 v205, s88, v205
 v_mul_f32 v206, s88, v206
 mvaa 136,192,24
 buffer_load_dwordx4 v1, s[52:55], s93 offen offset:1024 nt lds
 v_mul_f32 v207, s88, v207
 mvaa 140,200,24
 rta 184,5,50696
 pk 232,200
 mvaa 140,204,28
 rta 186,5,50952
 pk 233,202
 mvaa 108,204,20
 rta 188,5,51208
 pk 234,204
 mvaa 108,200,16
 rta 190,5,51464
 pk 235,206
 mvaa 76,200,8
 s_add_u32 m0, s92, 33856
 v_accvgpr_read_b32 v176, a96
 v_accvgpr_read_b32 v177, a97
 mvaa 76,204,12
 buffer_load_dwordx4 v1, s[52:55], s93 offen offset:2048 nt lds
 v_accvgpr_read_b32 v178, a98
 mvaa 44,204,4
 s_add_u32 m0, s92, 33888
 v_accvgpr_read_b32 v179, a99
 v_accvgpr_read_b32 v180, a100
 mvaa 44,200,0
 s_waitcnt lgkmcnt(4)
 buffer_load_dwordx4 v1, s[52:55], s93 offen offset:3072 nt lds
 v_accvgpr_read_b32 v181, a101
 mvaa 16,176,40
 rta 192,5,50752
 v_accvgpr_read_b32 v182, a102
 mvaa 16,180,44
 rta 194,5,51008
 v_accvgpr_read_b32 v183, a103
 mvaa 48,180,52
 rta 196,5,51264
 v_mul_f32 v176, s88, v176
 mvaa 48,176,48
 rta 198,5,51520
 v_mul_f32 v177, s88, v177
 mvaa 80,176,56
 v_mul_f32 v178, s88, v178
 v_mul_f32 v179, s88, v179
 mvaa 80,180,60
 v_mul_f32 v180, s88, v180
 v_mul_f32 v181, s88, v181
 mvaa 112,180,68
 v_mul_f32 v182, s88, v182
 v_mul_f32 v183, s88, v183
 mvaa 112,176,64
 s_waitcnt lgkmcnt(4)
 pk 236,176
 pk 237,178
 mvaa 116,184,64
 rta 200,5,50760
 pk 238,180
 mvaa 116,188,68
 rta 202,5,51016
 pk 239,182
 mvaa 84,188,60
 rta 204,5,51272
 v_accvgpr_read_b32 v184, a104
 mvaa 84,184,56
 rta 206,5,51528
 v_accvgpr_read_b32 v185, a105
 mvaa 52,184,48
 v_accvgpr_read_b32 v186, a106
 v_accvgpr_read_b32 v187, a107
 mvaa 52,188,52
 v_accvgpr_read_b32 v188, a108
 v_accvgpr_read_b32 v189, a109
 mvaa 20,188,44
 v_accvgpr_read_b32 v190, a110
 v_accvgpr_read_b32 v191, a111
 mvaa 20,184,40
 s_waitcnt lgkmcnt(4)
 v_mul_f32 v184, s88, v184
 v_mul_f32 v185, s88, v185
 mvaa 24,192,40
 rta 176,5,50816
 v_mul_f32 v186, s88, v186
 mvaa 24,196,44
 rta 178,5,51072
 v_mul_f32 v187, s88, v187
 mvaa 56,196,52
 rta 180,5,51328
 v_mul_f32 v188, s88, v188
 mvaa 56,192,48
 rta 182,5,51584
 v_mul_f32 v189, s88, v189
 mvaa 88,192,56
 v_mul_f32 v190, s88, v190
 v_mul_f32 v191, s88, v191
 mvaa 88,196,60
 pk 184,184
 pk 185,186
 mvaa 120,196,68
 pk 186,188
 pk 187,190
 mvaa 120,192,64
 s_waitcnt lgkmcnt(4)
 v_accvgpr_write_b32 a228, v184
 v_accvgpr_write_b32 a229, v185
 mvaa 124,200,64
 rta 184,5,50824
 v_accvgpr_write_b32 a230, v186
 mvaa 124,204,68
 rta 186,5,51080
 v_accvgpr_write_b32 a231, v187
 mvaa 92,204,60
 rta 188,5,51336
 v_accvgpr_read_b32 v192, a112
 mvaa 92,200,56
 rta 190,5,51592
 v_accvgpr_read_b32 v193, a113
 mvaa 60,200,48
 v_accvgpr_read_b32 v194, a114
 v_accvgpr_read_b32 v195, a115
 mvaa 60,204,52
 v_accvgpr_read_b32 v196, a116
 v_accvgpr_read_b32 v197, a117
 mvaa 28,204,44
 v_accvgpr_read_b32 v198, a118
 v_accvgpr_read_b32 v199, a119
 mvaa 28,200,40
 s_waitcnt lgkmcnt(4)
 v_mul_f32 v192, s88, v192
 v_mul_f32 v193, s88, v193
 mvaa 32,176,40
 rta 192,5,50880
 v_mul_f32 v194, s88, v194
 mvaa 32,180,44
 rta 194,5,51136
 v_mul_f32 v195, s88, v195
 mvaa 64,180,52
 rta 196,5,51392
 v_mul_f32 v196, s88, v196
 mvaa 64,176,48
 rta 198,5,51648
 v_mul_f32 v197, s88, v197
 mvaa 96,176,56
 v_mul_f32 v198, s88, v198
 v_mul_f32 v199, s88, v199
 mvaa 96,180,60
 pk 192,192
 pk 193,194
 mvaa 128,180,68
 pk 194,196
 pk 195,198
 mvaa 128,176,64
 s_waitcnt lgkmcnt(4)
 v_accvgpr_write_b32 a232, v192
 v_accvgpr_write_b32 a233, v193
 mvaa 132,184,64
 rta 200,5,50888
 v_accvgpr_write_b32 a234, v194
 mvaa 132,188,68
 rta 202,5,51144
 v_accvgpr_write_b32 a235, v195
 mvaa 100,188,60
 rta 204,5,51400
 v_accvgpr_read_b32 v200, a120
 mvaa 100,184,56
 rta 206,5,51656
 v_accvgpr_read_b32 v201, a121
 mvaa 68,184,48
 v_accvgpr_read_b32 v202, a122
 v_accvgpr_read_b32 v203, a123
 mvaa 68,188,52
 v_accvgpr_read_b32 v204, a124
 v_accvgpr_read_b32 v205, a125
 mvaa 36,188,44
 v_accvgpr_read_b32 v206, a126
 v_accvgpr_read_b32 v207, a127
 mvaa 36,184,40
 s_waitcnt lgkmcnt(4)
 v_mul_f32 v200, s88, v200
 v_mul_f32 v201, s88, v201
 mvaa 40,192,40
 s_waitcnt lgkmcnt(0)
 s_barrier
 mvaa 40,196,44
 v_mul_f32 v202, s88, v202
 v_mul_f32 v203, s88, v203
 mvaa 72,196,52
 v_mul_f32 v204, s88, v204
 v_mul_f32 v205, s88, v205
 mvaa 72,192,48
 v_mul_f32 v206, s88, v206
 v_mul_f32 v207, s88, v207
 mvaa 104,192,56
 s_add_u32 m0, s92, 50688
 s_xor_b32 s93, s39, 49152
 pk 200,200
 mvaa 104,196,60
 buffer_load_dwordx4 v1, s[56:59], s93 offen offset:0 nt lds
 pk 201,202
 mvaa 136,196,68
 s_add_u32 m0, s92, 50720
 pk 202,204
 pk 203,206
 mvaa 136,192,64
 buffer_load_dwordx4 v1, s[56:59], s93 offen offset:1024 nt lds
 v_accvgpr_write_b32 a236, v200
 mvaa 140,200,64
 v_accvgpr_write_b32 a237, v201
 v_accvgpr_write_b32 a238, v202
 mvaa 140,204,68
 v_accvgpr_write_b32 a239, v203
 v_accvgpr_read_b32 v176, a128
 mvaa 108,204,60
 v_accvgpr_read_b32 v177, a129
 v_accvgpr_read_b32 v178, a130
 mvaa 108,200,56
 v_accvgpr_read_b32 v179, a131
 v_accvgpr_read_b32 v180, a132
 mvaa 76,200,48
 s_add_u32 m0, s92, 50752
 v_accvgpr_read_b32 v181, a133
 v_accvgpr_read_b32 v182, a134
 mvaa 76,204,52
 buffer_load_dwordx4 v1, s[56:59], s93 offen offset:2048 nt lds
 v_accvgpr_read_b32 v183, a135
 mvaa 44,204,44
 s_add_u32 m0, s92, 50784
 v_mul_f32 v176, s88, v176
 v_mul_f32 v177, s88, v177
 mvaa 44,200,40
 buffer_load_dwordx4 v1, s[56:59], s93 offen offset:3072 nt lds
 v_mul_f32 v178, s88, v178
 v_mul_f32 v179, s88, v179
 v_mul_f32 v180, s88, v180
 v_mul_f32 v181, s88, v181
 v_mul_f32 v182, s88, v182
 v_mul_f32 v183, s88, v183
 pk 176,176
 pk 177,178
 pk 178,180
 pk 179,182
 v_accvgpr_write_b32 a240, v176
 v_accvgpr_write_b32 a241, v177
 v_accvgpr_write_b32 a242, v178
 v_accvgpr_write_b32 a243, v179
 v_accvgpr_read_b32 v184, a136
 v_accvgpr_read_b32 v185, a137
 v_accvgpr_read_b32 v186, a138
 v_accvgpr_read_b32 v187, a139
 v_accvgpr_read_b32 v188, a140
 v_accvgpr_read_b32 v189, a141
 v_accvgpr_read_b32 v190, a142
 v_accvgpr_read_b32 v191, a143
 v_pk_mul_f32 v[184:185], v[184:185], s[88:89]
 v_pk_mul_f32 v[186:187], v[186:187], s[88:89]
 v_pk_mul_f32 v[188:189], v[188:189], s[88:89]
 v_pk_mul_f32 v[190:191], v[190:191], s[88:89]
 pk 184,184
 pk 185,186
 pk 186,188
 pk 187,190
 v_accvgpr_write_b32 a244, v184
 v_accvgpr_write_b32 a245, v185
 v_accvgpr_write_b32 a246, v186
 v_accvgpr_write_b32 a247, v187
 s_mov_b32 s3, 67584
 v_lshrrev_b32 v15, 2, v0
 v_and_or_b32 v15, v15, 48, s3
 ds_read_b128 v[176:179], v15 offset:0
 ds_read_b128 v[180:183], v15 offset:64
 ds_read_b128 v[184:187], v15 offset:128
 ds_read_b128 v[188:191], v15 offset:192
 ds_read_b128 a[80:83], v3 offset:0
 ds_read_b128 a[84:87], v3 offset:64
 ds_read_b128 a[88:91], v3 offset:128
 ds_read_b128 a[92:95], v3 offset:192
 ds_read_b128 a[96:99], v3 offset:256
 ds_read_b128 a[100:103], v3 offset:320
 ds_read_b128 a[104:107], v3 offset:384
 ds_read_b128 a[108:111], v3 offset:448
 ds_read_b128 a[112:115], v3 offset:512
 ds_read_b128 a[116:119], v3 offset:576
 ds_read_b128 a[120:123], v3 offset:640
 ds_read_b128 a[124:127], v3 offset:704
 ds_read_b128 a[128:131], v3 offset:768
 ds_read_b128 a[132:135], v3 offset:832
 ds_read_b128 a[136:139], v3 offset:896
 ds_read_b128 a[140:143], v3 offset:960
 v_pk_mul_f32 v[16:17], v[16:17], s[88:89]
 v_pk_mul_f32 v[18:19], v[18:19], s[88:89]
 v_pk_mul_f32 v[20:21], v[20:21], s[88:89]
 v_pk_mul_f32 v[22:23], v[22:23], s[88:89]
 pk 16,16
 pk 17,18
 pk 18,20
 pk 19,22
 v_accvgpr_write_b32 a0, v16
 v_accvgpr_write_b32 a1, v17
 v_accvgpr_write_b32 a2, v18
 v_accvgpr_write_b32 a3, v19
 v_pk_mul_f32 v[24:25], v[24:25], s[88:89]
 v_pk_mul_f32 v[26:27], v[26:27], s[88:89]
 v_pk_mul_f32 v[28:29], v[28:29], s[88:89]
 v_pk_mul_f32 v[30:31], v[30:31], s[88:89]
 pk 24,24
 pk 25,26
 pk 26,28
 pk 27,30
 v_accvgpr_write_b32 a4, v24
 v_accvgpr_write_b32 a5, v25
 v_accvgpr_write_b32 a6, v26
 v_accvgpr_write_b32 a7, v27
 v_pk_mul_f32 v[32:33], v[32:33], s[88:89]
 v_pk_mul_f32 v[34:35], v[34:35], s[88:89]
 v_pk_mul_f32 v[36:37], v[36:37], s[88:89]
 v_pk_mul_f32 v[38:39], v[38:39], s[88:89]
 pk 32,32
 pk 33,34
 pk 34,36
 pk 35,38
 v_accvgpr_write_b32 a8, v32
 v_accvgpr_write_b32 a9, v33
 v_accvgpr_write_b32 a10, v34
 v_accvgpr_write_b32 a11, v35
 s_waitcnt lgkmcnt(15)
 v_xor_b32 v176, 0x80008000, v176
 v_xor_b32 v177, 0x80008000, v177
 v_xor_b32 v178, 0x80008000, v178
 v_xor_b32 v179, 0x80008000, v179
 v_xor_b32 v180, 0x80008000, v180
 v_xor_b32 v181, 0x80008000, v181
 v_xor_b32 v182, 0x80008000, v182
 v_xor_b32 v183, 0x80008000, v183
 v_xor_b32 v184, 0x80008000, v184
 v_xor_b32 v185, 0x80008000, v185
 v_xor_b32 v186, 0x80008000, v186
 v_xor_b32 v187, 0x80008000, v187
 v_xor_b32 v188, 0x80008000, v188
 v_xor_b32 v189, 0x80008000, v189
 v_xor_b32 v190, 0x80008000, v190
 v_xor_b32 v191, 0x80008000, v191
 v_pk_mul_f32 v[40:41], v[40:41], s[88:89]
 v_pk_mul_f32 v[42:43], v[42:43], s[88:89]
 v_pk_mul_f32 v[44:45], v[44:45], s[88:89]
 v_pk_mul_f32 v[46:47], v[46:47], s[88:89]
 pk 40,40
 pk 41,42
 pk 42,44
 pk 43,46
 v_accvgpr_write_b32 a12, v40
 v_accvgpr_write_b32 a13, v41
 v_accvgpr_write_b32 a14, v42
 v_accvgpr_write_b32 a15, v43
 v_pk_mul_f32 v[48:49], v[48:49], s[88:89]
 v_pk_mul_f32 v[50:51], v[50:51], s[88:89]
 v_pk_mul_f32 v[52:53], v[52:53], s[88:89]
 v_pk_mul_f32 v[54:55], v[54:55], s[88:89]
 mvvaz 208,176,0
 pk 48,48
 pk 49,50
 pk 50,52
 pk 51,54
 v_accvgpr_write_b32 a16, v48
 v_accvgpr_write_b32 a17, v49
 v_accvgpr_write_b32 a18, v50
 v_accvgpr_write_b32 a19, v51
 v_pk_mul_f32 v[56:57], v[56:57], s[88:89]
 v_pk_mul_f32 v[58:59], v[58:59], s[88:89]
 v_pk_mul_f32 v[60:61], v[60:61], s[88:89]
 v_pk_mul_f32 v[62:63], v[62:63], s[88:89]
 mvva 208,180,4
 pk 56,56
 pk 57,58
 pk 58,60
 pk 59,62
 v_accvgpr_write_b32 a20, v56
 v_accvgpr_write_b32 a21, v57
 v_accvgpr_write_b32 a22, v58
 v_accvgpr_write_b32 a23, v59
 v_pk_mul_f32 v[64:65], v[64:65], s[88:89]
 v_pk_mul_f32 v[66:67], v[66:67], s[88:89]
 v_pk_mul_f32 v[68:69], v[68:69], s[88:89]
 v_pk_mul_f32 v[70:71], v[70:71], s[88:89]
 mvva 208,184,8
 pk 64,64
 pk 65,66
 pk 66,68
 pk 67,70
 v_accvgpr_write_b32 a24, v64
 v_accvgpr_write_b32 a25, v65
 v_accvgpr_write_b32 a26, v66
 v_accvgpr_write_b32 a27, v67
 v_pk_mul_f32 v[72:73], v[72:73], s[88:89]
 v_pk_mul_f32 v[74:75], v[74:75], s[88:89]
 v_pk_mul_f32 v[76:77], v[76:77], s[88:89]
 v_pk_mul_f32 v[78:79], v[78:79], s[88:89]
 mvva 208,188,12
 pk 72,72
 pk 73,74
 pk 74,76
 pk 75,78
 v_accvgpr_write_b32 a28, v72
 v_accvgpr_write_b32 a29, v73
 v_accvgpr_write_b32 a30, v74
 v_accvgpr_write_b32 a31, v75
 v_pk_mul_f32 v[80:81], v[80:81], s[88:89]
 v_pk_mul_f32 v[82:83], v[82:83], s[88:89]
 v_pk_mul_f32 v[84:85], v[84:85], s[88:89]
 v_pk_mul_f32 v[86:87], v[86:87], s[88:89]
 mvvaz 212,176,16
 pk 80,80
 pk 81,82
 pk 82,84
 pk 83,86
 v_accvgpr_write_b32 a32, v80
 v_accvgpr_write_b32 a33, v81
 v_accvgpr_write_b32 a34, v82
 v_accvgpr_write_b32 a35, v83
 v_pk_mul_f32 v[88:89], v[88:89], s[88:89]
 v_pk_mul_f32 v[90:91], v[90:91], s[88:89]
 v_pk_mul_f32 v[92:93], v[92:93], s[88:89]
 v_pk_mul_f32 v[94:95], v[94:95], s[88:89]
 mvva 212,180,20
 pk 88,88
 pk 89,90
 pk 90,92
 pk 91,94
 v_accvgpr_write_b32 a36, v88
 v_accvgpr_write_b32 a37, v89
 v_accvgpr_write_b32 a38, v90
 v_accvgpr_write_b32 a39, v91
 v_pk_mul_f32 v[96:97], v[96:97], s[88:89]
 v_pk_mul_f32 v[98:99], v[98:99], s[88:89]
 v_pk_mul_f32 v[100:101], v[100:101], s[88:89]
 v_pk_mul_f32 v[102:103], v[102:103], s[88:89]
 mvva 212,184,24
 pk 96,96
 pk 97,98
 pk 98,100
 pk 99,102
 v_accvgpr_write_b32 a40, v96
 v_accvgpr_write_b32 a41, v97
 v_accvgpr_write_b32 a42, v98
 v_accvgpr_write_b32 a43, v99
 v_pk_mul_f32 v[104:105], v[104:105], s[88:89]
 v_pk_mul_f32 v[106:107], v[106:107], s[88:89]
 v_pk_mul_f32 v[108:109], v[108:109], s[88:89]
 v_pk_mul_f32 v[110:111], v[110:111], s[88:89]
 mvva 212,188,28
 pk 104,104
 pk 105,106
 pk 106,108
 pk 107,110
 v_accvgpr_write_b32 a44, v104
 v_accvgpr_write_b32 a45, v105
 v_accvgpr_write_b32 a46, v106
 v_accvgpr_write_b32 a47, v107
 v_pk_mul_f32 v[112:113], v[112:113], s[88:89]
 v_pk_mul_f32 v[114:115], v[114:115], s[88:89]
 v_pk_mul_f32 v[116:117], v[116:117], s[88:89]
 v_pk_mul_f32 v[118:119], v[118:119], s[88:89]
 mvvaz 216,176,32
 pk 112,112
 pk 113,114
 pk 114,116
 pk 115,118
 v_accvgpr_write_b32 a48, v112
 v_accvgpr_write_b32 a49, v113
 v_accvgpr_write_b32 a50, v114
 v_accvgpr_write_b32 a51, v115
 v_pk_mul_f32 v[120:121], v[120:121], s[88:89]
 v_pk_mul_f32 v[122:123], v[122:123], s[88:89]
 v_pk_mul_f32 v[124:125], v[124:125], s[88:89]
 v_pk_mul_f32 v[126:127], v[126:127], s[88:89]
 mvva 216,180,36
 pk 120,120
 pk 121,122
 pk 122,124
 pk 123,126
 v_accvgpr_write_b32 a52, v120
 v_accvgpr_write_b32 a53, v121
 v_accvgpr_write_b32 a54, v122
 v_accvgpr_write_b32 a55, v123
 v_pk_mul_f32 v[128:129], v[128:129], s[88:89]
 v_pk_mul_f32 v[130:131], v[130:131], s[88:89]
 v_pk_mul_f32 v[132:133], v[132:133], s[88:89]
 v_pk_mul_f32 v[134:135], v[134:135], s[88:89]
 mvva 216,184,40
 pk 128,128
 pk 129,130
 pk 130,132
 pk 131,134
 v_accvgpr_write_b32 a56, v128
 v_accvgpr_write_b32 a57, v129
 v_accvgpr_write_b32 a58, v130
 v_accvgpr_write_b32 a59, v131
 v_pk_mul_f32 v[136:137], v[136:137], s[88:89]
 v_pk_mul_f32 v[138:139], v[138:139], s[88:89]
 v_pk_mul_f32 v[140:141], v[140:141], s[88:89]
 v_pk_mul_f32 v[142:143], v[142:143], s[88:89]
 mvva 216,188,44
 pk 136,136
 pk 137,138
 pk 138,140
 pk 139,142
 v_accvgpr_write_b32 a60, v136
 v_accvgpr_write_b32 a61, v137
 v_accvgpr_write_b32 a62, v138
 v_accvgpr_write_b32 a63, v139
 v_and_b32 v14, 12, v0
 v_cmp_eq_u32 vcc, 0, v14
 v_mov_b32 v15, 0x3f803f80
 s_nop 0
 v_cndmask_b32 v14, 0, v15, vcc
 v_accvgpr_write_b32 a224, v14
 v_accvgpr_write_b32 a225, v14
 v_accvgpr_write_b32 a226, v14
 v_accvgpr_write_b32 a227, v14
 s_mov_b32 s81, 16384
 s_mov_b64 s[44:45], s[40:41]
 s_mov_b32 s46, 2048
 v_mov_b32 v14, 0
 s_lshl_b32 s3, s9, 6
 s_mov_b64 exec, 7
 buffer_store_dword v14, v0, s[44:47], s3 offen sc1
 s_mov_b64 exec, -1
 v_mov_b32 v160, -1
 v_mov_b32 v161, -1
 v_mov_b32 v162, -1
 v_mov_b32 v163, -1
 v_mov_b32 v164, v2
 mvvaz 220,176,48
 mvva 220,180,52
 mvva 220,184,56
 mvva 220,188,60
 s_mov_b32 s84, 0
L14_head:
 mvaac 176,80,0,208
 s_waitcnt lgkmcnt(0)
 rta 144,4,16896
 rta 146,4,17152
 mvaa 176,84,4
 rta 148,4,17408
 rta 150,4,17664
 mvaa 176,88,8
 rta 152,4,16928
 rta 154,4,17184
 mvaa 176,92,12
 rta 156,4,17440
 rta 158,4,17696
 mvaac 180,108,12,208
 rta 160,4,16960
 rta 162,4,17216
 mvaa 180,104,8
 rta 164,4,17472
 rta 166,4,17728
 mvaa 180,100,4
 rta 168,4,16992
 rta 170,4,17248
 mvaa 180,96,0
 rta 172,4,17504
 rta 174,4,17760
 mvaac 184,112,0,208
 v_exp_f32 v176, v176
 mvaa 184,116,4
 v_exp_f32 v177, v177
 mvaa 184,120,8
 rta 176,4,17024
 pk 176,176
 mvaa 184,124,12
 v_exp_f32 v178, v178
 mvaac 188,140,12,208
 v_exp_f32 v179, v179
 mvaa 188,136,8
 rta 178,4,17280
 pk 177,178
 mvaa 188,132,4
 v_exp_f32 v180, v180
 mvaa 188,128,0
 v_exp_f32 v181, v181
 mvaac 192,80,16,212
 rta 180,4,17536
 pk 178,180
 mvaa 192,84,20
 v_exp_f32 v182, v182
 mvaa 192,88,24
 v_exp_f32 v183, v183
 mvaa 192,92,28
 rta 182,4,17792
 pk 179,182
 mvaac 196,108,28,212
 v_exp_f32 v184, v184
 mvaa 196,104,24
 v_exp_f32 v185, v185
 mvaa 196,100,20
 rta 184,4,17056
 pk 184,184
 mvaa 196,96,16
 v_exp_f32 v186, v186
 mvaac 200,112,16,212
 v_exp_f32 v187, v187
 mvaa 200,116,20
 rta 186,4,17312
 pk 185,186
 mvaa 200,120,24
 v_exp_f32 v188, v188
 mvaa 200,124,28
 v_exp_f32 v189, v189
 mvaac 204,140,28,212
 rta 188,4,17568
 pk 186,188
 mvaa 204,136,24
 v_exp_f32 v190, v190
 mvaa 204,132,20
 v_exp_f32 v191, v191
 s_nop 0
 pk 187,190
 mvaa 204,128,16
 s_waitcnt lgkmcnt(2)
 rta 190,4,17824
 rta 192,4,17088
 mvavz 16,144,176
 rta 194,4,17344
 rta 196,4,17600
 mvav 16,148,184
 rta 198,4,17856
 rta 200,4,17120
 mvavz 20,152,176
 rta 202,4,17376
 rta 204,4,17632
 mvav 20,156,184
 v_exp_f32 v192, v192
 mvavz 24,160,176
 v_exp_f32 v193, v193
 mvav 24,164,184
 rta 206,4,17888
 pk 192,192
 mvavz 28,168,176
 v_exp_f32 v194, v194
 mvav 28,172,184
 v_exp_f32 v195, v195
 mvavz 32,176,176
 v_exp_f32 v196, v196
 mvav 32,180,184
 s_waitcnt lgkmcnt(5)
 v_exp_f32 v197, v197
 mvavz 36,184,176
 pk 193,194
 pk 194,196
 mvav 36,188,184
 v_exp_f32 v198, v198
 mvavz 40,192,176
 s_waitcnt lgkmcnt(1)
 v_exp_f32 v199, v199
 mvav 40,196,184
 v_exp_f32 v200, v200
 mvavz 44,200,176
 s_waitcnt lgkmcnt(0)
 v_exp_f32 v201, v201
 mvav 44,204,184
 pk 195,198
 pk 200,200
 maavz 208,224,176
 v_exp_f32 v202, v202
 maav 208,224,184
 v_exp_f32 v203, v203
 mvaac 176,80,32,216
 s_waitcnt vmcnt(13)
 s_barrier
 pk 201,202
 mvaa 176,84,36
 v_exp_f32 v204, v204
 mvaa 176,88,40
 s_add_u32 m0, s77, 0
 v_exp_f32 v205, v205
 mvaa 176,92,44
 buffer_load_dwordx4 v1, s[52:55], s76 offen offset:0 nt lds
 pk 202,204
 mvaac 180,108,44,216
 v_exp_f32 v206, v206
 mvaa 180,104,40
 s_add_u32 m0, s77, 32
 v_exp_f32 v207, v207
 mvaa 180,100,36
 buffer_load_dwordx4 v1, s[52:55], s76 offen offset:1024 nt lds
 pk 203,206
 mvaa 180,96,32
 mvaac 184,112,32,216
 v_exp_f32 v176, v176
 mvaa 184,116,36
 s_add_u32 m0, s77, 64
 v_exp_f32 v177, v177
 mvaa 184,120,40
 buffer_load_dwordx4 v1, s[52:55], s76 offen offset:2048 nt lds
 pk 176,176
 mvaa 184,124,44
 v_exp_f32 v178, v178
 mvaac 188,140,44,216
 s_add_u32 m0, s77, 96
 v_exp_f32 v179, v179
 mvaa 188,136,40
 buffer_load_dwordx4 v1, s[52:55], s76 offen offset:3072 nt lds
 pk 177,178
 mvaa 188,132,36
 v_exp_f32 v180, v180
 mvaa 188,128,32
 s_add_u32 m0, s77, 16896
 v_exp_f32 v181, v181
 mvavz 48,144,192
 buffer_load_dwordx4 v1, s[56:59], s76 offen offset:0 nt lds
 pk 178,180
 mvav 48,148,200
 v_exp_f32 v182, v182
 mvavz 52,152,192
 s_add_u32 m0, s77, 16928
 v_exp_f32 v183, v183
 mvav 52,156,200
 buffer_load_dwordx4 v1, s[56:59], s76 offen offset:1024 nt lds
 pk 179,182
 mvavz 56,160,192
 v_exp_f32 v184, v184
 mvav 56,164,200
 s_add_u32 m0, s77, 16960
 v_exp_f32 v185, v185
 mvavz 60,168,192
 buffer_load_dwordx4 v1, s[56:59], s76 offen offset:2048 nt lds
 pk 184,184
 mvav 60,172,200
 v_exp_f32 v186, v186
 mvavz 64,176,192
 s_add_u32 m0, s77, 16992
 v_exp_f32 v187, v187
 mvav 64,180,200
 buffer_load_dwordx4 v1, s[56:59], s76 offen offset:3072 nt lds
 pk 185,186
 mvavz 68,184,192
 v_exp_f32 v188, v188
 mvav 68,188,200
 v_exp_f32 v189, v189
 mvavz 72,192,192
 v_exp_f32 v190, v190
 mvav 72,196,200
 v_exp_f32 v191, v191
 mvavz 76,200,192
 pk 186,188
 pk 187,190
 mvav 76,204,200
 maavz 212,224,192
 maav 212,224,200
 mvaac 192,80,48,220
 s_add_u32 s5, s5, s81
 mvaa 192,84,52
 ds_read_b128 a[80:83], v3 offset:33792
 mvaa 192,88,56
 ds_read_b128 a[84:87], v3 offset:33856
 mvaa 192,92,60
 ds_read_b128 a[88:91], v3 offset:33920
 mvaac 196,108,60,220
 ds_read_b128 a[92:95], v3 offset:33984
 mvaa 196,104,56
 s_xor_b32 s76, s5, s39
 ds_read_b128 a[108:111], v3 offset:34240
 mvaa 196,100,52
 ds_read_b128 a[104:107], v3 offset:34176
 mvaa 196,96,48
 ds_read_b128 a[100:103], v3 offset:34112
 mvaac 200,112,48,220
 v_exp_f32 v192, v192
 mvaa 200,116,52
 v_exp_f32 v193, v193
 mvaa 200,120,56
 ds_read_b128 a[96:99], v3 offset:34048
 pk 192,192
 mvaa 200,124,60
 v_exp_f32 v194, v194
 mvaac 204,140,60,220
 v_exp_f32 v195, v195
 mvaa 204,136,56
 ds_read_b128 a[112:115], v3 offset:34304
 pk 193,194
 mvaa 204,132,52
 v_exp_f32 v196, v196
 mvaa 204,128,48
 ds_read_b128 a[116:119], v3 offset:34368
 ds_read_b128 a[120:123], v3 offset:34432
 mvavz 80,144,176
 v_exp_f32 v197, v197
 mvav 80,148,184
 ds_read_b128 a[124:127], v3 offset:34496
 pk 194,196
 mvavz 84,152,176
 v_exp_f32 v198, v198
 mvav 84,156,184
 ds_read_b128 a[140:143], v3 offset:34752
 ds_read_b128 a[136:139], v3 offset:34688
 mvavz 88,160,176
 v_exp_f32 v199, v199
 mvav 88,164,184
 ds_read_b128 a[132:135], v3 offset:34624
 pk 195,198
 mvavz 92,168,176
 v_exp_f32 v200, v200
 mvav 92,172,184
 v_exp_f32 v201, v201
 mvavz 96,176,176
 ds_read_b128 a[128:131], v3 offset:34560
 pk 200,200
 mvav 96,180,184
 v_exp_f32 v202, v202
 mvavz 100,184,176
 v_exp_f32 v203, v203
 mvav 100,188,184
 v_exp_f32 v204, v204
 mvavz 104,192,176
 v_exp_f32 v205, v205
 mvav 104,196,184
 pk 201,202
 pk 202,204
 mvavz 108,200,176
 v_exp_f32 v206, v206
 mvav 108,204,184
 v_exp_f32 v207, v207
 maavz 216,224,176
 pk 203,206
 maav 216,224,184
 s_waitcnt lgkmcnt(0)
 mvaac 176,80,0,208
 mvaa 176,84,4
 mvaa 176,88,8
 mvaa 176,92,12
 mvaac 180,108,12,208
 mvaa 180,104,8
 mvaa 180,100,4
 mvaa 180,96,0
 mvaac 184,112,0,208
 s_nop 2
 v_exp_f32 v176, v176
 mvaa 184,116,4
 v_exp_f32 v177, v177
 mvaa 184,120,8
 v_exp_f32 v178, v178
 mvaa 184,124,12
 v_exp_f32 v179, v179
 mvaac 188,140,12,208
 pk 176,176
 pk 177,178
 mvaa 188,136,8
 v_exp_f32 v180, v180
 mvaa 188,132,4
 v_exp_f32 v181, v181
 mvaa 188,128,0
 v_exp_f32 v182, v182
 mvavz 112,144,192
 v_exp_f32 v183, v183
 mvav 112,148,200
 pk 178,180
 pk 179,182
 mvavz 116,152,192
 v_exp_f32 v184, v184
 mvav 116,156,200
 v_exp_f32 v185, v185
 mvavz 120,160,192
 rta 144,4,50688
 pk 184,184
 mvav 120,164,200
 rta 146,4,50944
 rta 148,4,51200
 mvavz 124,168,192
 v_exp_f32 v186, v186
 mvav 124,172,200
 rta 150,4,51456
 rta 152,4,50720
 mvavz 128,176,192
 v_exp_f32 v187, v187
 mvav 128,180,200
 rta 154,4,50976
 pk 185,186
 mvavz 132,184,192
 v_exp_f32 v188, v188
 mvav 132,188,200
 rta 156,4,51232
 rta 158,4,51488
 mvavz 136,192,192
 v_exp_f32 v189, v189
 mvav 136,196,200
 rta 160,4,50752
 rta 162,4,51008
 mvavz 140,200,192
 rta 164,4,51264
 pk 186,188
 mvav 140,204,200
 rta 166,4,51520
 rta 168,4,50784
 maavz 220,224,192
 v_exp_f32 v190, v190
 maav 220,224,200
 rta 170,4,51040
 rta 172,4,51296
 mvaac 192,80,16,212
 v_exp_f32 v191, v191
 mvaa 192,84,20
 rta 174,4,51552
 pk 187,190
 mvaa 192,88,24
 rta 176,4,50816
 rta 178,4,51072
 mvaa 192,92,28
 rta 180,4,51328
 rta 182,4,51584
 mvaac 196,108,28,212
 rta 184,4,50848
 rta 186,4,51104
 mvaa 196,104,24
 rta 188,4,51360
 rta 190,4,51616
 mvaa 196,100,20
 rta 192,4,50880
 rta 194,4,51136
 mvaa 196,96,16
 rta 196,4,51392
 rta 198,4,51648
 mvaac 200,112,16,212
 rta 200,4,50912
 rta 202,4,51168
 mvaa 200,116,20
 rta 204,4,51424
 rta 206,4,51680
 mvaa 200,120,24
 v_exp_f32 v192, v192
 mvaa 200,124,28
 v_exp_f32 v193, v193
 mvaac 204,140,28,212
 v_exp_f32 v194, v194
 mvaa 204,136,24
 v_exp_f32 v195, v195
 mvaa 204,132,20
 pk 192,192
 pk 193,194
 mvaa 204,128,16
 s_waitcnt lgkmcnt(6)
 v_exp_f32 v196, v196
 mvav 16,144,176
 v_exp_f32 v197, v197
 mvav 16,148,184
 v_exp_f32 v198, v198
 mvav 20,152,176
 v_exp_f32 v199, v199
 mvav 20,156,184
 pk 194,196
 pk 195,198
 mvav 24,160,176
 v_exp_f32 v200, v200
 mvav 24,164,184
 v_exp_f32 v201, v201
 mvav 28,168,176
 v_exp_f32 v202, v202
 mvav 28,172,184
 v_exp_f32 v203, v203
 mvav 32,176,176
 pk 200,200
 pk 201,202
 mvav 32,180,184
 v_exp_f32 v204, v204
 mvav 36,184,176
 v_exp_f32 v205, v205
 mvav 36,188,184
 v_exp_f32 v206, v206
 mvav 40,192,176
 s_waitcnt lgkmcnt(0)
 v_exp_f32 v207, v207
 mvav 40,196,184
 pk 202,204
 pk 203,206
 mvav 44,200,176
 mvav 44,204,184
 maav 208,224,176
 maav 208,224,184
 mvaac 176,80,32,216
 s_waitcnt vmcnt(17)
 s_barrier
 v_add_u32 v3, s78, v3
 mvaa 176,84,36
 s_add_u32 m0, s77, 33792
 v_add_u32 v4, s78, v4
 mvaa 176,88,40
 buffer_load_dwordx4 v1, s[52:55], s76 offen offset:0 nt lds
 mvaa 176,92,44
 s_add_u32 m0, s77, 33824
 mvaac 180,108,44,216
 buffer_load_dwordx4 v1, s[52:55], s76 offen offset:1024 nt lds
 mvaa 180,104,40
 s_add_u32 m0, s77, 33856
 mvaa 180,100,36
 buffer_load_dwordx4 v1, s[52:55], s76 offen offset:2048 nt lds
 mvaa 180,96,32
 mvaac 184,112,32,216
 v_exp_f32 v176, v176
 mvaa 184,116,36
 s_add_u32 m0, s77, 33888
 v_exp_f32 v177, v177
 mvaa 184,120,40
 buffer_load_dwordx4 v1, s[52:55], s76 offen offset:3072 nt lds
 pk 176,176
 mvaa 184,124,44
 v_exp_f32 v178, v178
 mvaac 188,140,44,216
 s_add_u32 m0, s77, 50688
 v_exp_f32 v179, v179
 mvaa 188,136,40
 buffer_load_dwordx4 v1, s[56:59], s76 offen offset:0 nt lds
 pk 177,178
 mvaa 188,132,36
 v_exp_f32 v180, v180
 mvaa 188,128,32
 s_add_u32 m0, s77, 50720
 v_exp_f32 v181, v181
 mvav 48,144,192
 buffer_load_dwordx4 v1, s[56:59], s76 offen offset:1024 nt lds
 pk 178,180
 mvav 48,148,200
 v_exp_f32 v182, v182
 mvav 52,152,192
 s_add_u32 m0, s77, 50752
 v_exp_f32 v183, v183
 mvav 52,156,200
 buffer_load_dwordx4 v1, s[56:59], s76 offen offset:2048 nt lds
 pk 179,182
 mvav 56,160,192
 v_exp_f32 v184, v184
 mvav 56,164,200
 s_add_u32 m0, s77, 50784
 v_exp_f32 v185, v185
 mvav 60,168,192
 buffer_load_dwordx4 v1, s[56:59], s76 offen offset:3072 nt lds
 pk 184,184
 mvav 60,172,200
 v_exp_f32 v186, v186
 mvav 64,176,192
 v_exp_f32 v187, v187
 mvav 64,180,200
 v_exp_f32 v188, v188
 mvav 68,184,192
 v_exp_f32 v189, v189
 mvav 68,188,200
 pk 185,186
 pk 186,188
 mvav 72,192,192
 v_exp_f32 v190, v190
 mvav 72,196,200
 v_exp_f32 v191, v191
 mvav 76,200,192
 pk 187,190
 mvav 76,204,200
 maav 212,224,192
 maav 212,224,200
 mvaac 192,80,48,220
 s_add_u32 s5, s5, s81
 mvaa 192,84,52
 s_add_u32 s77, s77, s78
 ds_read_b128 a[80:83], v3 offset:0
 mvaa 192,88,56
 s_sub_u32 s78, 0, s78
 ds_read_b128 a[84:87], v3 offset:64
 mvaa 192,92,60
 ds_read_b128 a[88:91], v3 offset:128
 mvaac 196,108,60,220
 ds_read_b128 a[92:95], v3 offset:192
 mvaa 196,104,56
 s_xor_b32 s76, s5, s39
 ds_read_b128 a[108:111], v3 offset:448
 mvaa 196,100,52
 ds_read_b128 a[104:107], v3 offset:384
 mvaa 196,96,48
 ds_read_b128 a[100:103], v3 offset:320
 mvaac 200,112,48,220
 v_exp_f32 v192, v192
 mvaa 200,116,52
 v_exp_f32 v193, v193
 mvaa 200,120,56
 ds_read_b128 a[96:99], v3 offset:256
 pk 192,192
 mvaa 200,124,60
 v_exp_f32 v194, v194
 mvaac 204,140,60,220
 v_exp_f32 v195, v195
 mvaa 204,136,56
 v_exp_f32 v196, v196
 mvaa 204,132,52
 v_exp_f32 v197, v197
 mvaa 204,128,48
 v_exp_f32 v198, v198
 mvav 80,144,176
 v_exp_f32 v199, v199
 mvav 80,148,184
 v_exp_f32 v200, v200
 mvav 84,152,176
 v_exp_f32 v201, v201
 mvav 84,156,184
 v_exp_f32 v202, v202
 mvav 88,160,176
 v_exp_f32 v203, v203
 mvav 88,164,184
 v_exp_f32 v204, v204
 mvav 92,168,176
 v_exp_f32 v205, v205
 mvav 92,172,184
 v_exp_f32 v206, v206
 mvav 96,176,176
 v_exp_f32 v207, v207
 mvav 96,180,184
 ds_read_b128 a[112:115], v3 offset:512
 pk 193,194
 mvav 100,184,176
 ds_read_b128 a[116:119], v3 offset:576
 ds_read_b128 a[120:123], v3 offset:640
 mvav 100,188,184
 ds_read_b128 a[124:127], v3 offset:704
 pk 194,196
 mvav 104,192,176
 ds_read_b128 a[140:143], v3 offset:960
 pk 195,198
 mvav 104,196,184
 ds_read_b128 a[136:139], v3 offset:896
 ds_read_b128 a[132:135], v3 offset:832
 mvav 108,200,176
 ds_read_b128 a[128:131], v3 offset:768
 pk 200,200
 mvav 108,204,184
 pk 201,202
 pk 202,204
 maav 216,224,176
 pk 203,206
 maav 216,224,184
 s_cmp_eq_u32 s43, 0
 s_cbranch_scc1 L14_pre
L14_pre:
 s_mov_b32 s79, 7
L14_loop:
 s_waitcnt lgkmcnt(8)
 mvaac 176,80,0,208
 mvaa 176,84,4
 mvaa 176,88,8
 mvaa 176,92,12
 mvaac 180,108,12,208
 mvaa 180,104,8
 mvaa 180,100,4
 mvaa 180,96,0
 s_waitcnt lgkmcnt(0)
 mvaac 184,112,0,208
 s_nop 1
 v_exp_f32 v176, v176
 mvaa 184,116,4
 v_exp_f32 v177, v177
 mvaa 184,120,8
 v_exp_f32 v178, v178
 mvaa 184,124,12
 v_exp_f32 v179, v179
 mvaac 188,140,12,208
 pk 176,176
 pk 177,178
 mvaa 188,136,8
 v_exp_f32 v180, v180
 mvaa 188,132,4
 v_exp_f32 v181, v181
 mvaa 188,128,0
 v_exp_f32 v182, v182
 mvav 112,144,192
 v_exp_f32 v183, v183
 mvav 112,148,200
 pk 178,180
 pk 179,182
 mvav 116,152,192
 v_exp_f32 v184, v184
 mvav 116,156,200
 v_exp_f32 v185, v185
 mvav 120,160,192
 rta 144,4,16896
 pk 184,184
 mvav 120,164,200
 rta 146,4,17152
 rta 148,4,17408
 mvav 124,168,192
 v_exp_f32 v186, v186
 mvav 124,172,200
 rta 150,4,17664
 rta 152,4,16928
 mvav 128,176,192
 v_exp_f32 v187, v187
 mvav 128,180,200
 rta 154,4,17184
 pk 185,186
 mvav 132,184,192
 v_exp_f32 v188, v188
 mvav 132,188,200
 rta 156,4,17440
 rta 158,4,17696
 mvav 136,192,192
 v_exp_f32 v189, v189
 mvav 136,196,200
 rta 160,4,16960
 rta 162,4,17216
 mvav 140,200,192
 rta 164,4,17472
 pk 186,188
 mvav 140,204,200
 rta 166,4,17728
 rta 168,4,16992
 maav 220,224,192
 v_exp_f32 v190, v190
 maav 220,224,200
 rta 170,4,17248
 rta 172,4,17504
 mvaac 192,80,16,212
 v_exp_f32 v191, v191
 mvaa 192,84,20
 rta 174,4,17760
 pk 187,190
 mvaa 192,88,24
 rta 176,4,17024
 rta 178,4,17280
 mvaa 192,92,28
 rta 180,4,17536
 rta 182,4,17792
 mvaac 196,108,28,212
 rta 184,4,17056
 rta 186,4,17312
 mvaa 196,104,24
 rta 188,4,17568
 rta 190,4,17824
 mvaa 196,100,20
 rta 192,4,17088
 rta 194,4,17344
 mvaa 196,96,16
 rta 196,4,17600
 rta 198,4,17856
 mvaac 200,112,16,212
 rta 200,4,17120
 rta 202,4,17376
 mvaa 200,116,20
 rta 204,4,17632
 rta 206,4,17888
 mvaa 200,120,24
 v_exp_f32 v192, v192
 mvaa 200,124,28
 v_exp_f32 v193, v193
 mvaac 204,140,28,212
 v_exp_f32 v194, v194
 mvaa 204,136,24
 v_exp_f32 v195, v195
 mvaa 204,132,20
 pk 192,192
 pk 193,194
 mvaa 204,128,16
 s_waitcnt lgkmcnt(6)
 v_exp_f32 v196, v196
 mvav 16,144,176
 v_exp_f32 v197, v197
 mvav 16,148,184
 v_exp_f32 v198, v198
 mvav 20,152,176
 v_exp_f32 v199, v199
 mvav 20,156,184
 pk 194,196
 pk 195,198
 mvav 24,160,176
 v_exp_f32 v200, v200
 mvav 24,164,184
 v_exp_f32 v201, v201
 mvav 28,168,176
 v_exp_f32 v202, v202
 mvav 28,172,184
 v_exp_f32 v203, v203
 mvav 32,176,176
 pk 200,200
 pk 201,202
 mvav 32,180,184
 v_exp_f32 v204, v204
 mvav 36,184,176
 v_exp_f32 v205, v205
 mvav 36,188,184
 v_exp_f32 v206, v206
 mvav 40,192,176
 s_waitcnt lgkmcnt(0)
 v_exp_f32 v207, v207
 mvav 40,196,184
 pk 202,204
 pk 203,206
 mvav 44,200,176
 mvav 44,204,184
 maav 208,224,176
 maav 208,224,184
 mvaac 176,80,32,216
 s_waitcnt vmcnt(16)
 s_barrier
 mvaa 176,84,36
 s_add_u32 m0, s77, 0
 mvaa 176,88,40
 buffer_load_dwordx4 v1, s[52:55], s76 offen offset:0 nt lds
 mvaa 176,92,44
 s_add_u32 m0, s77, 32
 mvaac 180,108,44,216
 buffer_load_dwordx4 v1, s[52:55], s76 offen offset:1024 nt lds
 mvaa 180,104,40
 s_add_u32 m0, s77, 64
 mvaa 180,100,36
 buffer_load_dwordx4 v1, s[52:55], s76 offen offset:2048 nt lds
 mvaa 180,96,32
 mvaac 184,112,32,216
 v_exp_f32 v176, v176
 mvaa 184,116,36
 s_add_u32 m0, s77, 96
 v_exp_f32 v177, v177
 mvaa 184,120,40
 buffer_load_dwordx4 v1, s[52:55], s76 offen offset:3072 nt lds
 pk 176,176
 mvaa 184,124,44
 v_exp_f32 v178, v178
 mvaac 188,140,44,216
 s_add_u32 m0, s77, 16896
 v_exp_f32 v179, v179
 mvaa 188,136,40
 buffer_load_dwordx4 v1, s[56:59], s76 offen offset:0 nt lds
 pk 177,178
 mvaa 188,132,36
 v_exp_f32 v180, v180
 mvaa 188,128,32
 s_add_u32 m0, s77, 16928
 v_exp_f32 v181, v181
 mvav 48,144,192
 buffer_load_dwordx4 v1, s[56:59], s76 offen offset:1024 nt lds
 pk 178,180
 mvav 48,148,200
 v_exp_f32 v182, v182
 mvav 52,152,192
 s_add_u32 m0, s77, 16960
 v_exp_f32 v183, v183
 mvav 52,156,200
 buffer_load_dwordx4 v1, s[56:59], s76 offen offset:2048 nt lds
 pk 179,182
 mvav 56,160,192
 v_exp_f32 v184, v184
 mvav 56,164,200
 s_add_u32 m0, s77, 16992
 v_exp_f32 v185, v185
 mvav 60,168,192
 buffer_load_dwordx4 v1, s[56:59], s76 offen offset:3072 nt lds
 pk 184,184
 mvav 60,172,200
 v_exp_f32 v186, v186
 mvav 64,176,192
 v_exp_f32 v187, v187
 mvav 64,180,200
 v_exp_f32 v188, v188
 mvav 68,184,192
 v_exp_f32 v189, v189
 mvav 68,188,200
 pk 185,186
 pk 186,188
 mvav 72,192,192
 v_exp_f32 v190, v190
 mvav 72,196,200
 v_exp_f32 v191, v191
 mvav 76,200,192
 pk 187,190
 mvav 76,204,200
 maav 212,224,192
 maav 212,224,200
 mvaac 192,80,48,220
 s_add_u32 s5, s5, s81
 mvaa 192,84,52
 ds_read_b128 a[80:83], v3 offset:33792
 mvaa 192,88,56
 ds_read_b128 a[84:87], v3 offset:33856
 mvaa 192,92,60
 ds_read_b128 a[88:91], v3 offset:33920
 mvaac 196,108,60,220
 ds_read_b128 a[92:95], v3 offset:33984
 mvaa 196,104,56
 s_xor_b32 s76, s5, s39
 ds_read_b128 a[108:111], v3 offset:34240
 mvaa 196,100,52
 ds_read_b128 a[104:107], v3 offset:34176
 mvaa 196,96,48
 ds_read_b128 a[100:103], v3 offset:34112
 mvaac 200,112,48,220
 v_exp_f32 v192, v192
 mvaa 200,116,52
 v_exp_f32 v193, v193
 mvaa 200,120,56
 ds_read_b128 a[96:99], v3 offset:34048
 pk 192,192
 mvaa 200,124,60
 v_exp_f32 v194, v194
 mvaac 204,140,60,220
 v_exp_f32 v195, v195
 mvaa 204,136,56
 ds_read_b128 a[112:115], v3 offset:34304
 pk 193,194
 mvaa 204,132,52
 v_exp_f32 v196, v196
 mvaa 204,128,48
 ds_read_b128 a[116:119], v3 offset:34368
 ds_read_b128 a[120:123], v3 offset:34432
 mvav 80,144,176
 v_exp_f32 v197, v197
 mvav 80,148,184
 ds_read_b128 a[124:127], v3 offset:34496
 pk 194,196
 mvav 84,152,176
 v_exp_f32 v198, v198
 mvav 84,156,184
 ds_read_b128 a[140:143], v3 offset:34752
 ds_read_b128 a[136:139], v3 offset:34688
 mvav 88,160,176
 v_exp_f32 v199, v199
 mvav 88,164,184
 ds_read_b128 a[132:135], v3 offset:34624
 pk 195,198
 mvav 92,168,176
 v_exp_f32 v200, v200
 mvav 92,172,184
 v_exp_f32 v201, v201
 mvav 96,176,176
 ds_read_b128 a[128:131], v3 offset:34560
 pk 200,200
 mvav 96,180,184
 v_exp_f32 v202, v202
 mvav 100,184,176
 v_exp_f32 v203, v203
 mvav 100,188,184
 v_exp_f32 v204, v204
 mvav 104,192,176
 v_exp_f32 v205, v205
 mvav 104,196,184
 pk 201,202
 pk 202,204
 mvav 108,200,176
 v_exp_f32 v206, v206
 mvav 108,204,184
 v_exp_f32 v207, v207
 maav 216,224,176
 pk 203,206
 maav 216,224,184
 s_waitcnt lgkmcnt(0)
 mvaac 176,80,0,208
 mvaa 176,84,4
 mvaa 176,88,8
 mvaa 176,92,12
 mvaac 180,108,12,208
 mvaa 180,104,8
 mvaa 180,100,4
 mvaa 180,96,0
 mvaac 184,112,0,208
 s_nop 2
 v_exp_f32 v176, v176
 mvaa 184,116,4
 v_exp_f32 v177, v177
 mvaa 184,120,8
 v_exp_f32 v178, v178
 mvaa 184,124,12
 v_exp_f32 v179, v179
 mvaac 188,140,12,208
 pk 176,176
 pk 177,178
 mvaa 188,136,8
 v_exp_f32 v180, v180
 mvaa 188,132,4
 v_exp_f32 v181, v181
 mvaa 188,128,0
 v_exp_f32 v182, v182
 mvav 112,144,192
 v_exp_f32 v183, v183
 mvav 112,148,200
 pk 178,180
 pk 179,182
 mvav 116,152,192
 v_exp_f32 v184, v184
 mvav 116,156,200
 v_exp_f32 v185, v185
 mvav 120,160,192
 rta 144,4,50688
 pk 184,184
 mvav 120,164,200
 rta 146,4,50944
 rta 148,4,51200
 mvav 124,168,192
 v_exp_f32 v186, v186
 mvav 124,172,200
 rta 150,4,51456
 rta 152,4,50720
 mvav 128,176,192
 v_exp_f32 v187, v187
 mvav 128,180,200
 rta 154,4,50976
 pk 185,186
 mvav 132,184,192
 v_exp_f32 v188, v188
 mvav 132,188,200
 rta 156,4,51232
 rta 158,4,51488
 mvav 136,192,192
 v_exp_f32 v189, v189
 mvav 136,196,200
 rta 160,4,50752
 rta 162,4,51008
 mvav 140,200,192
 rta 164,4,51264
 pk 186,188
 mvav 140,204,200
 rta 166,4,51520
 rta 168,4,50784
 maav 220,224,192
 v_exp_f32 v190, v190
 maav 220,224,200
 rta 170,4,51040
 rta 172,4,51296
 mvaac 192,80,16,212
 v_exp_f32 v191, v191
 mvaa 192,84,20
 rta 174,4,51552
 pk 187,190
 mvaa 192,88,24
 rta 176,4,50816
 rta 178,4,51072
 mvaa 192,92,28
 rta 180,4,51328
 rta 182,4,51584
 mvaac 196,108,28,212
 rta 184,4,50848
 rta 186,4,51104
 mvaa 196,104,24
 rta 188,4,51360
 rta 190,4,51616
 mvaa 196,100,20
 rta 192,4,50880
 rta 194,4,51136
 mvaa 196,96,16
 rta 196,4,51392
 rta 198,4,51648
 mvaac 200,112,16,212
 rta 200,4,50912
 rta 202,4,51168
 mvaa 200,116,20
 rta 204,4,51424
 rta 206,4,51680
 mvaa 200,120,24
 v_exp_f32 v192, v192
 mvaa 200,124,28
 v_exp_f32 v193, v193
 mvaac 204,140,28,212
 v_exp_f32 v194, v194
 mvaa 204,136,24
 v_exp_f32 v195, v195
 mvaa 204,132,20
 pk 192,192
 pk 193,194
 mvaa 204,128,16
 s_waitcnt lgkmcnt(6)
 v_exp_f32 v196, v196
 mvav 16,144,176
 v_exp_f32 v197, v197
 mvav 16,148,184
 v_exp_f32 v198, v198
 mvav 20,152,176
 v_exp_f32 v199, v199
 mvav 20,156,184
 pk 194,196
 pk 195,198
 mvav 24,160,176
 v_exp_f32 v200, v200
 mvav 24,164,184
 v_exp_f32 v201, v201
 mvav 28,168,176
 v_exp_f32 v202, v202
 mvav 28,172,184
 v_exp_f32 v203, v203
 mvav 32,176,176
 pk 200,200
 pk 201,202
 mvav 32,180,184
 v_exp_f32 v204, v204
 mvav 36,184,176
 v_exp_f32 v205, v205
 mvav 36,188,184
 v_exp_f32 v206, v206
 mvav 40,192,176
 s_waitcnt lgkmcnt(0)
 v_exp_f32 v207, v207
 mvav 40,196,184
 pk 202,204
 pk 203,206
 mvav 44,200,176
 mvav 44,204,184
 maav 208,224,176
 maav 208,224,184
 mvaac 176,80,32,216
 s_waitcnt vmcnt(16)
 s_barrier
 v_add_u32 v3, s78, v3
 mvaa 176,84,36
 s_add_u32 m0, s77, 33792
 v_add_u32 v4, s78, v4
 mvaa 176,88,40
 buffer_load_dwordx4 v1, s[52:55], s76 offen offset:0 nt lds
 mvaa 176,92,44
 s_add_u32 m0, s77, 33824
 mvaac 180,108,44,216
 buffer_load_dwordx4 v1, s[52:55], s76 offen offset:1024 nt lds
 mvaa 180,104,40
 s_add_u32 m0, s77, 33856
 mvaa 180,100,36
 buffer_load_dwordx4 v1, s[52:55], s76 offen offset:2048 nt lds
 mvaa 180,96,32
 mvaac 184,112,32,216
 v_exp_f32 v176, v176
 mvaa 184,116,36
 s_add_u32 m0, s77, 33888
 v_exp_f32 v177, v177
 mvaa 184,120,40
 buffer_load_dwordx4 v1, s[52:55], s76 offen offset:3072 nt lds
 pk 176,176
 mvaa 184,124,44
 v_exp_f32 v178, v178
 mvaac 188,140,44,216
 s_add_u32 m0, s77, 50688
 v_exp_f32 v179, v179
 mvaa 188,136,40
 buffer_load_dwordx4 v1, s[56:59], s76 offen offset:0 nt lds
 pk 177,178
 mvaa 188,132,36
 v_exp_f32 v180, v180
 mvaa 188,128,32
 s_add_u32 m0, s77, 50720
 v_exp_f32 v181, v181
 mvav 48,144,192
 buffer_load_dwordx4 v1, s[56:59], s76 offen offset:1024 nt lds
 pk 178,180
 mvav 48,148,200
 v_exp_f32 v182, v182
 mvav 52,152,192
 s_add_u32 m0, s77, 50752
 v_exp_f32 v183, v183
 mvav 52,156,200
 buffer_load_dwordx4 v1, s[56:59], s76 offen offset:2048 nt lds
 pk 179,182
 mvav 56,160,192
 v_exp_f32 v184, v184
 mvav 56,164,200
 s_add_u32 m0, s77, 50784
 v_exp_f32 v185, v185
 mvav 60,168,192
 buffer_load_dwordx4 v1, s[56:59], s76 offen offset:3072 nt lds
 pk 184,184
 mvav 60,172,200
 v_exp_f32 v186, v186
 mvav 64,176,192
 v_exp_f32 v187, v187
 mvav 64,180,200
 v_exp_f32 v188, v188
 mvav 68,184,192
 v_exp_f32 v189, v189
 mvav 68,188,200
 pk 185,186
 pk 186,188
 mvav 72,192,192
 v_exp_f32 v190, v190
 mvav 72,196,200
 v_exp_f32 v191, v191
 mvav 76,200,192
 pk 187,190
 mvav 76,204,200
 maav 212,224,192
 maav 212,224,200
 mvaac 192,80,48,220
 s_add_u32 s5, s5, s81
 mvaa 192,84,52
 s_add_u32 s77, s77, s78
 ds_read_b128 a[80:83], v3 offset:0
 mvaa 192,88,56
 s_sub_u32 s78, 0, s78
 ds_read_b128 a[84:87], v3 offset:64
 mvaa 192,92,60
 s_sub_u32 s79, s79, 1
 ds_read_b128 a[88:91], v3 offset:128
 mvaac 196,108,60,220
 ds_read_b128 a[92:95], v3 offset:192
 mvaa 196,104,56
 s_xor_b32 s76, s5, s39
 ds_read_b128 a[108:111], v3 offset:448
 mvaa 196,100,52
 s_cmp_gt_u32 s79, s84
 ds_read_b128 a[104:107], v3 offset:384
 mvaa 196,96,48
 ds_read_b128 a[100:103], v3 offset:320
 mvaac 200,112,48,220
 v_exp_f32 v192, v192
 mvaa 200,116,52
 v_exp_f32 v193, v193
 mvaa 200,120,56
 ds_read_b128 a[96:99], v3 offset:256
 pk 192,192
 mvaa 200,124,60
 v_exp_f32 v194, v194
 mvaac 204,140,60,220
 v_exp_f32 v195, v195
 mvaa 204,136,56
 ds_read_b128 a[112:115], v3 offset:512
 pk 193,194
 mvaa 204,132,52
 v_exp_f32 v196, v196
 mvaa 204,128,48
 ds_read_b128 a[116:119], v3 offset:576
 ds_read_b128 a[120:123], v3 offset:640
 mvav 80,144,176
 v_exp_f32 v197, v197
 mvav 80,148,184
 ds_read_b128 a[124:127], v3 offset:704
 pk 194,196
 mvav 84,152,176
 v_exp_f32 v198, v198
 mvav 84,156,184
 ds_read_b128 a[140:143], v3 offset:960
 ds_read_b128 a[136:139], v3 offset:896
 mvav 88,160,176
 v_exp_f32 v199, v199
 mvav 88,164,184
 ds_read_b128 a[132:135], v3 offset:832
 pk 195,198
 mvav 92,168,176
 v_exp_f32 v200, v200
 mvav 92,172,184
 v_exp_f32 v201, v201
 mvav 96,176,176
 ds_read_b128 a[128:131], v3 offset:768
 pk 200,200
 mvav 96,180,184
 v_exp_f32 v202, v202
 mvav 100,184,176
 v_exp_f32 v203, v203
 mvav 100,188,184
 v_exp_f32 v204, v204
 mvav 104,192,176
 v_exp_f32 v205, v205
 mvav 104,196,184
 pk 201,202
 pk 202,204
 mvav 108,200,176
 v_exp_f32 v206, v206
 mvav 108,204,184
 v_exp_f32 v207, v207
 maav 216,224,176
 pk 203,206
 maav 216,224,184
 s_cbranch_scc1 L14_loop
 s_cmp_eq_u32 s79, 5
 s_cbranch_scc1 L14_hk5
 s_cmp_eq_u32 s79, 4
 s_cbranch_scc1 L14_hk4
 s_cmp_eq_u32 s79, 3
 s_cbranch_scc1 L14_hk3
L14_tail:
 mvav 112,144,192
 mvav 112,148,200
 mvav 116,152,192
 mvav 116,156,200
 mvav 120,160,192
 mvav 120,164,200
 mvav 124,168,192
 mvav 124,172,200
 mvav 128,176,192
 mvav 128,180,200
 mvav 132,184,192
 mvav 132,188,200
 mvav 136,192,192
 mvav 136,196,200
 mvav 140,200,192
 mvav 140,204,200
 maav 220,224,192
 maav 220,224,200
 v_accvgpr_read_b32 v6, a208
 v_accvgpr_read_b32 v7, a212
 v_accvgpr_read_b32 v8, a216
 s_nop 4
 v_accvgpr_read_b32 v9, a220
 v_add_f32 v14, v6, v7
 v_add_f32 v14, v14, v8
 v_add_f32 v14, v14, v9
 v_cmp_ngt_f32 s[94:95], s91, v14
 v_rcp_f32 v6, v6
 v_rcp_f32 v7, v7
 v_rcp_f32 v8, v8
 v_rcp_f32 v9, v9
 s_cmp_eq_u64 s[94:95], 0
 s_cbranch_scc1 L14_ok
 s_lshl_b32 s3, 1, s43
 s_or_b32 s87, s87, s3
 s_add_u32 s86, s90, 0
 buffer_store_dwordx4 a[0:3], v2, s[64:67], s86 offen offset:0
 buffer_store_dwordx4 a[4:7], v2, s[64:67], s86 offen offset:1024
 buffer_store_dwordx4 a[8:11], v2, s[64:67], s86 offen offset:2048
 buffer_store_dwordx4 a[12:15], v2, s[64:67], s86 offen offset:3072
 s_add_u32 s86, s90, 4096
 buffer_store_dwordx4 a[16:19], v2, s[64:67], s86 offen offset:0
 buffer_store_dwordx4 a[20:23], v2, s[64:67], s86 offen offset:1024
 buffer_store_dwordx4 a[24:27], v2, s[64:67], s86 offen offset:2048
 buffer_store_dwordx4 a[28:31], v2, s[64:67], s86 offen offset:3072
 s_add_u32 s86, s90, 8192
 buffer_store_dwordx4 a[32:35], v2, s[64:67], s86 offen offset:0
 buffer_store_dwordx4 a[36:39], v2, s[64:67], s86 offen offset:1024
 buffer_store_dwordx4 a[40:43], v2, s[64:67], s86 offen offset:2048
 buffer_store_dwordx4 a[44:47], v2, s[64:67], s86 offen offset:3072
 s_add_u32 s86, s90, 12288
 buffer_store_dwordx4 a[48:51], v2, s[64:67], s86 offen offset:0
 buffer_store_dwordx4 a[52:55], v2, s[64:67], s86 offen offset:1024
 buffer_store_dwordx4 a[56:59], v2, s[64:67], s86 offen offset:2048
 buffer_store_dwordx4 a[60:63], v2, s[64:67], s86 offen offset:3072
 s_waitcnt vmcnt(0) lgkmcnt(0)
 s_nop 7
L14_ok:
 s_lshl_b32 s3, s42, 1
 s_add_u32 s3, s3, 163776
 v_mov_b32 v14, s3
 v_mov_b32 v15, s87
 ds_write_b16 v14, v15
 s_cmp_lg_u32 s43, 0
 s_cbranch_scc1 L14_last
 s_mov_b32 s3, 67584
 v_lshrrev_b32 v15, 2, v0
 v_and_or_b32 v15, v15, 48, s3
 ds_read_b128 v[176:179], v15 offset:0
 ds_read_b128 v[180:183], v15 offset:64
 ds_read_b128 v[184:187], v15 offset:128
 ds_read_b128 v[188:191], v15 offset:192
 s_mul_i32 s3, s42, 7168
 s_add_u32 s3, s3, 135168
 v_add_u32 v14, s3, v2
 ds_read_b128 a[16:19], v14 offset:0
 ds_read_b128 a[20:23], v14 offset:1024
 ds_read_b128 a[24:27], v14 offset:2048
 ds_read_b128 a[28:31], v14 offset:3072
 v_accvgpr_write_b32 a0, v240
 v_accvgpr_write_b32 a1, v241
 v_accvgpr_write_b32 a2, v242
 v_accvgpr_write_b32 a3, v243
 v_accvgpr_write_b32 a4, v244
 v_accvgpr_write_b32 a5, v245
 v_accvgpr_write_b32 a6, v246
 v_accvgpr_write_b32 a7, v247
 v_accvgpr_write_b32 a8, v248
 v_accvgpr_write_b32 a9, v249
 v_accvgpr_write_b32 a10, v250
 v_accvgpr_write_b32 a11, v251
 v_accvgpr_write_b32 a12, v252
 v_accvgpr_write_b32 a13, v253
 v_accvgpr_write_b32 a14, v254
 v_accvgpr_write_b32 a15, v255
 v_accvgpr_write_b32 a32, v228
 v_accvgpr_write_b32 a33, v229
 v_accvgpr_write_b32 a34, v230
 v_accvgpr_write_b32 a35, v231
 v_accvgpr_write_b32 a36, v232
 v_accvgpr_write_b32 a37, v233
 v_accvgpr_write_b32 a38, v234
 v_accvgpr_write_b32 a39, v235
 v_accvgpr_write_b32 a40, v236
 v_accvgpr_write_b32 a41, v237
 v_accvgpr_write_b32 a42, v238
 v_accvgpr_write_b32 a43, v239
 v_accvgpr_mov_b32 a44, a228
 v_accvgpr_mov_b32 a45, a229
 v_accvgpr_mov_b32 a46, a230
 v_accvgpr_mov_b32 a47, a231
 v_accvgpr_mov_b32 a48, a232
 v_accvgpr_mov_b32 a49, a233
 v_accvgpr_mov_b32 a50, a234
 v_accvgpr_mov_b32 a51, a235
 v_accvgpr_mov_b32 a52, a236
 v_accvgpr_mov_b32 a53, a237
 v_accvgpr_mov_b32 a54, a238
 v_accvgpr_mov_b32 a55, a239
 v_accvgpr_mov_b32 a56, a240
 v_accvgpr_mov_b32 a57, a241
 v_accvgpr_mov_b32 a58, a242
 v_accvgpr_mov_b32 a59, a243
 v_accvgpr_mov_b32 a60, a244
 v_accvgpr_mov_b32 a61, a245
 v_accvgpr_mov_b32 a62, a246
 v_accvgpr_mov_b32 a63, a247
 s_waitcnt lgkmcnt(7)
 v_xor_b32 v176, 0x80008000, v176
 v_xor_b32 v177, 0x80008000, v177
 v_xor_b32 v178, 0x80008000, v178
 v_xor_b32 v179, 0x80008000, v179
 s_waitcnt lgkmcnt(6)
 v_xor_b32 v180, 0x80008000, v180
 v_xor_b32 v181, 0x80008000, v181
 v_xor_b32 v182, 0x80008000, v182
 v_xor_b32 v183, 0x80008000, v183
 s_waitcnt lgkmcnt(5)
 v_xor_b32 v184, 0x80008000, v184
 v_xor_b32 v185, 0x80008000, v185
 v_xor_b32 v186, 0x80008000, v186
 v_xor_b32 v187, 0x80008000, v187
 s_waitcnt lgkmcnt(4)
 v_xor_b32 v188, 0x80008000, v188
 v_xor_b32 v189, 0x80008000, v189
 v_xor_b32 v190, 0x80008000, v190
 v_xor_b32 v191, 0x80008000, v191
 v_pk_mul_f32 v[16:17], v[16:17], v[6:7] op_sel_hi:[1,0]
 v_pk_mul_f32 v[18:19], v[18:19], v[6:7] op_sel_hi:[1,0]
 v_pk_mul_f32 v[20:21], v[20:21], v[6:7] op_sel_hi:[1,0]
 v_pk_mul_f32 v[22:23], v[22:23], v[6:7] op_sel_hi:[1,0]
 mvvaz 208,176,0
 pk 16,16
 pk 17,18
 pk 18,20
 pk 19,22
 s_mov_b32 s86, 0
 buffer_store_dwordx4 v[16:19], v2, s[60:63], s86 offen offset:0 sc1
 ds_write_b128 v14, v[16:19] offset:0
 v_pk_mul_f32 v[48:49], v[48:49], v[6:7] op_sel:[0,1]
 v_pk_mul_f32 v[50:51], v[50:51], v[6:7] op_sel:[0,1]
 v_pk_mul_f32 v[52:53], v[52:53], v[6:7] op_sel:[0,1]
 v_pk_mul_f32 v[54:55], v[54:55], v[6:7] op_sel:[0,1]
 mvva 208,180,4
 pk 48,48
 pk 49,50
 pk 50,52
 pk 51,54
 s_mov_b32 s86, 0
 buffer_store_dwordx4 v[48:51], v2, s[60:63], s86 offen offset:1024 sc1
 ds_write_b128 v14, v[48:51] offset:1024
 v_pk_mul_f32 v[80:81], v[80:81], v[8:9] op_sel_hi:[1,0]
 v_pk_mul_f32 v[82:83], v[82:83], v[8:9] op_sel_hi:[1,0]
 v_pk_mul_f32 v[84:85], v[84:85], v[8:9] op_sel_hi:[1,0]
 v_pk_mul_f32 v[86:87], v[86:87], v[8:9] op_sel_hi:[1,0]
 mvva 208,184,8
 pk 240,80
 pk 241,82
 pk 242,84
 pk 243,86
 v_pk_mul_f32 v[112:113], v[112:113], v[8:9] op_sel:[0,1]
 v_pk_mul_f32 v[114:115], v[114:115], v[8:9] op_sel:[0,1]
 v_pk_mul_f32 v[116:117], v[116:117], v[8:9] op_sel:[0,1]
 v_pk_mul_f32 v[118:119], v[118:119], v[8:9] op_sel:[0,1]
 mvva 208,188,12
 pk 244,112
 pk 245,114
 pk 246,116
 pk 247,118
 v_pk_mul_f32 v[24:25], v[24:25], v[6:7] op_sel_hi:[1,0]
 v_pk_mul_f32 v[26:27], v[26:27], v[6:7] op_sel_hi:[1,0]
 v_pk_mul_f32 v[28:29], v[28:29], v[6:7] op_sel_hi:[1,0]
 v_pk_mul_f32 v[30:31], v[30:31], v[6:7] op_sel_hi:[1,0]
 s_waitcnt lgkmcnt(5)
 mvvaz 212,176,16
 pk 248,24
 pk 249,26
 pk 250,28
 pk 251,30
 v_pk_mul_f32 v[56:57], v[56:57], v[6:7] op_sel:[0,1]
 v_pk_mul_f32 v[58:59], v[58:59], v[6:7] op_sel:[0,1]
 v_pk_mul_f32 v[60:61], v[60:61], v[6:7] op_sel:[0,1]
 v_pk_mul_f32 v[62:63], v[62:63], v[6:7] op_sel:[0,1]
 s_waitcnt lgkmcnt(4)
 mvva 212,180,20
 pk 252,56
 pk 253,58
 pk 254,60
 pk 255,62
 v_pk_mul_f32 v[88:89], v[88:89], v[8:9] op_sel_hi:[1,0]
 v_pk_mul_f32 v[90:91], v[90:91], v[8:9] op_sel_hi:[1,0]
 v_pk_mul_f32 v[92:93], v[92:93], v[8:9] op_sel_hi:[1,0]
 v_pk_mul_f32 v[94:95], v[94:95], v[8:9] op_sel_hi:[1,0]
 s_waitcnt lgkmcnt(3)
 mvva 212,184,24
 pk 228,88
 pk 229,90
 pk 230,92
 pk 231,94
 v_pk_mul_f32 v[120:121], v[120:121], v[8:9] op_sel:[0,1]
 v_pk_mul_f32 v[122:123], v[122:123], v[8:9] op_sel:[0,1]
 v_pk_mul_f32 v[124:125], v[124:125], v[8:9] op_sel:[0,1]
 v_pk_mul_f32 v[126:127], v[126:127], v[8:9] op_sel:[0,1]
 s_waitcnt lgkmcnt(2)
 mvva 212,188,28
 pk 232,120
 pk 233,122
 pk 234,124
 pk 235,126
 v_pk_mul_f32 v[32:33], v[32:33], v[6:7] op_sel_hi:[1,0]
 v_pk_mul_f32 v[34:35], v[34:35], v[6:7] op_sel_hi:[1,0]
 v_pk_mul_f32 v[36:37], v[36:37], v[6:7] op_sel_hi:[1,0]
 v_pk_mul_f32 v[38:39], v[38:39], v[6:7] op_sel_hi:[1,0]
 mvvaz 216,176,32
 pk 236,32
 pk 237,34
 pk 238,36
 pk 239,38
 v_pk_mul_f32 v[64:65], v[64:65], v[6:7] op_sel:[0,1]
 v_pk_mul_f32 v[66:67], v[66:67], v[6:7] op_sel:[0,1]
 v_pk_mul_f32 v[68:69], v[68:69], v[6:7] op_sel:[0,1]
 v_pk_mul_f32 v[70:71], v[70:71], v[6:7] op_sel:[0,1]
 mvva 216,180,36
 pk 64,64
 pk 65,66
 pk 66,68
 pk 67,70
 v_accvgpr_write_b32 a228, v64
 v_accvgpr_write_b32 a229, v65
 v_accvgpr_write_b32 a230, v66
 v_accvgpr_write_b32 a231, v67
 v_pk_mul_f32 v[96:97], v[96:97], v[8:9] op_sel_hi:[1,0]
 v_pk_mul_f32 v[98:99], v[98:99], v[8:9] op_sel_hi:[1,0]
 v_pk_mul_f32 v[100:101], v[100:101], v[8:9] op_sel_hi:[1,0]
 v_pk_mul_f32 v[102:103], v[102:103], v[8:9] op_sel_hi:[1,0]
 mvva 216,184,40
 pk 96,96
 pk 97,98
 pk 98,100
 pk 99,102
 v_accvgpr_write_b32 a232, v96
 v_accvgpr_write_b32 a233, v97
 v_accvgpr_write_b32 a234, v98
 v_accvgpr_write_b32 a235, v99
 v_pk_mul_f32 v[128:129], v[128:129], v[8:9] op_sel:[0,1]
 v_pk_mul_f32 v[130:131], v[130:131], v[8:9] op_sel:[0,1]
 v_pk_mul_f32 v[132:133], v[132:133], v[8:9] op_sel:[0,1]
 v_pk_mul_f32 v[134:135], v[134:135], v[8:9] op_sel:[0,1]
 mvva 216,188,44
 pk 128,128
 pk 129,130
 pk 130,132
 pk 131,134
 v_accvgpr_write_b32 a236, v128
 v_accvgpr_write_b32 a237, v129
 v_accvgpr_write_b32 a238, v130
 v_accvgpr_write_b32 a239, v131
 v_pk_mul_f32 v[40:41], v[40:41], v[6:7] op_sel_hi:[1,0]
 v_pk_mul_f32 v[42:43], v[42:43], v[6:7] op_sel_hi:[1,0]
 v_pk_mul_f32 v[44:45], v[44:45], v[6:7] op_sel_hi:[1,0]
 v_pk_mul_f32 v[46:47], v[46:47], v[6:7] op_sel_hi:[1,0]
 mvvaz 220,176,48
 pk 40,40
 pk 41,42
 pk 42,44
 pk 43,46
 v_accvgpr_write_b32 a240, v40
 v_accvgpr_write_b32 a241, v41
 v_accvgpr_write_b32 a242, v42
 v_accvgpr_write_b32 a243, v43
 v_pk_mul_f32 v[72:73], v[72:73], v[6:7] op_sel:[0,1]
 v_pk_mul_f32 v[74:75], v[74:75], v[6:7] op_sel:[0,1]
 v_pk_mul_f32 v[76:77], v[76:77], v[6:7] op_sel:[0,1]
 v_pk_mul_f32 v[78:79], v[78:79], v[6:7] op_sel:[0,1]
 mvva 220,180,52
 pk 72,72
 pk 73,74
 pk 74,76
 pk 75,78
 v_accvgpr_write_b32 a244, v72
 v_accvgpr_write_b32 a245, v73
 v_accvgpr_write_b32 a246, v74
 v_accvgpr_write_b32 a247, v75
 v_pk_mul_f32 v[104:105], v[104:105], v[8:9] op_sel_hi:[1,0]
 v_pk_mul_f32 v[106:107], v[106:107], v[8:9] op_sel_hi:[1,0]
 v_pk_mul_f32 v[108:109], v[108:109], v[8:9] op_sel_hi:[1,0]
 v_pk_mul_f32 v[110:111], v[110:111], v[8:9] op_sel_hi:[1,0]
 mvva 220,184,56
 pk 104,104
 pk 105,106
 pk 106,108
 pk 107,110
 v_accvgpr_write_b32 a248, v104
 v_accvgpr_write_b32 a249, v105
 v_accvgpr_write_b32 a250, v106
 v_accvgpr_write_b32 a251, v107
 v_pk_mul_f32 v[136:137], v[136:137], v[8:9] op_sel:[0,1]
 v_pk_mul_f32 v[138:139], v[138:139], v[8:9] op_sel:[0,1]
 v_pk_mul_f32 v[140:141], v[140:141], v[8:9] op_sel:[0,1]
 v_pk_mul_f32 v[142:143], v[142:143], v[8:9] op_sel:[0,1]
 mvva 220,188,60
 pk 136,136
 pk 137,138
 pk 138,140
 pk 139,142
 v_accvgpr_write_b32 a252, v136
 v_accvgpr_write_b32 a253, v137
 v_accvgpr_write_b32 a254, v138
 v_accvgpr_write_b32 a255, v139
 s_mov_b32 s84, 5
 s_mov_b32 s90, 20480
 s_mov_b32 s43, 1
 s_branch L14_head
L14_last:
 s_mul_i32 s3, s42, 7168
 s_add_u32 s3, s3, 135168
 v_add_u32 v14, s3, v2
 ds_read_b128 a[160:163], v14 offset:0
 ds_read_b128 a[164:167], v14 offset:1024
 s_and_b32 s3, s98, 0x10001
 s_cbranch_scc1 L14_careful
 s_waitcnt vmcnt(16)
 v_cmp_ne_u32 vcc, 65535, v13
 s_nop 1
 s_and_b64 vcc, vcc, 1
 s_cbranch_scc1 L14_spin1
L14_s1:
L14_op:
 s_add_u32 s3, s8, 0
 s_and_b32 s3, s3, 3
 s_lshl_b32 s3, s3, 6
 s_add_u32 s3, s3, 67584
 v_add_u32 v208, s3, v5
 rtv 176,208,0
 rtv 178,208,256
 rtv 180,208,512
 rtv 182,208,768
 rtv 184,208,8
 rtv 186,208,264
 rtv 188,208,520
 rtv 190,208,776
 s_andn2_b32 s4, 1, s87
 v_mov_b32 v14, s4
 s_lshl_b32 s3, s9, 6
 s_mov_b64 exec, 1
 buffer_store_dword v14, off, s[44:47], s3 offset:4 sc1
 s_mov_b64 exec, -1
 s_nop 2
 s_add_u32 s3, s8, 1
 s_and_b32 s3, s3, 3
 s_lshl_b32 s3, s3, 6
 s_add_u32 s3, s3, 67584
 v_add_u32 v209, s3, v5
 s_add_u32 s3, s8, 2
 s_and_b32 s3, s3, 3
 s_lshl_b32 s3, s3, 6
 s_add_u32 s3, s3, 67584
 v_add_u32 v210, s3, v5
 s_add_u32 s3, s8, 3
 s_and_b32 s3, s3, 3
 s_lshl_b32 s3, s3, 6
 s_add_u32 s3, s3, 67584
 v_add_u32 v211, s3, v5
 v_lshlrev_b32 v14, 5, v0
 s_and_b32 s3, s85, 12
 s_lshr_b32 s3, 0x7536, s3
 s_and_b32 s3, s3, 7
 s_xor_b32 s3, s3, s9
 s_lshl_b32 s3, s3, 17
 s_lshl_b32 s4, s42, 15
 s_add_u32 s3, s3, s4
 v_and_b32 v15, 128, v14
 v_lshrrev_b32 v14, 3, v0
 v_lshl_add_u32 v14, v14, 10, v15
 s_mov_b32 exec_lo, 0
 buffer_load_dword v13, v14, s[68:71], s3 offen
 s_mov_b32 exec_lo, -1
 s_nop 2
 s_lshl_b32 s3, s9, 6
 v_mov_b32 v219, s3
 v_cmp_eq_u32 vcc, 0, v0
 s_lshr_b32 s4, s87, 1
 s_xor_b32 s4, s4, 1
 v_mov_b32 v218, s4
 v_cndmask_b32 v219, 0x40000000, v219, vcc
L14_16_op:
 s_waitcnt lgkmcnt(6)
 mavaz 0,176,160
 s_waitcnt lgkmcnt(4)
 rtv 192,209,0
 v_mul_f32 v16, v6, v16
 mavv 0,180,248
 rtv 194,209,256
 v_mul_f32 v17, v6, v17
 mavvz 32,180,252
 rtv 196,209,512
 v_mul_f32 v18, v6, v18
 mava 32,176,164
 rtv 198,209,768
 v_mul_f32 v19, v6, v19
 mavvz 64,176,240
 v_mul_f32 v20, v6, v20
 v_mul_f32 v21, v6, v21
 mavv 64,180,228
 v_mul_f32 v22, v6, v22
 v_mul_f32 v23, v6, v23
 mavvz 96,180,232
 pk 16,16
 pk 17,18
 mavv 96,176,244
 s_waitcnt lgkmcnt(6)
 pk 18,20
 pk 19,22
 mavvz 100,184,244
 s_waitcnt lgkmcnt(4)
 rtv 200,209,8
 v_mul_f32 v48, v7, v48
 mavv 100,188,232
 rtv 202,209,264
 v_mul_f32 v49, v7, v49
 mavvz 68,188,228
 rtv 204,209,520
 v_mul_f32 v50, v7, v50
 mavv 68,184,240
 rtv 206,209,776
 v_mul_f32 v51, v7, v51
 mavaz 36,184,164
 s_mov_b32 s86, 20480
 buffer_store_dwordx4 v[16:19], v2, s[60:63], s86 offen offset:0 sc1
 v_mul_f32 v52, v7, v52
 mavv 36,188,252
 v_mul_f32 v53, v7, v53
 v_mul_f32 v54, v7, v54
 mavvz 4,188,248
 v_mul_f32 v55, v7, v55
 pk 48,48
 mava 4,184,160
 s_waitcnt lgkmcnt(4)
 pk 49,50
 pk 50,52
 mavaz 8,192,160
 rtv 176,210,0
 pk 51,54
 mavv 8,196,248
 rtv 178,210,256
 v_mul_f32 v80, v8, v80
 mavvz 40,196,252
 rtv 180,210,512
 v_mul_f32 v81, v8, v81
 mava 40,192,164
 rtv 182,210,768
 v_mul_f32 v82, v8, v82
 mavvz 72,192,240
 v_mul_f32 v83, v8, v83
 v_mul_f32 v84, v8, v84
 mavv 72,196,228
 s_mov_b32 s86, 20480
 buffer_store_dwordx4 v[48:51], v2, s[60:63], s86 offen offset:1024 sc1
 v_mul_f32 v85, v8, v85
 mavvz 104,196,232
 v_mul_f32 v86, v8, v86
 v_mul_f32 v87, v8, v87
 mavv 104,192,244
 s_waitcnt lgkmcnt(4)
 pk 80,80
 pk 81,82
 mavvz 108,200,244
 rtv 184,210,8
 pk 82,84
 mavv 108,204,232
 rtv 186,210,264
 pk 83,86
 mavvz 76,204,228
 rtv 188,210,520
 v_mul_f32 v112, v9, v112
 mavv 76,200,240
 rtv 190,210,776
 v_mul_f32 v113, v9, v113
 mavaz 44,200,164
 v_mul_f32 v114, v9, v114
 v_mul_f32 v115, v9, v115
 mavv 44,204,252
 v_mul_f32 v116, v9, v116
 v_mul_f32 v117, v9, v117
 mavvz 12,204,248
 s_mov_b32 s86, 20480
 buffer_store_dwordx4 v[80:83], v2, s[60:63], s86 offen offset:2048 sc1
 v_mul_f32 v118, v9, v118
 mava 12,200,160
 s_waitcnt lgkmcnt(4)
 v_mul_f32 v119, v9, v119
 pk 112,112
 mavaz 16,176,160
 rtv 192,211,0
 pk 113,114
 mavv 16,180,248
 rtv 194,211,256
 pk 114,116
 mavvz 48,180,252
 rtv 196,211,512
 pk 115,118
 mava 48,176,164
 rtv 198,211,768
 v_mul_f32 v24, v6, v24
 mavvz 80,176,240
 v_mul_f32 v25, v6, v25
 v_mul_f32 v26, v6, v26
 mavv 80,180,228
 v_mul_f32 v27, v6, v27
 v_mul_f32 v28, v6, v28
 mavvz 112,180,232
 v_mul_f32 v29, v6, v29
 v_mul_f32 v30, v6, v30
 mavv 112,176,244
 s_waitcnt lgkmcnt(4)
 s_mov_b32 s86, 20480
 buffer_store_dwordx4 v[112:115], v2, s[60:63], s86 offen offset:3072 sc1
 v_mul_f32 v31, v6, v31
 mavvz 116,184,244
 rtv 200,211,8
 pk 24,24
 mavv 116,188,232
 rtv 202,211,264
 pk 25,26
 mavvz 84,188,228
 rtv 204,211,520
 pk 26,28
 mavv 84,184,240
 rtv 206,211,776
 pk 27,30
 mavaz 52,184,164
 v_mul_f32 v56, v7, v56
 v_mul_f32 v57, v7, v57
 mavv 52,188,252
 v_mul_f32 v58, v7, v58
 v_mul_f32 v59, v7, v59
 mavvz 20,188,248
 v_mul_f32 v60, v7, v60
 v_mul_f32 v61, v7, v61
 mava 20,184,160
 s_waitcnt lgkmcnt(4)
 v_mul_f32 v62, v7, v62
 v_mul_f32 v63, v7, v63
 mavaz 24,192,160
 s_waitcnt lgkmcnt(0)
 s_barrier
 mavv 24,196,248
 rtv 176,208,16896
 pk 56,56
 mavvz 56,196,252
 rtv 178,208,17152
 pk 57,58
 mava 56,192,164
 s_add_u32 m0, s92, 67584
 rtv 180,208,17408
 pk 58,60
 mavvz 88,192,240
 s_xor_b32 s83, s9, 6
 s_mul_i32 s83, s83, 131072
 rtv 182,208,17664
 mavv 88,196,228
 buffer_load_dwordx4 v11, s[68:71], s83 offen offset:0 lds
 pk 59,62
 mavvz 120,196,232
 s_add_u32 m0, s92, 67616
 v_mul_f32 v88, v8, v88
 v_mul_f32 v89, v8, v89
 mavv 120,192,244
 buffer_load_dwordx4 v11, s[68:71], s83 offen offset:1024 lds
 v_mul_f32 v90, v8, v90
 mavvz 124,200,244
 rtv 184,208,16904
 v_mul_f32 v91, v8, v91
 mavv 124,204,232
 rtv 186,208,17160
 v_mul_f32 v92, v8, v92
 mavvz 92,204,228
 rtv 188,208,17416
 v_mul_f32 v93, v8, v93
 mavv 92,200,240
 rtv 190,208,17672
 v_mul_f32 v94, v8, v94
 mavaz 60,200,164
 s_add_u32 m0, s92, 67648
 v_mul_f32 v95, v8, v95
 pk 88,88
 mavv 60,204,252
 buffer_load_dwordx4 v11, s[68:71], s83 offen offset:2048 lds
 pk 89,90
 mavvz 28,204,248
 s_add_u32 m0, s92, 67680
 pk 90,92
 pk 91,94
 mava 28,200,160
 s_waitcnt lgkmcnt(4)
 buffer_load_dwordx4 v11, s[68:71], s83 offen offset:3072 lds
 v_mul_f32 v120, v9, v120
 mavv 0,176,236
 rtv 192,209,16896
 v_mul_f32 v121, v9, v121
 mava 0,180,240
 rtv 194,209,17152
 v_mul_f32 v122, v9, v122
 mava 32,180,244
 rtv 196,209,17408
 v_mul_f32 v123, v9, v123
 mava 32,176,228
 rtv 198,209,17664
 v_mul_f32 v124, v9, v124
 mava 64,176,232
 s_mov_b32 s86, 24576
 buffer_store_dwordx4 v[24:27], v2, s[60:63], s86 offen offset:1024 sc1
 v_mul_f32 v125, v9, v125
 mava 64,180,248
 v_mul_f32 v126, v9, v126
 v_mul_f32 v127, v9, v127
 mava 96,180,252
 pk 120,120
 pk 121,122
 mava 96,176,236
 s_waitcnt lgkmcnt(4)
 pk 122,124
 pk 123,126
 mava 100,184,236
 rtv 200,209,16904
 v_mul_f32 v32, v6, v32
 mava 100,188,252
 rtv 202,209,17160
 v_mul_f32 v33, v6, v33
 mava 68,188,248
 rtv 204,209,17416
 v_mul_f32 v34, v6, v34
 mava 68,184,232
 rtv 206,209,17672
 v_mul_f32 v35, v6, v35
 mava 36,184,228
 v_mul_f32 v36, v6, v36
 v_mul_f32 v37, v6, v37
 mava 36,188,244
 s_mov_b32 s86, 24576
 buffer_store_dwordx4 v[56:59], v2, s[60:63], s86 offen offset:2048 sc1
 v_mul_f32 v38, v6, v38
 mava 4,188,240
 v_mul_f32 v39, v6, v39
 pk 32,32
 mavv 4,184,236
 s_waitcnt lgkmcnt(4)
 pk 33,34
 pk 34,36
 mavv 8,192,236
 rtv 176,210,16896
 pk 35,38
 mava 8,196,240
 rtv 178,210,17152
 v_mul_f32 v64, v7, v64
 mava 40,196,244
 rtv 180,210,17408
 v_mul_f32 v65, v7, v65
 mava 40,192,228
 rtv 182,210,17664
 v_mul_f32 v66, v7, v66
 mava 72,192,232
 v_mul_f32 v67, v7, v67
 v_mul_f32 v68, v7, v68
 mava 72,196,248
 v_mul_f32 v69, v7, v69
 v_mul_f32 v70, v7, v70
 mava 104,196,252
 s_mov_b32 s86, 24576
 buffer_store_dwordx4 v[88:91], v2, s[60:63], s86 offen offset:3072 sc1
 v_mul_f32 v71, v7, v71
 mava 104,192,236
 s_waitcnt lgkmcnt(4)
 pk 64,64
 pk 65,66
 mava 108,200,236
 rtv 184,210,16904
 pk 66,68
 mava 108,204,252
 rtv 186,210,17160
 pk 67,70
 mava 76,204,248
 rtv 188,210,17416
 v_mul_f32 v96, v8, v96
 mava 76,200,232
 rtv 190,210,17672
 v_mul_f32 v97, v8, v97
 mava 44,200,228
 v_mul_f32 v98, v8, v98
 v_mul_f32 v99, v8, v99
 mava 44,204,244
 v_mul_f32 v100, v8, v100
 v_mul_f32 v101, v8, v101
 mava 12,204,240
 v_mul_f32 v102, v8, v102
 v_mul_f32 v103, v8, v103
 mavv 12,200,236
 s_waitcnt lgkmcnt(4)
 s_mov_b32 s86, 28672
 buffer_store_dwordx4 v[120:123], v2, s[60:63], s86 offen offset:0 sc1
 pk 96,96
 mavv 16,176,236
 rtv 192,211,16896
 pk 97,98
 mava 16,180,240
 rtv 194,211,17152
 pk 98,100
 mava 48,180,244
 rtv 196,211,17408
 pk 99,102
 mava 48,176,228
 rtv 198,211,17664
 v_mul_f32 v128, v9, v128
 mava 80,176,232
 s_xor_b32 s94, s8, 0
 s_lshl_b32 s94, s94, 9
 v_mul_f32 v129, v9, v129
 mava 80,180,248
 v_min_u32 v15, 12, v0
 v_lshl_add_u32 v15, v15, 5, s94
 mava 112,180,252
 v_mul_f32 v130, v9, v130
 v_mul_f32 v131, v9, v131
 mava 112,176,236
 s_waitcnt lgkmcnt(4)
 buffer_load_dword v13, v15, s[44:47], 0 offen offset:4 sc1
 v_mul_f32 v132, v9, v132
 mava 116,184,236
 rtv 200,211,16904
 v_mul_f32 v133, v9, v133
 mava 116,188,252
 rtv 202,211,17160
 v_mul_f32 v134, v9, v134
 mava 84,188,248
 rtv 204,211,17416
 v_mul_f32 v135, v9, v135
 mava 84,184,232
 rtv 206,211,17672
 pk 128,128
 mava 52,184,228
 s_mov_b32 s86, 28672
 buffer_store_dwordx4 v[32:35], v2, s[60:63], s86 offen offset:2048 sc1
 pk 129,130
 mava 52,188,244
 pk 130,132
 pk 131,134
 mava 20,188,240
 v_mul_f32 v40, v6, v40
 v_mul_f32 v41, v6, v41
 mavv 20,184,236
 s_waitcnt lgkmcnt(4)
 v_mul_f32 v42, v6, v42
 v_mul_f32 v43, v6, v43
 mavv 24,192,236
 s_waitcnt lgkmcnt(0)
 s_barrier
 mava 24,196,240
 rtv 176,208,33792
 v_mul_f32 v44, v6, v44
 mava 56,196,244
 rtv 178,208,34048
 v_mul_f32 v45, v6, v45
 mava 56,192,228
 rtv 180,208,34304
 v_mul_f32 v46, v6, v46
 mava 88,192,232
 s_add_u32 m0, s92, 84480
 s_add_u32 s83, s83, 65536
 rtv 182,208,34560
 mava 88,196,248
 buffer_load_dwordx4 v11, s[68:71], s83 offen offset:0 lds
 v_mul_f32 v47, v6, v47
 mava 120,196,252
 s_add_u32 m0, s92, 84512
 pk 40,40
 pk 41,42
 mava 120,192,236
 buffer_load_dwordx4 v11, s[68:71], s83 offen offset:1024 lds
 pk 42,44
 mava 124,200,236
 rtv 184,208,33800
 pk 43,46
 mava 124,204,252
 rtv 186,208,34056
 v_mul_f32 v72, v7, v72
 mava 92,204,248
 rtv 188,208,34312
 v_mul_f32 v73, v7, v73
 mava 92,200,232
 rtv 190,208,34568
 v_mul_f32 v74, v7, v74
 mava 60,200,228
 s_add_u32 m0, s92, 84544
 v_mul_f32 v75, v7, v75
 v_mul_f32 v76, v7, v76
 mava 60,204,244
 buffer_load_dwordx4 v11, s[68:71], s83 offen offset:2048 lds
 v_mul_f32 v77, v7, v77
 mava 28,204,240
 s_add_u32 m0, s92, 84576
 v_mul_f32 v78, v7, v78
 v_mul_f32 v79, v7, v79
 mavv 28,200,236
 s_waitcnt lgkmcnt(4)
 buffer_load_dwordx4 v11, s[68:71], s83 offen offset:3072 lds
 pk 72,72
 mavv 0,176,16
 rtv 192,209,33792
 pk 73,74
 mavv 0,180,24
 rtv 194,209,34048
 pk 74,76
 mavv 32,180,56
 rtv 196,209,34304
 pk 75,78
 mavv 32,176,48
 rtv 198,209,34560
 v_mul_f32 v104, v8, v104
 mavv 64,176,80
 s_mov_b32 s86, 28672
 buffer_store_dwordx4 v[64:67], v2, s[60:63], s86 offen offset:3072 sc1
 v_mul_f32 v105, v8, v105
 mavv 64,180,88
 v_mul_f32 v106, v8, v106
 v_mul_f32 v107, v8, v107
 mavv 96,180,120
 v_mul_f32 v108, v8, v108
 v_mul_f32 v109, v8, v109
 mavv 96,176,112
 s_waitcnt lgkmcnt(4)
 v_mul_f32 v110, v8, v110
 v_mul_f32 v111, v8, v111
 mavv 100,184,112
 rtv 200,209,33800
 pk 104,104
 mavv 100,188,120
 rtv 202,209,34056
 pk 105,106
 mavv 68,188,88
 rtv 204,209,34312
 pk 106,108
 mavv 68,184,80
 rtv 206,209,34568
 pk 107,110
 mavv 36,184,48
 v_mul_f32 v136, v9, v136
 v_mul_f32 v137, v9, v137
 mavv 36,188,56
 s_mov_b32 s86, 32768
 buffer_store_dwordx4 v[96:99], v2, s[60:63], s86 offen offset:0 sc1
 v_mul_f32 v138, v9, v138
 mavv 4,188,24
 v_mul_f32 v139, v9, v139
 v_mul_f32 v140, v9, v140
 mavv 4,184,16
 s_waitcnt lgkmcnt(4)
 v_mul_f32 v141, v9, v141
 v_mul_f32 v142, v9, v142
 mavv 8,192,16
 rtv 176,210,33792
 v_mul_f32 v143, v9, v143
 mavv 8,196,24
 rtv 178,210,34048
 pk 136,136
 mavv 40,196,56
 rtv 180,210,34304
 pk 137,138
 mavv 40,192,48
 rtv 182,210,34560
 pk 138,140
 mavv 72,192,80
 pk 139,142
 mavv 72,196,88
 mavv 104,196,120
 s_mov_b32 s86, 32768
 buffer_store_dwordx4 v[128:131], v2, s[60:63], s86 offen offset:1024 sc1
 mavv 104,192,112
 s_waitcnt lgkmcnt(4)
 mavv 108,200,112
 rtv 184,210,33800
 mavv 108,204,120
 rtv 186,210,34056
 mavv 76,204,88
 rtv 188,210,34312
 mavv 76,200,80
 rtv 190,210,34568
 mavv 44,200,48
 mavv 44,204,56
 mavv 12,204,24
 mavv 12,200,16
 s_mov_b32 s86, 32768
 buffer_store_dwordx4 v[40:43], v2, s[60:63], s86 offen offset:3072 sc1
 s_waitcnt vmcnt(9)
 v_cmp_ne_u32 vcc, 1, v13
 s_nop 1
 s_and_b64 vcc, vcc, 15
 s_cbranch_scc1 L14_16_wgroup1
L14_16_ggroup1:
 s_waitcnt lgkmcnt(4)
 mavv 16,176,16
 rtv 192,211,33792
 mavv 16,180,24
 rtv 194,211,34048
 mavv 48,180,56
 rtv 196,211,34304
 mavv 48,176,48
 s_xor_b32 s82, s9, 2
 rtv 198,211,34560
 mavv 80,176,80
 s_mul_i32 s82, s82, 20480
 s_add_u32 s93, s82, 0
 buffer_load_dwordx4 a[168:171], v2, s[16:19], s93 offen offset:0 sc1
 mavv 80,180,88
 mavv 112,180,120
 mavv 112,176,112
 s_waitcnt lgkmcnt(4)
 mavv 116,184,112
 rtv 200,211,33800
 mavv 116,188,120
 rtv 202,211,34056
 mavv 84,188,88
 rtv 204,211,34312
 mavv 84,184,80
 rtv 206,211,34568
 mavv 52,184,48
 buffer_load_dwordx4 a[172:175], v2, s[16:19], s93 offen offset:1024 sc1
 mavv 52,188,56
 s_mov_b32 s86, 36864
 buffer_store_dwordx4 v[72:75], v2, s[60:63], s86 offen offset:0 sc1
 mavv 20,188,24
 mavv 20,184,16
 s_waitcnt lgkmcnt(4)
 mavv 24,192,16
 s_waitcnt lgkmcnt(0)
 s_barrier
 mavv 24,196,24
 rtv 176,208,50688
 mavv 56,196,56
 rtv 178,208,50944
 mavv 56,192,48
 s_add_u32 m0, s92, 101376
 rtv 180,208,51200
 mavv 88,192,80
 s_xor_b32 s83, s9, 3
 s_mul_i32 s83, s83, 131072
 rtv 182,208,51456
 mavv 88,196,88
 buffer_load_dwordx4 v11, s[68:71], s83 offen offset:0 lds
 mavv 120,196,120
 s_add_u32 m0, s92, 101408
 mavv 120,192,112
 buffer_load_dwordx4 v11, s[68:71], s83 offen offset:1024 lds
 mavv 124,200,112
 rtv 184,208,50696
 mavv 124,204,120
 rtv 186,208,50952
 mavv 92,204,88
 rtv 188,208,51208
 mavv 92,200,80
 rtv 190,208,51464
 mavv 60,200,48
 s_add_u32 m0, s92, 101440
 mavv 60,204,56
 buffer_load_dwordx4 v11, s[68:71], s83 offen offset:2048 lds
 mavv 28,204,24
 s_add_u32 m0, s92, 101472
 mavv 28,200,16
 s_waitcnt lgkmcnt(4)
 buffer_load_dwordx4 v11, s[68:71], s83 offen offset:3072 lds
 mavv 0,176,32
 rtv 192,209,50688
 mavv 0,180,40
 rtv 194,209,50944
 mavv 32,180,72
 rtv 196,209,51200
 mavv 32,176,64
 rtv 198,209,51456
 mavv 64,176,96
 buffer_load_dwordx4 a[176:179], v2, s[16:19], s93 offen offset:2048 sc1
 mavv 64,180,104
 s_mov_b32 s86, 36864
 buffer_store_dwordx4 v[104:107], v2, s[60:63], s86 offen offset:1024 sc1
 mavv 96,180,136
 buffer_load_dwordx4 a[180:183], v2, s[16:19], s93 offen offset:3072 sc1
 mavv 96,176,128
 s_waitcnt lgkmcnt(4)
 mavv 100,184,128
 rtv 200,209,50696
 mavv 100,188,136
 rtv 202,209,50952
 mavv 68,188,104
 rtv 204,209,51208
 mavv 68,184,96
 rtv 206,209,51464
 mavv 36,184,64
 s_add_u32 s93, s82, 4096
 buffer_load_dwordx4 a[184:187], v2, s[16:19], s93 offen offset:1024 sc1
 mavv 36,188,72
 mavv 4,188,40
 buffer_load_dwordx4 a[188:191], v2, s[16:19], s93 offen offset:2048 sc1
 mavv 4,184,32
 s_waitcnt lgkmcnt(4)
 s_mov_b32 s86, 36864
 buffer_store_dwordx4 v[136:139], v2, s[60:63], s86 offen offset:2048 sc1
 mavv 8,192,32
 rtv 176,210,50688
 mavv 8,196,40
 rtv 178,210,50944
 mavv 40,196,72
 rtv 180,210,51200
 mavv 40,192,64
 rtv 182,210,51456
 mavv 72,192,96
 buffer_load_dwordx4 a[192:195], v2, s[16:19], s93 offen offset:3072 sc1
 mavv 72,196,104
 mavv 104,196,136
 s_add_u32 s93, s82, 8192
 buffer_load_dwordx4 a[196:199], v2, s[16:19], s93 offen offset:0 sc1
 mavv 104,192,128
 s_waitcnt lgkmcnt(4)
 mavv 108,200,128
 rtv 184,210,50696
 mavv 108,204,136
 rtv 186,210,50952
 mavv 76,204,104
 rtv 188,210,51208
 mavv 76,200,96
 rtv 190,210,51464
 mavv 44,200,64
 mavv 44,204,72
 s_add_u32 s93, s82, 8192
 buffer_load_dwordx4 v[20:23], v2, s[16:19], s93 offen offset:2048 sc1
 mavv 12,204,40
 mavv 12,200,32
 s_waitcnt lgkmcnt(4)
 mavv 16,176,32
 rtv 192,211,50688
 mavv 16,180,40
 rtv 194,211,50944
 mavv 48,180,72
 rtv 196,211,51200
 mavv 48,176,64
 rtv 198,211,51456
 mavv 80,176,96
 buffer_load_dwordx4 v[52:55], v2, s[16:19], s93 offen offset:3072 sc1
 mavv 80,180,104
 mavv 112,180,136
 mavv 112,176,128
 s_waitcnt lgkmcnt(4)
 mavv 116,184,128
 rtv 200,211,50696
 mavv 116,188,136
 rtv 202,211,50952
 mavv 84,188,104
 rtv 204,211,51208
 mavv 84,184,96
 rtv 206,211,51464
 mavv 52,184,64
 s_add_u32 s93, s82, 12288
 buffer_load_dwordx4 v[84:87], v2, s[16:19], s93 offen offset:0 sc1
 mavv 52,188,72
 mavv 20,188,40
 v_add_u32 v208, 4294899712, v208
 mavv 20,184,32
 s_waitcnt lgkmcnt(4)
 mavv 24,192,32
 s_waitcnt lgkmcnt(0)
 s_barrier
 mavv 24,196,40
 rtv 176,208,0
 mavv 56,196,72
 rtv 178,208,256
 mavv 56,192,64
 rtv 180,208,512
 mavv 88,192,96
 s_add_u32 m0, s92, 118272
 s_add_u32 s83, s83, 65536
 rtv 182,208,768
 mavv 88,196,104
 buffer_load_dwordx4 v11, s[68:71], s83 offen offset:0 lds
 mavv 120,196,136
 s_add_u32 m0, s92, 118304
 mavv 120,192,128
 buffer_load_dwordx4 v11, s[68:71], s83 offen offset:1024 lds
 mavv 124,200,128
 rtv 184,208,8
 mavv 124,204,136
 rtv 186,208,264
 mavv 92,204,104
 rtv 188,208,520
 mavv 92,200,96
 rtv 190,208,776
 mavv 60,200,64
 s_add_u32 m0, s92, 118336
 mavv 60,204,72
 buffer_load_dwordx4 v11, s[68:71], s83 offen offset:2048 lds
 mavv 28,204,40
 s_add_u32 m0, s92, 118368
 v_add_u32 v209, 4294899712, v209
 mavv 28,200,32
 buffer_load_dwordx4 v11, s[68:71], s83 offen offset:3072 lds
 s_cmp_lg_u32 s38, 0
 s_cbranch_scc1 L14_16_skip
L14_16_flags:
 s_mov_b32 s38, 1
 v_mov_b32 v14, 163776
 ds_read_b64 v[14:15], v14
 s_waitcnt lgkmcnt(0)
 v_or_b32 v14, v14, v15
 s_nop 0
 v_readfirstlane_b32 s98, v14
 s_nop 1
 s_lshr_b32 s4, s98, 16
 s_or_b32 s98, s98, s4
 s_and_b32 s98, s98, 3
 s_cbranch_scc1 L14_slow
L14_16_go:
 s_waitcnt vmcnt(21)
 mava 0,176,168
 s_waitcnt vmcnt(11)
 rtv 192,209,0
 mava 0,180,184
 s_waitcnt vmcnt(10)
 rtv 194,209,256
 mava 32,180,188
 rtv 196,209,512
 mava 32,176,172
 rtv 198,209,768
 mava 64,176,176
 s_waitcnt vmcnt(8)
 buffer_load_dwordx4 v[116:119], v2, s[16:19], s93 offen offset:1024 sc1
 mava 64,180,192
 s_waitcnt vmcnt(8)
 mava 96,180,196
 buffer_load_dwordx4 v[28:31], v2, s[16:19], s93 offen offset:3072 sc1
 mava 96,176,180
 mava 100,184,180
 rtv 200,209,8
 mava 100,188,196
 rtv 202,209,264
 mava 68,188,192
 rtv 204,209,520
 mava 68,184,176
 rtv 206,209,776
 mava 36,184,172
 s_add_u32 s93, s82, 16384
 buffer_load_dwordx4 v[60:63], v2, s[16:19], s93 offen offset:0 sc1
 mava 36,188,188
 mava 4,188,184
 v_add_u32 v210, 4294899712, v210
 mava 4,184,168
 s_waitcnt lgkmcnt(4)
 buffer_load_dwordx4 v[92:95], v2, s[16:19], s93 offen offset:1024 sc1
 mava 8,192,168
 rtv 176,210,0
 mava 8,196,184
 rtv 178,210,256
 mava 40,196,188
 rtv 180,210,512
 mava 40,192,172
 rtv 182,210,768
 mava 72,192,176
 buffer_load_dwordx4 v[124:127], v2, s[16:19], s93 offen offset:2048 sc1
 mava 72,196,192
 buffer_store_dword v218, v219, s[44:47], 0 offen offset:0 sc1
 mava 104,196,196
 s_xor_b32 s82, s9, 4
 mava 104,192,180
 s_waitcnt lgkmcnt(4)
 s_mul_i32 s82, s82, 20480
 s_add_u32 s93, s82, 0
 buffer_load_dwordx4 v[36:39], v2, s[16:19], s93 offen offset:0 sc1
 mava 108,200,180
 rtv 184,210,8
 mava 108,204,196
 rtv 186,210,264
 mava 76,204,192
 rtv 188,210,520
 mava 76,200,176
 rtv 190,210,776
 mava 44,200,172
 mava 44,204,188
 mava 12,204,184
 v_add_u32 v211, 4294899712, v211
 mava 12,200,168
 s_waitcnt lgkmcnt(4)
 buffer_load_dwordx4 v[68:71], v2, s[16:19], s93 offen offset:1024 sc1
 mava 16,176,168
 rtv 192,211,0
 mava 16,180,184
 rtv 194,211,256
 mava 48,180,188
 rtv 196,211,512
 mava 48,176,172
 rtv 198,211,768
 mava 80,176,176
 mava 80,180,192
 buffer_load_dwordx4 v[100:103], v2, s[16:19], s93 offen offset:2048 sc1
 mava 112,180,196
 mava 112,176,180
 s_waitcnt lgkmcnt(4)
 mava 116,184,180
 rtv 200,211,8
 mava 116,188,196
 rtv 202,211,264
 mava 84,188,192
 rtv 204,211,520
 mava 84,184,176
 rtv 206,211,776
 mava 52,184,172
 buffer_load_dwordx4 v[132:135], v2, s[16:19], s93 offen offset:3072 sc1
 mava 52,188,188
 mava 20,188,184
 mava 20,184,168
 s_waitcnt lgkmcnt(4)
 mava 24,192,168
 s_waitcnt lgkmcnt(0)
 s_barrier
 mava 24,196,184
 rtv 176,208,16896
 mava 56,196,188
 rtv 178,208,17152
 mava 56,192,172
 s_add_u32 m0, s92, 0
 rtv 180,208,17408
 mava 88,192,176
 s_xor_b32 s83, s9, 5
 s_mul_i32 s83, s83, 131072
 rtv 182,208,17664
 mava 88,196,192
 buffer_load_dwordx4 v11, s[68:71], s83 offen offset:0 lds
 mava 120,196,196
 s_add_u32 m0, s92, 32
 mava 120,192,180
 buffer_load_dwordx4 v11, s[68:71], s83 offen offset:1024 lds
 mava 124,200,180
 rtv 184,208,16904
 mava 124,204,196
 rtv 186,208,17160
 mava 92,204,192
 rtv 188,208,17416
 mava 92,200,176
 rtv 190,208,17672
 mava 60,200,172
 s_add_u32 m0, s92, 64
 mava 60,204,188
 buffer_load_dwordx4 v11, s[68:71], s83 offen offset:2048 lds
 mava 28,204,184
 s_add_u32 m0, s92, 96
 mava 28,200,168
 s_waitcnt vmcnt(19) lgkmcnt(4)
 buffer_load_dwordx4 v11, s[68:71], s83 offen offset:3072 lds
 mavv 0,176,20
 s_waitcnt vmcnt(12)
 rtv 192,209,16896
 mavv 0,180,28
 s_waitcnt vmcnt(11)
 rtv 194,209,17152
 mavv 32,180,60
 rtv 196,209,17408
 mavv 32,176,52
 rtv 198,209,17664
 mavv 64,176,84
 s_waitcnt vmcnt(10)
 s_add_u32 s93, s82, 4096
 buffer_load_dwordx4 v[44:47], v2, s[16:19], s93 offen offset:1024 sc1
 mavv 64,180,92
 s_waitcnt vmcnt(10)
 mavv 96,180,124
 buffer_load_dwordx4 v[76:79], v2, s[16:19], s93 offen offset:2048 sc1
 mavv 96,176,116
 s_waitcnt lgkmcnt(4)
 mavv 100,184,116
 rtv 200,209,16904
 mavv 100,188,124
 rtv 202,209,17160
 mavv 68,188,92
 rtv 204,209,17416
 mavv 68,184,84
 rtv 206,209,17672
 mavv 36,184,52
 buffer_load_dwordx4 v[108:111], v2, s[16:19], s93 offen offset:3072 sc1
 mavv 36,188,60
 mavv 4,188,28
 s_add_u32 s93, s82, 8192
 buffer_load_dwordx4 v[140:143], v2, s[16:19], s93 offen offset:0 sc1
 mavv 4,184,20
 s_waitcnt lgkmcnt(4)
 mavv 8,192,20
 rtv 176,210,16896
 mavv 8,196,28
 rtv 178,210,17152
 mavv 40,196,60
 rtv 180,210,17408
 mavv 40,192,52
 rtv 182,210,17664
 mavv 72,192,84
 s_add_u32 s93, s82, 8192
 buffer_load_dwordx4 a[160:163], v2, s[16:19], s93 offen offset:2048 sc1
 mavv 72,196,92
 mavv 104,196,124
 mavv 104,192,116
 s_waitcnt lgkmcnt(4)
 mavv 108,200,116
 rtv 184,210,16904
 mavv 108,204,124
 rtv 186,210,17160
 mavv 76,204,92
 rtv 188,210,17416
 mavv 76,200,84
 rtv 190,210,17672
 mavv 44,200,52
 buffer_load_dwordx4 a[164:167], v2, s[16:19], s93 offen offset:3072 sc1
 mavv 44,204,60
 mavv 12,204,28
 mavv 12,200,20
 s_waitcnt lgkmcnt(4)
 s_add_u32 s93, s82, 12288
 buffer_load_dwordx4 v[240:243], v2, s[16:19], s93 offen offset:0 sc1
 mavv 16,176,20
 rtv 192,211,16896
 mavv 16,180,28
 rtv 194,211,17152
 mavv 48,180,60
 rtv 196,211,17408
 mavv 48,176,52
 rtv 198,211,17664
 mavv 80,176,84
 mavv 80,180,92
 mavv 112,180,124
 buffer_load_dwordx4 v[244:247], v2, s[16:19], s93 offen offset:1024 sc1
 mavv 112,176,116
 s_waitcnt lgkmcnt(4)
 mavv 116,184,116
 rtv 200,211,16904
 mavv 116,188,124
 rtv 202,211,17160
 mavv 84,188,92
 rtv 204,211,17416
 mavv 84,184,84
 rtv 206,211,17672
 mavv 52,184,52
 mavv 52,188,60
 mavv 20,188,28
 buffer_load_dwordx4 v[248:251], v2, s[16:19], s93 offen offset:3072 sc1
 mavv 20,184,20
 s_waitcnt lgkmcnt(4)
 mavv 24,192,20
 s_waitcnt lgkmcnt(0)
 s_barrier
 mavv 24,196,28
 rtv 176,208,33792
 mavv 56,196,60
 rtv 178,208,34048
 mavv 56,192,52
 rtv 180,208,34304
 mavv 88,192,84
 s_add_u32 m0, s92, 16896
 s_add_u32 s83, s83, 65536
 rtv 182,208,34560
 mavv 88,196,92
 buffer_load_dwordx4 v11, s[68:71], s83 offen offset:0 lds
 mavv 120,196,124
 s_add_u32 m0, s92, 16928
 mavv 120,192,116
 buffer_load_dwordx4 v11, s[68:71], s83 offen offset:1024 lds
 mavv 124,200,116
 rtv 184,208,33800
 mavv 124,204,124
 rtv 186,208,34056
 mavv 92,204,92
 rtv 188,208,34312
 mavv 92,200,84
 rtv 190,208,34568
 mavv 60,200,52
 s_add_u32 m0, s92, 16960
 mavv 60,204,60
 buffer_load_dwordx4 v11, s[68:71], s83 offen offset:2048 lds
 mavv 28,204,28
 s_add_u32 m0, s92, 16992
 mavv 28,200,20
 s_waitcnt vmcnt(19) lgkmcnt(4)
 buffer_load_dwordx4 v11, s[68:71], s83 offen offset:3072 lds
 mavv 0,176,36
 s_waitcnt vmcnt(12)
 rtv 192,209,33792
 mavv 0,180,44
 s_waitcnt vmcnt(11)
 rtv 194,209,34048
 mavv 32,180,76
 rtv 196,209,34304
 mavv 32,176,68
 rtv 198,209,34560
 mavv 64,176,100
 s_waitcnt vmcnt(10)
 s_add_u32 s93, s82, 16384
 buffer_load_dwordx4 v[252:255], v2, s[16:19], s93 offen offset:0 sc1
 mavv 64,180,108
 s_waitcnt vmcnt(10)
 mavv 96,180,140
 buffer_load_dwordx4 v[228:231], v2, s[16:19], s93 offen offset:1024 sc1
 mavv 96,176,132
 s_waitcnt lgkmcnt(4)
 mavv 100,184,132
 rtv 200,209,33800
 mavv 100,188,140
 rtv 202,209,34056
 mavv 68,188,108
 rtv 204,209,34312
 mavv 68,184,100
 rtv 206,209,34568
 mavv 36,184,68
 buffer_load_dwordx4 v[232:235], v2, s[16:19], s93 offen offset:2048 sc1
 mavv 36,188,76
 mavv 4,188,44
 s_xor_b32 s82, s9, 6
 mavv 4,184,36
 s_waitcnt lgkmcnt(4)
 s_mul_i32 s82, s82, 20480
 s_add_u32 s93, s82, 0
 buffer_load_dwordx4 v[236:239], v2, s[16:19], s93 offen offset:0 sc1
 mavv 8,192,36
 rtv 176,210,33792
 mavv 8,196,44
 rtv 178,210,34048
 mavv 40,196,76
 rtv 180,210,34304
 mavv 40,192,68
 rtv 182,210,34560
 mavv 72,192,100
 buffer_load_dwordx4 a[228:231], v2, s[16:19], s93 offen offset:1024 sc1
 mavv 72,196,108
 mavv 104,196,140
 mavv 104,192,132
 s_waitcnt lgkmcnt(4)
 mavv 108,200,132
 rtv 184,210,33800
 mavv 108,204,140
 rtv 186,210,34056
 mavv 76,204,108
 rtv 188,210,34312
 mavv 76,200,100
 rtv 190,210,34568
 mavv 44,200,68
 buffer_load_dwordx4 a[232:235], v2, s[16:19], s93 offen offset:2048 sc1
 mavv 44,204,76
 mavv 12,204,44
 mavv 12,200,36
 s_waitcnt lgkmcnt(4)
 mavv 16,176,36
 rtv 192,211,33792
 mavv 16,180,44
 rtv 194,211,34048
 mavv 48,180,76
 rtv 196,211,34304
 mavv 48,176,68
 rtv 198,211,34560
 mavv 80,176,100
 buffer_load_dwordx4 a[236:239], v2, s[16:19], s93 offen offset:3072 sc1
 mavv 80,180,108
 mavv 112,180,140
 mavv 112,176,132
 s_waitcnt lgkmcnt(4)
 mavv 116,184,132
 rtv 200,211,33800
 mavv 116,188,140
 rtv 202,211,34056
 mavv 84,188,108
 rtv 204,211,34312
 mavv 84,184,100
 rtv 206,211,34568
 mavv 52,184,68
 s_add_u32 s93, s82, 4096
 buffer_load_dwordx4 a[240:243], v2, s[16:19], s93 offen offset:1024 sc1
 mavv 52,188,76
 mavv 20,188,44
 mavv 20,184,36
 s_waitcnt lgkmcnt(4)
 buffer_load_dwordx4 a[244:247], v2, s[16:19], s93 offen offset:2048 sc1
 mavv 24,192,36
 s_waitcnt lgkmcnt(0)
 s_barrier
 mavv 24,196,44
 rtv 176,208,50688
 mavv 56,196,76
 rtv 178,208,50944
 mavv 56,192,68
 s_add_u32 m0, s92, 33792
 rtv 180,208,51200
 mavv 88,192,100
 s_xor_b32 s83, s9, 7
 s_mul_i32 s83, s83, 131072
 rtv 182,208,51456
 mavv 88,196,108
 buffer_load_dwordx4 v11, s[68:71], s83 offen offset:0 lds
 mavv 120,196,140
 s_add_u32 m0, s92, 33824
 mavv 120,192,132
 buffer_load_dwordx4 v11, s[68:71], s83 offen offset:1024 lds
 mavv 124,200,132
 rtv 184,208,50696
 mavv 124,204,140
 rtv 186,208,50952
 mavv 92,204,108
 rtv 188,208,51208
 mavv 92,200,100
 rtv 190,208,51464
 mavv 60,200,68
 s_add_u32 m0, s92, 33856
 mavv 60,204,76
 buffer_load_dwordx4 v11, s[68:71], s83 offen offset:2048 lds
 mavv 28,204,44
 s_add_u32 m0, s92, 33888
 mavv 28,200,36
 s_waitcnt vmcnt(20) lgkmcnt(4)
 buffer_load_dwordx4 v11, s[68:71], s83 offen offset:3072 lds
 mava 0,176,160
 s_waitcnt vmcnt(17)
 rtv 192,209,50688
 mavv 0,180,248
 s_waitcnt vmcnt(12)
 rtv 194,209,50944
 mavv 32,180,252
 rtv 196,209,51200
 mava 32,176,164
 rtv 198,209,51456
 mavv 64,176,240
 s_waitcnt vmcnt(11)
 buffer_load_dwordx4 a[248:251], v2, s[16:19], s93 offen offset:3072 sc1
 mavv 64,180,228
 s_waitcnt vmcnt(11)
 mavv 96,180,232
 s_add_u32 s93, s82, 8192
 buffer_load_dwordx4 a[252:255], v2, s[16:19], s93 offen offset:0 sc1
 mavv 96,176,244
 s_waitcnt lgkmcnt(4)
 mavv 100,184,244
 rtv 200,209,50696
 mavv 100,188,232
 rtv 202,209,50952
 mavv 68,188,228
 rtv 204,209,51208
 mavv 68,184,240
 rtv 206,209,51464
 mava 36,184,164
 s_add_u32 s93, s82, 8192
 buffer_load_dwordx4 a[168:171], v2, s[16:19], s93 offen offset:2048 sc1
 mavv 36,188,252
 mavv 4,188,248
 buffer_load_dwordx4 a[172:175], v2, s[16:19], s93 offen offset:3072 sc1
 mava 4,184,160
 s_waitcnt lgkmcnt(4)
 mava 8,192,160
 rtv 176,210,50688
 mavv 8,196,248
 rtv 178,210,50944
 mavv 40,196,252
 rtv 180,210,51200
 mava 40,192,164
 rtv 182,210,51456
 mavv 72,192,240
 s_add_u32 s93, s82, 12288
 buffer_load_dwordx4 a[176:179], v2, s[16:19], s93 offen offset:0 sc1
 mavv 72,196,228
 mavv 104,196,232
 mavv 104,192,244
 s_waitcnt lgkmcnt(4)
 mavv 108,200,244
 rtv 184,210,50696
 mavv 108,204,232
 rtv 186,210,50952
 mavv 76,204,228
 rtv 188,210,51208
 mavv 76,200,240
 rtv 190,210,51464
 mava 44,200,164
 buffer_load_dwordx4 a[180:183], v2, s[16:19], s93 offen offset:1024 sc1
 mavv 44,204,252
 mavv 12,204,248
 mava 12,200,160
 s_waitcnt lgkmcnt(4)
 mava 16,176,160
 rtv 192,211,50688
 mavv 16,180,248
 rtv 194,211,50944
 mavv 48,180,252
 rtv 196,211,51200
 mava 48,176,164
 rtv 198,211,51456
 mavv 80,176,240
 s_xor_b32 s94, s8, 0
 s_lshl_b32 s94, s94, 9
 buffer_load_dwordx4 a[184:187], v2, s[16:19], s93 offen offset:3072 sc1
 mavv 80,180,228
 v_min_u32 v15, 12, v0
 v_lshl_add_u32 v15, v15, 5, s94
 mavv 112,180,232
 mavv 112,176,244
 s_waitcnt lgkmcnt(4)
 buffer_load_dword v13, v15, s[44:47], 0 offen offset:0 sc1
 mavv 116,184,244
 rtv 200,211,50696
 mavv 116,188,232
 rtv 202,211,50952
 mavv 84,188,228
 rtv 204,211,51208
 mavv 84,184,240
 rtv 206,211,51464
 mava 52,184,164
 s_add_u32 s93, s82, 16384
 buffer_load_dwordx4 a[188:191], v2, s[16:19], s93 offen offset:0 sc1
 mavv 52,188,252
 mavv 20,188,248
 v_add_u32 v208, 67584, v208
 mava 20,184,160
 s_waitcnt lgkmcnt(4)
 mava 24,192,160
 s_waitcnt lgkmcnt(0)
 s_barrier
 mavv 24,196,248
 rtv 176,208,0
 mavv 56,196,252
 rtv 178,208,256
 mava 56,192,164
 rtv 180,208,512
 mavv 88,192,240
 s_add_u32 m0, s92, 50688
 s_add_u32 s83, s83, 65536
 rtv 182,208,768
 mavv 88,196,228
 buffer_load_dwordx4 v11, s[68:71], s83 offen offset:0 lds
 mavv 120,196,232
 s_add_u32 m0, s92, 50720
 mavv 120,192,244
 buffer_load_dwordx4 v11, s[68:71], s83 offen offset:1024 lds
 mavv 124,200,244
 rtv 184,208,8
 mavv 124,204,232
 rtv 186,208,264
 mavv 92,204,228
 rtv 188,208,520
 mavv 92,200,240
 rtv 190,208,776
 mava 60,200,164
 s_add_u32 m0, s92, 50752
 mavv 60,204,252
 buffer_load_dwordx4 v11, s[68:71], s83 offen offset:2048 lds
 mavv 28,204,248
 s_add_u32 m0, s92, 50784
 v_add_u32 v209, 67584, v209
 mava 28,200,160
 s_waitcnt vmcnt(21) lgkmcnt(4)
 buffer_load_dwordx4 v11, s[68:71], s83 offen offset:3072 lds
 mavv 0,176,236
 s_waitcnt vmcnt(18)
 rtv 192,209,0
 mava 0,180,240
 s_waitcnt vmcnt(17)
 rtv 194,209,256
 mava 32,180,244
 rtv 196,209,512
 mava 32,176,228
 rtv 198,209,768
 mava 64,176,232
 s_waitcnt vmcnt(12)
 buffer_load_dwordx4 a[192:195], v2, s[16:19], s93 offen offset:1024 sc1
 mava 64,180,248
 s_waitcnt vmcnt(12)
 mava 96,180,252
 buffer_load_dwordx4 a[196:199], v2, s[16:19], s93 offen offset:2048 sc1
 mava 96,176,236
 s_waitcnt vmcnt(7)
 v_cmp_ne_u32 vcc, 1, v13
 s_nop 1
 s_and_b64 vcc, vcc, 15
 s_cbranch_scc1 L14_16_wgroup
L14_16_ggroup:
 s_waitcnt lgkmcnt(4)
 mava 100,184,236
 rtv 200,209,8
 mava 100,188,252
 rtv 202,209,264
 mava 68,188,248
 rtv 204,209,520
 mava 68,184,232
 s_xor_b32 s82, s9, 3
 rtv 206,209,776
 mava 36,184,228
 s_mul_i32 s82, s82, 20480
 s_add_u32 s93, s82, 0
 buffer_load_dwordx4 v[16:19], v2, s[16:19], s93 offen offset:0 sc1
 mava 36,188,244
 mava 4,188,240
 v_add_u32 v210, 67584, v210
 mavv 4,184,236
 s_waitcnt lgkmcnt(4)
 buffer_load_dwordx4 v[48:51], v2, s[16:19], s93 offen offset:1024 sc1
 mavv 8,192,236
 rtv 176,210,0
 mava 8,196,240
 rtv 178,210,256
 mava 40,196,244
 rtv 180,210,512
 mava 40,192,228
 rtv 182,210,768
 mava 72,192,232
 buffer_load_dwordx4 v[80:83], v2, s[16:19], s93 offen offset:2048 sc1
 mava 72,196,248
 buffer_load_dwordx4 v[112:115], v2, s[16:19], s93 offen offset:3072 sc1
 mava 104,196,252
 mava 104,192,236
 s_waitcnt lgkmcnt(4)
 mava 108,200,236
 rtv 184,210,8
 mava 108,204,252
 rtv 186,210,264
 mava 76,204,248
 rtv 188,210,520
 mava 76,200,232
 rtv 190,210,776
 mava 44,200,228
 s_add_u32 s93, s82, 4096
 buffer_load_dwordx4 v[24:27], v2, s[16:19], s93 offen offset:1024 sc1
 mava 44,204,244
 buffer_load_dwordx4 v[56:59], v2, s[16:19], s93 offen offset:2048 sc1
 mava 12,204,240
 v_add_u32 v211, 67584, v211
 mavv 12,200,236
 s_waitcnt lgkmcnt(4)
 buffer_load_dwordx4 v[88:91], v2, s[16:19], s93 offen offset:3072 sc1
 mavv 16,176,236
 rtv 192,211,0
 mava 16,180,240
 rtv 194,211,256
 mava 48,180,244
 rtv 196,211,512
 mava 48,176,228
 rtv 198,211,768
 mava 80,176,232
 s_add_u32 s93, s82, 8192
 buffer_load_dwordx4 v[120:123], v2, s[16:19], s93 offen offset:0 sc1
 mava 80,180,248
 s_add_u32 s93, s82, 8192
 buffer_load_dwordx4 v[32:35], v2, s[16:19], s93 offen offset:2048 sc1
 mava 112,180,252
 mava 112,176,236
 s_waitcnt lgkmcnt(4)
 mava 116,184,236
 rtv 200,211,8
 mava 116,188,252
 rtv 202,211,264
 mava 84,188,248
 rtv 204,211,520
 mava 84,184,232
 rtv 206,211,776
 mava 52,184,228
 buffer_load_dwordx4 v[64:67], v2, s[16:19], s93 offen offset:3072 sc1
 mava 52,188,244
 s_add_u32 s93, s82, 12288
 buffer_load_dwordx4 v[96:99], v2, s[16:19], s93 offen offset:0 sc1
 mava 20,188,240
 mavv 20,184,236
 s_waitcnt lgkmcnt(4)
 buffer_load_dwordx4 v[128:131], v2, s[16:19], s93 offen offset:1024 sc1
 mavv 24,192,236
 s_waitcnt lgkmcnt(0)
 s_barrier
 mava 24,196,240
 rtv 176,208,16896
 mava 56,196,244
 rtv 178,208,17152
 mava 56,192,228
 rtv 180,208,17408
 mava 88,192,232
 rtv 182,208,17664
 mava 88,196,248
 buffer_load_dwordx4 v[40:43], v2, s[16:19], s93 offen offset:3072 sc1
 mava 120,196,252
 s_add_u32 s93, s82, 16384
 buffer_load_dwordx4 v[72:75], v2, s[16:19], s93 offen offset:0 sc1
 mava 120,192,236
 mava 124,200,236
 rtv 184,208,16904
 mava 124,204,252
 rtv 186,208,17160
 mava 92,204,248
 rtv 188,208,17416
 mava 92,200,232
 rtv 190,208,17672
 mava 60,200,228
 buffer_load_dwordx4 v[104:107], v2, s[16:19], s93 offen offset:1024 sc1
 mava 60,204,244
 buffer_load_dwordx4 v[136:139], v2, s[16:19], s93 offen offset:2048 sc1
 mava 28,204,240
 mavv 28,200,236
 s_waitcnt lgkmcnt(4)
 mava 0,176,168
 rtv 192,209,16896
 mava 0,180,184
 s_waitcnt vmcnt(22)
 rtv 194,209,17152
 mava 32,180,188
 rtv 196,209,17408
 mava 32,176,172
 s_xor_b32 s82, s9, 5
 rtv 198,209,17664
 mava 64,176,176
 s_waitcnt vmcnt(17)
 s_mul_i32 s82, s82, 20480
 s_add_u32 s93, s82, 0
 buffer_load_dwordx4 v[20:23], v2, s[16:19], s93 offen offset:0 sc1
 mava 64,180,192
 s_waitcnt vmcnt(17)
 buffer_load_dwordx4 v[52:55], v2, s[16:19], s93 offen offset:1024 sc1
 mava 96,180,196
 buffer_load_dwordx4 v[84:87], v2, s[16:19], s93 offen offset:2048 sc1
 mava 96,176,180
 s_waitcnt lgkmcnt(4)
 mava 100,184,180
 rtv 200,209,16904
 mava 100,188,196
 rtv 202,209,17160
 mava 68,188,192
 rtv 204,209,17416
 mava 68,184,176
 rtv 206,209,17672
 mava 36,184,172
 buffer_load_dwordx4 v[116:119], v2, s[16:19], s93 offen offset:3072 sc1
 mava 36,188,188
 s_add_u32 s93, s82, 4096
 buffer_load_dwordx4 v[28:31], v2, s[16:19], s93 offen offset:1024 sc1
 mava 4,188,184
 mava 4,184,168
 s_waitcnt lgkmcnt(4)
 mava 8,192,168
 rtv 176,210,16896
 mava 8,196,184
 rtv 178,210,17152
 mava 40,196,188
 rtv 180,210,17408
 mava 40,192,172
 rtv 182,210,17664
 mava 72,192,176
 buffer_load_dwordx4 v[60:63], v2, s[16:19], s93 offen offset:2048 sc1
 mava 72,196,192
 buffer_load_dwordx4 v[92:95], v2, s[16:19], s93 offen offset:3072 sc1
 mava 104,196,196
 s_add_u32 s93, s82, 8192
 buffer_load_dwordx4 v[124:127], v2, s[16:19], s93 offen offset:0 sc1
 mava 104,192,180
 s_waitcnt lgkmcnt(4)
 mava 108,200,180
 rtv 184,210,16904
 mava 108,204,196
 rtv 186,210,17160
 mava 76,204,192
 rtv 188,210,17416
 mava 76,200,176
 rtv 190,210,17672
 mava 44,200,172
 s_add_u32 s93, s82, 8192
 buffer_load_dwordx4 v[36:39], v2, s[16:19], s93 offen offset:2048 sc1
 mava 44,204,188
 buffer_load_dwordx4 v[68:71], v2, s[16:19], s93 offen offset:3072 sc1
 mava 12,204,184
 mava 12,200,168
 s_waitcnt lgkmcnt(4)
 mava 16,176,168
 rtv 192,211,16896
 mava 16,180,184
 rtv 194,211,17152
 mava 48,180,188
 rtv 196,211,17408
 mava 48,176,172
 rtv 198,211,17664
 mava 80,176,176
 s_add_u32 s93, s82, 12288
 buffer_load_dwordx4 v[100:103], v2, s[16:19], s93 offen offset:0 sc1
 mava 80,180,192
 buffer_load_dwordx4 v[132:135], v2, s[16:19], s93 offen offset:1024 sc1
 mava 112,180,196
 mava 112,176,180
 s_waitcnt lgkmcnt(4)
 buffer_load_dwordx4 v[44:47], v2, s[16:19], s93 offen offset:3072 sc1
 mava 116,184,180
 rtv 200,211,16904
 mava 116,188,196
 rtv 202,211,17160
 mava 84,188,192
 rtv 204,211,17416
 mava 84,184,176
 rtv 206,211,17672
 mava 52,184,172
 s_add_u32 s93, s82, 16384
 buffer_load_dwordx4 v[76:79], v2, s[16:19], s93 offen offset:0 sc1
 mava 52,188,188
 buffer_load_dwordx4 v[108:111], v2, s[16:19], s93 offen offset:1024 sc1
 mava 20,188,184
 mava 20,184,168
 s_waitcnt lgkmcnt(4)
 mava 24,192,168
 s_waitcnt lgkmcnt(0)
 s_barrier
 mava 24,196,184
 rtv 176,209,33792
 mava 56,196,188
 rtv 178,209,34048
 mava 56,192,172
 rtv 180,209,34304
 mava 88,192,176
 rtv 182,209,34560
 mava 88,196,192
 buffer_load_dwordx4 v[140:143], v2, s[16:19], s93 offen offset:2048 sc1
 mava 120,196,196
 mava 120,192,180
 mava 124,200,180
 rtv 184,209,33800
 mava 124,204,196
 rtv 186,209,34056
 mava 92,204,192
 rtv 188,209,34312
 mava 92,200,176
 s_xor_b32 s82, s9, 7
 rtv 190,209,34568
 mava 60,200,172
 s_mul_i32 s82, s82, 20480
 s_add_u32 s93, s82, 0
 buffer_load_dwordx4 a[160:163], v2, s[16:19], s93 offen offset:0 sc1
 mava 60,204,188
 buffer_load_dwordx4 a[164:167], v2, s[16:19], s93 offen offset:1024 sc1
 mava 28,204,184
 buffer_load_dwordx4 v[240:243], v2, s[16:19], s93 offen offset:2048 sc1
 mava 28,200,168
 s_waitcnt vmcnt(34) lgkmcnt(4)
 buffer_load_dwordx4 v[244:247], v2, s[16:19], s93 offen offset:3072 sc1
 mavv 8,176,16
 s_waitcnt vmcnt(31)
 rtv 192,209,50688
 mavv 8,180,24
 s_waitcnt vmcnt(30)
 rtv 194,209,50944
 mavv 40,180,56
 rtv 196,209,51200
 mavv 40,176,48
 rtv 198,209,51456
 mavv 72,176,80
 s_waitcnt vmcnt(29)
 s_add_u32 s93, s82, 4096
 buffer_load_dwordx4 v[248:251], v2, s[16:19], s93 offen offset:1024 sc1
 mavv 72,180,88
 s_waitcnt vmcnt(29)
 buffer_load_dwordx4 v[252:255], v2, s[16:19], s93 offen offset:2048 sc1
 mavv 104,180,120
 mavv 104,176,112
 s_waitcnt lgkmcnt(4)
 mavv 108,184,112
 rtv 200,209,50696
 mavv 108,188,120
 rtv 202,209,50952
 mavv 76,188,88
 rtv 204,209,51208
 mavv 76,184,80
 rtv 206,209,51464
 mavv 44,184,48
 buffer_load_dwordx4 v[228:231], v2, s[16:19], s93 offen offset:3072 sc1
 mavv 44,188,56
 s_add_u32 s93, s82, 8192
 buffer_load_dwordx4 v[232:235], v2, s[16:19], s93 offen offset:0 sc1
 mavv 12,188,24
 v_add_u32 v209, 4294899712, v209
 mavv 12,184,16
 s_waitcnt vmcnt(31) lgkmcnt(4)
 s_add_u32 s93, s82, 8192
 buffer_load_dwordx4 v[236:239], v2, s[16:19], s93 offen offset:2048 sc1
 mavv 8,192,32
 s_waitcnt vmcnt(28)
 rtv 176,209,0
 mavv 8,196,40
 s_waitcnt vmcnt(27)
 rtv 178,209,256
 mavv 40,196,72
 rtv 180,209,512
 mavv 40,192,64
 rtv 182,209,768
 mavv 72,192,96
 s_waitcnt vmcnt(26)
 buffer_load_dwordx4 a[228:231], v2, s[16:19], s93 offen offset:3072 sc1
 mavv 72,196,104
 s_waitcnt vmcnt(26)
 s_add_u32 s93, s82, 12288
 buffer_load_dwordx4 a[232:235], v2, s[16:19], s93 offen offset:0 sc1
 mavv 104,196,136
 mavv 104,192,128
 s_waitcnt lgkmcnt(4)
 mavv 108,200,128
 rtv 184,209,8
 mavv 108,204,136
 rtv 186,209,264
 mavv 76,204,104
 rtv 188,209,520
 mavv 76,200,96
 rtv 190,209,776
 mavv 44,200,64
 buffer_load_dwordx4 a[236:239], v2, s[16:19], s93 offen offset:1024 sc1
 mavv 44,204,72
 buffer_load_dwordx4 a[240:243], v2, s[16:19], s93 offen offset:3072 sc1
 mavv 12,204,40
 mavv 12,200,32
 s_waitcnt vmcnt(28) lgkmcnt(4)
 s_add_u32 s93, s82, 16384
 buffer_load_dwordx4 a[244:247], v2, s[16:19], s93 offen offset:0 sc1
 mavv 8,176,20
 s_waitcnt vmcnt(25)
 rtv 192,209,16896
 mavv 8,180,28
 s_waitcnt vmcnt(24)
 rtv 194,209,17152
 mavv 40,180,60
 rtv 196,209,17408
 mavv 40,176,52
 rtv 198,209,17664
 mavv 72,176,84
 s_waitcnt vmcnt(23)
 buffer_load_dwordx4 a[248:251], v2, s[16:19], s93 offen offset:1024 sc1
 mavv 72,180,92
 s_waitcnt vmcnt(23)
 mavv 104,180,124
 buffer_load_dwordx4 a[252:255], v2, s[16:19], s93 offen offset:2048 sc1
 mavv 104,176,116
 s_waitcnt lgkmcnt(4)
 mavv 108,184,116
 rtv 200,209,16904
 mavv 108,188,124
 rtv 202,209,17160
 mavv 76,188,92
 rtv 204,209,17416
 mavv 76,184,84
 rtv 206,209,17672
 mavv 44,184,52
 mavv 44,188,60
 mavv 12,188,28
 mavv 12,184,20
 s_waitcnt vmcnt(23) lgkmcnt(4)
 mavv 8,192,36
 s_waitcnt vmcnt(19)
 rtv 176,209,33792
 v_mov_b32 v9, 1
 mavv 8,196,44
 s_waitcnt vmcnt(18)
 rtv 178,209,34048
 v_cmp_eq_u32 vcc, 0, v0
 mavv 40,196,76
 s_add_u32 s4, s8, 1
 s_and_b32 s4, s4, 3
 rtv 180,209,34304
 mavv 40,192,68
 s_lshl_b32 s4, s4, 9
 rtv 182,209,34560
 v_mov_b32 v10, s4
 mavv 72,192,100
 s_waitcnt vmcnt(17)
 v_cndmask_b32 v6, 0x40000000, v10, vcc
 mavv 72,196,108
 s_waitcnt vmcnt(16)
 s_add_u32 s4, s8, 2
 s_and_b32 s4, s4, 3
 s_lshl_b32 s4, s4, 9
 mavv 104,196,140
 v_mov_b32 v10, s4
 v_cndmask_b32 v7, 0x40000000, v10, vcc
 mavv 104,192,132
 s_waitcnt lgkmcnt(4)
 s_add_u32 s4, s8, 3
 s_and_b32 s4, s4, 3
 s_lshl_b32 s4, s4, 9
 mavv 108,200,132
 rtv 184,209,33800
 v_mov_b32 v10, s4
 mavv 108,204,140
 rtv 186,209,34056
 v_cndmask_b32 v8, 0x40000000, v10, vcc
 mavv 76,204,108
 rtv 188,209,34312
 v_min_u32 v10, 8, v0
 mavv 76,200,100
 rtv 190,209,34568
 mavv 44,200,68
 mavv 44,204,76
 mavv 12,204,44
 mavv 12,200,36
 s_waitcnt vmcnt(15) lgkmcnt(4)
 mava 8,176,160
 s_waitcnt vmcnt(11)
 rtv 192,209,50688
 mavv 8,180,248
 s_waitcnt vmcnt(10)
 rtv 194,209,50944
 mavv 40,180,252
 rtv 196,209,51200
 mava 40,176,164
 rtv 198,209,51456
 mavv 72,176,240
 s_waitcnt vmcnt(9)
 mavv 72,180,228
 s_waitcnt vmcnt(8)
 mavv 104,180,232
 mavv 104,176,244
 s_waitcnt lgkmcnt(4)
 mavv 108,184,244
 rtv 200,209,50696
 mavv 108,188,232
 rtv 202,209,50952
 mavv 76,188,228
 rtv 204,209,51208
 mavv 76,184,240
 rtv 206,209,51464
 mava 44,184,164
 mavv 44,188,252
 mavv 12,188,248
 mava 12,184,160
 s_waitcnt vmcnt(7) lgkmcnt(4)
 mavv 8,192,236
 s_waitcnt vmcnt(3)
 rtv 176,210,33792
 mava 8,196,240
 s_waitcnt vmcnt(2)
 rtv 178,210,34048
 mava 40,196,244
 rtv 180,210,34304
 mava 40,192,228
 rtv 182,210,34560
 mava 72,192,232
 s_waitcnt vmcnt(1)
 mava 72,196,248
 s_waitcnt vmcnt(0)
 mava 104,196,252
 mava 104,192,236
 s_waitcnt lgkmcnt(4)
 mava 108,200,236
 rtv 184,210,33800
 mava 108,204,252
 rtv 186,210,34056
 mava 76,204,248
 rtv 188,210,34312
 mava 76,200,232
 rtv 190,210,34568
 mava 44,200,228
 mava 44,204,244
 mava 12,204,240
 mavv 12,200,236
 s_waitcnt lgkmcnt(4)
 mavv 16,176,16
 s_add_u32 s3, s8, 1
 s_and_b32 s3, s3, 3
 rtv 192,210,50688
 mavv 16,180,24
 s_mul_i32 s3, s3, 61440
 s_add_u32 s3, s3, 0
 rtv 194,210,50944
 mavv 48,180,56
 rtv 196,210,51200
 v_accvgpr_read_b32 v212, a8
 mavv 48,176,48
 rtv 198,210,51456
 v_accvgpr_read_b32 v213, a9
 mavv 80,176,80
 v_accvgpr_read_b32 v214, a10
 v_accvgpr_read_b32 v215, a11
 mavv 80,180,88
 v_accvgpr_read_b32 v216, a12
 v_accvgpr_read_b32 v217, a13
 mavv 112,180,120
 v_accvgpr_read_b32 v218, a14
 v_accvgpr_read_b32 v219, a15
 mavv 112,176,112
 s_waitcnt lgkmcnt(4)
 pk 212,212
 pk 213,214
 mavv 116,184,112
 rtv 200,210,50696
 pk 214,216
 mavv 116,188,120
 rtv 202,210,50952
 pk 215,218
 mavv 84,188,88
 s_add_u32 s86, s3, 0
 rtv 204,210,51208
 mavv 84,184,80
 rtv 206,210,51464
 mavv 52,184,48
 buffer_store_dwordx4 v[212:215], v2, s[20:23], s86 offen offset:0 sc1
 v_accvgpr_read_b32 v220, a40
 mavv 52,188,56
 v_accvgpr_read_b32 v221, a41
 v_accvgpr_read_b32 v222, a42
 mavv 20,188,24
 v_add_u32 v210, 4294899712, v210
 v_accvgpr_read_b32 v223, a43
 mavv 20,184,16
 s_waitcnt lgkmcnt(4)
 v_accvgpr_read_b32 v224, a44
 v_accvgpr_read_b32 v225, a45
 mavv 16,192,32
 rtv 176,210,0
 v_accvgpr_read_b32 v226, a46
 mavv 16,196,40
 rtv 178,210,256
 v_accvgpr_read_b32 v227, a47
 mavv 48,196,72
 rtv 180,210,512
 pk 220,220
 mavv 48,192,64
 rtv 182,210,768
 pk 221,222
 mavv 80,192,96
 pk 222,224
 pk 223,226
 mavv 80,196,104
 buffer_store_dwordx4 v[220:223], v2, s[20:23], s86 offen offset:1024 sc1
 v_accvgpr_read_b32 v212, a72
 mavv 112,196,136
 v_accvgpr_read_b32 v213, a73
 v_accvgpr_read_b32 v214, a74
 mavv 112,192,128
 s_waitcnt lgkmcnt(4)
 v_accvgpr_read_b32 v215, a75
 v_accvgpr_read_b32 v216, a76
 mavv 116,200,128
 rtv 184,210,8
 v_accvgpr_read_b32 v217, a77
 mavv 116,204,136
 rtv 186,210,264
 v_accvgpr_read_b32 v218, a78
 mavv 84,204,104
 rtv 188,210,520
 v_accvgpr_read_b32 v219, a79
 mavv 84,200,96
 rtv 190,210,776
 pk 212,212
 mavv 52,200,64
 pk 213,214
 pk 214,216
 mavv 52,204,72
 pk 215,218
 mavv 20,204,40
 buffer_store_dwordx4 v[212:215], v2, s[20:23], s86 offen offset:2048 sc1
 v_accvgpr_read_b32 v220, a104
 mavv 20,200,32
 s_waitcnt lgkmcnt(4)
 v_accvgpr_read_b32 v221, a105
 v_accvgpr_read_b32 v222, a106
 mavv 16,176,20
 rtv 192,210,16896
 v_accvgpr_read_b32 v223, a107
 mavv 16,180,28
 rtv 194,210,17152
 v_accvgpr_read_b32 v224, a108
 mavv 48,180,60
 rtv 196,210,17408
 v_accvgpr_read_b32 v225, a109
 mavv 48,176,52
 rtv 198,210,17664
 v_accvgpr_read_b32 v226, a110
 mavv 80,176,84
 v_accvgpr_read_b32 v227, a111
 pk 220,220
 mavv 80,180,92
 pk 221,222
 pk 222,224
 mavv 112,180,124
 pk 223,226
 mavv 112,176,116
 s_waitcnt lgkmcnt(4)
 buffer_store_dwordx4 v[220:223], v2, s[20:23], s86 offen offset:3072 sc1
 mavv 116,184,116
 rtv 200,210,16904
 mavv 116,188,124
 s_lshl_b32 s94, s8, 9
 rtv 202,210,17160
 mavv 84,188,92
 buffer_load_dword v13, v10, s[32:35], s94 offen sc1
 rtv 204,210,17416
 mavv 84,184,84
 rtv 206,210,17672
 mavv 52,184,52
 mavv 52,188,60
 mavv 20,188,28
 mavv 20,184,20
 s_waitcnt lgkmcnt(4)
 mavv 16,192,36
 rtv 176,210,33792
 mavv 16,196,44
 rtv 178,210,34048
 mavv 48,196,76
 rtv 180,210,34304
 mavv 48,192,68
 rtv 182,210,34560
 mavv 80,192,100
 mavv 80,196,108
 mavv 112,196,140
 mavv 112,192,132
 s_waitcnt lgkmcnt(4)
 mavv 116,200,132
 rtv 184,210,33800
 mavv 116,204,140
 rtv 186,210,34056
 mavv 84,204,108
 rtv 188,210,34312
 mavv 84,200,100
 rtv 190,210,34568
 mavv 52,200,68
 mavv 52,204,76
 mavv 20,204,44
 mavv 20,200,36
 s_waitcnt lgkmcnt(4)
 mava 16,176,160
 rtv 192,210,50688
 mavv 16,180,248
 rtv 194,210,50944
 mavv 48,180,252
 rtv 196,210,51200
 mava 48,176,164
 rtv 198,210,51456
 mavv 80,176,240
 mavv 80,180,228
 mavv 112,180,232
 mavv 112,176,244
 s_waitcnt lgkmcnt(4)
 mavv 116,184,244
 rtv 200,210,50696
 mavv 116,188,232
 rtv 202,210,50952
 mavv 84,188,228
 rtv 204,210,51208
 mavv 84,184,240
 rtv 206,210,51464
 mava 52,184,164
 mavv 52,188,252
 mavv 20,188,248
 mava 20,184,160
 s_waitcnt lgkmcnt(4)
 mavv 16,192,236
 rtv 176,211,33792
 mava 16,196,240
 rtv 178,211,34048
 mava 48,196,244
 rtv 180,211,34304
 mava 48,192,228
 rtv 182,211,34560
 mava 80,192,232
 mava 80,196,248
 mava 112,196,252
 mava 112,192,236
 s_waitcnt lgkmcnt(4)
 mava 116,200,236
 rtv 184,211,33800
 mava 116,204,252
 rtv 186,211,34056
 mava 84,204,248
 rtv 188,211,34312
 mava 84,200,232
 rtv 190,211,34568
 mava 52,200,228
 mava 52,204,244
 mava 20,204,240
 mavv 20,200,236
 s_waitcnt lgkmcnt(4)
 mavv 24,176,16
 s_add_u32 s3, s8, 2
 s_and_b32 s3, s3, 3
 rtv 192,211,50688
 mavv 24,180,24
 s_mul_i32 s3, s3, 61440
 s_add_u32 s3, s3, 20480
 rtv 194,211,50944
 mavv 56,180,56
 rtv 196,211,51200
 v_accvgpr_read_b32 v212, a16
 mavv 56,176,48
 rtv 198,211,51456
 v_accvgpr_read_b32 v213, a17
 mavv 88,176,80
 v_accvgpr_read_b32 v214, a18
 v_accvgpr_read_b32 v215, a19
 mavv 88,180,88
 v_accvgpr_read_b32 v216, a20
 v_accvgpr_read_b32 v217, a21
 mavv 120,180,120
 v_accvgpr_read_b32 v218, a22
 v_accvgpr_read_b32 v219, a23
 mavv 120,176,112
 s_waitcnt lgkmcnt(4)
 pk 212,212
 pk 213,214
 mavv 124,184,112
 rtv 200,211,50696
 pk 214,216
 mavv 124,188,120
 rtv 202,211,50952
 pk 215,218
 mavv 92,188,88
 s_add_u32 s86, s3, 0
 rtv 204,211,51208
 mavv 92,184,80
 rtv 206,211,51464
 mavv 60,184,48
 buffer_store_dwordx4 v[212:215], v2, s[20:23], s86 offen offset:0 sc1
 v_accvgpr_read_b32 v220, a48
 mavv 60,188,56
 v_accvgpr_read_b32 v221, a49
 v_accvgpr_read_b32 v222, a50
 mavv 28,188,24
 v_add_u32 v211, 4294899712, v211
 v_accvgpr_read_b32 v223, a51
 mavv 28,184,16
 s_waitcnt lgkmcnt(4)
 v_accvgpr_read_b32 v224, a52
 v_accvgpr_read_b32 v225, a53
 mavv 24,192,32
 rtv 176,211,0
 v_accvgpr_read_b32 v226, a54
 mavv 24,196,40
 rtv 178,211,256
 v_accvgpr_read_b32 v227, a55
 mavv 56,196,72
 rtv 180,211,512
 pk 220,220
 mavv 56,192,64
 rtv 182,211,768
 pk 221,222
 mavv 88,192,96
 pk 222,224
 pk 223,226
 mavv 88,196,104
 buffer_store_dwordx4 v[220:223], v2, s[20:23], s86 offen offset:1024 sc1
 v_accvgpr_read_b32 v212, a80
 mavv 120,196,136
 v_accvgpr_read_b32 v213, a81
 v_accvgpr_read_b32 v214, a82
 mavv 120,192,128
 s_waitcnt lgkmcnt(4)
 v_accvgpr_read_b32 v215, a83
 v_accvgpr_read_b32 v216, a84
 mavv 124,200,128
 rtv 184,211,8
 v_accvgpr_read_b32 v217, a85
 mavv 124,204,136
 rtv 186,211,264
 v_accvgpr_read_b32 v218, a86
 mavv 92,204,104
 rtv 188,211,520
 v_accvgpr_read_b32 v219, a87
 mavv 92,200,96
 rtv 190,211,776
 pk 212,212
 mavv 60,200,64
 pk 213,214
 pk 214,216
 mavv 60,204,72
 pk 215,218
 mavv 28,204,40
 buffer_store_dwordx4 v[212:215], v2, s[20:23], s86 offen offset:2048 sc1
 v_accvgpr_read_b32 v220, a112
 mavv 28,200,32
 s_waitcnt lgkmcnt(4)
 v_accvgpr_read_b32 v221, a113
 v_accvgpr_read_b32 v222, a114
 mavv 24,176,20
 rtv 192,211,16896
 v_accvgpr_read_b32 v223, a115
 mavv 24,180,28
 rtv 194,211,17152
 v_accvgpr_read_b32 v224, a116
 mavv 56,180,60
 rtv 196,211,17408
 v_accvgpr_read_b32 v225, a117
 mavv 56,176,52
 rtv 198,211,17664
 v_accvgpr_read_b32 v226, a118
 mavv 88,176,84
 v_accvgpr_read_b32 v227, a119
 pk 220,220
 mavv 88,180,92
 pk 221,222
 pk 222,224
 mavv 120,180,124
 pk 223,226
 mavv 120,176,116
 s_waitcnt lgkmcnt(4)
 buffer_store_dwordx4 v[220:223], v2, s[20:23], s86 offen offset:3072 sc1
 mavv 124,184,116
 rtv 200,211,16904
 mavv 124,188,124
 rtv 202,211,17160
 mavv 92,188,92
 rtv 204,211,17416
 mavv 92,184,84
 rtv 206,211,17672
 mavv 60,184,52
 s_waitcnt vmcnt(5)
 buffer_store_dword v9, v6, s[32:35], 0 offen offset:0 sc1
 mavv 60,188,60
 mavv 28,188,28
 mavv 28,184,20
 s_waitcnt lgkmcnt(4)
 mavv 24,192,36
 rtv 176,211,33792
 mavv 24,196,44
 rtv 178,211,34048
 mavv 56,196,76
 rtv 180,211,34304
 mavv 56,192,68
 rtv 182,211,34560
 mavv 88,192,100
 mavv 88,196,108
 mavv 120,196,140
 mavv 120,192,132
 s_waitcnt lgkmcnt(4)
 mavv 124,200,132
 rtv 184,211,33800
 mavv 124,204,140
 rtv 186,211,34056
 mavv 92,204,108
 rtv 188,211,34312
 mavv 92,200,100
 rtv 190,211,34568
 mavv 60,200,68
 mavv 60,204,76
 mavv 28,204,44
 mavv 28,200,36
 s_waitcnt lgkmcnt(4)
 mava 24,176,160
 rtv 192,211,50688
 mavv 24,180,248
 rtv 194,211,50944
 mavv 56,180,252
 rtv 196,211,51200
 mava 56,176,164
 rtv 198,211,51456
 mavv 88,176,240
 mavv 88,180,228
 mavv 120,180,232
 mavv 120,176,244
 s_waitcnt lgkmcnt(4)
 mavv 124,184,244
 rtv 200,211,50696
 mavv 124,188,232
 rtv 202,211,50952
 mavv 92,188,228
 rtv 204,211,51208
 mavv 92,184,240
 rtv 206,211,51464
 mava 60,184,164
 mavv 60,188,252
 mavv 28,188,248
 mava 28,184,160
 s_waitcnt lgkmcnt(4)
 mavv 24,192,236
 rtv 176,208,33792
 mava 24,196,240
 rtv 178,208,34048
 mava 56,196,244
 rtv 180,208,34304
 mava 56,192,228
 rtv 182,208,34560
 mava 88,192,232
 mava 88,196,248
 mava 120,196,252
 mava 120,192,236
 s_waitcnt lgkmcnt(4)
 mava 124,200,236
 rtv 184,208,33800
 mava 124,204,252
 rtv 186,208,34056
 mava 92,204,248
 rtv 188,208,34312
 mava 92,200,232
 rtv 190,208,34568
 mava 60,200,228
 mava 60,204,244
 mava 28,204,240
 mavv 28,200,236
 s_waitcnt lgkmcnt(4)
 mavv 0,176,16
 s_add_u32 s3, s8, 3
 s_and_b32 s3, s3, 3
 rtv 192,208,50688
 mavv 0,180,24
 s_mul_i32 s3, s3, 61440
 s_add_u32 s3, s3, 40960
 rtv 194,208,50944
 mavv 32,180,56
 rtv 196,208,51200
 v_accvgpr_read_b32 v212, a24
 mavv 32,176,48
 rtv 198,208,51456
 v_accvgpr_read_b32 v213, a25
 mavv 64,176,80
 v_accvgpr_read_b32 v214, a26
 v_accvgpr_read_b32 v215, a27
 mavv 64,180,88
 v_accvgpr_read_b32 v216, a28
 v_accvgpr_read_b32 v217, a29
 mavv 96,180,120
 v_accvgpr_read_b32 v218, a30
 v_accvgpr_read_b32 v219, a31
 mavv 96,176,112
 s_waitcnt lgkmcnt(4)
 pk 212,212
 pk 213,214
 mavv 100,184,112
 rtv 200,208,50696
 pk 214,216
 mavv 100,188,120
 rtv 202,208,50952
 pk 215,218
 mavv 68,188,88
 s_add_u32 s86, s3, 0
 rtv 204,208,51208
 mavv 68,184,80
 rtv 206,208,51464
 mavv 36,184,48
 buffer_store_dwordx4 v[212:215], v2, s[20:23], s86 offen offset:0 sc1
 v_accvgpr_read_b32 v220, a56
 mavv 36,188,56
 v_accvgpr_read_b32 v221, a57
 v_accvgpr_read_b32 v222, a58
 mavv 4,188,24
 v_add_u32 v208, 4294899712, v208
 v_accvgpr_read_b32 v223, a59
 mavv 4,184,16
 s_waitcnt lgkmcnt(4)
 v_accvgpr_read_b32 v224, a60
 v_accvgpr_read_b32 v225, a61
 mavv 0,192,32
 rtv 176,208,0
 v_accvgpr_read_b32 v226, a62
 mavv 0,196,40
 rtv 178,208,256
 v_accvgpr_read_b32 v227, a63
 mavv 32,196,72
 rtv 180,208,512
 pk 220,220
 mavv 32,192,64
 rtv 182,208,768
 pk 221,222
 mavv 64,192,96
 pk 222,224
 pk 223,226
 mavv 64,196,104
 buffer_store_dwordx4 v[220:223], v2, s[20:23], s86 offen offset:1024 sc1
 v_accvgpr_read_b32 v212, a88
 mavv 96,196,136
 v_accvgpr_read_b32 v213, a89
 v_accvgpr_read_b32 v214, a90
 mavv 96,192,128
 s_waitcnt lgkmcnt(4)
 v_accvgpr_read_b32 v215, a91
 v_accvgpr_read_b32 v216, a92
 mavv 100,200,128
 rtv 184,208,8
 v_accvgpr_read_b32 v217, a93
 mavv 100,204,136
 rtv 186,208,264
 v_accvgpr_read_b32 v218, a94
 mavv 68,204,104
 rtv 188,208,520
 v_accvgpr_read_b32 v219, a95
 mavv 68,200,96
 rtv 190,208,776
 pk 212,212
 mavv 36,200,64
 pk 213,214
 pk 214,216
 mavv 36,204,72
 pk 215,218
 mavv 4,204,40
 buffer_store_dwordx4 v[212:215], v2, s[20:23], s86 offen offset:2048 sc1
 v_accvgpr_read_b32 v220, a120
 mavv 4,200,32
 s_waitcnt lgkmcnt(4)
 v_accvgpr_read_b32 v221, a121
 v_accvgpr_read_b32 v222, a122
 mavv 0,176,20
 rtv 192,208,16896
 v_accvgpr_read_b32 v223, a123
 mavv 0,180,28
 rtv 194,208,17152
 v_accvgpr_read_b32 v224, a124
 mavv 32,180,60
 rtv 196,208,17408
 v_accvgpr_read_b32 v225, a125
 mavv 32,176,52
 rtv 198,208,17664
 v_accvgpr_read_b32 v226, a126
 mavv 64,176,84
 v_accvgpr_read_b32 v227, a127
 pk 220,220
 mavv 64,180,92
 pk 221,222
 pk 222,224
 mavv 96,180,124
 pk 223,226
 mavv 96,176,116
 s_waitcnt lgkmcnt(4)
 buffer_store_dwordx4 v[220:223], v2, s[20:23], s86 offen offset:3072 sc1
 mavv 100,184,116
 s_mov_b32 s91, 0x3f80
 rtv 200,208,16904
 mavv 100,188,124
 rtv 202,208,17160
 mavv 68,188,92
 rtv 204,208,17416
 v_mov_b32 v212, 0
 mavv 68,184,84
 rtv 206,208,17672
 v_mov_b32 v213, 0
 mavv 36,184,52
 s_waitcnt vmcnt(5)
 buffer_store_dword v9, v7, s[32:35], 0 offen offset:4 sc1
 v_mov_b32 v216, 0
 mavv 36,188,60
 v_mov_b32 v217, 0
 v_lshrrev_b32 v14, 6, v0
 mavv 4,188,28
 v_bfe_u32 v15, v0, 4, 2
 v_cmp_eq_u32 vcc, v14, v15
 mavv 4,184,20
 s_waitcnt lgkmcnt(4)
 v_and_b32 v14, 4, v0
 v_lshlrev_b32 v14, 2, v14
 mavv 0,192,36
 rtv 176,208,33792
 v_lshlrev_b32 v14, v14, s91
 mavv 0,196,44
 rtv 178,208,34048
 v_cndmask_b32 v14, 0, v14, vcc
 mavv 32,196,76
 rtv 180,208,34304
 v_and_b32 v15, 8, v0
 mavv 32,192,68
 rtv 182,208,34560
 v_cmp_eq_u32 vcc, 0, v15
 mavv 64,192,100
 s_nop 0
 v_cndmask_b32 v214, 0, v14, vcc
 v_cndmask_b32 v215, v14, 0, vcc
 mavv 64,196,108
 v_and_b32 v14, 60, v0
 v_lshlrev_b32 v14, 9, v14
 mavv 96,196,140
 v_lshrrev_b32 v15, 6, v0
 v_lshl_add_u32 v218, v15, 4, v14
 mavv 96,192,132
 s_waitcnt lgkmcnt(4)
 v_cmp_eq_u32 vcc, 1, v13
 s_nop 1
 s_and_b32 s37, vcc_lo, 7
 s_mul_i32 s4, s8, 61440
 mavv 100,200,132
 s_bitcmp1_b32 s37, 0
 s_cselect_b32 s22, 230400, 0
 rtv 184,208,33800
 mavv 100,204,140
 s_add_u32 s86, s4, 0
 rtv 186,208,34056
 mavv 68,204,108
 rtv 188,208,34312
 mavv 68,200,100
 rtv 190,208,34568
 mavv 36,200,68
 buffer_load_dwordx4 v[16:19], v2, s[20:23], s86 offen offset:0 sc1
 mavv 36,204,76
 mavv 4,204,44
 buffer_load_dwordx4 v[48:51], v2, s[20:23], s86 offen offset:1024 sc1
 mavv 4,200,36
 s_waitcnt lgkmcnt(4)
 mava 0,176,160
 rtv 192,208,50688
 mavv 0,180,248
 rtv 194,208,50944
 mavv 32,180,252
 rtv 196,208,51200
 mava 32,176,164
 rtv 198,208,51456
 mavv 64,176,240
 buffer_load_dwordx4 v[80:83], v2, s[20:23], s86 offen offset:2048 sc1
 mavv 64,180,228
 mavv 96,180,232
 buffer_load_dwordx4 v[112:115], v2, s[20:23], s86 offen offset:3072 sc1
 mavv 96,176,244
 s_waitcnt lgkmcnt(4)
 mavv 100,184,244
 s_bitcmp1_b32 s37, 1
 s_cselect_b32 s22, 230400, 0
 rtv 200,208,50696
 mavv 100,188,232
 s_add_u32 s86, s4, 20480
 rtv 202,208,50952
 mavv 68,188,228
 rtv 204,208,51208
 mavv 68,184,240
 rtv 206,208,51464
 mava 36,184,164
 buffer_load_dwordx4 v[24:27], v2, s[20:23], s86 offen offset:0 sc1
 mavv 36,188,252
 mavv 4,188,248
 buffer_load_dwordx4 v[56:59], v2, s[20:23], s86 offen offset:1024 sc1
 mava 4,184,160
 s_waitcnt lgkmcnt(4)
 mavv 0,192,236
 buffer_load_dwordx4 v[88:91], v2, s[20:23], s86 offen offset:2048 sc1
 mava 0,196,240
 mava 32,196,244
 buffer_load_dwordx4 v[120:123], v2, s[20:23], s86 offen offset:3072 sc1
 mava 32,192,228
 mava 64,192,232
 s_bitcmp1_b32 s37, 2
 s_cselect_b32 s22, 230400, 0
 mava 64,196,248
 s_add_u32 s86, s4, 40960
 buffer_load_dwordx4 v[32:35], v2, s[20:23], s86 offen offset:0 sc1
 mava 96,196,252
 mava 96,192,236
 s_waitcnt lgkmcnt(0)
 buffer_load_dwordx4 v[64:67], v2, s[20:23], s86 offen offset:1024 sc1
 mava 100,200,236
 mava 100,204,252
 buffer_load_dwordx4 v[96:99], v2, s[20:23], s86 offen offset:2048 sc1
 mava 68,204,248
 mava 68,200,232
 buffer_load_dwordx4 v[128:131], v2, s[20:23], s86 offen offset:3072 sc1
 mava 36,200,228
 mava 36,204,244
 mava 4,204,240
 mavv 4,200,236
 s_waitcnt vmcnt(13)
 buffer_store_dword v9, v8, s[32:35], 0 offen offset:8 sc1
 s_cmp_lg_u32 s37, 7
 s_cbranch_scc1 L14_16_more
 s_waitcnt vmcnt(1)
L14_16_fin:
 mavv 0,214,16
 mavv 0,214,24
 mavv 0,214,32
 mavv 4,212,16
 mavv 4,212,24
 mavv 4,212,32
 mavv 32,214,48
 mavv 32,214,56
 s_nop 2
 v_accvgpr_read_b32 v176, a0
 v_accvgpr_read_b32 v177, a1
 mavv 32,214,64
 v_accvgpr_read_b32 v178, a2
 v_accvgpr_read_b32 v179, a3
 mavv 36,212,48
 v_accvgpr_read_b32 v180, a4
 v_accvgpr_read_b32 v181, a5
 mavv 36,212,56
 v_accvgpr_read_b32 v182, a6
 v_accvgpr_read_b32 v183, a7
 mavv 36,212,64
 pk 176,176
 pk 177,178
 mavv 64,214,80
 pk 178,180
 pk 179,182
 mavv 64,214,88
 s_mov_b32 s86, 0
 buffer_store_dwordx4 v[176:179], v218, s[24:27], s86 offen nt
 v_accvgpr_read_b32 v184, a32
 mavv 64,214,96
 v_accvgpr_read_b32 v185, a33
 v_accvgpr_read_b32 v186, a34
 mavv 68,212,80
 v_accvgpr_read_b32 v187, a35
 v_accvgpr_read_b32 v188, a36
 mavv 68,212,88
 v_accvgpr_read_b32 v189, a37
 v_accvgpr_read_b32 v190, a38
 mavv 68,212,96
 v_accvgpr_read_b32 v191, a39
 pk 184,184
 mavv 96,214,112
 pk 185,186
 pk 186,188
 mavv 96,214,120
 pk 187,190
 v_accvgpr_read_b32 v192, a64
 mavv 96,214,128
 s_mov_b32 s86, 32768
 buffer_store_dwordx4 v[184:187], v218, s[24:27], s86 offen nt
 v_accvgpr_read_b32 v193, a65
 mavv 100,212,112
 v_accvgpr_read_b32 v194, a66
 v_accvgpr_read_b32 v195, a67
 mavv 100,212,120
 v_accvgpr_read_b32 v196, a68
 v_accvgpr_read_b32 v197, a69
 mavv 100,212,128
 v_accvgpr_read_b32 v198, a70
 v_accvgpr_read_b32 v199, a71
 pk 192,192
 pk 193,194
 pk 194,196
 pk 195,198
 s_mov_b32 s86, 65536
 buffer_store_dwordx4 v[192:195], v218, s[24:27], s86 offen nt
 v_accvgpr_read_b32 v200, a96
 v_accvgpr_read_b32 v201, a97
 v_accvgpr_read_b32 v202, a98
 v_accvgpr_read_b32 v203, a99
 v_accvgpr_read_b32 v204, a100
 v_accvgpr_read_b32 v205, a101
 v_accvgpr_read_b32 v206, a102
 v_accvgpr_read_b32 v207, a103
 pk 200,200
 pk 201,202
 pk 202,204
 pk 203,206
 s_mov_b32 s86, 98304
 buffer_store_dwordx4 v[200:203], v218, s[24:27], s86 offen nt
 s_endpgm
L14_16_skip:
 s_waitcnt vmcnt(0) lgkmcnt(0)
 s_nop 7
 s_branch L14_16_go
L14_16_wgroup1:
 s_xor_b32 s94, s8, 0
 s_lshl_b32 s94, s94, 9
 v_min_u32 v15, 12, v0
 v_lshl_add_u32 v15, v15, 5, s94
 s_mov_b32 s79, 0x40000
L14_16_sgroup1:
 s_sub_u32 s79, s79, 1
 s_cbranch_scc1 L14_16_sgroup1_end
 s_sleep 2
 buffer_load_dword v13, v15, s[44:47], 0 offen offset:4 sc1
 s_waitcnt vmcnt(0)
 v_cmp_ne_u32 vcc, 1, v13
 s_nop 1
 s_and_b64 vcc, vcc, 15
 s_cbranch_scc1 L14_16_sgroup1
L14_16_sgroup1_end:
 s_waitcnt vmcnt(0) lgkmcnt(0)
 s_nop 7
 s_branch L14_16_ggroup1
L14_16_wgroup:
 s_xor_b32 s94, s8, 0
 s_lshl_b32 s94, s94, 9
 v_min_u32 v15, 12, v0
 v_lshl_add_u32 v15, v15, 5, s94
 s_mov_b32 s79, 0x40000
L14_16_sgroup:
 s_sub_u32 s79, s79, 1
 s_cbranch_scc1 L14_16_sgroup_end
 s_sleep 2
 buffer_load_dword v13, v15, s[44:47], 0 offen offset:0 sc1
 s_waitcnt vmcnt(0)
 v_cmp_ne_u32 vcc, 1, v13
 s_nop 1
 s_and_b64 vcc, vcc, 15
 s_cbranch_scc1 L14_16_sgroup
L14_16_sgroup_end:
 s_waitcnt vmcnt(0) lgkmcnt(0)
 s_nop 7
 s_branch L14_16_ggroup
L14_16_more:
 s_mov_b32 s22, 230400
 s_mov_b32 s81, s37
 s_mov_b32 s79, 0x40000
L14_16_ask:
 s_mov_b32 s37, 7
 s_sub_u32 s79, s79, 1
 s_cbranch_scc1 L14_16_get
 s_sleep 1
 buffer_load_dword v13, v10, s[32:35], s94 offen sc1
 s_waitcnt vmcnt(0)
L14_16_look:
 v_cmp_eq_u32 vcc, 1, v13
 s_nop 1
 s_and_b32 s37, vcc_lo, 7
L14_16_get:
 s_andn2_b32 s37, s37, s81
 s_cbranch_scc0 L14_16_ask
 s_bitcmp0_b32 s37, 0
 s_cbranch_scc1 L14_16_l0
 s_add_u32 s86, s4, 0
 buffer_load_dwordx4 v[16:19], v2, s[20:23], s86 offen offset:0 sc1
 buffer_load_dwordx4 v[48:51], v2, s[20:23], s86 offen offset:1024 sc1
 buffer_load_dwordx4 v[80:83], v2, s[20:23], s86 offen offset:2048 sc1
 buffer_load_dwordx4 v[112:115], v2, s[20:23], s86 offen offset:3072 sc1
L14_16_l0:
 s_bitcmp0_b32 s37, 1
 s_cbranch_scc1 L14_16_l1
 s_add_u32 s86, s4, 20480
 buffer_load_dwordx4 v[24:27], v2, s[20:23], s86 offen offset:0 sc1
 buffer_load_dwordx4 v[56:59], v2, s[20:23], s86 offen offset:1024 sc1
 buffer_load_dwordx4 v[88:91], v2, s[20:23], s86 offen offset:2048 sc1
 buffer_load_dwordx4 v[120:123], v2, s[20:23], s86 offen offset:3072 sc1
L14_16_l1:
 s_bitcmp0_b32 s37, 2
 s_cbranch_scc1 L14_16_l2
 s_add_u32 s86, s4, 40960
 buffer_load_dwordx4 v[32:35], v2, s[20:23], s86 offen offset:0 sc1
 buffer_load_dwordx4 v[64:67], v2, s[20:23], s86 offen offset:1024 sc1
 buffer_load_dwordx4 v[96:99], v2, s[20:23], s86 offen offset:2048 sc1
 buffer_load_dwordx4 v[128:131], v2, s[20:23], s86 offen offset:3072 sc1
L14_16_l2:
 s_or_b32 s81, s81, s37
 s_cmp_lg_u32 s81, 7
 s_cbranch_scc1 L14_16_ask
 s_waitcnt vmcnt(0)
 s_branch L14_16_fin
L14_hk5:
 v_mov_b32 v14, s36
 s_mov_b64 exec, 1
 buffer_atomic_or v14, off, s[28:31], s85
 s_mov_b64 exec, -1
 s_nop 2
 s_branch L14_loop
L14_hk4:
 s_branch L14_loop
L14_hk3:
 s_waitcnt lgkmcnt(0)
 mvaac 176,80,0,208
 mvaa 176,84,4
 mvaa 176,88,8
 mvaa 176,92,12
 mvaac 180,108,12,208
 mvaa 180,104,8
 mvaa 180,100,4
 mvaa 180,96,0
 s_mov_b32 s86, 0
 buffer_store_dwordx4 v[240:243], v2, s[60:63], s86 offen offset:2048 sc1
 mvaac 184,112,0,208
 s_nop 0
 v_exp_f32 v176, v176
 mvaa 184,116,4
 v_exp_f32 v177, v177
 mvaa 184,120,8
 v_exp_f32 v178, v178
 mvaa 184,124,12
 v_exp_f32 v179, v179
 mvaac 188,140,12,208
 pk 176,176
 pk 177,178
 mvaa 188,136,8
 v_exp_f32 v180, v180
 mvaa 188,132,4
 v_exp_f32 v181, v181
 mvaa 188,128,0
 v_exp_f32 v182, v182
 mvav 112,144,192
 v_exp_f32 v183, v183
 mvav 112,148,200
 pk 178,180
 pk 179,182
 mvav 116,152,192
 v_exp_f32 v184, v184
 mvav 116,156,200
 v_exp_f32 v185, v185
 mvav 120,160,192
 rta 144,4,16896
 pk 184,184
 mvav 120,164,200
 rta 146,4,17152
 rta 148,4,17408
 mvav 124,168,192
 s_mov_b32 s86, 0
 buffer_store_dwordx4 v[244:247], v2, s[60:63], s86 offen offset:3072 sc1
 v_exp_f32 v186, v186
 mvav 124,172,200
 rta 150,4,17664
 rta 152,4,16928
 mvav 128,176,192
 v_exp_f32 v187, v187
 mvav 128,180,200
 rta 154,4,17184
 pk 185,186
 mvav 132,184,192
 v_exp_f32 v188, v188
 mvav 132,188,200
 rta 156,4,17440
 rta 158,4,17696
 mvav 136,192,192
 v_exp_f32 v189, v189
 mvav 136,196,200
 rta 160,4,16960
 rta 162,4,17216
 mvav 140,200,192
 rta 164,4,17472
 pk 186,188
 mvav 140,204,200
 rta 166,4,17728
 rta 168,4,16992
 maav 220,224,192
 v_exp_f32 v190, v190
 maav 220,224,200
 rta 170,4,17248
 rta 172,4,17504
 mvaac 192,80,16,212
 v_exp_f32 v191, v191
 mvaa 192,84,20
 rta 174,4,17760
 pk 187,190
 mvaa 192,88,24
 rta 176,4,17024
 rta 178,4,17280
 mvaa 192,92,28
 rta 180,4,17536
 rta 182,4,17792
 mvaac 196,108,28,212
 rta 184,4,17056
 rta 186,4,17312
 mvaa 196,104,24
 rta 188,4,17568
 rta 190,4,17824
 mvaa 196,100,20
 rta 192,4,17088
 rta 194,4,17344
 mvaa 196,96,16
 rta 196,4,17600
 rta 198,4,17856
 mvaac 200,112,16,212
 rta 200,4,17120
 rta 202,4,17376
 mvaa 200,116,20
 rta 204,4,17632
 rta 206,4,17888
 mvaa 200,120,24
 v_exp_f32 v192, v192
 mvaa 200,124,28
 s_mov_b32 s86, 4096
 buffer_store_dwordx4 v[248:251], v2, s[60:63], s86 offen offset:1024 sc1
 v_exp_f32 v193, v193
 mvaac 204,140,28,212
 v_exp_f32 v194, v194
 mvaa 204,136,24
 v_exp_f32 v195, v195
 mvaa 204,132,20
 pk 192,192
 pk 193,194
 mvaa 204,128,16
 s_waitcnt lgkmcnt(6)
 v_exp_f32 v196, v196
 mvav 16,144,176
 v_exp_f32 v197, v197
 mvav 16,148,184
 v_exp_f32 v198, v198
 mvav 20,152,176
 v_exp_f32 v199, v199
 mvav 20,156,184
 pk 194,196
 pk 195,198
 mvav 24,160,176
 v_exp_f32 v200, v200
 mvav 24,164,184
 v_exp_f32 v201, v201
 mvav 28,168,176
 v_exp_f32 v202, v202
 mvav 28,172,184
 v_exp_f32 v203, v203
 mvav 32,176,176
 pk 200,200
 pk 201,202
 mvav 32,180,184
 v_exp_f32 v204, v204
 mvav 36,184,176
 v_exp_f32 v205, v205
 mvav 36,188,184
 v_exp_f32 v206, v206
 mvav 40,192,176
 s_waitcnt lgkmcnt(0)
 v_exp_f32 v207, v207
 mvav 40,196,184
 pk 202,204
 pk 203,206
 mvav 44,200,176
 mvav 44,204,184
 maav 208,224,176
 maav 208,224,184
 s_mov_b32 s86, 4096
 buffer_store_dwordx4 v[252:255], v2, s[60:63], s86 offen offset:2048 sc1
 mvaac 176,80,32,216
 s_waitcnt vmcnt(20)
 s_barrier
 mvaa 176,84,36
 s_add_u32 m0, s77, 0
 mvaa 176,88,40
 buffer_load_dwordx4 v1, s[52:55], s76 offen offset:0 nt lds
 mvaa 176,92,44
 s_add_u32 m0, s77, 32
 mvaac 180,108,44,216
 buffer_load_dwordx4 v1, s[52:55], s76 offen offset:1024 nt lds
 mvaa 180,104,40
 s_add_u32 m0, s77, 64
 mvaa 180,100,36
 buffer_load_dwordx4 v1, s[52:55], s76 offen offset:2048 nt lds
 mvaa 180,96,32
 mvaac 184,112,32,216
 v_exp_f32 v176, v176
 mvaa 184,116,36
 s_add_u32 m0, s77, 96
 v_exp_f32 v177, v177
 mvaa 184,120,40
 buffer_load_dwordx4 v1, s[52:55], s76 offen offset:3072 nt lds
 pk 176,176
 mvaa 184,124,44
 v_exp_f32 v178, v178
 mvaac 188,140,44,216
 s_add_u32 m0, s77, 16896
 v_exp_f32 v179, v179
 mvaa 188,136,40
 buffer_load_dwordx4 v1, s[56:59], s76 offen offset:0 nt lds
 pk 177,178
 mvaa 188,132,36
 v_exp_f32 v180, v180
 mvaa 188,128,32
 s_add_u32 m0, s77, 16928
 v_exp_f32 v181, v181
 mvav 48,144,192
 buffer_load_dwordx4 v1, s[56:59], s76 offen offset:1024 nt lds
 pk 178,180
 mvav 48,148,200
 v_exp_f32 v182, v182
 mvav 52,152,192
 s_add_u32 m0, s77, 16960
 v_exp_f32 v183, v183
 mvav 52,156,200
 buffer_load_dwordx4 v1, s[56:59], s76 offen offset:2048 nt lds
 pk 179,182
 mvav 56,160,192
 v_exp_f32 v184, v184
 mvav 56,164,200
 s_add_u32 m0, s77, 16992
 v_exp_f32 v185, v185
 mvav 60,168,192
 buffer_load_dwordx4 v1, s[56:59], s76 offen offset:3072 nt lds
 pk 184,184
 mvav 60,172,200
 v_exp_f32 v186, v186
 mvav 64,176,192
 v_exp_f32 v187, v187
 mvav 64,180,200
 v_exp_f32 v188, v188
 mvav 68,184,192
 v_exp_f32 v189, v189
 mvav 68,188,200
 pk 185,186
 pk 186,188
 mvav 72,192,192
 v_exp_f32 v190, v190
 mvav 72,196,200
 v_exp_f32 v191, v191
 mvav 76,200,192
 pk 187,190
 mvav 76,204,200
 maav 212,224,192
 maav 212,224,200
 mvaac 192,80,48,220
 s_add_u32 s5, s5, s81
 mvaa 192,84,52
 ds_read_b128 a[80:83], v3 offset:33792
 mvaa 192,88,56
 ds_read_b128 a[84:87], v3 offset:33856
 mvaa 192,92,60
 ds_read_b128 a[88:91], v3 offset:33920
 mvaac 196,108,60,220
 ds_read_b128 a[92:95], v3 offset:33984
 mvaa 196,104,56
 s_xor_b32 s76, s5, s39
 ds_read_b128 a[108:111], v3 offset:34240
 mvaa 196,100,52
 ds_read_b128 a[104:107], v3 offset:34176
 mvaa 196,96,48
 ds_read_b128 a[100:103], v3 offset:34112
 mvaac 200,112,48,220
 v_exp_f32 v192, v192
 mvaa 200,116,52
 v_exp_f32 v193, v193
 mvaa 200,120,56
 ds_read_b128 a[96:99], v3 offset:34048
 pk 192,192
 mvaa 200,124,60
 v_exp_f32 v194, v194
 mvaac 204,140,60,220
 v_exp_f32 v195, v195
 mvaa 204,136,56
 ds_read_b128 a[112:115], v3 offset:34304
 pk 193,194
 mvaa 204,132,52
 v_exp_f32 v196, v196
 mvaa 204,128,48
 ds_read_b128 a[116:119], v3 offset:34368
 ds_read_b128 a[120:123], v3 offset:34432
 mvav 80,144,176
 v_exp_f32 v197, v197
 mvav 80,148,184
 ds_read_b128 a[124:127], v3 offset:34496
 pk 194,196
 mvav 84,152,176
 v_exp_f32 v198, v198
 mvav 84,156,184
 ds_read_b128 a[140:143], v3 offset:34752
 ds_read_b128 a[136:139], v3 offset:34688
 mvav 88,160,176
 v_exp_f32 v199, v199
 mvav 88,164,184
 ds_read_b128 a[132:135], v3 offset:34624
 pk 195,198
 mvav 92,168,176
 v_exp_f32 v200, v200
 mvav 92,172,184
 v_exp_f32 v201, v201
 mvav 96,176,176
 ds_read_b128 a[128:131], v3 offset:34560
 pk 200,200
 mvav 96,180,184
 v_exp_f32 v202, v202
 mvav 100,184,176
 v_exp_f32 v203, v203
 mvav 100,188,184
 v_exp_f32 v204, v204
 mvav 104,192,176
 v_exp_f32 v205, v205
 mvav 104,196,184
 pk 201,202
 pk 202,204
 mvav 108,200,176
 v_exp_f32 v206, v206
 mvav 108,204,184
 v_exp_f32 v207, v207
 maav 216,224,176
 pk 203,206
 maav 216,224,184
 s_waitcnt lgkmcnt(0)
 mvaac 176,80,0,208
 mvaa 176,84,4
 mvaa 176,88,8
 mvaa 176,92,12
 mvaac 180,108,12,208
 mvaa 180,104,8
 mvaa 180,100,4
 mvaa 180,96,0
 s_mov_b32 s86, 4096
 buffer_store_dwordx4 v[228:231], v2, s[60:63], s86 offen offset:3072 sc1
 mvaac 184,112,0,208
 s_nop 0
 v_exp_f32 v176, v176
 mvaa 184,116,4
 v_exp_f32 v177, v177
 mvaa 184,120,8
 v_exp_f32 v178, v178
 mvaa 184,124,12
 v_exp_f32 v179, v179
 mvaac 188,140,12,208
 pk 176,176
 pk 177,178
 mvaa 188,136,8
 v_exp_f32 v180, v180
 mvaa 188,132,4
 v_exp_f32 v181, v181
 mvaa 188,128,0
 v_exp_f32 v182, v182
 mvav 112,144,192
 v_exp_f32 v183, v183
 mvav 112,148,200
 pk 178,180
 pk 179,182
 mvav 116,152,192
 v_exp_f32 v184, v184
 mvav 116,156,200
 v_exp_f32 v185, v185
 mvav 120,160,192
 rta 144,4,50688
 pk 184,184
 mvav 120,164,200
 rta 146,4,50944
 rta 148,4,51200
 mvav 124,168,192
 s_mov_b32 s86, 8192
 buffer_store_dwordx4 v[232:235], v2, s[60:63], s86 offen offset:0 sc1
 v_exp_f32 v186, v186
 mvav 124,172,200
 rta 150,4,51456
 rta 152,4,50720
 mvav 128,176,192
 v_exp_f32 v187, v187
 mvav 128,180,200
 rta 154,4,50976
 pk 185,186
 mvav 132,184,192
 v_exp_f32 v188, v188
 mvav 132,188,200
 rta 156,4,51232
 rta 158,4,51488
 mvav 136,192,192
 v_exp_f32 v189, v189
 mvav 136,196,200
 rta 160,4,50752
 rta 162,4,51008
 mvav 140,200,192
 rta 164,4,51264
 pk 186,188
 mvav 140,204,200
 rta 166,4,51520
 rta 168,4,50784
 maav 220,224,192
 v_exp_f32 v190, v190
 maav 220,224,200
 rta 170,4,51040
 rta 172,4,51296
 mvaac 192,80,16,212
 v_exp_f32 v191, v191
 mvaa 192,84,20
 rta 174,4,51552
 pk 187,190
 mvaa 192,88,24
 rta 176,4,50816
 rta 178,4,51072
 mvaa 192,92,28
 rta 180,4,51328
 rta 182,4,51584
 mvaac 196,108,28,212
 rta 184,4,50848
 rta 186,4,51104
 mvaa 196,104,24
 rta 188,4,51360
 rta 190,4,51616
 mvaa 196,100,20
 rta 192,4,50880
 rta 194,4,51136
 mvaa 196,96,16
 rta 196,4,51392
 rta 198,4,51648
 mvaac 200,112,16,212
 rta 200,4,50912
 rta 202,4,51168
 mvaa 200,116,20
 rta 204,4,51424
 rta 206,4,51680
 mvaa 200,120,24
 v_exp_f32 v192, v192
 mvaa 200,124,28
 s_mov_b32 s86, 8192
 buffer_store_dwordx4 v[236:239], v2, s[60:63], s86 offen offset:2048 sc1
 v_exp_f32 v193, v193
 mvaac 204,140,28,212
 v_exp_f32 v194, v194
 mvaa 204,136,24
 v_exp_f32 v195, v195
 mvaa 204,132,20
 pk 192,192
 pk 193,194
 mvaa 204,128,16
 s_waitcnt lgkmcnt(6)
 v_exp_f32 v196, v196
 mvav 16,144,176
 v_exp_f32 v197, v197
 mvav 16,148,184
 v_exp_f32 v198, v198
 mvav 20,152,176
 v_exp_f32 v199, v199
 mvav 20,156,184
 pk 194,196
 pk 195,198
 mvav 24,160,176
 v_exp_f32 v200, v200
 mvav 24,164,184
 v_exp_f32 v201, v201
 mvav 28,168,176
 v_exp_f32 v202, v202
 mvav 28,172,184
 v_exp_f32 v203, v203
 mvav 32,176,176
 pk 200,200
 pk 201,202
 mvav 32,180,184
 v_exp_f32 v204, v204
 mvav 36,184,176
 v_exp_f32 v205, v205
 mvav 36,188,184
 v_exp_f32 v206, v206
 mvav 40,192,176
 s_waitcnt lgkmcnt(0)
 v_exp_f32 v207, v207
 mvav 40,196,184
 pk 202,204
 pk 203,206
 mvav 44,200,176
 mvav 44,204,184
 maav 208,224,176
 maav 208,224,184
 s_mov_b32 s86, 8192
 buffer_store_dwordx4 a[228:231], v2, s[60:63], s86 offen offset:3072 sc1
 mvaac 176,80,32,216
 s_waitcnt vmcnt(24)
 s_barrier
 v_add_u32 v3, s78, v3
 mvaa 176,84,36
 s_add_u32 m0, s77, 33792
 v_add_u32 v4, s78, v4
 mvaa 176,88,40
 buffer_load_dwordx4 v1, s[52:55], s76 offen offset:0 nt lds
 mvaa 176,92,44
 s_add_u32 m0, s77, 33824
 mvaac 180,108,44,216
 buffer_load_dwordx4 v1, s[52:55], s76 offen offset:1024 nt lds
 mvaa 180,104,40
 s_add_u32 m0, s77, 33856
 mvaa 180,100,36
 buffer_load_dwordx4 v1, s[52:55], s76 offen offset:2048 nt lds
 mvaa 180,96,32
 mvaac 184,112,32,216
 v_exp_f32 v176, v176
 mvaa 184,116,36
 s_add_u32 m0, s77, 33888
 v_exp_f32 v177, v177
 mvaa 184,120,40
 buffer_load_dwordx4 v1, s[52:55], s76 offen offset:3072 nt lds
 pk 176,176
 mvaa 184,124,44
 v_exp_f32 v178, v178
 mvaac 188,140,44,216
 s_add_u32 m0, s77, 50688
 v_exp_f32 v179, v179
 mvaa 188,136,40
 buffer_load_dwordx4 v1, s[56:59], s76 offen offset:0 nt lds
 pk 177,178
 mvaa 188,132,36
 v_exp_f32 v180, v180
 mvaa 188,128,32
 s_add_u32 m0, s77, 50720
 v_exp_f32 v181, v181
 mvav 48,144,192
 buffer_load_dwordx4 v1, s[56:59], s76 offen offset:1024 nt lds
 pk 178,180
 mvav 48,148,200
 v_exp_f32 v182, v182
 mvav 52,152,192
 s_add_u32 m0, s77, 50752
 v_exp_f32 v183, v183
 mvav 52,156,200
 buffer_load_dwordx4 v1, s[56:59], s76 offen offset:2048 nt lds
 pk 179,182
 mvav 56,160,192
 v_exp_f32 v184, v184
 mvav 56,164,200
 s_add_u32 m0, s77, 50784
 v_exp_f32 v185, v185
 mvav 60,168,192
 buffer_load_dwordx4 v1, s[56:59], s76 offen offset:3072 nt lds
 pk 184,184
 mvav 60,172,200
 v_exp_f32 v186, v186
 mvav 64,176,192
 v_exp_f32 v187, v187
 mvav 64,180,200
 v_exp_f32 v188, v188
 mvav 68,184,192
 v_exp_f32 v189, v189
 mvav 68,188,200
 pk 185,186
 pk 186,188
 mvav 72,192,192
 v_exp_f32 v190, v190
 mvav 72,196,200
 v_exp_f32 v191, v191
 mvav 76,200,192
 pk 187,190
 mvav 76,204,200
 maav 212,224,192
 maav 212,224,200
 mvaac 192,80,48,220
 s_add_u32 s5, s5, s81
 mvaa 192,84,52
 s_add_u32 s77, s77, s78
 ds_read_b128 a[80:83], v3 offset:0
 mvaa 192,88,56
 s_sub_u32 s78, 0, s78
 ds_read_b128 a[84:87], v3 offset:64
 mvaa 192,92,60
 ds_read_b128 a[88:91], v3 offset:128
 mvaac 196,108,60,220
 ds_read_b128 a[92:95], v3 offset:192
 mvaa 196,104,56
 s_xor_b32 s76, s5, s39
 ds_read_b128 a[108:111], v3 offset:448
 mvaa 196,100,52
 ds_read_b128 a[104:107], v3 offset:384
 mvaa 196,96,48
 ds_read_b128 a[100:103], v3 offset:320
 mvaac 200,112,48,220
 v_exp_f32 v192, v192
 mvaa 200,116,52
 v_exp_f32 v193, v193
 mvaa 200,120,56
 ds_read_b128 a[96:99], v3 offset:256
 pk 192,192
 mvaa 200,124,60
 v_exp_f32 v194, v194
 mvaac 204,140,60,220
 v_exp_f32 v195, v195
 mvaa 204,136,56
 ds_read_b128 a[112:115], v3 offset:512
 pk 193,194
 mvaa 204,132,52
 v_exp_f32 v196, v196
 mvaa 204,128,48
 ds_read_b128 a[116:119], v3 offset:576
 ds_read_b128 a[120:123], v3 offset:640
 mvav 80,144,176
 v_exp_f32 v197, v197
 mvav 80,148,184
 ds_read_b128 a[124:127], v3 offset:704
 pk 194,196
 mvav 84,152,176
 v_exp_f32 v198, v198
 mvav 84,156,184
 ds_read_b128 a[140:143], v3 offset:960
 ds_read_b128 a[136:139], v3 offset:896
 mvav 88,160,176
 v_exp_f32 v199, v199
 mvav 88,164,184
 ds_read_b128 a[132:135], v3 offset:832
 pk 195,198
 mvav 92,168,176
 v_exp_f32 v200, v200
 mvav 92,172,184
 v_exp_f32 v201, v201
 mvav 96,176,176
 ds_read_b128 a[128:131], v3 offset:768
 pk 200,200
 mvav 96,180,184
 v_exp_f32 v202, v202
 mvav 100,184,176
 v_exp_f32 v203, v203
 mvav 100,188,184
 v_exp_f32 v204, v204
 mvav 104,192,176
 v_exp_f32 v205, v205
 mvav 104,196,184
 pk 201,202
 pk 202,204
 mvav 108,200,176
 v_exp_f32 v206, v206
 mvav 108,204,184
 v_exp_f32 v207, v207
 maav 216,224,176
 pk 203,206
 maav 216,224,184
L14_hk2:
 v_lshlrev_b32 v14, 5, v0
 s_mov_b32 s3, 0
 s_mov_b32 exec_hi, 0
 buffer_load_dword v13, v14, s[60:63], s3 offen sc1
 s_mov_b32 exec_hi, -1
 s_nop 2
 s_mov_b64 s[52:53], s[68:69]
 s_mov_b32 s54, s70
 s_add_u32 s56, s68, 65536
 s_addc_u32 s57, s69, 0
 s_sub_u32 s58, s70, 65536
 v_mov_b32 v1, v11
 s_xor_b32 s76, s9, 0
 s_mul_i32 s76, s76, 131072
 s_xor_b32 s81, s9, 1
 s_mul_i32 s81, s81, 131072
 s_sub_u32 s81, s81, s76
 s_mov_b32 s5, s76
 s_mov_b32 s39, 0
 s_waitcnt lgkmcnt(0)
 mvaac 176,80,0,208
 mvaa 176,84,4
 mvaa 176,88,8
 mvaa 176,92,12
 mvaac 180,108,12,208
 mvaa 180,104,8
 mvaa 180,100,4
 mvaa 180,96,0
 mvaac 184,112,0,208
 s_nop 2
 v_exp_f32 v176, v176
 mvaa 184,116,4
 v_exp_f32 v177, v177
 mvaa 184,120,8
 v_exp_f32 v178, v178
 mvaa 184,124,12
 v_exp_f32 v179, v179
 mvaac 188,140,12,208
 pk 176,176
 pk 177,178
 mvaa 188,136,8
 v_exp_f32 v180, v180
 mvaa 188,132,4
 v_exp_f32 v181, v181
 mvaa 188,128,0
 v_exp_f32 v182, v182
 mvav 112,144,192
 v_exp_f32 v183, v183
 mvav 112,148,200
 pk 178,180
 pk 179,182
 mvav 116,152,192
 v_exp_f32 v184, v184
 mvav 116,156,200
 v_exp_f32 v185, v185
 mvav 120,160,192
 rta 144,4,16896
 pk 184,184
 mvav 120,164,200
 rta 146,4,17152
 rta 148,4,17408
 mvav 124,168,192
 s_mov_b32 s86, 12288
 buffer_store_dwordx4 a[232:235], v2, s[60:63], s86 offen offset:0 sc1
 v_exp_f32 v186, v186
 mvav 124,172,200
 rta 150,4,17664
 rta 152,4,16928
 mvav 128,176,192
 v_exp_f32 v187, v187
 mvav 128,180,200
 rta 154,4,17184
 pk 185,186
 mvav 132,184,192
 v_exp_f32 v188, v188
 mvav 132,188,200
 rta 156,4,17440
 rta 158,4,17696
 mvav 136,192,192
 v_exp_f32 v189, v189
 mvav 136,196,200
 rta 160,4,16960
 rta 162,4,17216
 mvav 140,200,192
 rta 164,4,17472
 pk 186,188
 mvav 140,204,200
 rta 166,4,17728
 rta 168,4,16992
 maav 220,224,192
 v_exp_f32 v190, v190
 maav 220,224,200
 rta 170,4,17248
 rta 172,4,17504
 mvaac 192,80,16,212
 v_exp_f32 v191, v191
 mvaa 192,84,20
 rta 174,4,17760
 pk 187,190
 mvaa 192,88,24
 rta 176,4,17024
 rta 178,4,17280
 mvaa 192,92,28
 rta 180,4,17536
 rta 182,4,17792
 mvaac 196,108,28,212
 rta 184,4,17056
 rta 186,4,17312
 mvaa 196,104,24
 rta 188,4,17568
 rta 190,4,17824
 mvaa 196,100,20
 rta 192,4,17088
 rta 194,4,17344
 mvaa 196,96,16
 rta 196,4,17600
 rta 198,4,17856
 mvaac 200,112,16,212
 rta 200,4,17120
 rta 202,4,17376
 mvaa 200,116,20
 rta 204,4,17632
 rta 206,4,17888
 mvaa 200,120,24
 v_exp_f32 v192, v192
 mvaa 200,124,28
 s_mov_b32 s86, 12288
 buffer_store_dwordx4 a[236:239], v2, s[60:63], s86 offen offset:1024 sc1
 v_exp_f32 v193, v193
 mvaac 204,140,28,212
 v_exp_f32 v194, v194
 mvaa 204,136,24
 v_exp_f32 v195, v195
 mvaa 204,132,20
 pk 192,192
 pk 193,194
 mvaa 204,128,16
 s_waitcnt lgkmcnt(6)
 v_exp_f32 v196, v196
 mvav 16,144,176
 v_exp_f32 v197, v197
 mvav 16,148,184
 v_exp_f32 v198, v198
 mvav 20,152,176
 v_exp_f32 v199, v199
 mvav 20,156,184
 pk 194,196
 pk 195,198
 mvav 24,160,176
 v_exp_f32 v200, v200
 mvav 24,164,184
 v_exp_f32 v201, v201
 mvav 28,168,176
 v_exp_f32 v202, v202
 mvav 28,172,184
 v_exp_f32 v203, v203
 mvav 32,176,176
 pk 200,200
 pk 201,202
 mvav 32,180,184
 v_exp_f32 v204, v204
 mvav 36,184,176
 v_exp_f32 v205, v205
 mvav 36,188,184
 v_exp_f32 v206, v206
 mvav 40,192,176
 s_waitcnt lgkmcnt(0)
 v_exp_f32 v207, v207
 mvav 40,196,184
 pk 202,204
 pk 203,206
 mvav 44,200,176
 mvav 44,204,184
 maav 208,224,176
 maav 208,224,184
 s_mov_b32 s86, 12288
 buffer_store_dwordx4 a[240:243], v2, s[60:63], s86 offen offset:3072 sc1
 mvaac 176,80,32,216
 s_waitcnt vmcnt(28)
 s_barrier
 mvaa 176,84,36
 s_add_u32 m0, s77, 0
 mvaa 176,88,40
 buffer_load_dwordx4 v1, s[52:55], s76 offen offset:0 lds
 mvaa 176,92,44
 s_add_u32 m0, s77, 32
 mvaac 180,108,44,216
 buffer_load_dwordx4 v1, s[52:55], s76 offen offset:1024 lds
 mvaa 180,104,40
 s_add_u32 m0, s77, 64
 mvaa 180,100,36
 buffer_load_dwordx4 v1, s[52:55], s76 offen offset:2048 lds
 mvaa 180,96,32
 mvaac 184,112,32,216
 v_exp_f32 v176, v176
 mvaa 184,116,36
 s_add_u32 m0, s77, 96
 v_exp_f32 v177, v177
 mvaa 184,120,40
 buffer_load_dwordx4 v1, s[52:55], s76 offen offset:3072 lds
 pk 176,176
 mvaa 184,124,44
 v_exp_f32 v178, v178
 mvaac 188,140,44,216
 s_add_u32 m0, s77, 16896
 v_exp_f32 v179, v179
 mvaa 188,136,40
 buffer_load_dwordx4 v1, s[56:59], s76 offen offset:0 lds
 pk 177,178
 mvaa 188,132,36
 v_exp_f32 v180, v180
 mvaa 188,128,32
 s_add_u32 m0, s77, 16928
 v_exp_f32 v181, v181
 mvav 48,144,192
 buffer_load_dwordx4 v1, s[56:59], s76 offen offset:1024 lds
 pk 178,180
 mvav 48,148,200
 v_exp_f32 v182, v182
 mvav 52,152,192
 s_add_u32 m0, s77, 16960
 v_exp_f32 v183, v183
 mvav 52,156,200
 buffer_load_dwordx4 v1, s[56:59], s76 offen offset:2048 lds
 pk 179,182
 mvav 56,160,192
 v_exp_f32 v184, v184
 mvav 56,164,200
 s_add_u32 m0, s77, 16992
 v_exp_f32 v185, v185
 mvav 60,168,192
 buffer_load_dwordx4 v1, s[56:59], s76 offen offset:3072 lds
 pk 184,184
 mvav 60,172,200
 v_exp_f32 v186, v186
 mvav 64,176,192
 v_exp_f32 v187, v187
 mvav 64,180,200
 v_exp_f32 v188, v188
 mvav 68,184,192
 v_exp_f32 v189, v189
 mvav 68,188,200
 pk 185,186
 pk 186,188
 mvav 72,192,192
 v_exp_f32 v190, v190
 mvav 72,196,200
 v_exp_f32 v191, v191
 mvav 76,200,192
 pk 187,190
 mvav 76,204,200
 maav 212,224,192
 maav 212,224,200
 mvaac 192,80,48,220
 s_add_u32 s5, s5, s81
 mvaa 192,84,52
 ds_read_b128 a[80:83], v3 offset:33792
 mvaa 192,88,56
 ds_read_b128 a[84:87], v3 offset:33856
 mvaa 192,92,60
 ds_read_b128 a[88:91], v3 offset:33920
 mvaac 196,108,60,220
 ds_read_b128 a[92:95], v3 offset:33984
 mvaa 196,104,56
 s_xor_b32 s76, s5, s39
 ds_read_b128 a[108:111], v3 offset:34240
 mvaa 196,100,52
 ds_read_b128 a[104:107], v3 offset:34176
 mvaa 196,96,48
 ds_read_b128 a[100:103], v3 offset:34112
 mvaac 200,112,48,220
 v_exp_f32 v192, v192
 mvaa 200,116,52
 v_exp_f32 v193, v193
 mvaa 200,120,56
 ds_read_b128 a[96:99], v3 offset:34048
 pk 192,192
 mvaa 200,124,60
 v_exp_f32 v194, v194
 mvaac 204,140,60,220
 v_exp_f32 v195, v195
 mvaa 204,136,56
 ds_read_b128 a[112:115], v3 offset:34304
 pk 193,194
 mvaa 204,132,52
 v_exp_f32 v196, v196
 mvaa 204,128,48
 ds_read_b128 a[116:119], v3 offset:34368
 ds_read_b128 a[120:123], v3 offset:34432
 mvav 80,144,176
 v_exp_f32 v197, v197
 mvav 80,148,184
 ds_read_b128 a[124:127], v3 offset:34496
 pk 194,196
 mvav 84,152,176
 v_exp_f32 v198, v198
 mvav 84,156,184
 ds_read_b128 a[140:143], v3 offset:34752
 ds_read_b128 a[136:139], v3 offset:34688
 mvav 88,160,176
 v_exp_f32 v199, v199
 mvav 88,164,184
 ds_read_b128 a[132:135], v3 offset:34624
 pk 195,198
 mvav 92,168,176
 v_exp_f32 v200, v200
 mvav 92,172,184
 v_exp_f32 v201, v201
 mvav 96,176,176
 ds_read_b128 a[128:131], v3 offset:34560
 pk 200,200
 mvav 96,180,184
 v_exp_f32 v202, v202
 mvav 100,184,176
 v_exp_f32 v203, v203
 mvav 100,188,184
 v_exp_f32 v204, v204
 mvav 104,192,176
 v_exp_f32 v205, v205
 mvav 104,196,184
 pk 201,202
 pk 202,204
 mvav 108,200,176
 v_exp_f32 v206, v206
 mvav 108,204,184
 v_exp_f32 v207, v207
 maav 216,224,176
 pk 203,206
 maav 216,224,184
 s_waitcnt lgkmcnt(0)
 mvaac 176,80,0,208
 mvaa 176,84,4
 mvaa 176,88,8
 mvaa 176,92,12
 mvaac 180,108,12,208
 mvaa 180,104,8
 mvaa 180,100,4
 mvaa 180,96,0
 mvaac 184,112,0,208
 s_nop 2
 v_exp_f32 v176, v176
 mvaa 184,116,4
 v_exp_f32 v177, v177
 mvaa 184,120,8
 v_exp_f32 v178, v178
 mvaa 184,124,12
 v_exp_f32 v179, v179
 mvaac 188,140,12,208
 pk 176,176
 pk 177,178
 mvaa 188,136,8
 v_exp_f32 v180, v180
 mvaa 188,132,4
 v_exp_f32 v181, v181
 mvaa 188,128,0
 v_exp_f32 v182, v182
 mvav 112,144,192
 v_exp_f32 v183, v183
 mvav 112,148,200
 pk 178,180
 pk 179,182
 mvav 116,152,192
 v_exp_f32 v184, v184
 mvav 116,156,200
 v_exp_f32 v185, v185
 mvav 120,160,192
 rta 144,4,50688
 pk 184,184
 mvav 120,164,200
 rta 146,4,50944
 rta 148,4,51200
 mvav 124,168,192
 s_mov_b32 s86, 16384
 buffer_store_dwordx4 a[244:247], v2, s[60:63], s86 offen offset:0 sc1
 v_exp_f32 v186, v186
 mvav 124,172,200
 rta 150,4,51456
 rta 152,4,50720
 mvav 128,176,192
 v_exp_f32 v187, v187
 mvav 128,180,200
 rta 154,4,50976
 pk 185,186
 mvav 132,184,192
 v_exp_f32 v188, v188
 mvav 132,188,200
 rta 156,4,51232
 rta 158,4,51488
 mvav 136,192,192
 v_exp_f32 v189, v189
 mvav 136,196,200
 rta 160,4,50752
 rta 162,4,51008
 mvav 140,200,192
 rta 164,4,51264
 pk 186,188
 mvav 140,204,200
 rta 166,4,51520
 rta 168,4,50784
 maav 220,224,192
 v_exp_f32 v190, v190
 maav 220,224,200
 rta 170,4,51040
 rta 172,4,51296
 mvaac 192,80,16,212
 v_exp_f32 v191, v191
 mvaa 192,84,20
 rta 174,4,51552
 pk 187,190
 mvaa 192,88,24
 rta 176,4,50816
 rta 178,4,51072
 mvaa 192,92,28
 rta 180,4,51328
 rta 182,4,51584
 mvaac 196,108,28,212
 rta 184,4,50848
 rta 186,4,51104
 mvaa 196,104,24
 rta 188,4,51360
 rta 190,4,51616
 mvaa 196,100,20
 rta 192,4,50880
 rta 194,4,51136
 mvaa 196,96,16
 rta 196,4,51392
 rta 198,4,51648
 mvaac 200,112,16,212
 rta 200,4,50912
 rta 202,4,51168
 mvaa 200,116,20
 rta 204,4,51424
 rta 206,4,51680
 mvaa 200,120,24
 v_exp_f32 v192, v192
 mvaa 200,124,28
 s_mov_b32 s86, 16384
 buffer_store_dwordx4 a[248:251], v2, s[60:63], s86 offen offset:1024 sc1
 v_exp_f32 v193, v193
 mvaac 204,140,28,212
 v_exp_f32 v194, v194
 mvaa 204,136,24
 v_exp_f32 v195, v195
 mvaa 204,132,20
 pk 192,192
 pk 193,194
 mvaa 204,128,16
 s_waitcnt lgkmcnt(6)
 v_exp_f32 v196, v196
 mvav 16,144,176
 v_exp_f32 v197, v197
 mvav 16,148,184
 v_exp_f32 v198, v198
 mvav 20,152,176
 v_exp_f32 v199, v199
 mvav 20,156,184
 pk 194,196
 pk 195,198
 mvav 24,160,176
 v_exp_f32 v200, v200
 mvav 24,164,184
 v_exp_f32 v201, v201
 mvav 28,168,176
 v_exp_f32 v202, v202
 mvav 28,172,184
 v_exp_f32 v203, v203
 mvav 32,176,176
 pk 200,200
 pk 201,202
 mvav 32,180,184
 v_exp_f32 v204, v204
 mvav 36,184,176
 v_exp_f32 v205, v205
 mvav 36,188,184
 v_exp_f32 v206, v206
 mvav 40,192,176
 s_waitcnt lgkmcnt(0)
 v_exp_f32 v207, v207
 mvav 40,196,184
 pk 202,204
 pk 203,206
 mvav 44,200,176
 mvav 44,204,184
 maav 208,224,176
 maav 208,224,184
 s_mov_b32 s86, 16384
 buffer_store_dwordx4 a[252:255], v2, s[60:63], s86 offen offset:2048 sc1
 mvaac 176,80,32,216
 s_waitcnt vmcnt(27)
 s_barrier
 v_add_u32 v3, s78, v3
 mvaa 176,84,36
 s_add_u32 m0, s77, 33792
 v_add_u32 v4, s78, v4
 mvaa 176,88,40
 buffer_load_dwordx4 v1, s[52:55], s76 offen offset:0 lds
 mvaa 176,92,44
 s_add_u32 m0, s77, 33824
 mvaac 180,108,44,216
 buffer_load_dwordx4 v1, s[52:55], s76 offen offset:1024 lds
 mvaa 180,104,40
 s_add_u32 m0, s77, 33856
 mvaa 180,100,36
 buffer_load_dwordx4 v1, s[52:55], s76 offen offset:2048 lds
 mvaa 180,96,32
 mvaac 184,112,32,216
 v_exp_f32 v176, v176
 mvaa 184,116,36
 s_add_u32 m0, s77, 33888
 v_exp_f32 v177, v177
 mvaa 184,120,40
 buffer_load_dwordx4 v1, s[52:55], s76 offen offset:3072 lds
 pk 176,176
 mvaa 184,124,44
 v_exp_f32 v178, v178
 mvaac 188,140,44,216
 s_add_u32 m0, s77, 50688
 v_exp_f32 v179, v179
 mvaa 188,136,40
 buffer_load_dwordx4 v1, s[56:59], s76 offen offset:0 lds
 pk 177,178
 mvaa 188,132,36
 v_exp_f32 v180, v180
 mvaa 188,128,32
 s_add_u32 m0, s77, 50720
 v_exp_f32 v181, v181
 mvav 48,144,192
 buffer_load_dwordx4 v1, s[56:59], s76 offen offset:1024 lds
 pk 178,180
 mvav 48,148,200
 v_exp_f32 v182, v182
 mvav 52,152,192
 s_add_u32 m0, s77, 50752
 v_exp_f32 v183, v183
 mvav 52,156,200
 buffer_load_dwordx4 v1, s[56:59], s76 offen offset:2048 lds
 pk 179,182
 mvav 56,160,192
 v_exp_f32 v184, v184
 mvav 56,164,200
 s_add_u32 m0, s77, 50784
 v_exp_f32 v185, v185
 mvav 60,168,192
 buffer_load_dwordx4 v1, s[56:59], s76 offen offset:3072 lds
 pk 184,184
 mvav 60,172,200
 v_exp_f32 v186, v186
 mvav 64,176,192
 v_exp_f32 v187, v187
 mvav 64,180,200
 v_exp_f32 v188, v188
 mvav 68,184,192
 v_exp_f32 v189, v189
 mvav 68,188,200
 pk 185,186
 pk 186,188
 mvav 72,192,192
 v_exp_f32 v190, v190
 mvav 72,196,200
 v_exp_f32 v191, v191
 mvav 76,200,192
 pk 187,190
 mvav 76,204,200
 maav 212,224,192
 maav 212,224,200
 mvaac 192,80,48,220
 s_add_u32 s5, s5, s81
 mvaa 192,84,52
 s_add_u32 s77, s77, s78
 ds_read_b128 a[80:83], v3 offset:0
 mvaa 192,88,56
 s_sub_u32 s78, 0, s78
 ds_read_b128 a[84:87], v3 offset:64
 mvaa 192,92,60
 ds_read_b128 a[88:91], v3 offset:128
 mvaac 196,108,60,220
 ds_read_b128 a[92:95], v3 offset:192
 mvaa 196,104,56
 s_xor_b32 s76, s5, s39
 ds_read_b128 a[108:111], v3 offset:448
 mvaa 196,100,52
 ds_read_b128 a[104:107], v3 offset:384
 mvaa 196,96,48
 ds_read_b128 a[100:103], v3 offset:320
 mvaac 200,112,48,220
 v_exp_f32 v192, v192
 mvaa 200,116,52
 v_exp_f32 v193, v193
 mvaa 200,120,56
 ds_read_b128 a[96:99], v3 offset:256
 pk 192,192
 mvaa 200,124,60
 v_exp_f32 v194, v194
 mvaac 204,140,60,220
 v_exp_f32 v195, v195
 mvaa 204,136,56
 ds_read_b128 a[112:115], v3 offset:512
 pk 193,194
 mvaa 204,132,52
 v_exp_f32 v196, v196
 mvaa 204,128,48
 ds_read_b128 a[116:119], v3 offset:576
 ds_read_b128 a[120:123], v3 offset:640
 mvav 80,144,176
 v_exp_f32 v197, v197
 mvav 80,148,184
 ds_read_b128 a[124:127], v3 offset:704
 pk 194,196
 mvav 84,152,176
 v_exp_f32 v198, v198
 mvav 84,156,184
 ds_read_b128 a[140:143], v3 offset:960
 ds_read_b128 a[136:139], v3 offset:896
 mvav 88,160,176
 v_exp_f32 v199, v199
 mvav 88,164,184
 ds_read_b128 a[132:135], v3 offset:832
 pk 195,198
 mvav 92,168,176
 v_exp_f32 v200, v200
 mvav 92,172,184
 v_exp_f32 v201, v201
 mvav 96,176,176
 ds_read_b128 a[128:131], v3 offset:768
 pk 200,200
 mvav 96,180,184
 v_exp_f32 v202, v202
 mvav 100,184,176
 v_exp_f32 v203, v203
 mvav 100,188,184
 v_exp_f32 v204, v204
 mvav 104,192,176
 v_exp_f32 v205, v205
 mvav 104,196,184
 pk 201,202
 pk 202,204
 mvav 108,200,176
 v_exp_f32 v206, v206
 mvav 108,204,184
 v_exp_f32 v207, v207
 maav 216,224,176
 pk 203,206
 maav 216,224,184
L14_hk1:
 v_mov_b32 v14, 163776
 ds_read_b64 v[6:7], v14
 v_lshlrev_b32 v14, 5, v0
 s_mov_b32 s3, 4096
 s_mov_b32 exec_hi, 0
 buffer_load_dword v13, v14, s[60:63], s3 offen sc1
 s_mov_b32 exec_hi, -1
 s_nop 2
 v_lshlrev_b32 v14, 5, v0
 s_and_b32 s3, s85, 12
 s_lshr_b32 s3, 0x7536, s3
 s_and_b32 s3, s3, 7
 s_xor_b32 s3, s3, s9
 s_lshl_b32 s3, s3, 17
 s_lshl_b32 s4, s42, 15
 s_add_u32 s3, s3, s4
 v_and_b32 v15, 128, v14
 v_lshrrev_b32 v14, 3, v0
 v_lshl_add_u32 v14, v14, 10, v15
 s_mov_b32 exec_hi, 0
 buffer_load_dword v13, v14, s[68:71], s3 offen
 s_mov_b32 exec_hi, -1
 s_nop 2
 s_xor_b32 s76, s9, 2
 s_mul_i32 s76, s76, 131072
 s_xor_b32 s81, s9, 4
 s_mul_i32 s81, s81, 131072
 s_sub_u32 s81, s81, s76
 s_mov_b32 s5, s76
 s_mov_b32 s39, 0
 buffer_load_dword v13, off, s[28:31], s85 sc1
 s_waitcnt lgkmcnt(0)
 v_or_b32 v6, v6, v7
 s_nop 0
 v_readfirstlane_b32 s98, v6
 mvaac 176,80,0,208
 mvaa 176,84,4
 mvaa 176,88,8
 mvaa 176,92,12
 mvaac 180,108,12,208
 mvaa 180,104,8
 mvaa 180,100,4
 mvaa 180,96,0
 mvaac 184,112,0,208
 s_nop 2
 v_exp_f32 v176, v176
 mvaa 184,116,4
 v_exp_f32 v177, v177
 mvaa 184,120,8
 v_exp_f32 v178, v178
 mvaa 184,124,12
 v_exp_f32 v179, v179
 mvaac 188,140,12,208
 pk 176,176
 pk 177,178
 mvaa 188,136,8
 v_exp_f32 v180, v180
 mvaa 188,132,4
 v_exp_f32 v181, v181
 mvaa 188,128,0
 v_exp_f32 v182, v182
 mvav 112,144,192
 v_exp_f32 v183, v183
 mvav 112,148,200
 pk 178,180
 pk 179,182
 mvav 116,152,192
 v_exp_f32 v184, v184
 mvav 116,156,200
 v_exp_f32 v185, v185
 mvav 120,160,192
 rta 144,4,16896
 pk 184,184
 mvav 120,164,200
 rta 146,4,17152
 rta 148,4,17408
 mvav 124,168,192
 v_exp_f32 v186, v186
 mvav 124,172,200
 rta 150,4,17664
 rta 152,4,16928
 mvav 128,176,192
 v_exp_f32 v187, v187
 mvav 128,180,200
 rta 154,4,17184
 pk 185,186
 mvav 132,184,192
 v_exp_f32 v188, v188
 mvav 132,188,200
 rta 156,4,17440
 rta 158,4,17696
 mvav 136,192,192
 v_exp_f32 v189, v189
 mvav 136,196,200
 rta 160,4,16960
 rta 162,4,17216
 mvav 140,200,192
 rta 164,4,17472
 pk 186,188
 mvav 140,204,200
 rta 166,4,17728
 rta 168,4,16992
 maav 220,224,192
 v_exp_f32 v190, v190
 maav 220,224,200
 rta 170,4,17248
 rta 172,4,17504
 mvaac 192,80,16,212
 v_exp_f32 v191, v191
 mvaa 192,84,20
 rta 174,4,17760
 pk 187,190
 mvaa 192,88,24
 rta 176,4,17024
 rta 178,4,17280
 mvaa 192,92,28
 rta 180,4,17536
 rta 182,4,17792
 mvaac 196,108,28,212
 rta 184,4,17056
 rta 186,4,17312
 mvaa 196,104,24
 rta 188,4,17568
 rta 190,4,17824
 mvaa 196,100,20
 rta 192,4,17088
 rta 194,4,17344
 mvaa 196,96,16
 rta 196,4,17600
 rta 198,4,17856
 mvaac 200,112,16,212
 rta 200,4,17120
 rta 202,4,17376
 mvaa 200,116,20
 rta 204,4,17632
 rta 206,4,17888
 mvaa 200,120,24
 v_exp_f32 v192, v192
 mvaa 200,124,28
 v_exp_f32 v193, v193
 mvaac 204,140,28,212
 v_exp_f32 v194, v194
 mvaa 204,136,24
 v_exp_f32 v195, v195
 mvaa 204,132,20
 pk 192,192
 pk 193,194
 mvaa 204,128,16
 s_waitcnt lgkmcnt(6)
 v_exp_f32 v196, v196
 mvav 16,144,176
 v_exp_f32 v197, v197
 mvav 16,148,184
 v_exp_f32 v198, v198
 mvav 20,152,176
 v_exp_f32 v199, v199
 mvav 20,156,184
 pk 194,196
 pk 195,198
 mvav 24,160,176
 v_exp_f32 v200, v200
 mvav 24,164,184
 v_exp_f32 v201, v201
 mvav 28,168,176
 v_exp_f32 v202, v202
 mvav 28,172,184
 v_exp_f32 v203, v203
 mvav 32,176,176
 pk 200,200
 pk 201,202
 mvav 32,180,184
 v_exp_f32 v204, v204
 mvav 36,184,176
 v_exp_f32 v205, v205
 mvav 36,188,184
 v_exp_f32 v206, v206
 mvav 40,192,176
 s_waitcnt lgkmcnt(0)
 v_exp_f32 v207, v207
 mvav 40,196,184
 pk 202,204
 pk 203,206
 mvav 44,200,176
 mvav 44,204,184
 maav 208,224,176
 maav 208,224,184
 mvaac 176,80,32,216
 s_waitcnt vmcnt(26)
 s_barrier
 mvaa 176,84,36
 s_add_u32 m0, s77, 0
 mvaa 176,88,40
 buffer_load_dwordx4 v1, s[52:55], s76 offen offset:0 lds
 mvaa 176,92,44
 s_add_u32 m0, s77, 32
 mvaac 180,108,44,216
 buffer_load_dwordx4 v1, s[52:55], s76 offen offset:1024 lds
 mvaa 180,104,40
 s_add_u32 m0, s77, 64
 mvaa 180,100,36
 buffer_load_dwordx4 v1, s[52:55], s76 offen offset:2048 lds
 mvaa 180,96,32
 mvaac 184,112,32,216
 v_exp_f32 v176, v176
 mvaa 184,116,36
 s_add_u32 m0, s77, 96
 v_exp_f32 v177, v177
 mvaa 184,120,40
 buffer_load_dwordx4 v1, s[52:55], s76 offen offset:3072 lds
 pk 176,176
 mvaa 184,124,44
 v_exp_f32 v178, v178
 mvaac 188,140,44,216
 s_add_u32 m0, s77, 16896
 v_exp_f32 v179, v179
 mvaa 188,136,40
 buffer_load_dwordx4 v1, s[56:59], s76 offen offset:0 lds
 pk 177,178
 mvaa 188,132,36
 v_exp_f32 v180, v180
 mvaa 188,128,32
 s_add_u32 m0, s77, 16928
 v_exp_f32 v181, v181
 mvav 48,144,192
 buffer_load_dwordx4 v1, s[56:59], s76 offen offset:1024 lds
 pk 178,180
 mvav 48,148,200
 v_exp_f32 v182, v182
 mvav 52,152,192
 s_add_u32 m0, s77, 16960
 v_exp_f32 v183, v183
 mvav 52,156,200
 buffer_load_dwordx4 v1, s[56:59], s76 offen offset:2048 lds
 pk 179,182
 mvav 56,160,192
 v_exp_f32 v184, v184
 mvav 56,164,200
 s_add_u32 m0, s77, 16992
 v_exp_f32 v185, v185
 mvav 60,168,192
 buffer_load_dwordx4 v1, s[56:59], s76 offen offset:3072 lds
 pk 184,184
 mvav 60,172,200
 v_exp_f32 v186, v186
 mvav 64,176,192
 v_exp_f32 v187, v187
 mvav 64,180,200
 v_exp_f32 v188, v188
 mvav 68,184,192
 v_exp_f32 v189, v189
 mvav 68,188,200
 pk 185,186
 pk 186,188
 mvav 72,192,192
 v_exp_f32 v190, v190
 mvav 72,196,200
 v_exp_f32 v191, v191
 mvav 76,200,192
 pk 187,190
 mvav 76,204,200
 maav 212,224,192
 maav 212,224,200
 mvaac 192,80,48,220
 s_add_u32 s5, s5, s81
 mvaa 192,84,52
 ds_read_b128 a[80:83], v3 offset:33792
 mvaa 192,88,56
 ds_read_b128 a[84:87], v3 offset:33856
 mvaa 192,92,60
 ds_read_b128 a[88:91], v3 offset:33920
 mvaac 196,108,60,220
 ds_read_b128 a[92:95], v3 offset:33984
 mvaa 196,104,56
 s_xor_b32 s76, s5, s39
 ds_read_b128 a[108:111], v3 offset:34240
 mvaa 196,100,52
 ds_read_b128 a[104:107], v3 offset:34176
 mvaa 196,96,48
 ds_read_b128 a[100:103], v3 offset:34112
 mvaac 200,112,48,220
 v_exp_f32 v192, v192
 mvaa 200,116,52
 v_exp_f32 v193, v193
 mvaa 200,120,56
 ds_read_b128 a[96:99], v3 offset:34048
 pk 192,192
 mvaa 200,124,60
 v_exp_f32 v194, v194
 mvaac 204,140,60,220
 v_exp_f32 v195, v195
 mvaa 204,136,56
 ds_read_b128 a[112:115], v3 offset:34304
 pk 193,194
 mvaa 204,132,52
 v_exp_f32 v196, v196
 mvaa 204,128,48
 ds_read_b128 a[116:119], v3 offset:34368
 ds_read_b128 a[120:123], v3 offset:34432
 mvav 80,144,176
 v_exp_f32 v197, v197
 mvav 80,148,184
 ds_read_b128 a[124:127], v3 offset:34496
 pk 194,196
 mvav 84,152,176
 v_exp_f32 v198, v198
 mvav 84,156,184
 ds_read_b128 a[140:143], v3 offset:34752
 ds_read_b128 a[136:139], v3 offset:34688
 mvav 88,160,176
 v_exp_f32 v199, v199
 mvav 88,164,184
 ds_read_b128 a[132:135], v3 offset:34624
 pk 195,198
 mvav 92,168,176
 v_exp_f32 v200, v200
 mvav 92,172,184
 v_exp_f32 v201, v201
 mvav 96,176,176
 ds_read_b128 a[128:131], v3 offset:34560
 pk 200,200
 mvav 96,180,184
 v_exp_f32 v202, v202
 mvav 100,184,176
 v_exp_f32 v203, v203
 mvav 100,188,184
 v_exp_f32 v204, v204
 mvav 104,192,176
 v_exp_f32 v205, v205
 mvav 104,196,184
 pk 201,202
 pk 202,204
 mvav 108,200,176
 v_exp_f32 v206, v206
 mvav 108,204,184
 v_exp_f32 v207, v207
 maav 216,224,176
 pk 203,206
 maav 216,224,184
 s_waitcnt lgkmcnt(0)
 mvaac 176,80,0,208
 mvaa 176,84,4
 mvaa 176,88,8
 mvaa 176,92,12
 mvaac 180,108,12,208
 mvaa 180,104,8
 mvaa 180,100,4
 mvaa 180,96,0
 mvaac 184,112,0,208
 s_nop 2
 v_exp_f32 v176, v176
 mvaa 184,116,4
 v_exp_f32 v177, v177
 mvaa 184,120,8
 v_exp_f32 v178, v178
 mvaa 184,124,12
 v_exp_f32 v179, v179
 mvaac 188,140,12,208
 pk 176,176
 pk 177,178
 mvaa 188,136,8
 v_exp_f32 v180, v180
 mvaa 188,132,4
 v_exp_f32 v181, v181
 mvaa 188,128,0
 v_exp_f32 v182, v182
 mvav 112,144,192
 v_exp_f32 v183, v183
 mvav 112,148,200
 pk 178,180
 pk 179,182
 mvav 116,152,192
 v_exp_f32 v184, v184
 mvav 116,156,200
 v_exp_f32 v185, v185
 mvav 120,160,192
 rta 144,4,50688
 pk 184,184
 mvav 120,164,200
 rta 146,4,50944
 rta 148,4,51200
 mvav 124,168,192
 v_exp_f32 v186, v186
 mvav 124,172,200
 rta 150,4,51456
 rta 152,4,50720
 mvav 128,176,192
 v_exp_f32 v187, v187
 mvav 128,180,200
 rta 154,4,50976
 pk 185,186
 mvav 132,184,192
 v_exp_f32 v188, v188
 mvav 132,188,200
 rta 156,4,51232
 rta 158,4,51488
 mvav 136,192,192
 v_exp_f32 v189, v189
 mvav 136,196,200
 rta 160,4,50752
 rta 162,4,51008
 mvav 140,200,192
 rta 164,4,51264
 pk 186,188
 mvav 140,204,200
 rta 166,4,51520
 rta 168,4,50784
 maav 220,224,192
 v_exp_f32 v190, v190
 maav 220,224,200
 rta 170,4,51040
 rta 172,4,51296
 mvaac 192,80,16,212
 v_exp_f32 v191, v191
 mvaa 192,84,20
 rta 174,4,51552
 pk 187,190
 mvaa 192,88,24
 rta 176,4,50816
 rta 178,4,51072
 mvaa 192,92,28
 rta 180,4,51328
 rta 182,4,51584
 mvaac 196,108,28,212
 rta 184,4,50848
 rta 186,4,51104
 mvaa 196,104,24
 rta 188,4,51360
 rta 190,4,51616
 mvaa 196,100,20
 rta 192,4,50880
 rta 194,4,51136
 mvaa 196,96,16
 rta 196,4,51392
 rta 198,4,51648
 mvaac 200,112,16,212
 rta 200,4,50912
 rta 202,4,51168
 mvaa 200,116,20
 rta 204,4,51424
 rta 206,4,51680
 mvaa 200,120,24
 v_exp_f32 v192, v192
 mvaa 200,124,28
 v_exp_f32 v193, v193
 mvaac 204,140,28,212
 v_exp_f32 v194, v194
 mvaa 204,136,24
 v_exp_f32 v195, v195
 mvaa 204,132,20
 pk 192,192
 pk 193,194
 mvaa 204,128,16
 s_waitcnt lgkmcnt(6)
 v_exp_f32 v196, v196
 mvav 16,144,176
 v_exp_f32 v197, v197
 mvav 16,148,184
 v_exp_f32 v198, v198
 mvav 20,152,176
 v_exp_f32 v199, v199
 mvav 20,156,184
 pk 194,196
 pk 195,198
 mvav 24,160,176
 v_exp_f32 v200, v200
 mvav 24,164,184
 v_exp_f32 v201, v201
 mvav 28,168,176
 v_exp_f32 v202, v202
 mvav 28,172,184
 v_exp_f32 v203, v203
 mvav 32,176,176
 pk 200,200
 pk 201,202
 mvav 32,180,184
 v_exp_f32 v204, v204
 mvav 36,184,176
 v_exp_f32 v205, v205
 mvav 36,188,184
 v_exp_f32 v206, v206
 mvav 40,192,176
 s_waitcnt lgkmcnt(0)
 v_exp_f32 v207, v207
 mvav 40,196,184
 pk 202,204
 pk 203,206
 mvav 44,200,176
 mvav 44,204,184
 maav 208,224,176
 maav 208,224,184
 mvaac 176,80,32,216
 s_waitcnt vmcnt(22)
 s_barrier
 v_add_u32 v3, s78, v3
 mvaa 176,84,36
 s_add_u32 m0, s77, 33792
 v_add_u32 v4, s78, v4
 mvaa 176,88,40
 buffer_load_dwordx4 v1, s[52:55], s76 offen offset:0 lds
 mvaa 176,92,44
 s_add_u32 m0, s77, 33824
 mvaac 180,108,44,216
 buffer_load_dwordx4 v1, s[52:55], s76 offen offset:1024 lds
 mvaa 180,104,40
 s_add_u32 m0, s77, 33856
 mvaa 180,100,36
 buffer_load_dwordx4 v1, s[52:55], s76 offen offset:2048 lds
 mvaa 180,96,32
 mvaac 184,112,32,216
 v_exp_f32 v176, v176
 mvaa 184,116,36
 s_add_u32 m0, s77, 33888
 v_exp_f32 v177, v177
 mvaa 184,120,40
 buffer_load_dwordx4 v1, s[52:55], s76 offen offset:3072 lds
 pk 176,176
 mvaa 184,124,44
 v_exp_f32 v178, v178
 mvaac 188,140,44,216
 s_add_u32 m0, s77, 50688
 v_exp_f32 v179, v179
 mvaa 188,136,40
 buffer_load_dwordx4 v1, s[56:59], s76 offen offset:0 lds
 pk 177,178
 mvaa 188,132,36
 v_exp_f32 v180, v180
 mvaa 188,128,32
 s_add_u32 m0, s77, 50720
 v_exp_f32 v181, v181
 mvav 48,144,192
 buffer_load_dwordx4 v1, s[56:59], s76 offen offset:1024 lds
 pk 178,180
 mvav 48,148,200
 v_exp_f32 v182, v182
 mvav 52,152,192
 s_add_u32 m0, s77, 50752
 v_exp_f32 v183, v183
 mvav 52,156,200
 buffer_load_dwordx4 v1, s[56:59], s76 offen offset:2048 lds
 pk 179,182
 mvav 56,160,192
 v_exp_f32 v184, v184
 mvav 56,164,200
 s_add_u32 m0, s77, 50784
 v_exp_f32 v185, v185
 mvav 60,168,192
 buffer_load_dwordx4 v1, s[56:59], s76 offen offset:3072 lds
 pk 184,184
 mvav 60,172,200
 v_exp_f32 v186, v186
 mvav 64,176,192
 v_exp_f32 v187, v187
 mvav 64,180,200
 v_exp_f32 v188, v188
 mvav 68,184,192
 v_exp_f32 v189, v189
 mvav 68,188,200
 pk 185,186
 pk 186,188
 mvav 72,192,192
 v_exp_f32 v190, v190
 mvav 72,196,200
 v_exp_f32 v191, v191
 mvav 76,200,192
 pk 187,190
 mvav 76,204,200
 maav 212,224,192
 maav 212,224,200
 mvaac 192,80,48,220
 s_add_u32 s5, s5, s81
 mvaa 192,84,52
 s_add_u32 s77, s77, s78
 ds_read_b128 a[80:83], v3 offset:0
 mvaa 192,88,56
 s_sub_u32 s78, 0, s78
 ds_read_b128 a[84:87], v3 offset:64
 mvaa 192,92,60
 ds_read_b128 a[88:91], v3 offset:128
 mvaac 196,108,60,220
 ds_read_b128 a[92:95], v3 offset:192
 mvaa 196,104,56
 s_xor_b32 s76, s5, s39
 ds_read_b128 a[108:111], v3 offset:448
 mvaa 196,100,52
 ds_read_b128 a[104:107], v3 offset:384
 mvaa 196,96,48
 ds_read_b128 a[100:103], v3 offset:320
 mvaac 200,112,48,220
 v_exp_f32 v192, v192
 mvaa 200,116,52
 v_exp_f32 v193, v193
 mvaa 200,120,56
 ds_read_b128 a[96:99], v3 offset:256
 pk 192,192
 mvaa 200,124,60
 v_exp_f32 v194, v194
 mvaac 204,140,60,220
 v_exp_f32 v195, v195
 mvaa 204,136,56
 ds_read_b128 a[112:115], v3 offset:512
 pk 193,194
 mvaa 204,132,52
 v_exp_f32 v196, v196
 mvaa 204,128,48
 ds_read_b128 a[116:119], v3 offset:576
 ds_read_b128 a[120:123], v3 offset:640
 mvav 80,144,176
 v_exp_f32 v197, v197
 mvav 80,148,184
 ds_read_b128 a[124:127], v3 offset:704
 pk 194,196
 mvav 84,152,176
 v_exp_f32 v198, v198
 mvav 84,156,184
 ds_read_b128 a[140:143], v3 offset:960
 ds_read_b128 a[136:139], v3 offset:896
 mvav 88,160,176
 v_exp_f32 v199, v199
 mvav 88,164,184
 ds_read_b128 a[132:135], v3 offset:832
 pk 195,198
 mvav 92,168,176
 v_exp_f32 v200, v200
 mvav 92,172,184
 v_exp_f32 v201, v201
 mvav 96,176,176
 ds_read_b128 a[128:131], v3 offset:768
 pk 200,200
 mvav 96,180,184
 v_exp_f32 v202, v202
 mvav 100,184,176
 v_exp_f32 v203, v203
 mvav 100,188,184
 v_exp_f32 v204, v204
 mvav 104,192,176
 v_exp_f32 v205, v205
 mvav 104,196,184
 pk 201,202
 pk 202,204
 mvav 108,200,176
 v_exp_f32 v206, v206
 mvav 108,204,184
 v_exp_f32 v207, v207
 maav 216,224,176
 pk 203,206
 maav 216,224,184
 s_branch L14_tail
L14_hot_end:
L14_careful:
 s_waitcnt lgkmcnt(0)
 v_pk_mul_f32 v[16:17], v[16:17], v[6:7] op_sel_hi:[1,0]
 v_pk_mul_f32 v[18:19], v[18:19], v[6:7] op_sel_hi:[1,0]
 v_pk_mul_f32 v[20:21], v[20:21], v[6:7] op_sel_hi:[1,0]
 v_pk_mul_f32 v[22:23], v[22:23], v[6:7] op_sel_hi:[1,0]
 pk 16,16
 pk 17,18
 pk 18,20
 pk 19,22
 s_add_u32 s86, s90, 0
 buffer_store_dwordx4 v[16:19], v2, s[60:63], s86 offen offset:0 sc1
 v_pk_mul_f32 v[24:25], v[24:25], v[6:7] op_sel_hi:[1,0]
 v_pk_mul_f32 v[26:27], v[26:27], v[6:7] op_sel_hi:[1,0]
 v_pk_mul_f32 v[28:29], v[28:29], v[6:7] op_sel_hi:[1,0]
 v_pk_mul_f32 v[30:31], v[30:31], v[6:7] op_sel_hi:[1,0]
 pk 24,24
 pk 25,26
 pk 26,28
 pk 27,30
 s_add_u32 s86, s90, 4096
 buffer_store_dwordx4 v[24:27], v2, s[60:63], s86 offen offset:1024 sc1
 v_pk_mul_f32 v[32:33], v[32:33], v[6:7] op_sel_hi:[1,0]
 v_pk_mul_f32 v[34:35], v[34:35], v[6:7] op_sel_hi:[1,0]
 v_pk_mul_f32 v[36:37], v[36:37], v[6:7] op_sel_hi:[1,0]
 v_pk_mul_f32 v[38:39], v[38:39], v[6:7] op_sel_hi:[1,0]
 pk 32,32
 pk 33,34
 pk 34,36
 pk 35,38
 s_add_u32 s86, s90, 8192
 buffer_store_dwordx4 v[32:35], v2, s[60:63], s86 offen offset:2048 sc1
 v_pk_mul_f32 v[40:41], v[40:41], v[6:7] op_sel_hi:[1,0]
 v_pk_mul_f32 v[42:43], v[42:43], v[6:7] op_sel_hi:[1,0]
 v_pk_mul_f32 v[44:45], v[44:45], v[6:7] op_sel_hi:[1,0]
 v_pk_mul_f32 v[46:47], v[46:47], v[6:7] op_sel_hi:[1,0]
 pk 40,40
 pk 41,42
 pk 42,44
 pk 43,46
 s_add_u32 s86, s90, 12288
 buffer_store_dwordx4 v[40:43], v2, s[60:63], s86 offen offset:3072 sc1
 v_pk_mul_f32 v[48:49], v[48:49], v[6:7] op_sel:[0,1]
 v_pk_mul_f32 v[50:51], v[50:51], v[6:7] op_sel:[0,1]
 v_pk_mul_f32 v[52:53], v[52:53], v[6:7] op_sel:[0,1]
 v_pk_mul_f32 v[54:55], v[54:55], v[6:7] op_sel:[0,1]
 pk 48,48
 pk 49,50
 pk 50,52
 pk 51,54
 s_add_u32 s86, s90, 0
 buffer_store_dwordx4 v[48:51], v2, s[60:63], s86 offen offset:1024 sc1
 v_pk_mul_f32 v[56:57], v[56:57], v[6:7] op_sel:[0,1]
 v_pk_mul_f32 v[58:59], v[58:59], v[6:7] op_sel:[0,1]
 v_pk_mul_f32 v[60:61], v[60:61], v[6:7] op_sel:[0,1]
 v_pk_mul_f32 v[62:63], v[62:63], v[6:7] op_sel:[0,1]
 pk 56,56
 pk 57,58
 pk 58,60
 pk 59,62
 s_add_u32 s86, s90, 4096
 buffer_store_dwordx4 v[56:59], v2, s[60:63], s86 offen offset:2048 sc1
 v_pk_mul_f32 v[64:65], v[64:65], v[6:7] op_sel:[0,1]
 v_pk_mul_f32 v[66:67], v[66:67], v[6:7] op_sel:[0,1]
 v_pk_mul_f32 v[68:69], v[68:69], v[6:7] op_sel:[0,1]
 v_pk_mul_f32 v[70:71], v[70:71], v[6:7] op_sel:[0,1]
 pk 64,64
 pk 65,66
 pk 66,68
 pk 67,70
 s_add_u32 s86, s90, 8192
 buffer_store_dwordx4 v[64:67], v2, s[60:63], s86 offen offset:3072 sc1
 v_pk_mul_f32 v[72:73], v[72:73], v[6:7] op_sel:[0,1]
 v_pk_mul_f32 v[74:75], v[74:75], v[6:7] op_sel:[0,1]
 v_pk_mul_f32 v[76:77], v[76:77], v[6:7] op_sel:[0,1]
 v_pk_mul_f32 v[78:79], v[78:79], v[6:7] op_sel:[0,1]
 pk 72,72
 pk 73,74
 pk 74,76
 pk 75,78
 s_add_u32 s86, s90, 16384
 buffer_store_dwordx4 v[72:75], v2, s[60:63], s86 offen offset:0 sc1
 v_pk_mul_f32 v[80:81], v[80:81], v[8:9] op_sel_hi:[1,0]
 v_pk_mul_f32 v[82:83], v[82:83], v[8:9] op_sel_hi:[1,0]
 v_pk_mul_f32 v[84:85], v[84:85], v[8:9] op_sel_hi:[1,0]
 v_pk_mul_f32 v[86:87], v[86:87], v[8:9] op_sel_hi:[1,0]
 pk 80,80
 pk 81,82
 pk 82,84
 pk 83,86
 s_add_u32 s86, s90, 0
 buffer_store_dwordx4 v[80:83], v2, s[60:63], s86 offen offset:2048 sc1
 v_pk_mul_f32 v[88:89], v[88:89], v[8:9] op_sel_hi:[1,0]
 v_pk_mul_f32 v[90:91], v[90:91], v[8:9] op_sel_hi:[1,0]
 v_pk_mul_f32 v[92:93], v[92:93], v[8:9] op_sel_hi:[1,0]
 v_pk_mul_f32 v[94:95], v[94:95], v[8:9] op_sel_hi:[1,0]
 pk 88,88
 pk 89,90
 pk 90,92
 pk 91,94
 s_add_u32 s86, s90, 4096
 buffer_store_dwordx4 v[88:91], v2, s[60:63], s86 offen offset:3072 sc1
 v_pk_mul_f32 v[96:97], v[96:97], v[8:9] op_sel_hi:[1,0]
 v_pk_mul_f32 v[98:99], v[98:99], v[8:9] op_sel_hi:[1,0]
 v_pk_mul_f32 v[100:101], v[100:101], v[8:9] op_sel_hi:[1,0]
 v_pk_mul_f32 v[102:103], v[102:103], v[8:9] op_sel_hi:[1,0]
 pk 96,96
 pk 97,98
 pk 98,100
 pk 99,102
 s_add_u32 s86, s90, 12288
 buffer_store_dwordx4 v[96:99], v2, s[60:63], s86 offen offset:0 sc1
 v_pk_mul_f32 v[104:105], v[104:105], v[8:9] op_sel_hi:[1,0]
 v_pk_mul_f32 v[106:107], v[106:107], v[8:9] op_sel_hi:[1,0]
 v_pk_mul_f32 v[108:109], v[108:109], v[8:9] op_sel_hi:[1,0]
 v_pk_mul_f32 v[110:111], v[110:111], v[8:9] op_sel_hi:[1,0]
 pk 104,104
 pk 105,106
 pk 106,108
 pk 107,110
 s_add_u32 s86, s90, 16384
 buffer_store_dwordx4 v[104:107], v2, s[60:63], s86 offen offset:1024 sc1
 v_pk_mul_f32 v[112:113], v[112:113], v[8:9] op_sel:[0,1]
 v_pk_mul_f32 v[114:115], v[114:115], v[8:9] op_sel:[0,1]
 v_pk_mul_f32 v[116:117], v[116:117], v[8:9] op_sel:[0,1]
 v_pk_mul_f32 v[118:119], v[118:119], v[8:9] op_sel:[0,1]
 pk 112,112
 pk 113,114
 pk 114,116
 pk 115,118
 s_add_u32 s86, s90, 0
 buffer_store_dwordx4 v[112:115], v2, s[60:63], s86 offen offset:3072 sc1
 v_pk_mul_f32 v[120:121], v[120:121], v[8:9] op_sel:[0,1]
 v_pk_mul_f32 v[122:123], v[122:123], v[8:9] op_sel:[0,1]
 v_pk_mul_f32 v[124:125], v[124:125], v[8:9] op_sel:[0,1]
 v_pk_mul_f32 v[126:127], v[126:127], v[8:9] op_sel:[0,1]
 pk 120,120
 pk 121,122
 pk 122,124
 pk 123,126
 s_add_u32 s86, s90, 8192
 buffer_store_dwordx4 v[120:123], v2, s[60:63], s86 offen offset:0 sc1
 v_pk_mul_f32 v[128:129], v[128:129], v[8:9] op_sel:[0,1]
 v_pk_mul_f32 v[130:131], v[130:131], v[8:9] op_sel:[0,1]
 v_pk_mul_f32 v[132:133], v[132:133], v[8:9] op_sel:[0,1]
 v_pk_mul_f32 v[134:135], v[134:135], v[8:9] op_sel:[0,1]
 pk 128,128
 pk 129,130
 pk 130,132
 pk 131,134
 s_add_u32 s86, s90, 12288
 buffer_store_dwordx4 v[128:131], v2, s[60:63], s86 offen offset:1024 sc1
 v_pk_mul_f32 v[136:137], v[136:137], v[8:9] op_sel:[0,1]
 v_pk_mul_f32 v[138:139], v[138:139], v[8:9] op_sel:[0,1]
 v_pk_mul_f32 v[140:141], v[140:141], v[8:9] op_sel:[0,1]
 v_pk_mul_f32 v[142:143], v[142:143], v[8:9] op_sel:[0,1]
 pk 136,136
 pk 137,138
 pk 138,140
 pk 139,142
 s_add_u32 s86, s90, 16384
 buffer_store_dwordx4 v[136:139], v2, s[60:63], s86 offen offset:2048 sc1
 s_waitcnt vmcnt(0) lgkmcnt(0)
 s_barrier
 s_branch L14_16_flags
L14_spin1:
 s_mov_b32 s79, 0x40000
L14_sp1:
 s_sub_u32 s79, s79, 1
 s_cbranch_scc1 L14_sp1_end
 s_sleep 4
 buffer_load_dword v13, off, s[28:31], s85 sc1
 s_waitcnt vmcnt(0)
 v_cmp_ne_u32 vcc, 65535, v13
 s_nop 1
 s_and_b64 vcc, vcc, 1
 s_cbranch_scc1 L14_sp1
L14_sp1_end:
 s_branch L14_s1
L14_slow:
 s_waitcnt vmcnt(0) lgkmcnt(0)
 s_nop 7
 s_mov_b64 s[52:53], s[72:73]
 s_mov_b32 s54, 524288
 s_mov_b64 s[56:57], s[74:75]
 s_mov_b32 s58, 524288
 v_mov_b32 v1, v12
 s_mov_b32 s43, 0
 v_mov_b32 v14, 0x3f803f80
 v_accvgpr_write_b32 a252, v14
 v_accvgpr_write_b32 a253, v14
 v_accvgpr_write_b32 a254, v14
 v_accvgpr_write_b32 a255, v14
L14_slow_head:
 s_lshr_b32 s3, s98, s43
 s_and_b32 s3, s3, 1
 s_cmp_eq_u32 s3, 0
 s_cbranch_scc1 L14_slow_next
 s_mul_i32 s90, s43, 20480
 s_add_u32 s86, s90, 0
 buffer_load_dwordx4 a[0:3], v2, s[64:67], s86 offen offset:0
 buffer_load_dwordx4 a[4:7], v2, s[64:67], s86 offen offset:1024
 buffer_load_dwordx4 a[8:11], v2, s[64:67], s86 offen offset:2048
 buffer_load_dwordx4 a[12:15], v2, s[64:67], s86 offen offset:3072
 s_add_u32 s86, s90, 4096
 buffer_load_dwordx4 a[16:19], v2, s[64:67], s86 offen offset:0
 buffer_load_dwordx4 a[20:23], v2, s[64:67], s86 offen offset:1024
 buffer_load_dwordx4 a[24:27], v2, s[64:67], s86 offen offset:2048
 buffer_load_dwordx4 a[28:31], v2, s[64:67], s86 offen offset:3072
 s_add_u32 s86, s90, 8192
 buffer_load_dwordx4 a[32:35], v2, s[64:67], s86 offen offset:0
 buffer_load_dwordx4 a[36:39], v2, s[64:67], s86 offen offset:1024
 buffer_load_dwordx4 a[40:43], v2, s[64:67], s86 offen offset:2048
 buffer_load_dwordx4 a[44:47], v2, s[64:67], s86 offen offset:3072
 s_add_u32 s86, s90, 12288
 buffer_load_dwordx4 a[48:51], v2, s[64:67], s86 offen offset:0
 buffer_load_dwordx4 a[52:55], v2, s[64:67], s86 offen offset:1024
 buffer_load_dwordx4 a[56:59], v2, s[64:67], s86 offen offset:2048
 buffer_load_dwordx4 a[60:63], v2, s[64:67], s86 offen offset:3072
 v_mov_b32 v208, 0xff800000
 v_mov_b32 v212, 0xff800000
 v_mov_b32 v216, 0xff800000
 v_mov_b32 v220, 0xff800000
 s_lshl_b32 s76, s43, 18
 s_mov_b32 s79, 16
 s_waitcnt vmcnt(0) lgkmcnt(0)
L14_slow_l1:
 s_barrier
 s_add_u32 m0, s92, 67584
 s_nop 0
 buffer_load_dwordx4 v1, s[52:55], s76 offen offset:0 lds
 s_add_u32 m0, s92, 67616
 s_nop 0
 buffer_load_dwordx4 v1, s[52:55], s76 offen offset:1024 lds
 s_add_u32 m0, s92, 67648
 s_nop 0
 buffer_load_dwordx4 v1, s[52:55], s76 offen offset:2048 lds
 s_add_u32 m0, s92, 67680
 s_nop 0
 buffer_load_dwordx4 v1, s[52:55], s76 offen offset:3072 lds
 s_waitcnt vmcnt(0) lgkmcnt(0)
 s_barrier
 ds_read_b128 a[80:83], v3 offset:0
 ds_read_b128 a[84:87], v3 offset:64
 ds_read_b128 a[88:91], v3 offset:128
 ds_read_b128 a[92:95], v3 offset:192
 ds_read_b128 a[96:99], v3 offset:256
 ds_read_b128 a[100:103], v3 offset:320
 ds_read_b128 a[104:107], v3 offset:384
 ds_read_b128 a[108:111], v3 offset:448
 ds_read_b128 a[112:115], v3 offset:512
 ds_read_b128 a[116:119], v3 offset:576
 ds_read_b128 a[120:123], v3 offset:640
 ds_read_b128 a[124:127], v3 offset:704
 ds_read_b128 a[128:131], v3 offset:768
 ds_read_b128 a[132:135], v3 offset:832
 ds_read_b128 a[136:139], v3 offset:896
 ds_read_b128 a[140:143], v3 offset:960
 s_waitcnt lgkmcnt(15)
 mvaaz 176,80,0
 s_waitcnt lgkmcnt(14)
 mvaa 176,84,4
 s_waitcnt lgkmcnt(13)
 mvaa 176,88,8
 s_waitcnt lgkmcnt(12)
 mvaa 176,92,12
 s_waitcnt lgkmcnt(11)
 mvaaz 180,96,0
 s_waitcnt lgkmcnt(10)
 mvaa 180,100,4
 s_waitcnt lgkmcnt(9)
 mvaa 180,104,8
 s_waitcnt lgkmcnt(8)
 mvaa 180,108,12
 s_waitcnt lgkmcnt(7)
 mvaaz 184,112,0
 s_waitcnt lgkmcnt(0)
 mvaa 184,116,4
 mvaa 184,120,8
 mvaa 184,124,12
 mvaaz 188,128,0
 mvaa 188,132,4
 mvaa 188,136,8
 mvaa 188,140,12
 v_max_f32 v208, v208, v176
 v_max_f32 v208, v208, v177
 v_max_f32 v208, v208, v178
 v_max_f32 v208, v208, v179
 v_max_f32 v208, v208, v180
 v_max_f32 v208, v208, v181
 v_max_f32 v208, v208, v182
 v_max_f32 v208, v208, v183
 v_max_f32 v208, v208, v184
 v_max_f32 v208, v208, v185
 v_max_f32 v208, v208, v186
 v_max_f32 v208, v208, v187
 v_max_f32 v208, v208, v188
 v_max_f32 v208, v208, v189
 v_max_f32 v208, v208, v190
 v_max_f32 v208, v208, v191
 mvaaz 176,80,16
 mvaa 176,84,20
 mvaa 176,88,24
 mvaa 176,92,28
 mvaaz 180,96,16
 mvaa 180,100,20
 mvaa 180,104,24
 mvaa 180,108,28
 mvaaz 184,112,16
 mvaa 184,116,20
 mvaa 184,120,24
 mvaa 184,124,28
 mvaaz 188,128,16
 mvaa 188,132,20
 mvaa 188,136,24
 mvaa 188,140,28
 v_max_f32 v212, v212, v176
 v_max_f32 v212, v212, v177
 v_max_f32 v212, v212, v178
 v_max_f32 v212, v212, v179
 v_max_f32 v212, v212, v180
 v_max_f32 v212, v212, v181
 v_max_f32 v212, v212, v182
 v_max_f32 v212, v212, v183
 v_max_f32 v212, v212, v184
 v_max_f32 v212, v212, v185
 v_max_f32 v212, v212, v186
 v_max_f32 v212, v212, v187
 v_max_f32 v212, v212, v188
 v_max_f32 v212, v212, v189
 v_max_f32 v212, v212, v190
 v_max_f32 v212, v212, v191
 mvaaz 176,80,32
 mvaa 176,84,36
 mvaa 176,88,40
 mvaa 176,92,44
 mvaaz 180,96,32
 mvaa 180,100,36
 mvaa 180,104,40
 mvaa 180,108,44
 mvaaz 184,112,32
 mvaa 184,116,36
 mvaa 184,120,40
 mvaa 184,124,44
 mvaaz 188,128,32
 mvaa 188,132,36
 mvaa 188,136,40
 mvaa 188,140,44
 v_max_f32 v216, v216, v176
 v_max_f32 v216, v216, v177
 v_max_f32 v216, v216, v178
 v_max_f32 v216, v216, v179
 v_max_f32 v216, v216, v180
 v_max_f32 v216, v216, v181
 v_max_f32 v216, v216, v182
 v_max_f32 v216, v216, v183
 v_max_f32 v216, v216, v184
 v_max_f32 v216, v216, v185
 v_max_f32 v216, v216, v186
 v_max_f32 v216, v216, v187
 v_max_f32 v216, v216, v188
 v_max_f32 v216, v216, v189
 v_max_f32 v216, v216, v190
 v_max_f32 v216, v216, v191
 mvaaz 176,80,48
 mvaa 176,84,52
 mvaa 176,88,56
 mvaa 176,92,60
 mvaaz 180,96,48
 mvaa 180,100,52
 mvaa 180,104,56
 mvaa 180,108,60
 mvaaz 184,112,48
 mvaa 184,116,52
 mvaa 184,120,56
 mvaa 184,124,60
 mvaaz 188,128,48
 mvaa 188,132,52
 mvaa 188,136,56
 mvaa 188,140,60
 v_max_f32 v220, v220, v176
 v_max_f32 v220, v220, v177
 v_max_f32 v220, v220, v178
 v_max_f32 v220, v220, v179
 v_max_f32 v220, v220, v180
 v_max_f32 v220, v220, v181
 v_max_f32 v220, v220, v182
 v_max_f32 v220, v220, v183
 v_max_f32 v220, v220, v184
 v_max_f32 v220, v220, v185
 v_max_f32 v220, v220, v186
 v_max_f32 v220, v220, v187
 v_max_f32 v220, v220, v188
 v_max_f32 v220, v220, v189
 v_max_f32 v220, v220, v190
 v_max_f32 v220, v220, v191
 s_waitcnt vmcnt(0) lgkmcnt(0)
 s_add_u32 s76, s76, 16384
 s_sub_u32 s79, s79, 1
 s_cmp_lg_u32 s79, 0
 s_cbranch_scc1 L14_slow_l1
 v_mov_b32 v209, v208
 v_mov_b32 v213, v212
 v_mov_b32 v217, v216
 v_mov_b32 v221, v220
 v_permlane32_swap_b32 v208, v209
 v_permlane32_swap_b32 v212, v213
 v_permlane32_swap_b32 v216, v217
 v_permlane32_swap_b32 v220, v221
 v_max_f32 v208, v208, v209
 v_max_f32 v212, v212, v213
 v_max_f32 v216, v216, v217
 v_max_f32 v220, v220, v221
 v_mov_b32 v209, v208
 v_mov_b32 v213, v212
 v_mov_b32 v217, v216
 v_mov_b32 v221, v220
 v_permlane16_swap_b32 v208, v209
 v_permlane16_swap_b32 v212, v213
 v_permlane16_swap_b32 v216, v217
 v_permlane16_swap_b32 v220, v221
 v_max_f32 v208, v208, v209
 v_max_f32 v212, v212, v213
 v_max_f32 v216, v216, v217
 v_max_f32 v220, v220, v221
 v_sub_f32 v211, 0, v208
 v_sub_f32 v210, 0, v208
 v_sub_f32 v209, 0, v208
 v_sub_f32 v208, 0, v208
 v_sub_f32 v215, 0, v212
 v_sub_f32 v214, 0, v212
 v_sub_f32 v213, 0, v212
 v_sub_f32 v212, 0, v212
 v_sub_f32 v219, 0, v216
 v_sub_f32 v218, 0, v216
 v_sub_f32 v217, 0, v216
 v_sub_f32 v216, 0, v216
 v_sub_f32 v223, 0, v220
 v_sub_f32 v222, 0, v220
 v_sub_f32 v221, 0, v220
 v_sub_f32 v220, 0, v220
 v_mov_b32 v16, 0
 v_mov_b32 v17, 0
 v_mov_b32 v18, 0
 v_mov_b32 v19, 0
 v_mov_b32 v20, 0
 v_mov_b32 v21, 0
 v_mov_b32 v22, 0
 v_mov_b32 v23, 0
 v_mov_b32 v24, 0
 v_mov_b32 v25, 0
 v_mov_b32 v26, 0
 v_mov_b32 v27, 0
 v_mov_b32 v28, 0
 v_mov_b32 v29, 0
 v_mov_b32 v30, 0
 v_mov_b32 v31, 0
 v_mov_b32 v32, 0
 v_mov_b32 v33, 0
 v_mov_b32 v34, 0
 v_mov_b32 v35, 0
 v_mov_b32 v36, 0
 v_mov_b32 v37, 0
 v_mov_b32 v38, 0
 v_mov_b32 v39, 0
 v_mov_b32 v40, 0
 v_mov_b32 v41, 0
 v_mov_b32 v42, 0
 v_mov_b32 v43, 0
 v_mov_b32 v44, 0
 v_mov_b32 v45, 0
 v_mov_b32 v46, 0
 v_mov_b32 v47, 0
 v_mov_b32 v48, 0
 v_mov_b32 v49, 0
 v_mov_b32 v50, 0
 v_mov_b32 v51, 0
 v_mov_b32 v52, 0
 v_mov_b32 v53, 0
 v_mov_b32 v54, 0
 v_mov_b32 v55, 0
 v_mov_b32 v56, 0
 v_mov_b32 v57, 0
 v_mov_b32 v58, 0
 v_mov_b32 v59, 0
 v_mov_b32 v60, 0
 v_mov_b32 v61, 0
 v_mov_b32 v62, 0
 v_mov_b32 v63, 0
 v_mov_b32 v64, 0
 v_mov_b32 v65, 0
 v_mov_b32 v66, 0
 v_mov_b32 v67, 0
 v_mov_b32 v68, 0
 v_mov_b32 v69, 0
 v_mov_b32 v70, 0
 v_mov_b32 v71, 0
 v_mov_b32 v72, 0
 v_mov_b32 v73, 0
 v_mov_b32 v74, 0
 v_mov_b32 v75, 0
 v_mov_b32 v76, 0
 v_mov_b32 v77, 0
 v_mov_b32 v78, 0
 v_mov_b32 v79, 0
 v_mov_b32 v80, 0
 v_mov_b32 v81, 0
 v_mov_b32 v82, 0
 v_mov_b32 v83, 0
 v_mov_b32 v84, 0
 v_mov_b32 v85, 0
 v_mov_b32 v86, 0
 v_mov_b32 v87, 0
 v_mov_b32 v88, 0
 v_mov_b32 v89, 0
 v_mov_b32 v90, 0
 v_mov_b32 v91, 0
 v_mov_b32 v92, 0
 v_mov_b32 v93, 0
 v_mov_b32 v94, 0
 v_mov_b32 v95, 0
 v_mov_b32 v96, 0
 v_mov_b32 v97, 0
 v_mov_b32 v98, 0
 v_mov_b32 v99, 0
 v_mov_b32 v100, 0
 v_mov_b32 v101, 0
 v_mov_b32 v102, 0
 v_mov_b32 v103, 0
 v_mov_b32 v104, 0
 v_mov_b32 v105, 0
 v_mov_b32 v106, 0
 v_mov_b32 v107, 0
 v_mov_b32 v108, 0
 v_mov_b32 v109, 0
 v_mov_b32 v110, 0
 v_mov_b32 v111, 0
 v_mov_b32 v112, 0
 v_mov_b32 v113, 0
 v_mov_b32 v114, 0
 v_mov_b32 v115, 0
 v_mov_b32 v116, 0
 v_mov_b32 v117, 0
 v_mov_b32 v118, 0
 v_mov_b32 v119, 0
 v_mov_b32 v120, 0
 v_mov_b32 v121, 0
 v_mov_b32 v122, 0
 v_mov_b32 v123, 0
 v_mov_b32 v124, 0
 v_mov_b32 v125, 0
 v_mov_b32 v126, 0
 v_mov_b32 v127, 0
 v_mov_b32 v128, 0
 v_mov_b32 v129, 0
 v_mov_b32 v130, 0
 v_mov_b32 v131, 0
 v_mov_b32 v132, 0
 v_mov_b32 v133, 0
 v_mov_b32 v134, 0
 v_mov_b32 v135, 0
 v_mov_b32 v136, 0
 v_mov_b32 v137, 0
 v_mov_b32 v138, 0
 v_mov_b32 v139, 0
 v_mov_b32 v140, 0
 v_mov_b32 v141, 0
 v_mov_b32 v142, 0
 v_mov_b32 v143, 0
 v_mov_b32 v232, 0
 v_mov_b32 v233, 0
 v_mov_b32 v234, 0
 v_mov_b32 v235, 0
 v_mov_b32 v236, 0
 v_mov_b32 v237, 0
 v_mov_b32 v238, 0
 v_mov_b32 v239, 0
 v_mov_b32 v240, 0
 v_mov_b32 v241, 0
 v_mov_b32 v242, 0
 v_mov_b32 v243, 0
 v_mov_b32 v244, 0
 v_mov_b32 v245, 0
 v_mov_b32 v246, 0
 v_mov_b32 v247, 0
 s_lshl_b32 s76, s43, 18
 s_mov_b32 s79, 16
L14_slow_l2:
 s_barrier
 s_add_u32 m0, s92, 67584
 s_nop 0
 buffer_load_dwordx4 v1, s[52:55], s76 offen offset:0 lds
 s_add_u32 m0, s92, 67616
 s_nop 0
 buffer_load_dwordx4 v1, s[52:55], s76 offen offset:1024 lds
 s_add_u32 m0, s92, 67648
 s_nop 0
 buffer_load_dwordx4 v1, s[52:55], s76 offen offset:2048 lds
 s_add_u32 m0, s92, 67680
 s_nop 0
 buffer_load_dwordx4 v1, s[52:55], s76 offen offset:3072 lds
 s_add_u32 m0, s92, 84480
 s_nop 0
 buffer_load_dwordx4 v1, s[56:59], s76 offen offset:0 lds
 s_add_u32 m0, s92, 84512
 s_nop 0
 buffer_load_dwordx4 v1, s[56:59], s76 offen offset:1024 lds
 s_add_u32 m0, s92, 84544
 s_nop 0
 buffer_load_dwordx4 v1, s[56:59], s76 offen offset:2048 lds
 s_add_u32 m0, s92, 84576
 s_nop 0
 buffer_load_dwordx4 v1, s[56:59], s76 offen offset:3072 lds
 s_waitcnt vmcnt(0) lgkmcnt(0)
 s_barrier
 ds_read_b128 a[80:83], v3 offset:0
 ds_read_b128 a[84:87], v3 offset:64
 ds_read_b128 a[88:91], v3 offset:128
 ds_read_b128 a[92:95], v3 offset:192
 ds_read_b128 a[96:99], v3 offset:256
 ds_read_b128 a[100:103], v3 offset:320
 ds_read_b128 a[104:107], v3 offset:384
 ds_read_b128 a[108:111], v3 offset:448
 ds_read_b128 a[112:115], v3 offset:512
 ds_read_b128 a[116:119], v3 offset:576
 ds_read_b128 a[120:123], v3 offset:640
 ds_read_b128 a[124:127], v3 offset:704
 ds_read_b128 a[128:131], v3 offset:768
 ds_read_b128 a[132:135], v3 offset:832
 ds_read_b128 a[136:139], v3 offset:896
 ds_read_b128 a[140:143], v3 offset:960
 rta 144,4,16896
 rta 146,4,17152
 rta 148,4,17408
 rta 150,4,17664
 rta 152,4,16928
 rta 154,4,17184
 rta 156,4,17440
 rta 158,4,17696
 rta 160,4,16960
 rta 162,4,17216
 rta 164,4,17472
 rta 166,4,17728
 rta 168,4,16992
 rta 170,4,17248
 rta 172,4,17504
 rta 174,4,17760
 rta 176,4,17024
 rta 178,4,17280
 rta 180,4,17536
 rta 182,4,17792
 rta 184,4,17056
 rta 186,4,17312
 rta 188,4,17568
 rta 190,4,17824
 rta 192,4,17088
 rta 194,4,17344
 rta 196,4,17600
 rta 198,4,17856
 rta 200,4,17120
 rta 202,4,17376
 rta 204,4,17632
 rta 206,4,17888
 s_waitcnt lgkmcnt(15)
 mvaac 176,80,0,208
 mvaa 176,84,4
 mvaa 176,88,8
 mvaa 176,92,12
 mvaac 180,96,0,208
 mvaa 180,100,4
 mvaa 180,104,8
 mvaa 180,108,12
 mvaac 184,112,0,208
 mvaa 184,116,4
 mvaa 184,120,8
 mvaa 184,124,12
 mvaac 188,128,0,208
 mvaa 188,132,4
 mvaa 188,136,8
 mvaa 188,140,12
 v_exp_f32 v176, v176
 v_exp_f32 v177, v177
 v_exp_f32 v178, v178
 v_exp_f32 v179, v179
 v_exp_f32 v180, v180
 v_exp_f32 v181, v181
 v_exp_f32 v182, v182
 v_exp_f32 v183, v183
 v_exp_f32 v184, v184
 v_exp_f32 v185, v185
 v_exp_f32 v186, v186
 v_exp_f32 v187, v187
 v_exp_f32 v188, v188
 v_exp_f32 v189, v189
 v_exp_f32 v190, v190
 v_exp_f32 v191, v191
 pk 192,176
 pk 193,178
 pk 194,180
 pk 195,182
 pk 196,184
 pk 197,186
 pk 198,188
 pk 199,190
 mvav 16,144,192
 s_nop 0
 mvav 16,148,196
 mvav 20,152,192
 mvav 20,156,196
 mvav 24,160,192
 mvav 24,164,196
 mvav 28,168,192
 mvav 28,172,196
 s_waitcnt lgkmcnt(0)
 mvav 32,176,192
 mvav 32,180,196
 mvav 36,184,192
 mvav 36,188,196
 mvav 40,192,192
 mvav 40,196,196
 mvav 44,200,192
 mvav 44,204,196
 mvav 232,252,192
 mvav 232,252,196
 mvaac 176,80,16,212
 mvaa 176,84,20
 mvaa 176,88,24
 mvaa 176,92,28
 mvaac 180,96,16,212
 mvaa 180,100,20
 mvaa 180,104,24
 mvaa 180,108,28
 mvaac 184,112,16,212
 mvaa 184,116,20
 mvaa 184,120,24
 mvaa 184,124,28
 mvaac 188,128,16,212
 mvaa 188,132,20
 mvaa 188,136,24
 mvaa 188,140,28
 v_exp_f32 v176, v176
 v_exp_f32 v177, v177
 v_exp_f32 v178, v178
 v_exp_f32 v179, v179
 v_exp_f32 v180, v180
 v_exp_f32 v181, v181
 v_exp_f32 v182, v182
 v_exp_f32 v183, v183
 v_exp_f32 v184, v184
 v_exp_f32 v185, v185
 v_exp_f32 v186, v186
 v_exp_f32 v187, v187
 v_exp_f32 v188, v188
 v_exp_f32 v189, v189
 v_exp_f32 v190, v190
 v_exp_f32 v191, v191
 pk 192,176
 pk 193,178
 pk 194,180
 pk 195,182
 pk 196,184
 pk 197,186
 pk 198,188
 pk 199,190
 mvav 48,144,192
 s_nop 0
 mvav 48,148,196
 mvav 52,152,192
 mvav 52,156,196
 mvav 56,160,192
 mvav 56,164,196
 mvav 60,168,192
 mvav 60,172,196
 mvav 64,176,192
 mvav 64,180,196
 mvav 68,184,192
 mvav 68,188,196
 mvav 72,192,192
 mvav 72,196,196
 mvav 76,200,192
 mvav 76,204,196
 mvav 236,252,192
 mvav 236,252,196
 mvaac 176,80,32,216
 mvaa 176,84,36
 mvaa 176,88,40
 mvaa 176,92,44
 mvaac 180,96,32,216
 mvaa 180,100,36
 mvaa 180,104,40
 mvaa 180,108,44
 mvaac 184,112,32,216
 mvaa 184,116,36
 mvaa 184,120,40
 mvaa 184,124,44
 mvaac 188,128,32,216
 mvaa 188,132,36
 mvaa 188,136,40
 mvaa 188,140,44
 v_exp_f32 v176, v176
 v_exp_f32 v177, v177
 v_exp_f32 v178, v178
 v_exp_f32 v179, v179
 v_exp_f32 v180, v180
 v_exp_f32 v181, v181
 v_exp_f32 v182, v182
 v_exp_f32 v183, v183
 v_exp_f32 v184, v184
 v_exp_f32 v185, v185
 v_exp_f32 v186, v186
 v_exp_f32 v187, v187
 v_exp_f32 v188, v188
 v_exp_f32 v189, v189
 v_exp_f32 v190, v190
 v_exp_f32 v191, v191
 pk 192,176
 pk 193,178
 pk 194,180
 pk 195,182
 pk 196,184
 pk 197,186
 pk 198,188
 pk 199,190
 mvav 80,144,192
 s_nop 0
 mvav 80,148,196
 mvav 84,152,192
 mvav 84,156,196
 mvav 88,160,192
 mvav 88,164,196
 mvav 92,168,192
 mvav 92,172,196
 mvav 96,176,192
 mvav 96,180,196
 mvav 100,184,192
 mvav 100,188,196
 mvav 104,192,192
 mvav 104,196,196
 mvav 108,200,192
 mvav 108,204,196
 mvav 240,252,192
 mvav 240,252,196
 mvaac 176,80,48,220
 mvaa 176,84,52
 mvaa 176,88,56
 mvaa 176,92,60
 mvaac 180,96,48,220
 mvaa 180,100,52
 mvaa 180,104,56
 mvaa 180,108,60
 mvaac 184,112,48,220
 mvaa 184,116,52
 mvaa 184,120,56
 mvaa 184,124,60
 mvaac 188,128,48,220
 mvaa 188,132,52
 mvaa 188,136,56
 mvaa 188,140,60
 v_exp_f32 v176, v176
 v_exp_f32 v177, v177
 v_exp_f32 v178, v178
 v_exp_f32 v179, v179
 v_exp_f32 v180, v180
 v_exp_f32 v181, v181
 v_exp_f32 v182, v182
 v_exp_f32 v183, v183
 v_exp_f32 v184, v184
 v_exp_f32 v185, v185
 v_exp_f32 v186, v186
 v_exp_f32 v187, v187
 v_exp_f32 v188, v188
 v_exp_f32 v189, v189
 v_exp_f32 v190, v190
 v_exp_f32 v191, v191
 pk 192,176
 pk 193,178
 pk 194,180
 pk 195,182
 pk 196,184
 pk 197,186
 pk 198,188
 pk 199,190
 mvav 112,144,192
 s_nop 0
 mvav 112,148,196
 mvav 116,152,192
 mvav 116,156,196
 mvav 120,160,192
 mvav 120,164,196
 mvav 124,168,192
 mvav 124,172,196
 mvav 128,176,192
 mvav 128,180,196
 mvav 132,184,192
 mvav 132,188,196
 mvav 136,192,192
 mvav 136,196,196
 mvav 140,200,192
 mvav 140,204,196
 mvav 244,252,192
 mvav 244,252,196
 s_waitcnt vmcnt(0) lgkmcnt(0)
 s_add_u32 s76, s76, 16384
 s_sub_u32 s79, s79, 1
 s_cmp_lg_u32 s79, 0
 s_cbranch_scc1 L14_slow_l2
 s_lshr_b32 s3, s87, s43
 s_and_b32 s3, s3, 1
 s_cmp_eq_u32 s3, 0
 s_cbranch_scc1 L14_slow_next
 s_nop 7
 v_rcp_f32 v6, v232
 v_rcp_f32 v7, v236
 v_rcp_f32 v8, v240
 v_rcp_f32 v9, v244
 v_pk_mul_f32 v[16:17], v[16:17], v[6:7] op_sel_hi:[1,0]
 v_pk_mul_f32 v[18:19], v[18:19], v[6:7] op_sel_hi:[1,0]
 v_pk_mul_f32 v[20:21], v[20:21], v[6:7] op_sel_hi:[1,0]
 v_pk_mul_f32 v[22:23], v[22:23], v[6:7] op_sel_hi:[1,0]
 pk 16,16
 pk 17,18
 pk 18,20
 pk 19,22
 s_add_u32 s86, s90, 0
 buffer_store_dwordx4 v[16:19], v2, s[60:63], s86 offen offset:0 sc1
 v_pk_mul_f32 v[24:25], v[24:25], v[6:7] op_sel_hi:[1,0]
 v_pk_mul_f32 v[26:27], v[26:27], v[6:7] op_sel_hi:[1,0]
 v_pk_mul_f32 v[28:29], v[28:29], v[6:7] op_sel_hi:[1,0]
 v_pk_mul_f32 v[30:31], v[30:31], v[6:7] op_sel_hi:[1,0]
 pk 24,24
 pk 25,26
 pk 26,28
 pk 27,30
 s_add_u32 s86, s90, 4096
 buffer_store_dwordx4 v[24:27], v2, s[60:63], s86 offen offset:1024 sc1
 v_pk_mul_f32 v[32:33], v[32:33], v[6:7] op_sel_hi:[1,0]
 v_pk_mul_f32 v[34:35], v[34:35], v[6:7] op_sel_hi:[1,0]
 v_pk_mul_f32 v[36:37], v[36:37], v[6:7] op_sel_hi:[1,0]
 v_pk_mul_f32 v[38:39], v[38:39], v[6:7] op_sel_hi:[1,0]
 pk 32,32
 pk 33,34
 pk 34,36
 pk 35,38
 s_add_u32 s86, s90, 8192
 buffer_store_dwordx4 v[32:35], v2, s[60:63], s86 offen offset:2048 sc1
 v_pk_mul_f32 v[40:41], v[40:41], v[6:7] op_sel_hi:[1,0]
 v_pk_mul_f32 v[42:43], v[42:43], v[6:7] op_sel_hi:[1,0]
 v_pk_mul_f32 v[44:45], v[44:45], v[6:7] op_sel_hi:[1,0]
 v_pk_mul_f32 v[46:47], v[46:47], v[6:7] op_sel_hi:[1,0]
 pk 40,40
 pk 41,42
 pk 42,44
 pk 43,46
 s_add_u32 s86, s90, 12288
 buffer_store_dwordx4 v[40:43], v2, s[60:63], s86 offen offset:3072 sc1
 v_pk_mul_f32 v[48:49], v[48:49], v[6:7] op_sel:[0,1]
 v_pk_mul_f32 v[50:51], v[50:51], v[6:7] op_sel:[0,1]
 v_pk_mul_f32 v[52:53], v[52:53], v[6:7] op_sel:[0,1]
 v_pk_mul_f32 v[54:55], v[54:55], v[6:7] op_sel:[0,1]
 pk 48,48
 pk 49,50
 pk 50,52
 pk 51,54
 s_add_u32 s86, s90, 0
 buffer_store_dwordx4 v[48:51], v2, s[60:63], s86 offen offset:1024 sc1
 v_pk_mul_f32 v[56:57], v[56:57], v[6:7] op_sel:[0,1]
 v_pk_mul_f32 v[58:59], v[58:59], v[6:7] op_sel:[0,1]
 v_pk_mul_f32 v[60:61], v[60:61], v[6:7] op_sel:[0,1]
 v_pk_mul_f32 v[62:63], v[62:63], v[6:7] op_sel:[0,1]
 pk 56,56
 pk 57,58
 pk 58,60
 pk 59,62
 s_add_u32 s86, s90, 4096
 buffer_store_dwordx4 v[56:59], v2, s[60:63], s86 offen offset:2048 sc1
 v_pk_mul_f32 v[64:65], v[64:65], v[6:7] op_sel:[0,1]
 v_pk_mul_f32 v[66:67], v[66:67], v[6:7] op_sel:[0,1]
 v_pk_mul_f32 v[68:69], v[68:69], v[6:7] op_sel:[0,1]
 v_pk_mul_f32 v[70:71], v[70:71], v[6:7] op_sel:[0,1]
 pk 64,64
 pk 65,66
 pk 66,68
 pk 67,70
 s_add_u32 s86, s90, 8192
 buffer_store_dwordx4 v[64:67], v2, s[60:63], s86 offen offset:3072 sc1
 v_pk_mul_f32 v[72:73], v[72:73], v[6:7] op_sel:[0,1]
 v_pk_mul_f32 v[74:75], v[74:75], v[6:7] op_sel:[0,1]
 v_pk_mul_f32 v[76:77], v[76:77], v[6:7] op_sel:[0,1]
 v_pk_mul_f32 v[78:79], v[78:79], v[6:7] op_sel:[0,1]
 pk 72,72
 pk 73,74
 pk 74,76
 pk 75,78
 s_add_u32 s86, s90, 16384
 buffer_store_dwordx4 v[72:75], v2, s[60:63], s86 offen offset:0 sc1
 v_pk_mul_f32 v[80:81], v[80:81], v[8:9] op_sel_hi:[1,0]
 v_pk_mul_f32 v[82:83], v[82:83], v[8:9] op_sel_hi:[1,0]
 v_pk_mul_f32 v[84:85], v[84:85], v[8:9] op_sel_hi:[1,0]
 v_pk_mul_f32 v[86:87], v[86:87], v[8:9] op_sel_hi:[1,0]
 pk 80,80
 pk 81,82
 pk 82,84
 pk 83,86
 s_add_u32 s86, s90, 0
 buffer_store_dwordx4 v[80:83], v2, s[60:63], s86 offen offset:2048 sc1
 v_pk_mul_f32 v[88:89], v[88:89], v[8:9] op_sel_hi:[1,0]
 v_pk_mul_f32 v[90:91], v[90:91], v[8:9] op_sel_hi:[1,0]
 v_pk_mul_f32 v[92:93], v[92:93], v[8:9] op_sel_hi:[1,0]
 v_pk_mul_f32 v[94:95], v[94:95], v[8:9] op_sel_hi:[1,0]
 pk 88,88
 pk 89,90
 pk 90,92
 pk 91,94
 s_add_u32 s86, s90, 4096
 buffer_store_dwordx4 v[88:91], v2, s[60:63], s86 offen offset:3072 sc1
 v_pk_mul_f32 v[96:97], v[96:97], v[8:9] op_sel_hi:[1,0]
 v_pk_mul_f32 v[98:99], v[98:99], v[8:9] op_sel_hi:[1,0]
 v_pk_mul_f32 v[100:101], v[100:101], v[8:9] op_sel_hi:[1,0]
 v_pk_mul_f32 v[102:103], v[102:103], v[8:9] op_sel_hi:[1,0]
 pk 96,96
 pk 97,98
 pk 98,100
 pk 99,102
 s_add_u32 s86, s90, 12288
 buffer_store_dwordx4 v[96:99], v2, s[60:63], s86 offen offset:0 sc1
 v_pk_mul_f32 v[104:105], v[104:105], v[8:9] op_sel_hi:[1,0]
 v_pk_mul_f32 v[106:107], v[106:107], v[8:9] op_sel_hi:[1,0]
 v_pk_mul_f32 v[108:109], v[108:109], v[8:9] op_sel_hi:[1,0]
 v_pk_mul_f32 v[110:111], v[110:111], v[8:9] op_sel_hi:[1,0]
 pk 104,104
 pk 105,106
 pk 106,108
 pk 107,110
 s_add_u32 s86, s90, 16384
 buffer_store_dwordx4 v[104:107], v2, s[60:63], s86 offen offset:1024 sc1
 v_pk_mul_f32 v[112:113], v[112:113], v[8:9] op_sel:[0,1]
 v_pk_mul_f32 v[114:115], v[114:115], v[8:9] op_sel:[0,1]
 v_pk_mul_f32 v[116:117], v[116:117], v[8:9] op_sel:[0,1]
 v_pk_mul_f32 v[118:119], v[118:119], v[8:9] op_sel:[0,1]
 pk 112,112
 pk 113,114
 pk 114,116
 pk 115,118
 s_add_u32 s86, s90, 0
 buffer_store_dwordx4 v[112:115], v2, s[60:63], s86 offen offset:3072 sc1
 v_pk_mul_f32 v[120:121], v[120:121], v[8:9] op_sel:[0,1]
 v_pk_mul_f32 v[122:123], v[122:123], v[8:9] op_sel:[0,1]
 v_pk_mul_f32 v[124:125], v[124:125], v[8:9] op_sel:[0,1]
 v_pk_mul_f32 v[126:127], v[126:127], v[8:9] op_sel:[0,1]
 pk 120,120
 pk 121,122
 pk 122,124
 pk 123,126
 s_add_u32 s86, s90, 8192
 buffer_store_dwordx4 v[120:123], v2, s[60:63], s86 offen offset:0 sc1
 v_pk_mul_f32 v[128:129], v[128:129], v[8:9] op_sel:[0,1]
 v_pk_mul_f32 v[130:131], v[130:131], v[8:9] op_sel:[0,1]
 v_pk_mul_f32 v[132:133], v[132:133], v[8:9] op_sel:[0,1]
 v_pk_mul_f32 v[134:135], v[134:135], v[8:9] op_sel:[0,1]
 pk 128,128
 pk 129,130
 pk 130,132
 pk 131,134
 s_add_u32 s86, s90, 12288
 buffer_store_dwordx4 v[128:131], v2, s[60:63], s86 offen offset:1024 sc1
 v_pk_mul_f32 v[136:137], v[136:137], v[8:9] op_sel:[0,1]
 v_pk_mul_f32 v[138:139], v[138:139], v[8:9] op_sel:[0,1]
 v_pk_mul_f32 v[140:141], v[140:141], v[8:9] op_sel:[0,1]
 v_pk_mul_f32 v[142:143], v[142:143], v[8:9] op_sel:[0,1]
 pk 136,136
 pk 137,138
 pk 138,140
 pk 139,142
 s_add_u32 s86, s90, 16384
 buffer_store_dwordx4 v[136:139], v2, s[60:63], s86 offen offset:2048 sc1
L14_slow_next:
 s_waitcnt vmcnt(0) lgkmcnt(0)
 s_nop 7
 s_add_u32 s43, s43, 1
 s_cmp_lt_u32 s43, 2
 s_cbranch_scc1 L14_slow_head
 s_barrier
 s_add_u32 m0, s92, 67584
 s_xor_b32 s83, s9, 0
 s_mul_i32 s83, s83, 131072
 buffer_load_dwordx4 v11, s[68:71], s83 offen offset:0 lds
 s_add_u32 m0, s92, 67616
 s_nop 0
 buffer_load_dwordx4 v11, s[68:71], s83 offen offset:1024 lds
 s_add_u32 m0, s92, 67648
 s_nop 0
 buffer_load_dwordx4 v11, s[68:71], s83 offen offset:2048 lds
 s_add_u32 m0, s92, 67680
 s_nop 0
 buffer_load_dwordx4 v11, s[68:71], s83 offen offset:3072 lds
 s_add_u32 m0, s92, 84480
 s_add_u32 s83, s83, 65536
 buffer_load_dwordx4 v11, s[68:71], s83 offen offset:0 lds
 s_add_u32 m0, s92, 84512
 s_nop 0
 buffer_load_dwordx4 v11, s[68:71], s83 offen offset:1024 lds
 s_add_u32 m0, s92, 84544
 s_nop 0
 buffer_load_dwordx4 v11, s[68:71], s83 offen offset:2048 lds
 s_add_u32 m0, s92, 84576
 s_nop 0
 buffer_load_dwordx4 v11, s[68:71], s83 offen offset:3072 lds
 s_add_u32 m0, s92, 101376
 s_xor_b32 s83, s9, 1
 s_mul_i32 s83, s83, 131072
 buffer_load_dwordx4 v11, s[68:71], s83 offen offset:0 lds
 s_add_u32 m0, s92, 101408
 s_nop 0
 buffer_load_dwordx4 v11, s[68:71], s83 offen offset:1024 lds
 s_add_u32 m0, s92, 101440
 s_nop 0
 buffer_load_dwordx4 v11, s[68:71], s83 offen offset:2048 lds
 s_add_u32 m0, s92, 101472
 s_nop 0
 buffer_load_dwordx4 v11, s[68:71], s83 offen offset:3072 lds
 s_add_u32 m0, s92, 118272
 s_add_u32 s83, s83, 65536
 buffer_load_dwordx4 v11, s[68:71], s83 offen offset:0 lds
 s_add_u32 m0, s92, 118304
 s_nop 0
 buffer_load_dwordx4 v11, s[68:71], s83 offen offset:1024 lds
 s_add_u32 m0, s92, 118336
 s_nop 0
 buffer_load_dwordx4 v11, s[68:71], s83 offen offset:2048 lds
 s_add_u32 m0, s92, 118368
 s_nop 0
 buffer_load_dwordx4 v11, s[68:71], s83 offen offset:3072 lds
 s_add_u32 m0, s92, 0
 s_xor_b32 s83, s9, 2
 s_mul_i32 s83, s83, 131072
 buffer_load_dwordx4 v11, s[68:71], s83 offen offset:0 lds
 s_add_u32 m0, s92, 32
 s_nop 0
 buffer_load_dwordx4 v11, s[68:71], s83 offen offset:1024 lds
 s_add_u32 m0, s92, 64
 s_nop 0
 buffer_load_dwordx4 v11, s[68:71], s83 offen offset:2048 lds
 s_add_u32 m0, s92, 96
 s_nop 0
 buffer_load_dwordx4 v11, s[68:71], s83 offen offset:3072 lds
 s_add_u32 m0, s92, 16896
 s_add_u32 s83, s83, 65536
 buffer_load_dwordx4 v11, s[68:71], s83 offen offset:0 lds
 s_add_u32 m0, s92, 16928
 s_nop 0
 buffer_load_dwordx4 v11, s[68:71], s83 offen offset:1024 lds
 s_add_u32 m0, s92, 16960
 s_nop 0
 buffer_load_dwordx4 v11, s[68:71], s83 offen offset:2048 lds
 s_add_u32 m0, s92, 16992
 s_nop 0
 buffer_load_dwordx4 v11, s[68:71], s83 offen offset:3072 lds
 s_add_u32 m0, s92, 33792
 s_xor_b32 s83, s9, 4
 s_mul_i32 s83, s83, 131072
 buffer_load_dwordx4 v11, s[68:71], s83 offen offset:0 lds
 s_add_u32 m0, s92, 33824
 s_nop 0
 buffer_load_dwordx4 v11, s[68:71], s83 offen offset:1024 lds
 s_add_u32 m0, s92, 33856
 s_nop 0
 buffer_load_dwordx4 v11, s[68:71], s83 offen offset:2048 lds
 s_add_u32 m0, s92, 33888
 s_nop 0
 buffer_load_dwordx4 v11, s[68:71], s83 offen offset:3072 lds
 s_add_u32 m0, s92, 50688
 s_add_u32 s83, s83, 65536
 buffer_load_dwordx4 v11, s[68:71], s83 offen offset:0 lds
 s_add_u32 m0, s92, 50720
 s_nop 0
 buffer_load_dwordx4 v11, s[68:71], s83 offen offset:1024 lds
 s_add_u32 m0, s92, 50752
 s_nop 0
 buffer_load_dwordx4 v11, s[68:71], s83 offen offset:2048 lds
 s_add_u32 m0, s92, 50784
 s_nop 0
 buffer_load_dwordx4 v11, s[68:71], s83 offen offset:3072 lds
 s_mov_b32 s86, 0
 buffer_load_dwordx4 a[160:163], v2, s[60:63], s86 offen offset:0 sc1
 s_mov_b32 s86, 20480
 buffer_load_dwordx4 v[176:179], v2, s[60:63], s86 offen offset:0 sc1
 s_waitcnt vmcnt(0)
 v_lshlrev_b32 v16, 16, v176
 v_and_b32 v17, 0xffff0000, v176
 v_lshlrev_b32 v18, 16, v177
 v_and_b32 v19, 0xffff0000, v177
 v_lshlrev_b32 v20, 16, v178
 v_and_b32 v21, 0xffff0000, v178
 v_lshlrev_b32 v22, 16, v179
 v_and_b32 v23, 0xffff0000, v179
 s_mov_b32 s86, 0
 buffer_load_dwordx4 a[164:167], v2, s[60:63], s86 offen offset:1024 sc1
 s_mov_b32 s86, 20480
 buffer_load_dwordx4 v[176:179], v2, s[60:63], s86 offen offset:1024 sc1
 s_waitcnt vmcnt(0)
 v_lshlrev_b32 v48, 16, v176
 v_and_b32 v49, 0xffff0000, v176
 v_lshlrev_b32 v50, 16, v177
 v_and_b32 v51, 0xffff0000, v177
 v_lshlrev_b32 v52, 16, v178
 v_and_b32 v53, 0xffff0000, v178
 v_lshlrev_b32 v54, 16, v179
 v_and_b32 v55, 0xffff0000, v179
 s_mov_b32 s86, 0
 buffer_load_dwordx4 v[240:243], v2, s[60:63], s86 offen offset:2048 sc1
 s_mov_b32 s86, 20480
 buffer_load_dwordx4 v[176:179], v2, s[60:63], s86 offen offset:2048 sc1
 s_waitcnt vmcnt(0)
 v_lshlrev_b32 v80, 16, v176
 v_and_b32 v81, 0xffff0000, v176
 v_lshlrev_b32 v82, 16, v177
 v_and_b32 v83, 0xffff0000, v177
 v_lshlrev_b32 v84, 16, v178
 v_and_b32 v85, 0xffff0000, v178
 v_lshlrev_b32 v86, 16, v179
 v_and_b32 v87, 0xffff0000, v179
 s_mov_b32 s86, 0
 buffer_load_dwordx4 v[244:247], v2, s[60:63], s86 offen offset:3072 sc1
 s_mov_b32 s86, 20480
 buffer_load_dwordx4 v[176:179], v2, s[60:63], s86 offen offset:3072 sc1
 s_waitcnt vmcnt(0)
 v_lshlrev_b32 v112, 16, v176
 v_and_b32 v113, 0xffff0000, v176
 v_lshlrev_b32 v114, 16, v177
 v_and_b32 v115, 0xffff0000, v177
 v_lshlrev_b32 v116, 16, v178
 v_and_b32 v117, 0xffff0000, v178
 v_lshlrev_b32 v118, 16, v179
 v_and_b32 v119, 0xffff0000, v179
 s_mov_b32 s86, 4096
 buffer_load_dwordx4 v[248:251], v2, s[60:63], s86 offen offset:1024 sc1
 s_mov_b32 s86, 24576
 buffer_load_dwordx4 v[176:179], v2, s[60:63], s86 offen offset:1024 sc1
 s_waitcnt vmcnt(0)
 v_lshlrev_b32 v24, 16, v176
 v_and_b32 v25, 0xffff0000, v176
 v_lshlrev_b32 v26, 16, v177
 v_and_b32 v27, 0xffff0000, v177
 v_lshlrev_b32 v28, 16, v178
 v_and_b32 v29, 0xffff0000, v178
 v_lshlrev_b32 v30, 16, v179
 v_and_b32 v31, 0xffff0000, v179
 s_mov_b32 s86, 4096
 buffer_load_dwordx4 v[252:255], v2, s[60:63], s86 offen offset:2048 sc1
 s_mov_b32 s86, 24576
 buffer_load_dwordx4 v[176:179], v2, s[60:63], s86 offen offset:2048 sc1
 s_waitcnt vmcnt(0)
 v_lshlrev_b32 v56, 16, v176
 v_and_b32 v57, 0xffff0000, v176
 v_lshlrev_b32 v58, 16, v177
 v_and_b32 v59, 0xffff0000, v177
 v_lshlrev_b32 v60, 16, v178
 v_and_b32 v61, 0xffff0000, v178
 v_lshlrev_b32 v62, 16, v179
 v_and_b32 v63, 0xffff0000, v179
 s_mov_b32 s86, 4096
 buffer_load_dwordx4 v[228:231], v2, s[60:63], s86 offen offset:3072 sc1
 s_mov_b32 s86, 24576
 buffer_load_dwordx4 v[176:179], v2, s[60:63], s86 offen offset:3072 sc1
 s_waitcnt vmcnt(0)
 v_lshlrev_b32 v88, 16, v176
 v_and_b32 v89, 0xffff0000, v176
 v_lshlrev_b32 v90, 16, v177
 v_and_b32 v91, 0xffff0000, v177
 v_lshlrev_b32 v92, 16, v178
 v_and_b32 v93, 0xffff0000, v178
 v_lshlrev_b32 v94, 16, v179
 v_and_b32 v95, 0xffff0000, v179
 s_mov_b32 s86, 8192
 buffer_load_dwordx4 v[232:235], v2, s[60:63], s86 offen offset:0 sc1
 s_mov_b32 s86, 28672
 buffer_load_dwordx4 v[176:179], v2, s[60:63], s86 offen offset:0 sc1
 s_waitcnt vmcnt(0)
 v_lshlrev_b32 v120, 16, v176
 v_and_b32 v121, 0xffff0000, v176
 v_lshlrev_b32 v122, 16, v177
 v_and_b32 v123, 0xffff0000, v177
 v_lshlrev_b32 v124, 16, v178
 v_and_b32 v125, 0xffff0000, v178
 v_lshlrev_b32 v126, 16, v179
 v_and_b32 v127, 0xffff0000, v179
 s_mov_b32 s86, 8192
 buffer_load_dwordx4 v[236:239], v2, s[60:63], s86 offen offset:2048 sc1
 s_mov_b32 s86, 28672
 buffer_load_dwordx4 v[176:179], v2, s[60:63], s86 offen offset:2048 sc1
 s_waitcnt vmcnt(0)
 v_lshlrev_b32 v32, 16, v176
 v_and_b32 v33, 0xffff0000, v176
 v_lshlrev_b32 v34, 16, v177
 v_and_b32 v35, 0xffff0000, v177
 v_lshlrev_b32 v36, 16, v178
 v_and_b32 v37, 0xffff0000, v178
 v_lshlrev_b32 v38, 16, v179
 v_and_b32 v39, 0xffff0000, v179
 s_mov_b32 s86, 8192
 buffer_load_dwordx4 a[228:231], v2, s[60:63], s86 offen offset:3072 sc1
 s_mov_b32 s86, 28672
 buffer_load_dwordx4 v[176:179], v2, s[60:63], s86 offen offset:3072 sc1
 s_waitcnt vmcnt(0)
 v_lshlrev_b32 v64, 16, v176
 v_and_b32 v65, 0xffff0000, v176
 v_lshlrev_b32 v66, 16, v177
 v_and_b32 v67, 0xffff0000, v177
 v_lshlrev_b32 v68, 16, v178
 v_and_b32 v69, 0xffff0000, v178
 v_lshlrev_b32 v70, 16, v179
 v_and_b32 v71, 0xffff0000, v179
 s_mov_b32 s86, 12288
 buffer_load_dwordx4 a[232:235], v2, s[60:63], s86 offen offset:0 sc1
 s_mov_b32 s86, 32768
 buffer_load_dwordx4 v[176:179], v2, s[60:63], s86 offen offset:0 sc1
 s_waitcnt vmcnt(0)
 v_lshlrev_b32 v96, 16, v176
 v_and_b32 v97, 0xffff0000, v176
 v_lshlrev_b32 v98, 16, v177
 v_and_b32 v99, 0xffff0000, v177
 v_lshlrev_b32 v100, 16, v178
 v_and_b32 v101, 0xffff0000, v178
 v_lshlrev_b32 v102, 16, v179
 v_and_b32 v103, 0xffff0000, v179
 s_mov_b32 s86, 12288
 buffer_load_dwordx4 a[236:239], v2, s[60:63], s86 offen offset:1024 sc1
 s_mov_b32 s86, 32768
 buffer_load_dwordx4 v[176:179], v2, s[60:63], s86 offen offset:1024 sc1
 s_waitcnt vmcnt(0)
 v_lshlrev_b32 v128, 16, v176
 v_and_b32 v129, 0xffff0000, v176
 v_lshlrev_b32 v130, 16, v177
 v_and_b32 v131, 0xffff0000, v177
 v_lshlrev_b32 v132, 16, v178
 v_and_b32 v133, 0xffff0000, v178
 v_lshlrev_b32 v134, 16, v179
 v_and_b32 v135, 0xffff0000, v179
 s_mov_b32 s86, 12288
 buffer_load_dwordx4 a[240:243], v2, s[60:63], s86 offen offset:3072 sc1
 s_mov_b32 s86, 32768
 buffer_load_dwordx4 v[176:179], v2, s[60:63], s86 offen offset:3072 sc1
 s_waitcnt vmcnt(0)
 v_lshlrev_b32 v40, 16, v176
 v_and_b32 v41, 0xffff0000, v176
 v_lshlrev_b32 v42, 16, v177
 v_and_b32 v43, 0xffff0000, v177
 v_lshlrev_b32 v44, 16, v178
 v_and_b32 v45, 0xffff0000, v178
 v_lshlrev_b32 v46, 16, v179
 v_and_b32 v47, 0xffff0000, v179
 s_mov_b32 s86, 16384
 buffer_load_dwordx4 a[244:247], v2, s[60:63], s86 offen offset:0 sc1
 s_mov_b32 s86, 36864
 buffer_load_dwordx4 v[176:179], v2, s[60:63], s86 offen offset:0 sc1
 s_waitcnt vmcnt(0)
 v_lshlrev_b32 v72, 16, v176
 v_and_b32 v73, 0xffff0000, v176
 v_lshlrev_b32 v74, 16, v177
 v_and_b32 v75, 0xffff0000, v177
 v_lshlrev_b32 v76, 16, v178
 v_and_b32 v77, 0xffff0000, v178
 v_lshlrev_b32 v78, 16, v179
 v_and_b32 v79, 0xffff0000, v179
 s_mov_b32 s86, 16384
 buffer_load_dwordx4 a[248:251], v2, s[60:63], s86 offen offset:1024 sc1
 s_mov_b32 s86, 36864
 buffer_load_dwordx4 v[176:179], v2, s[60:63], s86 offen offset:1024 sc1
 s_waitcnt vmcnt(0)
 v_lshlrev_b32 v104, 16, v176
 v_and_b32 v105, 0xffff0000, v176
 v_lshlrev_b32 v106, 16, v177
 v_and_b32 v107, 0xffff0000, v177
 v_lshlrev_b32 v108, 16, v178
 v_and_b32 v109, 0xffff0000, v178
 v_lshlrev_b32 v110, 16, v179
 v_and_b32 v111, 0xffff0000, v179
 s_mov_b32 s86, 16384
 buffer_load_dwordx4 a[252:255], v2, s[60:63], s86 offen offset:2048 sc1
 s_mov_b32 s86, 36864
 buffer_load_dwordx4 v[176:179], v2, s[60:63], s86 offen offset:2048 sc1
 s_waitcnt vmcnt(0)
 v_lshlrev_b32 v136, 16, v176
 v_and_b32 v137, 0xffff0000, v176
 v_lshlrev_b32 v138, 16, v177
 v_and_b32 v139, 0xffff0000, v177
 v_lshlrev_b32 v140, 16, v178
 v_and_b32 v141, 0xffff0000, v178
 v_lshlrev_b32 v142, 16, v179
 v_and_b32 v143, 0xffff0000, v179
 v_mov_b32 v6, 1.0
 v_mov_b32 v7, 1.0
 v_mov_b32 v8, 1.0
 v_mov_b32 v9, 1.0
 v_mov_b32 v14, 1
 s_lshl_b32 s3, s9, 6
 s_mov_b64 exec, 7
 buffer_store_dword v14, v0, s[44:47], s3 offen sc1
 s_mov_b64 exec, -1
 s_mov_b32 s87, 0
 s_mov_b32 s79, 0x40000
L14_sp1b:
 s_sub_u32 s79, s79, 1
 s_cbranch_scc1 L14_sp1b_end
 s_sleep 4
 buffer_load_dword v13, off, s[28:31], s85 sc1
 s_waitcnt vmcnt(0)
 v_cmp_ne_u32 vcc, 65535, v13
 s_nop 1
 s_and_b64 vcc, vcc, 1
 s_cbranch_scc1 L14_sp1b
L14_sp1b_end:
 s_waitcnt vmcnt(0) lgkmcnt(0)
 s_barrier
 s_branch L14_op
.section .rodata,"a"
.p2align 6
.amdhsa_kernel concat_heads__mha_block_cached__gqa_block_cached__near_ridge_kernel
  .amdhsa_next_free_vgpr 512
  .amdhsa_next_free_sgpr 102
  .amdhsa_accum_offset 256
  .amdhsa_group_segment_fixed_size 0
  .amdhsa_kernarg_size 104
  .amdhsa_user_sgpr_count 2
  .amdhsa_user_sgpr_kernarg_segment_ptr 1
  .amdhsa_system_sgpr_workgroup_id_x 1
.end_amdhsa_kernel
```
